```python
import torch

def _softmax(x, axis=-1):
    return torch.softmax(x, dim=axis)
def _gelu(x):
    return torch.nn.functional.gelu(x, approximate="tanh")
def _silu(x):
    return torch.nn.functional.silu(x)
def _sigmoid(x):
    return torch.sigmoid(x)
def _layernorm(x, axis=-1, eps=1e-5):
    m = x.mean(dim=axis, keepdim=True)
    v = x.var(dim=axis, keepdim=True, unbiased=False)
    return (x - m) / torch.sqrt(v + eps)
def _scatter_add(tgt, idx, src, axis=0):
    return tgt.clone().index_add_(axis, idx, src)
def _segment_sum(src, seg, n):
    out = torch.zeros((n,) + src.shape[1:], dtype=src.dtype)
    return out.index_add_(0, seg, src)
def _pad(x, pw):
    flat = tuple(v for pair in reversed(pw) for v in pair)
    return torch.nn.functional.pad(x, flat)

kernel_name = 'interleave_layers__mha_block_cached__glu_gated_reglu__decode'

def setup_inputs():

    _w = (lambda a: (lambda t: t.to(torch.bfloat16) if t.is_floating_point() else t)(torch.as_tensor(a)))
    def _A_setup():
        B, Sq, D = 2, 1, 640
        H, Sk, Dh = 32, 4096, 192
        return {
            "x": _w((lambda *s: torch.randn(*s, dtype=torch.bfloat16) * 0.05)(B, Sq, D)),
            "k_cache": _w((lambda *s: torch.randn(*s, dtype=torch.bfloat16) * 0.8)(B, H, Sk, Dh)),
            "v_cache": _w((lambda *s: torch.randn(*s, dtype=torch.bfloat16) * 0.8)(B, H, Sk, Dh)),
            "wq": _w((lambda *s: torch.randn(*s, dtype=torch.bfloat16) * 0.8)(D, H * Dh) * (D ** -0.5)),
            "wo": _w((lambda *s: torch.randn(*s, dtype=torch.bfloat16) * 0.8)(H * Dh, D) * ((H * Dh) ** -0.5)),
        }
    _A_in = _A_setup()

    def _B_setup():
        B, S, D, F = 2, 1, 640, 1536
        return {
            "x": _w((lambda *s: torch.randn(*s, dtype=torch.bfloat16) * 0.05)(B, S, D)),
            "W_gate": _w((lambda *s: torch.randn(*s, dtype=torch.bfloat16) * 0.2)(D, F) * (2.0 / D) ** 0.5),
            "W_up": _w((lambda *s: torch.randn(*s, dtype=torch.bfloat16) * 0.2)(D, F) * (2.0 / D) ** 0.5),
            "W_down": _w((lambda *s: torch.randn(*s, dtype=torch.bfloat16) * 0.2)(F, D) * (1.0 / F) ** 0.5),
        }
    _B_in = _B_setup()

    return {
        "A_x": _A_in["x"],
        "A_k_cache": _A_in["k_cache"],
        "A_v_cache": _A_in["v_cache"],
        "A_wq": _A_in["wq"],
        "A_wo": _A_in["wo"],
        "B_x": _B_in["x"],
        "B_W_gate": _B_in["W_gate"],
        "B_W_up": _B_in["W_up"],
        "B_W_down": _B_in["W_down"],
    }

def reference(A_x, A_k_cache, A_v_cache, A_wq, A_wo, B_x, B_W_gate, B_W_up, B_W_down):
    def _A_ref(x, k_cache, v_cache, wq, wo):
        B, Sq, D = x.shape
        H, Dh = 32, 192
        q = (lambda x, *d: x.permute(*d))((x @ wq).reshape(B, Sq, H, Dh), 0, 2, 1, 3)
        scores = torch.einsum("bhqd,bhkd->bhqk", q, k_cache) * (Dh ** -0.5)
        p = _softmax(scores, axis=-1)
        o = torch.einsum("bhqk,bhkd->bhqd", p, v_cache)
        return (lambda x, *d: x.permute(*d))(o, 0, 2, 1, 3).reshape(B, Sq, H * Dh) @ wo

    def _B_ref(x, W_gate, W_up, W_down):
        gate = torch.einsum("bsd,df->bsf", x, W_gate)
        up = torch.einsum("bsd,df->bsf", x, W_up)
        gate = gate * (lambda x, dt: x.to(dt))(gate > 0, gate.dtype)
        h = gate * up
        return torch.einsum("bsf,fd->bsd", h, W_down)

    x = A_x
    x = x + _A_ref(_layernorm(x, axis=-1), A_k_cache, A_v_cache, A_wq, A_wo)
    x = x + _B_ref(_layernorm(x, axis=-1), B_W_gate, B_W_up, B_W_down)
    x = x + _A_ref(_layernorm(x, axis=-1), A_k_cache, A_v_cache, A_wq, A_wo)
    x = x + _B_ref(_layernorm(x, axis=-1), B_W_gate, B_W_up, B_W_down)
    return x
```

```asm
; @launch grid=(256,1,1) block=(256,1,1) lds=163840
.amdgcn_target "amdgcn-amd-amdhsa--gfx950"
.text
.globl interleave_layers__mha_block_cached__glu_gated_reglu__decode_kernel
.p2align 8
.type interleave_layers__mha_block_cached__glu_gated_reglu__decode_kernel,@function
interleave_layers__mha_block_cached__glu_gated_reglu__decode_kernel:
  s_cmp_ge_u32 s2, 256
  s_cbranch_scc1 L_done
  s_load_dwordx16 s[4:19], s[0:1], 0
  s_load_dwordx8 s[20:27], s[0:1], 64
  v_lshrrev_b32 v1, 6, v0
  s_and_b32 s28, s2, 7
  s_lshr_b32 s29, s2, 6
  v_readfirstlane_b32 s3, v1
  s_lshr_b32 s30, s2, 3
  s_and_b32 s30, s30, 7
  s_lshl_b32 s31, s28, 2
  s_add_u32 s31, s31, s29
  s_mul_i32 s40, s31, 1572864
  s_mul_i32 s66, s30, 196608
  s_add_u32 s40, s40, s66
  s_add_u32 s66, s3, 3
  s_and_b32 s66, s66, 3
  s_mul_i32 s67, s66, 61440
  s_add_u32 s40, s40, s67
  v_mbcnt_lo_u32_b32 v8, -1, 0
  v_mbcnt_hi_u32_b32 v8, -1, v8
  v_mov_b32 v14, 0
  v_mov_b32 v15, 163792
  v_lshl_add_u32 v15, v8, 2, v15
  s_mov_b32 exec_lo, 0xff
  s_mov_b32 exec_hi, 0
  ds_write_b32 v15, v14
  s_mov_b64 exec, -1
  v_and_b32 v10, 15, v8
  v_lshrrev_b32 v11, 4, v8
  v_and_b32 v12, 7, v10
  v_lshrrev_b32 v13, 3, v10
  v_mul_u32_u24 v1, 384, v12
  v_lshl_add_u32 v1, v11, 4, v1
  v_lshl_add_u32 v1, v13, 6, v1
  v_mul_u32_u24 v2, 768, v11
  v_mul_u32_u24 v13, 384, v13
  v_add_u32 v3, v2, v13
  v_lshl_add_u32 v3, v12, 4, v3
  v_add_u32 v3, 256, v3
  v_lshl_add_u32 v2, v10, 4, v2
  s_waitcnt lgkmcnt(0)
  s_barrier
  s_mov_b32 s32, s6
  s_and_b32 s33, s7, 0xffff
  s_mov_b32 s34, 100663296
  s_mov_b32 s35, 0x20000
  s_cmp_eq_u32 s3, 0
  s_cbranch_scc1 L_chain
  s_add_u32 s42, s40, 0
  buffer_load_dwordx4 a[0:3], v1, s[32:35], s42 offen offset:0 nt
  buffer_load_dwordx4 a[4:7], v1, s[32:35], s42 offen offset:128 nt
  buffer_load_dwordx4 a[8:11], v1, s[32:35], s42 offen offset:256 nt
  s_add_u32 s42, s40, 3072
  buffer_load_dwordx4 a[12:15], v1, s[32:35], s42 offen offset:0 nt
  buffer_load_dwordx4 a[16:19], v1, s[32:35], s42 offen offset:128 nt
  buffer_load_dwordx4 a[20:23], v1, s[32:35], s42 offen offset:256 nt
  s_add_u32 s42, s40, 6144
  buffer_load_dwordx4 a[24:27], v1, s[32:35], s42 offen offset:0 nt
  buffer_load_dwordx4 a[28:31], v1, s[32:35], s42 offen offset:128 nt
  buffer_load_dwordx4 a[32:35], v1, s[32:35], s42 offen offset:256 nt
  s_add_u32 s42, s40, 9216
  buffer_load_dwordx4 a[36:39], v1, s[32:35], s42 offen offset:0 nt
  buffer_load_dwordx4 a[40:43], v1, s[32:35], s42 offen offset:128 nt
  buffer_load_dwordx4 a[44:47], v1, s[32:35], s42 offen offset:256 nt
  s_mov_b32 s36, s8
  s_and_b32 s37, s9, 0xffff
  s_mov_b32 s38, 100663296
  s_mov_b32 s39, 0x20000
  s_mov_b32 s48, s26
  s_and_b32 s49, s27, 0xffff
  s_mov_b32 s50, 6291456
  s_mov_b32 s51, 0x20000
  s_mov_b32 s56, 0x3dd53b95
  s_mov_b32 s70, 0
  s_mov_b32 s71, -1
  s_mul_i32 s69, s3, 1536
  s_add_u32 s69, s69, 153600
  s_lshl_b32 s72, s3, 3
  s_add_u32 s72, s72, 159744
  s_add_u32 s41, s40, 50331648
  s_sub_u32 s66, s3, 1
  s_mul_i32 s43, s66, 51200
  s_getreg_b32 s66, hwreg(HW_REG_XCC_ID)
  s_and_b32 s15, s66, 1
  s_cmp_eq_u32 s3, 2
  s_cbranch_scc1 L_w2_1
  s_cmp_eq_u32 s3, 3
  s_cbranch_scc1 L_w3_2
  s_mov_b32 s44, s10
  s_and_b32 s45, s11, 0xffff
  s_mov_b32 s46, 7864320
  s_mov_b32 s47, 0x20000
  v_mul_u32_u24 v20, 43, v8
  v_lshrrev_b32 v20, 10, v20
  v_mul_u32_u24 v21, 24, v20
  v_sub_u32 v21, v8, v21
  s_mov_b32 s67, 12288
  v_mul_lo_u32 v20, v20, s67
  v_lshl_add_u32 v20, v21, 4, v20
  s_mul_i32 s42, s30, 983040
  s_mul_i32 s67, s31, 384
  s_add_u32 s42, s42, s67
  s_mov_b32 exec_lo, 0xffffffff
  s_mov_b32 exec_hi, 0x0000ffff
  s_mov_b32 m0, 0
  s_nop 0
  buffer_load_dwordx4 v20, s[44:47], s42 offen nt lds
  s_mov_b32 m0, 768
  s_add_u32 s42, s42, 24576
  buffer_load_dwordx4 v20, s[44:47], s42 offen nt lds
  s_mov_b32 m0, 1536
  s_add_u32 s42, s42, 24576
  buffer_load_dwordx4 v20, s[44:47], s42 offen nt lds
  s_mov_b32 m0, 2304
  s_add_u32 s42, s42, 24576
  buffer_load_dwordx4 v20, s[44:47], s42 offen nt lds
  s_mov_b32 m0, 3072
  s_add_u32 s42, s42, 24576
  buffer_load_dwordx4 v20, s[44:47], s42 offen nt lds
  s_mov_b32 m0, 3840
  s_add_u32 s42, s42, 24576
  buffer_load_dwordx4 v20, s[44:47], s42 offen nt lds
  s_mov_b32 m0, 4608
  s_add_u32 s42, s42, 24576
  buffer_load_dwordx4 v20, s[44:47], s42 offen nt lds
  s_mov_b32 m0, 5376
  s_add_u32 s42, s42, 24576
  buffer_load_dwordx4 v20, s[44:47], s42 offen nt lds
  s_mov_b32 m0, 6144
  s_add_u32 s42, s42, 24576
  buffer_load_dwordx4 v20, s[44:47], s42 offen nt lds
  s_mov_b32 m0, 6912
  s_add_u32 s42, s42, 24576
  buffer_load_dwordx4 v20, s[44:47], s42 offen nt lds
  s_mov_b32 m0, 7680
  s_add_u32 s42, s42, 24576
  buffer_load_dwordx4 v20, s[44:47], s42 offen nt lds
  s_mov_b32 m0, 8448
  s_add_u32 s42, s42, 24576
  buffer_load_dwordx4 v20, s[44:47], s42 offen nt lds
  s_mov_b32 m0, 9216
  s_add_u32 s42, s42, 24576
  s_waitcnt vmcnt(23)
  buffer_load_dwordx4 v20, s[44:47], s42 offen nt lds
  s_mov_b32 m0, 9984
  s_add_u32 s42, s42, 24576
  s_waitcnt vmcnt(23)
  buffer_load_dwordx4 v20, s[44:47], s42 offen nt lds
  s_mov_b32 m0, 10752
  s_add_u32 s42, s42, 24576
  s_waitcnt vmcnt(23)
  buffer_load_dwordx4 v20, s[44:47], s42 offen nt lds
  s_mov_b32 m0, 11520
  s_add_u32 s42, s42, 24576
  s_waitcnt vmcnt(23)
  buffer_load_dwordx4 v20, s[44:47], s42 offen nt lds
  s_mov_b32 m0, 12288
  s_add_u32 s42, s42, 24576
  s_waitcnt vmcnt(23)
  buffer_load_dwordx4 v20, s[44:47], s42 offen nt lds
  s_mov_b32 m0, 13056
  s_add_u32 s42, s42, 24576
  s_waitcnt vmcnt(23)
  buffer_load_dwordx4 v20, s[44:47], s42 offen nt lds
  s_mov_b32 m0, 13824
  s_add_u32 s42, s42, 24576
  s_waitcnt vmcnt(23)
  buffer_load_dwordx4 v20, s[44:47], s42 offen nt lds
  s_mov_b32 m0, 14592
  s_add_u32 s42, s42, 24576
  s_waitcnt vmcnt(23)
  buffer_load_dwordx4 v20, s[44:47], s42 offen nt lds
  s_mov_b64 exec, -1
  s_branch L_wend_3
L_w2_1:
  s_mov_b32 s44, s10
  s_and_b32 s45, s11, 0xffff
  s_mov_b32 s46, 7864320
  s_mov_b32 s47, 0x20000
  v_mul_u32_u24 v20, 43, v8
  v_lshrrev_b32 v20, 10, v20
  v_mul_u32_u24 v21, 24, v20
  v_sub_u32 v21, v8, v21
  s_mov_b32 s67, 12288
  v_mul_lo_u32 v20, v20, s67
  v_lshl_add_u32 v20, v21, 4, v20
  s_mul_i32 s42, s30, 983040
  s_mul_i32 s67, s31, 384
  s_add_u32 s42, s42, s67
  s_add_u32 s42, s42, 491520
  s_mov_b32 exec_lo, 0xffffffff
  s_mov_b32 exec_hi, 0x0000ffff
  s_mov_b32 m0, 15360
  s_nop 0
  buffer_load_dwordx4 v20, s[44:47], s42 offen nt lds
  s_mov_b32 m0, 16128
  s_add_u32 s42, s42, 24576
  buffer_load_dwordx4 v20, s[44:47], s42 offen nt lds
  s_mov_b32 m0, 16896
  s_add_u32 s42, s42, 24576
  buffer_load_dwordx4 v20, s[44:47], s42 offen nt lds
  s_mov_b32 m0, 17664
  s_add_u32 s42, s42, 24576
  buffer_load_dwordx4 v20, s[44:47], s42 offen nt lds
  s_mov_b32 m0, 18432
  s_add_u32 s42, s42, 24576
  buffer_load_dwordx4 v20, s[44:47], s42 offen nt lds
  s_mov_b32 m0, 19200
  s_add_u32 s42, s42, 24576
  buffer_load_dwordx4 v20, s[44:47], s42 offen nt lds
  s_mov_b32 m0, 19968
  s_add_u32 s42, s42, 24576
  buffer_load_dwordx4 v20, s[44:47], s42 offen nt lds
  s_mov_b32 m0, 20736
  s_add_u32 s42, s42, 24576
  buffer_load_dwordx4 v20, s[44:47], s42 offen nt lds
  s_mov_b32 m0, 21504
  s_add_u32 s42, s42, 24576
  buffer_load_dwordx4 v20, s[44:47], s42 offen nt lds
  s_mov_b32 m0, 22272
  s_add_u32 s42, s42, 24576
  buffer_load_dwordx4 v20, s[44:47], s42 offen nt lds
  s_mov_b32 m0, 23040
  s_add_u32 s42, s42, 24576
  buffer_load_dwordx4 v20, s[44:47], s42 offen nt lds
  s_mov_b32 m0, 23808
  s_add_u32 s42, s42, 24576
  buffer_load_dwordx4 v20, s[44:47], s42 offen nt lds
  s_mov_b32 m0, 24576
  s_add_u32 s42, s42, 24576
  s_waitcnt vmcnt(23)
  buffer_load_dwordx4 v20, s[44:47], s42 offen nt lds
  s_mov_b32 m0, 25344
  s_add_u32 s42, s42, 24576
  s_waitcnt vmcnt(23)
  buffer_load_dwordx4 v20, s[44:47], s42 offen nt lds
  s_mov_b32 m0, 26112
  s_add_u32 s42, s42, 24576
  s_waitcnt vmcnt(23)
  buffer_load_dwordx4 v20, s[44:47], s42 offen nt lds
  s_mov_b32 m0, 26880
  s_add_u32 s42, s42, 24576
  s_waitcnt vmcnt(23)
  buffer_load_dwordx4 v20, s[44:47], s42 offen nt lds
  s_mov_b32 m0, 27648
  s_add_u32 s42, s42, 24576
  s_waitcnt vmcnt(23)
  buffer_load_dwordx4 v20, s[44:47], s42 offen nt lds
  s_mov_b32 m0, 28416
  s_add_u32 s42, s42, 24576
  s_waitcnt vmcnt(23)
  buffer_load_dwordx4 v20, s[44:47], s42 offen nt lds
  s_mov_b32 m0, 29184
  s_add_u32 s42, s42, 24576
  s_waitcnt vmcnt(23)
  buffer_load_dwordx4 v20, s[44:47], s42 offen nt lds
  s_mov_b32 m0, 29952
  s_add_u32 s42, s42, 24576
  s_waitcnt vmcnt(23)
  buffer_load_dwordx4 v20, s[44:47], s42 offen nt lds
  s_mov_b64 exec, -1
  s_branch L_wend_3
L_w3_2:
  s_mov_b32 s44, s16
  s_and_b32 s45, s17, 0xffff
  s_mov_b32 s46, 1966080
  s_mov_b32 s47, 0x20000
  v_mul_u32_u24 v20, 43, v8
  v_lshrrev_b32 v20, 8, v20
  v_mul_u32_u24 v21, 6, v20
  v_sub_u32 v21, v8, v21
  s_mov_b32 s67, 3072
  v_mul_lo_u32 v20, v20, s67
  v_lshl_add_u32 v20, v21, 4, v20
  s_mul_i32 s42, s30, 245760
  s_mul_i32 s67, s31, 96
  s_add_u32 s42, s42, s67
  s_mov_b32 exec_lo, 0xffffffff
  s_mov_b32 exec_hi, 0x0fffffff
  s_mov_b32 m0, 51200
  s_nop 0
  buffer_load_dwordx4 v20, s[44:47], s42 offen nt lds
  s_mov_b32 m0, 52160
  s_add_u32 s42, s42, 30720
  buffer_load_dwordx4 v20, s[44:47], s42 offen nt lds
  s_mov_b32 m0, 53120
  s_add_u32 s42, s42, 30720
  buffer_load_dwordx4 v20, s[44:47], s42 offen nt lds
  s_mov_b32 m0, 54080
  s_add_u32 s42, s42, 30720
  buffer_load_dwordx4 v20, s[44:47], s42 offen nt lds
  s_mov_b32 m0, 55040
  s_add_u32 s42, s42, 30720
  buffer_load_dwordx4 v20, s[44:47], s42 offen nt lds
  s_mov_b32 m0, 56000
  s_add_u32 s42, s42, 30720
  buffer_load_dwordx4 v20, s[44:47], s42 offen nt lds
  s_mov_b32 m0, 56960
  s_add_u32 s42, s42, 30720
  buffer_load_dwordx4 v20, s[44:47], s42 offen nt lds
  s_mov_b32 m0, 57920
  s_add_u32 s42, s42, 30720
  buffer_load_dwordx4 v20, s[44:47], s42 offen nt lds
  s_mov_b64 exec, -1
  s_mov_b32 s44, s18
  s_and_b32 s45, s19, 0xffff
  s_mov_b32 s46, 1966080
  s_mov_b32 s47, 0x20000
  v_mul_u32_u24 v20, 43, v8
  v_lshrrev_b32 v20, 8, v20
  v_mul_u32_u24 v21, 6, v20
  v_sub_u32 v21, v8, v21
  s_mov_b32 s67, 3072
  v_mul_lo_u32 v20, v20, s67
  v_lshl_add_u32 v20, v21, 4, v20
  s_mul_i32 s42, s30, 245760
  s_mul_i32 s67, s31, 96
  s_add_u32 s42, s42, s67
  s_mov_b32 exec_lo, 0xffffffff
  s_mov_b32 exec_hi, 0x0fffffff
  s_mov_b32 m0, 58880
  s_nop 0
  buffer_load_dwordx4 v20, s[44:47], s42 offen nt lds
  s_mov_b32 m0, 59840
  s_add_u32 s42, s42, 30720
  buffer_load_dwordx4 v20, s[44:47], s42 offen nt lds
  s_mov_b32 m0, 60800
  s_add_u32 s42, s42, 30720
  buffer_load_dwordx4 v20, s[44:47], s42 offen nt lds
  s_mov_b32 m0, 61760
  s_add_u32 s42, s42, 30720
  buffer_load_dwordx4 v20, s[44:47], s42 offen nt lds
  s_mov_b32 m0, 62720
  s_add_u32 s42, s42, 30720
  s_waitcnt vmcnt(23)
  buffer_load_dwordx4 v20, s[44:47], s42 offen nt lds
  s_mov_b32 m0, 63680
  s_add_u32 s42, s42, 30720
  s_waitcnt vmcnt(23)
  buffer_load_dwordx4 v20, s[44:47], s42 offen nt lds
  s_mov_b32 m0, 64640
  s_add_u32 s42, s42, 30720
  s_waitcnt vmcnt(23)
  buffer_load_dwordx4 v20, s[44:47], s42 offen nt lds
  s_mov_b32 m0, 65600
  s_add_u32 s42, s42, 30720
  s_waitcnt vmcnt(23)
  buffer_load_dwordx4 v20, s[44:47], s42 offen nt lds
  s_mov_b64 exec, -1
L_wend_3:
  v_lshlrev_b32 v0, 4, v8
  v_add_u32 v0, s43, v0
  v_and_b32 v10, 15, v8
  v_lshrrev_b32 v11, 3, v10
  v_mul_u32_u24 v11, 0x202, v11
  v_add_u32 v11, 0x100, v11
  v_or_b32 v12, 0x0c0c0000, v11
  v_lshlrev_b32 v13, 16, v11
  v_or_b32 v13, 0x0c0c, v13
  v_and_b32 v11, 1, v10
  v_cmp_eq_u32 vcc, 1, v11
  s_nop 1
  v_cndmask_b32 v12, v12, v13, vcc
  v_bfe_u32 v11, v10, 1, 2
  v_mov_b32 v13, 0x0c0c0c0c
  v_cmp_eq_u32 vcc, 0, v11
  s_nop 1
  v_cndmask_b32 v4, v13, v12, vcc
  v_cmp_eq_u32 vcc, 1, v11
  s_nop 1
  v_cndmask_b32 v5, v13, v12, vcc
  v_cmp_eq_u32 vcc, 2, v11
  s_nop 1
  v_cndmask_b32 v6, v13, v12, vcc
  v_cmp_eq_u32 vcc, 3, v11
  s_nop 1
  v_cndmask_b32 v7, v13, v12, vcc
  s_waitcnt vmcnt(23)
  s_cmp_lg_u32 s15, 0
  s_cbranch_scc1 L_par_4
  s_waitcnt vmcnt(13)
L_par_4:
  s_add_u32 s42, s40, 12288
  buffer_load_dwordx4 a[48:51], v1, s[32:35], s42 offen offset:0 nt
  s_waitcnt vmcnt(23)
  s_cmp_lg_u32 s15, 0
  s_cbranch_scc1 L_par_5
  s_waitcnt vmcnt(13)
L_par_5:
  buffer_load_dwordx4 a[52:55], v1, s[32:35], s42 offen offset:128 nt
  s_waitcnt vmcnt(23)
  s_cmp_lg_u32 s15, 0
  s_cbranch_scc1 L_par_6
  s_waitcnt vmcnt(13)
L_par_6:
  buffer_load_dwordx4 a[56:59], v1, s[32:35], s42 offen offset:256 nt
  s_waitcnt vmcnt(23)
  s_cmp_lg_u32 s15, 0
  s_cbranch_scc1 L_par_7
  s_waitcnt vmcnt(13)
L_par_7:
  s_add_u32 s42, s40, 15360
  buffer_load_dwordx4 a[60:63], v1, s[32:35], s42 offen offset:0 nt
  s_waitcnt vmcnt(23)
  s_cmp_lg_u32 s15, 0
  s_cbranch_scc1 L_par_8
  s_waitcnt vmcnt(13)
L_par_8:
  buffer_load_dwordx4 a[64:67], v1, s[32:35], s42 offen offset:128 nt
  s_waitcnt vmcnt(23)
  s_cmp_lg_u32 s15, 0
  s_cbranch_scc1 L_par_9
  s_waitcnt vmcnt(13)
L_par_9:
  buffer_load_dwordx4 a[68:71], v1, s[32:35], s42 offen offset:256 nt
  s_waitcnt vmcnt(23)
  s_cmp_lg_u32 s15, 0
  s_cbranch_scc1 L_par_10
  s_waitcnt vmcnt(13)
L_par_10:
  s_add_u32 s42, s40, 18432
  buffer_load_dwordx4 a[72:75], v1, s[32:35], s42 offen offset:0 nt
  s_waitcnt vmcnt(23)
  s_cmp_lg_u32 s15, 0
  s_cbranch_scc1 L_par_11
  s_waitcnt vmcnt(13)
L_par_11:
  buffer_load_dwordx4 a[76:79], v1, s[32:35], s42 offen offset:128 nt
  s_waitcnt vmcnt(23)
  s_cmp_lg_u32 s15, 0
  s_cbranch_scc1 L_par_12
  s_waitcnt vmcnt(13)
L_par_12:
  buffer_load_dwordx4 a[80:83], v1, s[32:35], s42 offen offset:256 nt
  s_waitcnt vmcnt(23)
  s_cmp_lg_u32 s15, 0
  s_cbranch_scc1 L_par_13
  s_waitcnt vmcnt(13)
L_par_13:
  s_add_u32 s42, s40, 21504
  buffer_load_dwordx4 a[84:87], v1, s[32:35], s42 offen offset:0 nt
  s_waitcnt vmcnt(23)
  s_cmp_lg_u32 s15, 0
  s_cbranch_scc1 L_par_14
  s_waitcnt vmcnt(13)
L_par_14:
  buffer_load_dwordx4 a[88:91], v1, s[32:35], s42 offen offset:128 nt
  s_waitcnt vmcnt(23)
  s_cmp_lg_u32 s15, 0
  s_cbranch_scc1 L_par_15
  s_waitcnt vmcnt(13)
L_par_15:
  buffer_load_dwordx4 a[92:95], v1, s[32:35], s42 offen offset:256 nt
  s_waitcnt vmcnt(23)
  s_cmp_lg_u32 s15, 0
  s_cbranch_scc1 L_par_16
  s_waitcnt vmcnt(13)
L_par_16:
  s_add_u32 s42, s40, 24576
  buffer_load_dwordx4 a[96:99], v1, s[32:35], s42 offen offset:0 nt
  s_waitcnt vmcnt(23)
  s_cmp_lg_u32 s15, 0
  s_cbranch_scc1 L_par_17
  s_waitcnt vmcnt(13)
L_par_17:
  buffer_load_dwordx4 a[100:103], v1, s[32:35], s42 offen offset:128 nt
  s_waitcnt vmcnt(23)
  s_cmp_lg_u32 s15, 0
  s_cbranch_scc1 L_par_18
  s_waitcnt vmcnt(13)
L_par_18:
  buffer_load_dwordx4 a[104:107], v1, s[32:35], s42 offen offset:256 nt
  s_waitcnt vmcnt(23)
  s_cmp_lg_u32 s15, 0
  s_cbranch_scc1 L_par_19
  s_waitcnt vmcnt(13)
L_par_19:
  s_add_u32 s42, s40, 27648
  buffer_load_dwordx4 a[108:111], v1, s[32:35], s42 offen offset:0 nt
  s_waitcnt vmcnt(23)
  s_cmp_lg_u32 s15, 0
  s_cbranch_scc1 L_par_20
  s_waitcnt vmcnt(13)
L_par_20:
  buffer_load_dwordx4 a[112:115], v1, s[32:35], s42 offen offset:128 nt
  s_waitcnt vmcnt(23)
  s_cmp_lg_u32 s15, 0
  s_cbranch_scc1 L_par_21
  s_waitcnt vmcnt(13)
L_par_21:
  buffer_load_dwordx4 a[116:119], v1, s[32:35], s42 offen offset:256 nt
  s_waitcnt vmcnt(23)
  s_cmp_lg_u32 s15, 0
  s_cbranch_scc1 L_par_22
  s_waitcnt vmcnt(13)
L_par_22:
  s_add_u32 s42, s40, 30720
  buffer_load_dwordx4 a[120:123], v1, s[32:35], s42 offen offset:0 nt
  s_waitcnt vmcnt(23)
  s_cmp_lg_u32 s15, 0
  s_cbranch_scc1 L_par_23
  s_waitcnt vmcnt(13)
L_par_23:
  buffer_load_dwordx4 a[124:127], v1, s[32:35], s42 offen offset:128 nt
  s_waitcnt vmcnt(23)
  s_cmp_lg_u32 s15, 0
  s_cbranch_scc1 L_par_24
  s_waitcnt vmcnt(13)
L_par_24:
  buffer_load_dwordx4 a[128:131], v1, s[32:35], s42 offen offset:256 nt
  s_waitcnt vmcnt(23)
  s_cmp_lg_u32 s15, 0
  s_cbranch_scc1 L_par_25
  s_waitcnt vmcnt(13)
L_par_25:
  s_add_u32 s42, s40, 33792
  buffer_load_dwordx4 a[132:135], v1, s[32:35], s42 offen offset:0 nt
  s_waitcnt vmcnt(23)
  s_cmp_lg_u32 s15, 0
  s_cbranch_scc1 L_par_26
  s_waitcnt vmcnt(13)
L_par_26:
  buffer_load_dwordx4 a[136:139], v1, s[32:35], s42 offen offset:128 nt
  s_waitcnt vmcnt(23)
  s_cmp_lg_u32 s15, 0
  s_cbranch_scc1 L_par_27
  s_waitcnt vmcnt(13)
L_par_27:
  buffer_load_dwordx4 a[140:143], v1, s[32:35], s42 offen offset:256 nt
  s_waitcnt vmcnt(23)
  s_cmp_lg_u32 s15, 0
  s_cbranch_scc1 L_par_28
  s_waitcnt vmcnt(13)
L_par_28:
  s_lshl_b32 s66, s3, 2
  s_add_u32 s66, s66, 163788
  v_mov_b32 v20, s66
  v_mov_b32 v21, 1
  ds_write_b32 v20, v21
  s_add_u32 s42, s40, 36864
  buffer_load_dwordx4 a[144:147], v1, s[32:35], s42 offen offset:0 nt
  s_waitcnt vmcnt(23)
  s_cmp_lg_u32 s15, 0
  s_cbranch_scc1 L_par_29
  s_waitcnt vmcnt(13)
L_par_29:
  buffer_load_dwordx4 a[148:151], v1, s[32:35], s42 offen offset:128 nt
  s_waitcnt vmcnt(23)
  s_cmp_lg_u32 s15, 0
  s_cbranch_scc1 L_par_30
  s_waitcnt vmcnt(13)
L_par_30:
  buffer_load_dwordx4 a[152:155], v1, s[32:35], s42 offen offset:256 nt
  s_waitcnt vmcnt(23)
  s_cmp_lg_u32 s15, 0
  s_cbranch_scc1 L_par_31
  s_waitcnt vmcnt(13)
L_par_31:
  s_add_u32 s42, s40, 39936
  buffer_load_dwordx4 a[156:159], v1, s[32:35], s42 offen offset:0 nt
  s_waitcnt vmcnt(23)
  s_cmp_lg_u32 s15, 0
  s_cbranch_scc1 L_par_32
  s_waitcnt vmcnt(13)
L_par_32:
  buffer_load_dwordx4 a[160:163], v1, s[32:35], s42 offen offset:128 nt
  s_waitcnt vmcnt(23)
  s_cmp_lg_u32 s15, 0
  s_cbranch_scc1 L_par_33
  s_waitcnt vmcnt(13)
L_par_33:
  buffer_load_dwordx4 a[164:167], v1, s[32:35], s42 offen offset:256 nt
  s_waitcnt vmcnt(23)
  s_cmp_lg_u32 s15, 0
  s_cbranch_scc1 L_par_34
  s_waitcnt vmcnt(13)
L_par_34:
  s_add_u32 s42, s40, 43008
  buffer_load_dwordx4 a[168:171], v1, s[32:35], s42 offen offset:0 nt
  s_waitcnt vmcnt(23)
  s_cmp_lg_u32 s15, 0
  s_cbranch_scc1 L_par_35
  s_waitcnt vmcnt(13)
L_par_35:
  buffer_load_dwordx4 a[172:175], v1, s[32:35], s42 offen offset:128 nt
  s_waitcnt vmcnt(23)
  s_cmp_lg_u32 s15, 0
  s_cbranch_scc1 L_par_36
  s_waitcnt vmcnt(13)
L_par_36:
  buffer_load_dwordx4 a[176:179], v1, s[32:35], s42 offen offset:256 nt
  s_waitcnt vmcnt(23)
  s_cmp_lg_u32 s15, 0
  s_cbranch_scc1 L_par_37
  s_waitcnt vmcnt(13)
L_par_37:
  s_add_u32 s42, s40, 46080
  buffer_load_dwordx4 a[180:183], v1, s[32:35], s42 offen offset:0 nt
  s_waitcnt vmcnt(23)
  s_cmp_lg_u32 s15, 0
  s_cbranch_scc1 L_par_38
  s_waitcnt vmcnt(13)
L_par_38:
  buffer_load_dwordx4 a[184:187], v1, s[32:35], s42 offen offset:128 nt
  s_waitcnt vmcnt(23)
  s_cmp_lg_u32 s15, 0
  s_cbranch_scc1 L_par_39
  s_waitcnt vmcnt(13)
L_par_39:
  buffer_load_dwordx4 a[188:191], v1, s[32:35], s42 offen offset:256 nt
  s_waitcnt vmcnt(23)
  s_cmp_lg_u32 s15, 0
  s_cbranch_scc1 L_par_40
  s_waitcnt vmcnt(13)
L_par_40:
  s_add_u32 s42, s40, 49152
  buffer_load_dwordx4 a[192:195], v1, s[32:35], s42 offen offset:0 nt
  s_waitcnt vmcnt(23)
  s_cmp_lg_u32 s15, 0
  s_cbranch_scc1 L_par_41
  s_waitcnt vmcnt(13)
L_par_41:
  buffer_load_dwordx4 a[196:199], v1, s[32:35], s42 offen offset:128 nt
  s_waitcnt vmcnt(23)
  s_cmp_lg_u32 s15, 0
  s_cbranch_scc1 L_par_42
  s_waitcnt vmcnt(13)
L_par_42:
  buffer_load_dwordx4 a[200:203], v1, s[32:35], s42 offen offset:256 nt
  s_waitcnt vmcnt(23)
  s_cmp_lg_u32 s15, 0
  s_cbranch_scc1 L_par_43
  s_waitcnt vmcnt(13)
L_par_43:
  s_add_u32 s42, s40, 52224
  buffer_load_dwordx4 a[204:207], v1, s[32:35], s42 offen offset:0 nt
  s_waitcnt vmcnt(23)
  s_cmp_lg_u32 s15, 0
  s_cbranch_scc1 L_par_44
  s_waitcnt vmcnt(13)
L_par_44:
  buffer_load_dwordx4 a[208:211], v1, s[32:35], s42 offen offset:128 nt
  s_waitcnt vmcnt(23)
  s_cmp_lg_u32 s15, 0
  s_cbranch_scc1 L_par_45
  s_waitcnt vmcnt(13)
L_par_45:
  buffer_load_dwordx4 a[212:215], v1, s[32:35], s42 offen offset:256 nt
  s_waitcnt vmcnt(23)
  s_cmp_lg_u32 s15, 0
  s_cbranch_scc1 L_par_46
  s_waitcnt vmcnt(13)
L_par_46:
  s_add_u32 s42, s40, 55296
  buffer_load_dwordx4 a[216:219], v1, s[32:35], s42 offen offset:0 nt
  s_waitcnt vmcnt(23)
  s_cmp_lg_u32 s15, 0
  s_cbranch_scc1 L_par_47
  s_waitcnt vmcnt(13)
L_par_47:
  buffer_load_dwordx4 a[220:223], v1, s[32:35], s42 offen offset:128 nt
  s_waitcnt vmcnt(23)
  s_cmp_lg_u32 s15, 0
  s_cbranch_scc1 L_par_48
  s_waitcnt vmcnt(13)
L_par_48:
  buffer_load_dwordx4 a[224:227], v1, s[32:35], s42 offen offset:256 nt
  s_waitcnt vmcnt(23)
  s_cmp_lg_u32 s15, 0
  s_cbranch_scc1 L_par_49
  s_waitcnt vmcnt(13)
L_par_49:
  s_add_u32 s42, s40, 58368
  buffer_load_dwordx4 a[228:231], v1, s[32:35], s42 offen offset:0 nt
  s_waitcnt vmcnt(23)
  s_cmp_lg_u32 s15, 0
  s_cbranch_scc1 L_par_50
  s_waitcnt vmcnt(13)
L_par_50:
  buffer_load_dwordx4 a[232:235], v1, s[32:35], s42 offen offset:128 nt
  s_waitcnt vmcnt(23)
  s_cmp_lg_u32 s15, 0
  s_cbranch_scc1 L_par_51
  s_waitcnt vmcnt(13)
L_par_51:
  buffer_load_dwordx4 a[236:239], v1, s[32:35], s42 offen offset:256 nt
  s_waitcnt vmcnt(23)
  s_cmp_lg_u32 s15, 0
  s_cbranch_scc1 L_par_52
  s_waitcnt vmcnt(13)
L_par_52:
  s_add_u32 s42, s40, 0
  buffer_load_dwordx4 a[240:243], v2, s[36:39], s42 offen offset:0 nt
  s_waitcnt vmcnt(23)
  s_cmp_lg_u32 s15, 0
  s_cbranch_scc1 L_par_53
  s_waitcnt vmcnt(13)
L_par_53:
  buffer_load_dwordx4 a[244:247], v2, s[36:39], s42 offen offset:384 nt
  s_waitcnt vmcnt(23)
  s_cmp_lg_u32 s15, 0
  s_cbranch_scc1 L_par_54
  s_waitcnt vmcnt(13)
L_par_54:
  buffer_load_dwordx4 a[248:251], v3, s[36:39], s42 offen offset:0 nt
  s_waitcnt vmcnt(23)
  s_cmp_lg_u32 s15, 0
  s_cbranch_scc1 L_par_55
  s_waitcnt vmcnt(13)
L_par_55:
  s_add_u32 s42, s40, 3072
  buffer_load_dwordx4 a[252:255], v2, s[36:39], s42 offen offset:0 nt
  s_waitcnt vmcnt(23)
  s_cmp_lg_u32 s15, 0
  s_cbranch_scc1 L_par_56
  s_waitcnt vmcnt(13)
L_par_56:
  v_mbcnt_lo_u32_b32 v37, -1, 0
  v_mbcnt_hi_u32_b32 v37, -1, v37
  v_mul_u32_u24 v38, 103, v37
  v_lshrrev_b32 v38, 10, v38
  v_mul_u32_u24 v39, 10, v38
  v_sub_u32 v39, v37, v39
  v_mul_u32_u24 v38, 1280, v38
  v_lshl_add_u32 v37, v39, 4, v38
  s_mov_b32 s44, s12
  s_and_b32 s45, s13, 0xffff
  s_mov_b32 s46, 7864320
  s_mov_b32 s47, 0x20000
  s_sub_u32 s66, s3, 1
  s_mul_i32 s16, s31, 245760
  s_mul_i32 s67, s66, 81920
  s_add_u32 s16, s16, s67
  s_mul_i32 s67, s30, 160
  s_add_u32 s16, s16, s67
  s_add_u32 m0, s43, 35840
  s_mov_b32 exec_lo, 0xffffffff
  s_mov_b32 exec_hi, 0x0fffffff
  buffer_load_dwordx4 v37, s[44:47], s16 offen nt lds
  s_mov_b64 exec, -1
  s_waitcnt vmcnt(23)
  s_add_u32 s16, s16, 7680
  s_add_u32 m0, s43, 36800
  s_mov_b32 exec_lo, 0xffffffff
  s_mov_b32 exec_hi, 0x0fffffff
  buffer_load_dwordx4 v37, s[44:47], s16 offen nt lds
  s_mov_b64 exec, -1
  s_waitcnt vmcnt(23)
  s_add_u32 s16, s16, 7680
  s_add_u32 m0, s43, 37760
  s_mov_b32 exec_lo, 0xffffffff
  s_mov_b32 exec_hi, 0x0fffffff
  buffer_load_dwordx4 v37, s[44:47], s16 offen nt lds
  s_mov_b64 exec, -1
  s_waitcnt vmcnt(23)
  s_add_u32 s16, s16, 7680
  s_add_u32 m0, s43, 38720
  s_mov_b32 exec_lo, 0xffffffff
  s_mov_b32 exec_hi, 0x0fffffff
  buffer_load_dwordx4 v37, s[44:47], s16 offen nt lds
  s_mov_b64 exec, -1
  s_waitcnt vmcnt(23)
  s_add_u32 s16, s16, 7680
  s_add_u32 m0, s43, 39680
  s_mov_b32 exec_lo, 0xffffffff
  s_mov_b32 exec_hi, 0x0fffffff
  buffer_load_dwordx4 v37, s[44:47], s16 offen nt lds
  s_mov_b64 exec, -1
  s_waitcnt vmcnt(23)
  s_add_u32 s16, s16, 7680
  s_add_u32 m0, s43, 40640
  s_mov_b32 exec_lo, 0xffffffff
  s_mov_b32 exec_hi, 0x0fffffff
  buffer_load_dwordx4 v37, s[44:47], s16 offen nt lds
  s_mov_b64 exec, -1
  s_waitcnt vmcnt(23)
  s_add_u32 s16, s16, 7680
  s_add_u32 m0, s43, 41600
  s_mov_b32 exec_lo, 0xffffffff
  s_mov_b32 exec_hi, 0x0fffffff
  buffer_load_dwordx4 v37, s[44:47], s16 offen nt lds
  s_mov_b64 exec, -1
  s_waitcnt vmcnt(23)
  s_add_u32 s16, s16, 7680
  s_add_u32 m0, s43, 42560
  s_mov_b32 exec_lo, 0xffffffff
  s_mov_b32 exec_hi, 0x0fffffff
  buffer_load_dwordx4 v37, s[44:47], s16 offen nt lds
  s_mov_b64 exec, -1
  s_waitcnt vmcnt(23)
  s_add_u32 s16, s16, 7680
  s_add_u32 m0, s43, 43520
  s_mov_b32 exec_lo, 0xffffffff
  s_mov_b32 exec_hi, 0x0fffffff
  buffer_load_dwordx4 v37, s[44:47], s16 offen nt lds
  s_mov_b64 exec, -1
  s_waitcnt vmcnt(23)
  s_add_u32 s16, s16, 7680
  s_add_u32 m0, s43, 44480
  s_mov_b32 exec_lo, 0xffffffff
  s_mov_b32 exec_hi, 0x0fffffff
  buffer_load_dwordx4 v37, s[44:47], s16 offen nt lds
  s_mov_b64 exec, -1
  s_waitcnt vmcnt(23)
  s_add_u32 s16, s16, 7680
  s_add_u32 m0, s43, 45440
  s_mov_b32 exec_lo, 0xffffffff
  s_mov_b32 exec_hi, 0x000000ff
  buffer_load_dwordx4 v37, s[44:47], s16 offen nt lds
  s_mov_b64 exec, -1
  s_waitcnt vmcnt(23)
  s_mov_b32 s44, s20
  s_and_b32 s45, s21, 0xffff
  s_mov_b32 s46, 1966080
  s_mov_b32 s47, 0x20000
  s_sub_u32 s66, s3, 1
  s_mul_i32 s16, s31, 61440
  s_mul_i32 s67, s66, 20480
  s_add_u32 s16, s16, s67
  s_mul_i32 s67, s30, 160
  s_add_u32 s16, s16, s67
  s_add_u32 m0, s43, 46080
  s_mov_b32 exec_lo, 0xffffffff
  s_mov_b32 exec_hi, 0x0fffffff
  buffer_load_dwordx4 v37, s[44:47], s16 offen nt lds
  s_mov_b64 exec, -1
  s_waitcnt vmcnt(23)
  s_add_u32 s16, s16, 7680
  s_add_u32 m0, s43, 47040
  s_mov_b32 exec_lo, 0xffffffff
  s_mov_b32 exec_hi, 0x0fffffff
  buffer_load_dwordx4 v37, s[44:47], s16 offen nt lds
  s_mov_b64 exec, -1
  s_waitcnt vmcnt(23)
  s_add_u32 s16, s16, 7680
  s_add_u32 m0, s43, 48000
  s_mov_b32 exec_lo, 0xffffffff
  s_mov_b32 exec_hi, 0x000000ff
  buffer_load_dwordx4 v37, s[44:47], s16 offen nt lds
  s_mov_b64 exec, -1
  s_add_u32 s42, s40, 3072
  buffer_load_dwordx4 v[40:43], v2, s[36:39], s42 offen offset:384 nt
  s_waitcnt vmcnt(23)
  s_cmp_lg_u32 s15, 0
  s_cbranch_scc1 L_par_57
  s_waitcnt vmcnt(13)
L_par_57:
  buffer_load_dwordx4 v[44:47], v3, s[36:39], s42 offen offset:0 nt
  s_waitcnt vmcnt(23)
  s_cmp_lg_u32 s15, 0
  s_cbranch_scc1 L_par_58
  s_waitcnt vmcnt(13)
L_par_58:
  s_add_u32 s42, s40, 6144
  buffer_load_dwordx4 v[48:51], v2, s[36:39], s42 offen offset:0 nt
  s_waitcnt vmcnt(23)
  s_cmp_lg_u32 s15, 0
  s_cbranch_scc1 L_par_59
  s_waitcnt vmcnt(13)
L_par_59:
  buffer_load_dwordx4 v[52:55], v2, s[36:39], s42 offen offset:384 nt
  s_waitcnt vmcnt(23)
  s_cmp_lg_u32 s15, 0
  s_cbranch_scc1 L_par_60
  s_waitcnt vmcnt(13)
L_par_60:
  buffer_load_dwordx4 v[56:59], v3, s[36:39], s42 offen offset:0 nt
  s_waitcnt vmcnt(23)
  s_cmp_lg_u32 s15, 0
  s_cbranch_scc1 L_par_61
  s_waitcnt vmcnt(13)
L_par_61:
  s_add_u32 s42, s40, 9216
  buffer_load_dwordx4 v[60:63], v2, s[36:39], s42 offen offset:0 nt
  s_waitcnt vmcnt(23)
  s_cmp_lg_u32 s15, 0
  s_cbranch_scc1 L_par_62
  s_waitcnt vmcnt(13)
L_par_62:
  buffer_load_dwordx4 v[64:67], v2, s[36:39], s42 offen offset:384 nt
  s_waitcnt vmcnt(23)
  s_cmp_lg_u32 s15, 0
  s_cbranch_scc1 L_par_63
  s_waitcnt vmcnt(13)
L_par_63:
  buffer_load_dwordx4 v[68:71], v3, s[36:39], s42 offen offset:0 nt
  s_waitcnt vmcnt(23)
  s_cmp_lg_u32 s15, 0
  s_cbranch_scc1 L_par_64
  s_waitcnt vmcnt(13)
L_par_64:
  s_add_u32 s42, s40, 12288
  buffer_load_dwordx4 v[72:75], v2, s[36:39], s42 offen offset:0 nt
  s_waitcnt vmcnt(23)
  s_cmp_lg_u32 s15, 0
  s_cbranch_scc1 L_par_65
  s_waitcnt vmcnt(13)
L_par_65:
  buffer_load_dwordx4 v[76:79], v2, s[36:39], s42 offen offset:384 nt
  s_waitcnt vmcnt(23)
  s_cmp_lg_u32 s15, 0
  s_cbranch_scc1 L_par_66
  s_waitcnt vmcnt(13)
L_par_66:
  buffer_load_dwordx4 v[80:83], v3, s[36:39], s42 offen offset:0 nt
  s_waitcnt vmcnt(23)
  s_cmp_lg_u32 s15, 0
  s_cbranch_scc1 L_par_67
  s_waitcnt vmcnt(13)
L_par_67:
  s_add_u32 s42, s40, 15360
  buffer_load_dwordx4 v[84:87], v2, s[36:39], s42 offen offset:0 nt
  s_waitcnt vmcnt(23)
  s_cmp_lg_u32 s15, 0
  s_cbranch_scc1 L_par_68
  s_waitcnt vmcnt(13)
L_par_68:
  buffer_load_dwordx4 v[88:91], v2, s[36:39], s42 offen offset:384 nt
  s_waitcnt vmcnt(23)
  s_cmp_lg_u32 s15, 0
  s_cbranch_scc1 L_par_69
  s_waitcnt vmcnt(13)
L_par_69:
  buffer_load_dwordx4 v[92:95], v3, s[36:39], s42 offen offset:0 nt
  s_waitcnt vmcnt(23)
  s_cmp_lg_u32 s15, 0
  s_cbranch_scc1 L_par_70
  s_waitcnt vmcnt(13)
L_par_70:
  s_add_u32 s42, s40, 18432
  buffer_load_dwordx4 v[96:99], v2, s[36:39], s42 offen offset:0 nt
  s_waitcnt vmcnt(23)
  s_cmp_lg_u32 s15, 0
  s_cbranch_scc1 L_par_71
  s_waitcnt vmcnt(13)
L_par_71:
  buffer_load_dwordx4 v[100:103], v2, s[36:39], s42 offen offset:384 nt
  s_waitcnt vmcnt(23)
  s_cmp_lg_u32 s15, 0
  s_cbranch_scc1 L_par_72
  s_waitcnt vmcnt(13)
L_par_72:
  buffer_load_dwordx4 v[104:107], v3, s[36:39], s42 offen offset:0 nt
  s_waitcnt vmcnt(23)
  s_cmp_lg_u32 s15, 0
  s_cbranch_scc1 L_par_73
  s_waitcnt vmcnt(13)
L_par_73:
  s_add_u32 s42, s40, 21504
  buffer_load_dwordx4 v[108:111], v2, s[36:39], s42 offen offset:0 nt
  s_waitcnt vmcnt(23)
  s_cmp_lg_u32 s15, 0
  s_cbranch_scc1 L_par_74
  s_waitcnt vmcnt(13)
L_par_74:
  buffer_load_dwordx4 v[112:115], v2, s[36:39], s42 offen offset:384 nt
  s_waitcnt vmcnt(23)
  s_cmp_lg_u32 s15, 0
  s_cbranch_scc1 L_par_75
  s_waitcnt vmcnt(13)
L_par_75:
  buffer_load_dwordx4 v[116:119], v3, s[36:39], s42 offen offset:0 nt
  s_waitcnt vmcnt(23)
  s_cmp_lg_u32 s15, 0
  s_cbranch_scc1 L_par_76
  s_waitcnt vmcnt(13)
L_par_76:
  s_add_u32 s42, s40, 24576
  buffer_load_dwordx4 v[120:123], v2, s[36:39], s42 offen offset:0 nt
  s_waitcnt vmcnt(23)
  s_cmp_lg_u32 s15, 0
  s_cbranch_scc1 L_par_77
  s_waitcnt vmcnt(13)
L_par_77:
  buffer_load_dwordx4 v[124:127], v2, s[36:39], s42 offen offset:384 nt
  s_waitcnt vmcnt(23)
  s_cmp_lg_u32 s15, 0
  s_cbranch_scc1 L_par_78
  s_waitcnt vmcnt(13)
L_par_78:
  buffer_load_dwordx4 v[128:131], v3, s[36:39], s42 offen offset:0 nt
  s_waitcnt vmcnt(23)
  s_cmp_lg_u32 s15, 0
  s_cbranch_scc1 L_par_79
  s_waitcnt vmcnt(13)
L_par_79:
  s_add_u32 s42, s40, 27648
  buffer_load_dwordx4 v[132:135], v2, s[36:39], s42 offen offset:0 nt
  s_waitcnt vmcnt(23)
  s_cmp_lg_u32 s15, 0
  s_cbranch_scc1 L_par_80
  s_waitcnt vmcnt(13)
L_par_80:
  s_lshl_b32 s66, s3, 2
  s_add_u32 s66, s66, 163804
  v_mov_b32 v20, s66
  v_mov_b32 v21, 1
  ds_write_b32 v20, v21
  buffer_load_dwordx4 v[136:139], v2, s[36:39], s42 offen offset:384 nt
  s_waitcnt vmcnt(23)
  s_cmp_lg_u32 s15, 0
  s_cbranch_scc1 L_par_81
  s_waitcnt vmcnt(13)
L_par_81:
  buffer_load_dwordx4 v[140:143], v3, s[36:39], s42 offen offset:0 nt
  s_waitcnt vmcnt(23)
  s_cmp_lg_u32 s15, 0
  s_cbranch_scc1 L_par_82
  s_waitcnt vmcnt(13)
L_par_82:
  s_add_u32 s42, s40, 30720
  buffer_load_dwordx4 v[144:147], v2, s[36:39], s42 offen offset:0 nt
  s_waitcnt vmcnt(23)
  s_cmp_lg_u32 s15, 0
  s_cbranch_scc1 L_par_83
  s_waitcnt vmcnt(13)
L_par_83:
  buffer_load_dwordx4 v[148:151], v2, s[36:39], s42 offen offset:384 nt
  s_waitcnt vmcnt(23)
  s_cmp_lg_u32 s15, 0
  s_cbranch_scc1 L_par_84
  s_waitcnt vmcnt(13)
L_par_84:
  buffer_load_dwordx4 v[152:155], v3, s[36:39], s42 offen offset:0 nt
  s_waitcnt vmcnt(23)
  s_cmp_lg_u32 s15, 0
  s_cbranch_scc1 L_par_85
  s_waitcnt vmcnt(13)
L_par_85:
  s_add_u32 s42, s40, 33792
  buffer_load_dwordx4 v[156:159], v2, s[36:39], s42 offen offset:0 nt
  s_waitcnt vmcnt(23)
  s_cmp_lg_u32 s15, 0
  s_cbranch_scc1 L_par_86
  s_waitcnt vmcnt(13)
L_par_86:
  buffer_load_dwordx4 v[160:163], v2, s[36:39], s42 offen offset:384 nt
  s_waitcnt vmcnt(23)
  s_cmp_lg_u32 s15, 0
  s_cbranch_scc1 L_par_87
  s_waitcnt vmcnt(13)
L_par_87:
  buffer_load_dwordx4 v[164:167], v3, s[36:39], s42 offen offset:0 nt
  s_waitcnt vmcnt(23)
  s_cmp_lg_u32 s15, 0
  s_cbranch_scc1 L_par_88
  s_waitcnt vmcnt(13)
L_par_88:
  s_add_u32 s42, s40, 36864
  buffer_load_dwordx4 v[168:171], v2, s[36:39], s42 offen offset:0 nt
  s_waitcnt vmcnt(23)
  s_cmp_lg_u32 s15, 0
  s_cbranch_scc1 L_par_89
  s_waitcnt vmcnt(13)
L_par_89:
  buffer_load_dwordx4 v[172:175], v2, s[36:39], s42 offen offset:384 nt
  s_waitcnt vmcnt(23)
  s_cmp_lg_u32 s15, 0
  s_cbranch_scc1 L_par_90
  s_waitcnt vmcnt(13)
L_par_90:
  buffer_load_dwordx4 v[176:179], v3, s[36:39], s42 offen offset:0 nt
  s_waitcnt vmcnt(23)
  s_cmp_lg_u32 s15, 0
  s_cbranch_scc1 L_par_91
  s_waitcnt vmcnt(13)
L_par_91:
  s_add_u32 s42, s40, 39936
  buffer_load_dwordx4 v[180:183], v2, s[36:39], s42 offen offset:0 nt
  s_waitcnt vmcnt(23)
  s_cmp_lg_u32 s15, 0
  s_cbranch_scc1 L_par_92
  s_waitcnt vmcnt(13)
L_par_92:
  buffer_load_dwordx4 v[184:187], v2, s[36:39], s42 offen offset:384 nt
  s_waitcnt vmcnt(23)
  s_cmp_lg_u32 s15, 0
  s_cbranch_scc1 L_par_93
  s_waitcnt vmcnt(13)
L_par_93:
  buffer_load_dwordx4 v[188:191], v3, s[36:39], s42 offen offset:0 nt
  s_waitcnt vmcnt(23)
  s_cmp_lg_u32 s15, 0
  s_cbranch_scc1 L_par_94
  s_waitcnt vmcnt(13)
L_par_94:
  s_add_u32 s42, s40, 43008
  buffer_load_dwordx4 v[192:195], v2, s[36:39], s42 offen offset:0 nt
  s_waitcnt vmcnt(23)
  s_cmp_lg_u32 s15, 0
  s_cbranch_scc1 L_par_95
  s_waitcnt vmcnt(13)
L_par_95:
  buffer_load_dwordx4 v[196:199], v2, s[36:39], s42 offen offset:384 nt
  s_waitcnt vmcnt(23)
  s_cmp_lg_u32 s15, 0
  s_cbranch_scc1 L_par_96
  s_waitcnt vmcnt(13)
L_par_96:
  buffer_load_dwordx4 v[200:203], v3, s[36:39], s42 offen offset:0 nt
  s_waitcnt vmcnt(23)
  s_cmp_lg_u32 s15, 0
  s_cbranch_scc1 L_par_97
  s_waitcnt vmcnt(13)
L_par_97:
  s_add_u32 s42, s40, 46080
  buffer_load_dwordx4 v[204:207], v2, s[36:39], s42 offen offset:0 nt
  s_waitcnt vmcnt(23)
  s_cmp_lg_u32 s15, 0
  s_cbranch_scc1 L_par_98
  s_waitcnt vmcnt(13)
L_par_98:
  buffer_load_dwordx4 v[208:211], v2, s[36:39], s42 offen offset:384 nt
  s_waitcnt vmcnt(23)
  s_cmp_lg_u32 s15, 0
  s_cbranch_scc1 L_par_99
  s_waitcnt vmcnt(13)
L_par_99:
  buffer_load_dwordx4 v[212:215], v3, s[36:39], s42 offen offset:0 nt
  s_waitcnt vmcnt(23)
  s_cmp_lg_u32 s15, 0
  s_cbranch_scc1 L_par_100
  s_waitcnt vmcnt(13)
L_par_100:
  s_add_u32 s42, s40, 49152
  buffer_load_dwordx4 v[216:219], v2, s[36:39], s42 offen offset:0 nt
  s_waitcnt vmcnt(23)
  s_cmp_lg_u32 s15, 0
  s_cbranch_scc1 L_par_101
  s_waitcnt vmcnt(13)
L_par_101:
  buffer_load_dwordx4 v[220:223], v2, s[36:39], s42 offen offset:384 nt
  s_waitcnt vmcnt(23)
  s_cmp_lg_u32 s15, 0
  s_cbranch_scc1 L_par_102
  s_waitcnt vmcnt(13)
L_par_102:
  buffer_load_dwordx4 v[224:227], v3, s[36:39], s42 offen offset:0 nt
  s_waitcnt vmcnt(23)
  s_cmp_lg_u32 s15, 0
  s_cbranch_scc1 L_par_103
  s_waitcnt vmcnt(13)
L_par_103:
  s_add_u32 s42, s40, 52224
  buffer_load_dwordx4 v[228:231], v2, s[36:39], s42 offen offset:0 nt
  s_waitcnt vmcnt(23)
  s_cmp_lg_u32 s15, 0
  s_cbranch_scc1 L_par_104
  s_waitcnt vmcnt(13)
L_par_104:
  buffer_load_dwordx4 v[232:235], v2, s[36:39], s42 offen offset:384 nt
  s_waitcnt vmcnt(23)
  s_cmp_lg_u32 s15, 0
  s_cbranch_scc1 L_par_105
  s_waitcnt vmcnt(13)
L_par_105:
  buffer_load_dwordx4 v[236:239], v3, s[36:39], s42 offen offset:0 nt
  s_waitcnt vmcnt(23)
  s_cmp_lg_u32 s15, 0
  s_cbranch_scc1 L_par_106
  s_waitcnt vmcnt(13)
L_par_106:
  s_add_u32 s42, s40, 55296
  buffer_load_dwordx4 v[240:243], v2, s[36:39], s42 offen offset:0 nt
  s_waitcnt vmcnt(23)
  s_cmp_lg_u32 s15, 0
  s_cbranch_scc1 L_par_107
  s_waitcnt vmcnt(13)
L_par_107:
  buffer_load_dwordx4 v[244:247], v2, s[36:39], s42 offen offset:384 nt
  s_waitcnt vmcnt(23)
  s_cmp_lg_u32 s15, 0
  s_cbranch_scc1 L_par_108
  s_waitcnt vmcnt(13)
L_par_108:
  buffer_load_dwordx4 v[248:251], v3, s[36:39], s42 offen offset:0 nt
  s_waitcnt vmcnt(23)
  s_cmp_lg_u32 s15, 0
  s_cbranch_scc1 L_par_109
  s_waitcnt vmcnt(13)
L_par_109:
  s_add_u32 s42, s40, 58368
  buffer_load_dwordx4 v[252:255], v2, s[36:39], s42 offen offset:0 nt
  s_waitcnt vmcnt(23)
  s_cmp_lg_u32 s15, 0
  s_cbranch_scc1 L_par_110
  s_waitcnt vmcnt(13)
L_par_110:
  s_add_u32 m0, s43, 48768
  s_nop 0
  buffer_load_dwordx4 v2, s[36:39], s42 offen offset:384 nt lds
  s_waitcnt vmcnt(23)
  s_cmp_lg_u32 s15, 0
  s_cbranch_scc1 L_par_111
  s_waitcnt vmcnt(13)
L_par_111:
  s_add_u32 m0, s43, 50176
  s_nop 0
  buffer_load_dwordx4 v3, s[36:39], s42 offen offset:0 nt lds
  v_mbcnt_lo_u32_b32 v20, -1, 0
  v_mbcnt_hi_u32_b32 v20, -1, v20
  v_and_b32 v21, 1, v20
  v_lshrrev_b32 v22, 4, v20
  v_lshlrev_b32 v22, 4, v22
  v_lshl_add_u32 v21, v21, 6, v22
  v_add_u32 v21, 159808, v21
  v_add_u32 v36, s69, v22
  v_lshrrev_b32 v22, 5, v20
  v_lshlrev_b32 v35, 6, v22
  v_bfe_u32 v22, v20, 1, 2
  v_lshl_add_u32 v35, v22, 4, v35
  v_bfe_u32 v22, v20, 3, 2
  v_lshl_add_u32 v35, v22, 2, v35
  v_and_b32 v22, 1, v20
  v_lshl_add_u32 v35, v22, 1, v35
  v_add_u32 v35, s69, v35
  v_mov_b32 v34, 0xff800000
  s_barrier
  ds_read_b128 v[8:11], v21 offset:0
  ds_read_b128 v[12:15], v21 offset:128
  ds_read_b128 v[16:19], v21 offset:256
  s_waitcnt lgkmcnt(0)
  v_mfma_f32_16x16x32_bf16 v[20:23], v[8:11], a[0:3], 0
  v_mfma_f32_16x16x32_bf16 v[20:23], v[12:15], a[4:7], v[20:23]
  v_mfma_f32_16x16x32_bf16 v[20:23], v[16:19], a[8:11], v[20:23]
  v_mfma_f32_16x16x32_bf16 v[24:27], v[8:11], a[12:15], 0
  v_mfma_f32_16x16x32_bf16 v[24:27], v[12:15], a[16:19], v[24:27]
  v_mfma_f32_16x16x32_bf16 v[24:27], v[16:19], a[20:23], v[24:27]
  v_mfma_f32_16x16x32_bf16 v[28:31], v[8:11], a[24:27], 0
  v_mfma_f32_16x16x32_bf16 v[28:31], v[12:15], a[28:31], v[28:31]
  v_mfma_f32_16x16x32_bf16 v[28:31], v[16:19], a[32:35], v[28:31]
  s_nop 1
  v_add_f32_dpp v32, v21, v20 row_ror:8 row_mask:0x1 bank_mask:0x3
  v_mfma_f32_16x16x32_bf16 v[20:23], v[8:11], a[36:39], 0
  v_mfma_f32_16x16x32_bf16 v[20:23], v[12:15], a[40:43], v[20:23]
  v_mfma_f32_16x16x32_bf16 v[20:23], v[16:19], a[44:47], v[20:23]
  v_add_f32_dpp v32, v24, v25 row_ror:8 row_mask:0x1 bank_mask:0xc
  v_mfma_f32_16x16x32_bf16 v[24:27], v[8:11], a[48:51], 0
  v_mfma_f32_16x16x32_bf16 v[24:27], v[12:15], a[52:55], v[24:27]
  v_mfma_f32_16x16x32_bf16 v[24:27], v[16:19], a[56:59], v[24:27]
  v_add_f32_dpp v32, v29, v28 row_ror:8 row_mask:0x2 bank_mask:0x3
  v_mfma_f32_16x16x32_bf16 v[28:31], v[8:11], a[60:63], 0
  v_mfma_f32_16x16x32_bf16 v[28:31], v[12:15], a[64:67], v[28:31]
  v_mfma_f32_16x16x32_bf16 v[28:31], v[16:19], a[68:71], v[28:31]
  v_add_f32_dpp v32, v20, v21 row_ror:8 row_mask:0x2 bank_mask:0xc
  v_mfma_f32_16x16x32_bf16 v[20:23], v[8:11], a[72:75], 0
  v_mfma_f32_16x16x32_bf16 v[20:23], v[12:15], a[76:79], v[20:23]
  v_mfma_f32_16x16x32_bf16 v[20:23], v[16:19], a[80:83], v[20:23]
  v_add_f32_dpp v32, v25, v24 row_ror:8 row_mask:0x4 bank_mask:0x3
  v_mfma_f32_16x16x32_bf16 v[24:27], v[8:11], a[84:87], 0
  v_mfma_f32_16x16x32_bf16 v[24:27], v[12:15], a[88:91], v[24:27]
  v_mfma_f32_16x16x32_bf16 v[24:27], v[16:19], a[92:95], v[24:27]
  v_add_f32_dpp v32, v28, v29 row_ror:8 row_mask:0x4 bank_mask:0xc
  v_mfma_f32_16x16x32_bf16 v[28:31], v[8:11], a[96:99], 0
  v_mfma_f32_16x16x32_bf16 v[28:31], v[12:15], a[100:103], v[28:31]
  v_mfma_f32_16x16x32_bf16 v[28:31], v[16:19], a[104:107], v[28:31]
  v_add_f32_dpp v32, v21, v20 row_ror:8 row_mask:0x8 bank_mask:0x3
  v_mfma_f32_16x16x32_bf16 v[20:23], v[8:11], a[108:111], 0
  v_mfma_f32_16x16x32_bf16 v[20:23], v[12:15], a[112:115], v[20:23]
  v_mfma_f32_16x16x32_bf16 v[20:23], v[16:19], a[116:119], v[20:23]
  v_add_f32_dpp v32, v24, v25 row_ror:8 row_mask:0x8 bank_mask:0xc
  v_mfma_f32_16x16x32_bf16 v[24:27], v[8:11], a[120:123], 0
  v_mfma_f32_16x16x32_bf16 v[24:27], v[12:15], a[124:127], v[24:27]
  v_mfma_f32_16x16x32_bf16 v[24:27], v[16:19], a[128:131], v[24:27]
  v_add_f32_dpp v33, v29, v28 row_ror:8 row_mask:0x1 bank_mask:0x3
  v_mfma_f32_16x16x32_bf16 v[28:31], v[8:11], a[132:135], 0
  v_mfma_f32_16x16x32_bf16 v[28:31], v[12:15], a[136:139], v[28:31]
  v_mfma_f32_16x16x32_bf16 v[28:31], v[16:19], a[140:143], v[28:31]
  v_add_f32_dpp v33, v20, v21 row_ror:8 row_mask:0x1 bank_mask:0xc
  v_mfma_f32_16x16x32_bf16 v[20:23], v[8:11], a[144:147], 0
  v_mfma_f32_16x16x32_bf16 v[20:23], v[12:15], a[148:151], v[20:23]
  v_mfma_f32_16x16x32_bf16 v[20:23], v[16:19], a[152:155], v[20:23]
  v_add_f32_dpp v33, v25, v24 row_ror:8 row_mask:0x2 bank_mask:0x3
  v_mfma_f32_16x16x32_bf16 v[24:27], v[8:11], a[156:159], 0
  v_mfma_f32_16x16x32_bf16 v[24:27], v[12:15], a[160:163], v[24:27]
  v_mfma_f32_16x16x32_bf16 v[24:27], v[16:19], a[164:167], v[24:27]
  v_add_f32_dpp v33, v28, v29 row_ror:8 row_mask:0x2 bank_mask:0xc
  v_mfma_f32_16x16x32_bf16 v[28:31], v[8:11], a[168:171], 0
  v_mfma_f32_16x16x32_bf16 v[28:31], v[12:15], a[172:175], v[28:31]
  v_mfma_f32_16x16x32_bf16 v[28:31], v[16:19], a[176:179], v[28:31]
  v_add_f32_dpp v33, v21, v20 row_ror:8 row_mask:0x4 bank_mask:0x3
  v_mfma_f32_16x16x32_bf16 v[20:23], v[8:11], a[180:183], 0
  v_mfma_f32_16x16x32_bf16 v[20:23], v[12:15], a[184:187], v[20:23]
  v_mfma_f32_16x16x32_bf16 v[20:23], v[16:19], a[188:191], v[20:23]
  v_add_f32_dpp v33, v24, v25 row_ror:8 row_mask:0x4 bank_mask:0xc
  v_mfma_f32_16x16x32_bf16 v[24:27], v[8:11], a[192:195], 0
  v_mfma_f32_16x16x32_bf16 v[24:27], v[12:15], a[196:199], v[24:27]
  v_mfma_f32_16x16x32_bf16 v[24:27], v[16:19], a[200:203], v[24:27]
  v_add_f32_dpp v33, v29, v28 row_ror:8 row_mask:0x8 bank_mask:0x3
  v_mfma_f32_16x16x32_bf16 v[28:31], v[8:11], a[204:207], 0
  v_mfma_f32_16x16x32_bf16 v[28:31], v[12:15], a[208:211], v[28:31]
  v_mfma_f32_16x16x32_bf16 v[28:31], v[16:19], a[212:215], v[28:31]
  v_add_f32_dpp v33, v20, v21 row_ror:8 row_mask:0x8 bank_mask:0xc
  v_mfma_f32_16x16x32_bf16 v[20:23], v[8:11], a[216:219], 0
  v_mfma_f32_16x16x32_bf16 v[20:23], v[12:15], a[220:223], v[20:23]
  v_mfma_f32_16x16x32_bf16 v[20:23], v[16:19], a[224:227], v[20:23]
  v_add_f32_dpp v34, v25, v24 row_ror:8 row_mask:0x1 bank_mask:0x3
  v_mfma_f32_16x16x32_bf16 v[24:27], v[8:11], a[228:231], 0
  v_mfma_f32_16x16x32_bf16 v[24:27], v[12:15], a[232:235], v[24:27]
  v_mfma_f32_16x16x32_bf16 v[24:27], v[16:19], a[236:239], v[24:27]
  v_add_f32_dpp v34, v28, v29 row_ror:8 row_mask:0x1 bank_mask:0xc
  s_nop 2
  v_add_f32_dpp v34, v21, v20 row_ror:8 row_mask:0x2 bank_mask:0x3
  s_nop 2
  v_add_f32_dpp v34, v24, v25 row_ror:8 row_mask:0x2 bank_mask:0xc
  v_max3_f32 v20, v32, v33, v34
  s_nop 1
  v_max_f32_dpp v20, v20, v20 row_ror:8 row_mask:0xf bank_mask:0xf
  s_nop 1
  v_max_f32_dpp v20, v20, v20 row_ror:4 row_mask:0xf bank_mask:0xf
  s_nop 1
  v_max_f32_dpp v20, v20, v20 row_ror:2 row_mask:0xf bank_mask:0xf
  s_nop 1
  v_max_f32_dpp v20, v20, v20 row_ror:1 row_mask:0xf bank_mask:0xf
  v_mov_b32 v21, v20
  s_nop 1
  v_permlane16_swap_b32 v20, v21
  v_max_f32 v20, v20, v21
  v_mov_b32 v21, v20
  s_nop 1
  v_permlane32_swap_b32 v20, v21
  v_max_f32 v20, v20, v21
  v_mul_f32 v38, s56, v20
  v_fma_f32 v32, v32, s56, -v38
  v_fma_f32 v33, v33, s56, -v38
  v_fma_f32 v34, v34, s56, -v38
  v_exp_f32 v32, v32
  v_exp_f32 v33, v33
  v_exp_f32 v34, v34
  v_cvt_pk_bf16_f32 v22, v32, v32
  v_cvt_pk_bf16_f32 v23, v33, v33
  v_cvt_pk_bf16_f32 v24, v34, v34
  ds_write_b16 v35, v22 offset:0
  ds_write_b16 v35, v23 offset:128
  ds_write_b16 v35, v24 offset:256
  v_add_f32 v39, v32, v33
  v_add_f32 v39, v39, v34
  ds_read_b128 v[28:31], v36
  ds_read_b128 v[32:35], v36 offset:64
  s_waitcnt lgkmcnt(1)
  v_perm_b32 v20, v28, v28, v4
  v_perm_b32 v21, v28, v28, v5
  v_perm_b32 v22, v28, v28, v6
  v_perm_b32 v23, v28, v28, v7
  s_nop 1
  v_mfma_f32_16x16x32_bf16 v[8:11], v[20:23], a[240:243], 0
  v_perm_b32 v24, v29, v29, v4
  v_perm_b32 v25, v29, v29, v5
  v_mfma_f32_16x16x32_bf16 v[12:15], v[20:23], a[244:247], 0
  v_perm_b32 v26, v29, v29, v6
  v_perm_b32 v27, v29, v29, v7
  v_mfma_f32_16x16x32_bf16 v[16:19], v[20:23], a[248:251], 0
  s_nop 0
  v_mfma_f32_16x16x32_bf16 v[8:11], v[24:27], a[252:255], v[8:11]
  v_perm_b32 v20, v30, v30, v4
  v_perm_b32 v21, v30, v30, v5
  v_mfma_f32_16x16x32_bf16 v[12:15], v[24:27], v[40:43], v[12:15]
  v_perm_b32 v22, v30, v30, v6
  v_perm_b32 v23, v30, v30, v7
  v_mfma_f32_16x16x32_bf16 v[16:19], v[24:27], v[44:47], v[16:19]
  v_add_f32_dpp v39, v39, v39 row_ror:8 row_mask:0xf bank_mask:0xf
  v_mfma_f32_16x16x32_bf16 v[8:11], v[20:23], v[48:51], v[8:11]
  v_perm_b32 v24, v31, v31, v4
  v_perm_b32 v25, v31, v31, v5
  v_mfma_f32_16x16x32_bf16 v[12:15], v[20:23], v[52:55], v[12:15]
  v_perm_b32 v26, v31, v31, v6
  v_perm_b32 v27, v31, v31, v7
  v_mfma_f32_16x16x32_bf16 v[16:19], v[20:23], v[56:59], v[16:19]
  ds_read_b128 v[28:31], v36 offset:128
  v_add_f32_dpp v39, v39, v39 row_ror:4 row_mask:0xf bank_mask:0xf
  s_waitcnt lgkmcnt(1)
  v_mfma_f32_16x16x32_bf16 v[8:11], v[24:27], v[60:63], v[8:11]
  v_perm_b32 v20, v32, v32, v4
  v_perm_b32 v21, v32, v32, v5
  v_mfma_f32_16x16x32_bf16 v[12:15], v[24:27], v[64:67], v[12:15]
  v_perm_b32 v22, v32, v32, v6
  v_perm_b32 v23, v32, v32, v7
  v_mfma_f32_16x16x32_bf16 v[16:19], v[24:27], v[68:71], v[16:19]
  v_add_f32_dpp v39, v39, v39 row_ror:2 row_mask:0xf bank_mask:0xf
  v_mfma_f32_16x16x32_bf16 v[8:11], v[20:23], v[72:75], v[8:11]
  v_perm_b32 v24, v33, v33, v4
  v_perm_b32 v25, v33, v33, v5
  v_mfma_f32_16x16x32_bf16 v[12:15], v[20:23], v[76:79], v[12:15]
  v_perm_b32 v26, v33, v33, v6
  v_perm_b32 v27, v33, v33, v7
  v_mfma_f32_16x16x32_bf16 v[16:19], v[20:23], v[80:83], v[16:19]
  v_add_f32_dpp v39, v39, v39 row_ror:1 row_mask:0xf bank_mask:0xf
  v_mfma_f32_16x16x32_bf16 v[8:11], v[24:27], v[84:87], v[8:11]
  v_perm_b32 v20, v34, v34, v4
  v_perm_b32 v21, v34, v34, v5
  v_mfma_f32_16x16x32_bf16 v[12:15], v[24:27], v[88:91], v[12:15]
  v_perm_b32 v22, v34, v34, v6
  v_perm_b32 v23, v34, v34, v7
  v_mfma_f32_16x16x32_bf16 v[16:19], v[24:27], v[92:95], v[16:19]
  v_mov_b32 v37, v39
  v_mfma_f32_16x16x32_bf16 v[8:11], v[20:23], v[96:99], v[8:11]
  v_perm_b32 v24, v35, v35, v4
  v_perm_b32 v25, v35, v35, v5
  v_mfma_f32_16x16x32_bf16 v[12:15], v[20:23], v[100:103], v[12:15]
  v_perm_b32 v26, v35, v35, v6
  v_perm_b32 v27, v35, v35, v7
  v_mfma_f32_16x16x32_bf16 v[16:19], v[20:23], v[104:107], v[16:19]
  ds_read_b128 v[32:35], v36 offset:192
  v_permlane16_swap_b32 v39, v37
  s_waitcnt lgkmcnt(1)
  v_mfma_f32_16x16x32_bf16 v[8:11], v[24:27], v[108:111], v[8:11]
  v_perm_b32 v20, v28, v28, v4
  v_perm_b32 v21, v28, v28, v5
  v_mfma_f32_16x16x32_bf16 v[12:15], v[24:27], v[112:115], v[12:15]
  v_perm_b32 v22, v28, v28, v6
  v_perm_b32 v23, v28, v28, v7
  v_mfma_f32_16x16x32_bf16 v[16:19], v[24:27], v[116:119], v[16:19]
  v_add_f32 v39, v39, v37
  v_mfma_f32_16x16x32_bf16 v[8:11], v[20:23], v[120:123], v[8:11]
  v_perm_b32 v24, v29, v29, v4
  v_perm_b32 v25, v29, v29, v5
  v_mfma_f32_16x16x32_bf16 v[12:15], v[20:23], v[124:127], v[12:15]
  v_perm_b32 v26, v29, v29, v6
  v_perm_b32 v27, v29, v29, v7
  v_mfma_f32_16x16x32_bf16 v[16:19], v[20:23], v[128:131], v[16:19]
  v_mov_b32 v37, v39
  v_mfma_f32_16x16x32_bf16 v[8:11], v[24:27], v[132:135], v[8:11]
  v_perm_b32 v20, v30, v30, v4
  v_perm_b32 v21, v30, v30, v5
  v_mfma_f32_16x16x32_bf16 v[12:15], v[24:27], v[136:139], v[12:15]
  v_perm_b32 v22, v30, v30, v6
  v_perm_b32 v23, v30, v30, v7
  v_mfma_f32_16x16x32_bf16 v[16:19], v[24:27], v[140:143], v[16:19]
  v_permlane32_swap_b32 v39, v37
  v_mfma_f32_16x16x32_bf16 v[8:11], v[20:23], v[144:147], v[8:11]
  v_perm_b32 v24, v31, v31, v4
  v_perm_b32 v25, v31, v31, v5
  v_mfma_f32_16x16x32_bf16 v[12:15], v[20:23], v[148:151], v[12:15]
  v_perm_b32 v26, v31, v31, v6
  v_perm_b32 v27, v31, v31, v7
  v_mfma_f32_16x16x32_bf16 v[16:19], v[20:23], v[152:155], v[16:19]
  ds_read_b128 v[28:31], v36 offset:256
  v_add_f32 v39, v39, v37
  s_waitcnt lgkmcnt(1)
  v_mfma_f32_16x16x32_bf16 v[8:11], v[24:27], v[156:159], v[8:11]
  v_perm_b32 v20, v32, v32, v4
  v_perm_b32 v21, v32, v32, v5
  v_mfma_f32_16x16x32_bf16 v[12:15], v[24:27], v[160:163], v[12:15]
  v_perm_b32 v22, v32, v32, v6
  v_perm_b32 v23, v32, v32, v7
  v_mfma_f32_16x16x32_bf16 v[16:19], v[24:27], v[164:167], v[16:19]
  s_waitcnt vmcnt(23)
  v_mfma_f32_16x16x32_bf16 v[8:11], v[20:23], v[168:171], v[8:11]
  v_perm_b32 v24, v33, v33, v4
  v_perm_b32 v25, v33, v33, v5
  s_waitcnt vmcnt(22)
  v_mfma_f32_16x16x32_bf16 v[12:15], v[20:23], v[172:175], v[12:15]
  v_perm_b32 v26, v33, v33, v6
  v_perm_b32 v27, v33, v33, v7
  s_waitcnt vmcnt(21)
  v_mfma_f32_16x16x32_bf16 v[16:19], v[20:23], v[176:179], v[16:19]
  s_add_u32 s42, s41, 0
  s_add_u32 m0, s43, 0
  s_nop 0
  buffer_load_dwordx4 v1, s[32:35], s42 offen offset:0 nt lds
  s_add_u32 m0, s43, 896
  s_nop 0
  buffer_load_dwordx4 v1, s[32:35], s42 offen offset:128 nt lds
  s_add_u32 m0, s43, 1792
  s_nop 0
  buffer_load_dwordx4 v1, s[32:35], s42 offen offset:256 nt lds
  s_waitcnt vmcnt(23)
  v_mfma_f32_16x16x32_bf16 v[8:11], v[24:27], v[180:183], v[8:11]
  v_perm_b32 v20, v34, v34, v4
  v_perm_b32 v21, v34, v34, v5
  s_waitcnt vmcnt(22)
  v_mfma_f32_16x16x32_bf16 v[12:15], v[24:27], v[184:187], v[12:15]
  v_perm_b32 v22, v34, v34, v6
  v_perm_b32 v23, v34, v34, v7
  s_waitcnt vmcnt(21)
  v_mfma_f32_16x16x32_bf16 v[16:19], v[24:27], v[188:191], v[16:19]
  s_add_u32 s42, s41, 3072
  s_add_u32 m0, s43, 3072
  s_nop 0
  buffer_load_dwordx4 v1, s[32:35], s42 offen offset:0 nt lds
  s_add_u32 m0, s43, 3968
  s_nop 0
  buffer_load_dwordx4 v1, s[32:35], s42 offen offset:128 nt lds
  s_add_u32 m0, s43, 4864
  s_nop 0
  buffer_load_dwordx4 v1, s[32:35], s42 offen offset:256 nt lds
  s_waitcnt vmcnt(23)
  v_mfma_f32_16x16x32_bf16 v[8:11], v[20:23], v[192:195], v[8:11]
  v_perm_b32 v24, v35, v35, v4
  v_perm_b32 v25, v35, v35, v5
  s_waitcnt vmcnt(22)
  v_mfma_f32_16x16x32_bf16 v[12:15], v[20:23], v[196:199], v[12:15]
  v_perm_b32 v26, v35, v35, v6
  v_perm_b32 v27, v35, v35, v7
  s_waitcnt vmcnt(21)
  v_mfma_f32_16x16x32_bf16 v[16:19], v[20:23], v[200:203], v[16:19]
  s_add_u32 s42, s41, 6144
  s_add_u32 m0, s43, 6144
  s_nop 0
  buffer_load_dwordx4 v1, s[32:35], s42 offen offset:0 nt lds
  s_add_u32 m0, s43, 7040
  s_nop 0
  buffer_load_dwordx4 v1, s[32:35], s42 offen offset:128 nt lds
  s_waitcnt lgkmcnt(0)
  s_waitcnt vmcnt(22)
  v_mfma_f32_16x16x32_bf16 v[8:11], v[24:27], v[204:207], v[8:11]
  v_perm_b32 v20, v28, v28, v4
  v_perm_b32 v21, v28, v28, v5
  s_waitcnt vmcnt(21)
  v_mfma_f32_16x16x32_bf16 v[12:15], v[24:27], v[208:211], v[12:15]
  v_perm_b32 v22, v28, v28, v6
  v_perm_b32 v23, v28, v28, v7
  s_waitcnt vmcnt(20)
  v_mfma_f32_16x16x32_bf16 v[16:19], v[24:27], v[212:215], v[16:19]
  s_waitcnt vmcnt(19)
  v_mfma_f32_16x16x32_bf16 v[8:11], v[20:23], v[216:219], v[8:11]
  v_perm_b32 v24, v29, v29, v4
  v_perm_b32 v25, v29, v29, v5
  s_waitcnt vmcnt(18)
  v_mfma_f32_16x16x32_bf16 v[12:15], v[20:23], v[220:223], v[12:15]
  v_perm_b32 v26, v29, v29, v6
  v_perm_b32 v27, v29, v29, v7
  s_waitcnt vmcnt(17)
  v_mfma_f32_16x16x32_bf16 v[16:19], v[20:23], v[224:227], v[16:19]
  s_waitcnt vmcnt(16)
  v_mfma_f32_16x16x32_bf16 v[8:11], v[24:27], v[228:231], v[8:11]
  v_perm_b32 v20, v30, v30, v4
  v_perm_b32 v21, v30, v30, v5
  s_waitcnt vmcnt(15)
  v_mfma_f32_16x16x32_bf16 v[12:15], v[24:27], v[232:235], v[12:15]
  v_perm_b32 v22, v30, v30, v6
  v_perm_b32 v23, v30, v30, v7
  s_waitcnt vmcnt(14)
  v_mfma_f32_16x16x32_bf16 v[16:19], v[24:27], v[236:239], v[16:19]
  s_waitcnt vmcnt(13)
  v_mfma_f32_16x16x32_bf16 v[8:11], v[20:23], v[240:243], v[8:11]
  v_perm_b32 v24, v31, v31, v4
  v_perm_b32 v25, v31, v31, v5
  s_waitcnt vmcnt(12)
  v_mfma_f32_16x16x32_bf16 v[12:15], v[20:23], v[244:247], v[12:15]
  v_perm_b32 v26, v31, v31, v6
  v_perm_b32 v27, v31, v31, v7
  s_waitcnt vmcnt(11)
  v_mfma_f32_16x16x32_bf16 v[16:19], v[20:23], v[248:251], v[16:19]
  s_waitcnt vmcnt(8)
  ds_read_b128 v[32:35], v0 offset:49152
  ds_read_b128 v[28:31], v0 offset:50176
  v_mfma_f32_16x16x32_bf16 v[8:11], v[24:27], v[252:255], v[8:11]
  s_waitcnt lgkmcnt(1)
  v_mfma_f32_16x16x32_bf16 v[12:15], v[24:27], v[32:35], v[12:15]
  s_waitcnt lgkmcnt(0)
  v_mfma_f32_16x16x32_bf16 v[16:19], v[24:27], v[28:31], v[16:19]
  v_mbcnt_lo_u32_b32 v28, -1, 0
  v_mbcnt_hi_u32_b32 v28, -1, v28
  v_and_b32 v29, 15, v28
  v_lshrrev_b32 v30, 4, v28
  v_and_b32 v31, 1, v30
  v_lshrrev_b32 v30, 1, v30
  v_mul_u32_u24 v30, 768, v30
  v_lshl_add_u32 v30, v31, 4, v30
  v_add_u32 v30, s69, v30
  v_lshl_add_u32 v32, v29, 5, v30
  v_and_b32 v29, 7, v29
  v_lshl_add_u32 v33, v29, 5, v30
  v_mov_b32 v34, s72
  v_mov_b32 v20, v38
  v_mov_b32 v21, v39
  v_cndmask_b32 v8, v8, v12, s[70:71]
  v_cndmask_b32 v9, v9, v13, s[70:71]
  v_cndmask_b32 v10, v10, v14, s[70:71]
  v_cndmask_b32 v11, v11, v15, s[70:71]
  ds_write_b128 v32, v[8:11]
  s_mov_b32 exec_lo, 0x00ff00ff
  s_mov_b32 exec_hi, 0xff00ff00
  ds_write_b128 v33, v[16:19] offset:512
  s_mov_b64 exec, 1
  ds_write_b64 v34, v[20:21] offset:0
  s_mov_b64 exec, -1
  s_waitcnt lgkmcnt(0)
  s_barrier
  s_waitcnt vmcnt(7)
  s_add_u32 m0, s43, 7936
  s_nop 0
  buffer_load_dwordx4 v1, s[32:35], s42 offen offset:256 nt lds
  s_waitcnt vmcnt(7)
  s_add_u32 s42, s41, 9216
  s_add_u32 m0, s43, 9216
  s_nop 0
  buffer_load_dwordx4 v1, s[32:35], s42 offen offset:0 nt lds
  s_waitcnt vmcnt(7)
  s_add_u32 m0, s43, 10112
  s_nop 0
  buffer_load_dwordx4 v1, s[32:35], s42 offen offset:128 nt lds
  s_waitcnt vmcnt(7)
  s_add_u32 m0, s43, 11008
  s_nop 0
  buffer_load_dwordx4 v1, s[32:35], s42 offen offset:256 nt lds
  s_waitcnt vmcnt(7)
  s_add_u32 s42, s41, 12288
  s_add_u32 m0, s43, 12288
  s_nop 0
  buffer_load_dwordx4 v1, s[32:35], s42 offen offset:0 nt lds
  s_waitcnt vmcnt(7)
  s_add_u32 m0, s43, 13184
  s_nop 0
  buffer_load_dwordx4 v1, s[32:35], s42 offen offset:128 nt lds
  s_waitcnt vmcnt(7)
  s_add_u32 m0, s43, 14080
  s_nop 0
  buffer_load_dwordx4 v1, s[32:35], s42 offen offset:256 nt lds
  s_waitcnt vmcnt(7)
  s_add_u32 s42, s41, 15360
  s_add_u32 m0, s43, 15360
  s_nop 0
  buffer_load_dwordx4 v1, s[32:35], s42 offen offset:0 nt lds
  s_waitcnt vmcnt(7)
  s_add_u32 m0, s43, 16256
  s_nop 0
  buffer_load_dwordx4 v1, s[32:35], s42 offen offset:128 nt lds
  s_waitcnt vmcnt(7)
  s_add_u32 m0, s43, 17152
  s_nop 0
  buffer_load_dwordx4 v1, s[32:35], s42 offen offset:256 nt lds
  s_waitcnt vmcnt(7)
  s_add_u32 s42, s41, 18432
  s_add_u32 m0, s43, 18432
  s_nop 0
  buffer_load_dwordx4 v1, s[32:35], s42 offen offset:0 nt lds
  s_waitcnt vmcnt(7)
  s_add_u32 m0, s43, 19328
  s_nop 0
  buffer_load_dwordx4 v1, s[32:35], s42 offen offset:128 nt lds
  s_waitcnt vmcnt(7)
  s_add_u32 m0, s43, 20224
  s_nop 0
  buffer_load_dwordx4 v1, s[32:35], s42 offen offset:256 nt lds
  s_waitcnt vmcnt(7)
  s_add_u32 s42, s41, 21504
  s_add_u32 m0, s43, 21504
  s_nop 0
  buffer_load_dwordx4 v1, s[32:35], s42 offen offset:0 nt lds
  s_waitcnt vmcnt(7)
  s_add_u32 m0, s43, 22400
  s_nop 0
  buffer_load_dwordx4 v1, s[32:35], s42 offen offset:128 nt lds
  s_waitcnt vmcnt(7)
  s_add_u32 m0, s43, 23296
  s_nop 0
  buffer_load_dwordx4 v1, s[32:35], s42 offen offset:256 nt lds
  s_waitcnt vmcnt(7)
  s_add_u32 s42, s41, 24576
  s_add_u32 m0, s43, 24576
  s_nop 0
  buffer_load_dwordx4 v1, s[32:35], s42 offen offset:0 nt lds
  s_waitcnt vmcnt(7)
  s_add_u32 m0, s43, 25472
  s_nop 0
  buffer_load_dwordx4 v1, s[32:35], s42 offen offset:128 nt lds
  s_waitcnt vmcnt(7)
  s_add_u32 m0, s43, 26368
  s_nop 0
  buffer_load_dwordx4 v1, s[32:35], s42 offen offset:256 nt lds
  s_waitcnt vmcnt(7)
  s_add_u32 s42, s41, 27648
  s_add_u32 m0, s43, 27648
  s_nop 0
  buffer_load_dwordx4 v1, s[32:35], s42 offen offset:0 nt lds
  s_waitcnt vmcnt(7)
  s_add_u32 m0, s43, 28544
  s_nop 0
  buffer_load_dwordx4 v1, s[32:35], s42 offen offset:128 nt lds
  s_waitcnt vmcnt(7)
  s_add_u32 m0, s43, 29440
  s_nop 0
  buffer_load_dwordx4 v1, s[32:35], s42 offen offset:256 nt lds
  s_waitcnt vmcnt(7)
  s_add_u32 s42, s41, 30720
  s_add_u32 m0, s43, 30720
  s_nop 0
  buffer_load_dwordx4 v1, s[32:35], s42 offen offset:0 nt lds
  s_waitcnt vmcnt(7)
  s_add_u32 m0, s43, 31616
  s_nop 0
  buffer_load_dwordx4 v1, s[32:35], s42 offen offset:128 nt lds
  s_waitcnt vmcnt(7)
  s_add_u32 m0, s43, 32512
  s_nop 0
  buffer_load_dwordx4 v1, s[32:35], s42 offen offset:256 nt lds
  s_waitcnt vmcnt(7)
  s_add_u32 s42, s41, 33792
  s_add_u32 m0, s43, 33792
  s_nop 0
  buffer_load_dwordx4 v1, s[32:35], s42 offen offset:0 nt lds
  s_waitcnt vmcnt(7)
  s_add_u32 m0, s43, 34688
  s_nop 0
  buffer_load_dwordx4 v1, s[32:35], s42 offen offset:128 nt lds
  s_waitcnt vmcnt(7)
  s_add_u32 m0, s43, 35584
  s_nop 0
  buffer_load_dwordx4 v1, s[32:35], s42 offen offset:256 nt lds
  s_waitcnt vmcnt(7)
  s_add_u32 s42, s41, 36864
  s_add_u32 m0, s43, 36864
  s_nop 0
  buffer_load_dwordx4 v1, s[32:35], s42 offen offset:0 nt lds
  s_waitcnt vmcnt(7)
  s_add_u32 m0, s43, 37760
  s_nop 0
  buffer_load_dwordx4 v1, s[32:35], s42 offen offset:128 nt lds
  s_waitcnt vmcnt(7)
  s_add_u32 m0, s43, 38656
  s_nop 0
  buffer_load_dwordx4 v1, s[32:35], s42 offen offset:256 nt lds
  s_waitcnt vmcnt(7)
  s_add_u32 s42, s41, 39936
  s_add_u32 m0, s43, 39936
  s_nop 0
  buffer_load_dwordx4 v1, s[32:35], s42 offen offset:0 nt lds
  s_waitcnt vmcnt(7)
  s_add_u32 m0, s43, 40832
  s_nop 0
  buffer_load_dwordx4 v1, s[32:35], s42 offen offset:128 nt lds
  s_waitcnt vmcnt(7)
  s_add_u32 m0, s43, 41728
  s_nop 0
  buffer_load_dwordx4 v1, s[32:35], s42 offen offset:256 nt lds
  s_waitcnt vmcnt(7)
  s_add_u32 s42, s41, 43008
  s_add_u32 m0, s43, 43008
  s_nop 0
  buffer_load_dwordx4 v1, s[32:35], s42 offen offset:0 nt lds
  s_waitcnt vmcnt(7)
  s_add_u32 m0, s43, 43904
  s_nop 0
  buffer_load_dwordx4 v1, s[32:35], s42 offen offset:128 nt lds
  s_waitcnt vmcnt(7)
  s_add_u32 m0, s43, 44800
  s_nop 0
  buffer_load_dwordx4 v1, s[32:35], s42 offen offset:256 nt lds
  s_waitcnt vmcnt(7)
  s_add_u32 s42, s41, 46080
  s_add_u32 m0, s43, 46080
  s_nop 0
  buffer_load_dwordx4 v1, s[32:35], s42 offen offset:0 nt lds
  s_waitcnt vmcnt(7)
  s_add_u32 m0, s43, 46976
  s_nop 0
  buffer_load_dwordx4 v1, s[32:35], s42 offen offset:128 nt lds
  s_waitcnt vmcnt(7)
  s_add_u32 m0, s43, 47872
  s_nop 0
  buffer_load_dwordx4 v1, s[32:35], s42 offen offset:256 nt lds
  v_mbcnt_lo_u32_b32 v20, -1, 0
  v_mbcnt_hi_u32_b32 v20, -1, v20
  v_and_b32 v21, 1, v20
  v_lshrrev_b32 v22, 4, v20
  v_lshlrev_b32 v22, 4, v22
  v_lshl_add_u32 v21, v21, 6, v22
  v_add_u32 v21, 159808, v21
  v_add_u32 v36, s69, v22
  v_lshrrev_b32 v22, 5, v20
  v_lshlrev_b32 v35, 6, v22
  v_bfe_u32 v22, v20, 1, 2
  v_lshl_add_u32 v35, v22, 4, v35
  v_bfe_u32 v22, v20, 3, 2
  v_lshl_add_u32 v35, v22, 2, v35
  v_and_b32 v22, 1, v20
  v_lshl_add_u32 v35, v22, 1, v35
  v_add_u32 v35, s69, v35
  v_mov_b32 v34, 0xff800000
  s_barrier
  s_add_u32 s68, s43, 49152
  ds_read_b128 v[8:11], v21 offset:0
  ds_read_b128 v[12:15], v21 offset:128
  ds_read_b128 v[16:19], v21 offset:256
  s_waitcnt lgkmcnt(0)
  v_mfma_f32_16x16x32_bf16 v[20:23], v[8:11], a[0:3], 0
  v_mfma_f32_16x16x32_bf16 v[20:23], v[12:15], a[4:7], v[20:23]
  v_mfma_f32_16x16x32_bf16 v[20:23], v[16:19], a[8:11], v[20:23]
  s_add_u32 s42, s41, 49152
  s_cmp_lg_u32 s15, 0
  s_cbranch_scc1 L_par_112
  s_waitcnt vmcnt(23)
L_par_112:
  buffer_load_dwordx4 a[0:3], v1, s[32:35], s42 offen offset:0 nt
  s_cmp_lg_u32 s15, 0
  s_cbranch_scc1 L_par_113
  s_waitcnt vmcnt(23)
L_par_113:
  buffer_load_dwordx4 a[4:7], v1, s[32:35], s42 offen offset:128 nt
  s_cmp_lg_u32 s15, 0
  s_cbranch_scc1 L_par_114
  s_waitcnt vmcnt(23)
L_par_114:
  buffer_load_dwordx4 a[8:11], v1, s[32:35], s42 offen offset:256 nt
  v_mfma_f32_16x16x32_bf16 v[24:27], v[8:11], a[12:15], 0
  v_mfma_f32_16x16x32_bf16 v[24:27], v[12:15], a[16:19], v[24:27]
  v_mfma_f32_16x16x32_bf16 v[24:27], v[16:19], a[20:23], v[24:27]
  s_add_u32 s42, s41, 52224
  s_cmp_lg_u32 s15, 0
  s_cbranch_scc1 L_par_115
  s_waitcnt vmcnt(23)
L_par_115:
  buffer_load_dwordx4 a[12:15], v1, s[32:35], s42 offen offset:0 nt
  s_cmp_lg_u32 s15, 0
  s_cbranch_scc1 L_par_116
  s_waitcnt vmcnt(23)
L_par_116:
  buffer_load_dwordx4 a[16:19], v1, s[32:35], s42 offen offset:128 nt
  s_cmp_lg_u32 s15, 0
  s_cbranch_scc1 L_par_117
  s_waitcnt vmcnt(23)
L_par_117:
  buffer_load_dwordx4 a[20:23], v1, s[32:35], s42 offen offset:256 nt
  v_mfma_f32_16x16x32_bf16 v[28:31], v[8:11], a[24:27], 0
  v_mfma_f32_16x16x32_bf16 v[28:31], v[12:15], a[28:31], v[28:31]
  v_mfma_f32_16x16x32_bf16 v[28:31], v[16:19], a[32:35], v[28:31]
  s_add_u32 s42, s41, 55296
  s_cmp_lg_u32 s15, 0
  s_cbranch_scc1 L_par_118
  s_waitcnt vmcnt(23)
L_par_118:
  buffer_load_dwordx4 a[24:27], v1, s[32:35], s42 offen offset:0 nt
  s_cmp_lg_u32 s15, 0
  s_cbranch_scc1 L_par_119
  s_waitcnt vmcnt(23)
L_par_119:
  buffer_load_dwordx4 a[28:31], v1, s[32:35], s42 offen offset:128 nt
  s_cmp_lg_u32 s15, 0
  s_cbranch_scc1 L_par_120
  s_waitcnt vmcnt(23)
L_par_120:
  buffer_load_dwordx4 a[32:35], v1, s[32:35], s42 offen offset:256 nt
  v_add_f32_dpp v32, v21, v20 row_ror:8 row_mask:0x1 bank_mask:0x3
  v_mfma_f32_16x16x32_bf16 v[20:23], v[8:11], a[36:39], 0
  v_mfma_f32_16x16x32_bf16 v[20:23], v[12:15], a[40:43], v[20:23]
  v_mfma_f32_16x16x32_bf16 v[20:23], v[16:19], a[44:47], v[20:23]
  s_add_u32 s42, s41, 58368
  s_cmp_lg_u32 s15, 0
  s_cbranch_scc1 L_par_121
  s_waitcnt vmcnt(23)
L_par_121:
  buffer_load_dwordx4 a[36:39], v1, s[32:35], s42 offen offset:0 nt
  s_cmp_lg_u32 s15, 0
  s_cbranch_scc1 L_par_122
  s_waitcnt vmcnt(23)
L_par_122:
  buffer_load_dwordx4 a[40:43], v1, s[32:35], s42 offen offset:128 nt
  s_cmp_lg_u32 s15, 0
  s_cbranch_scc1 L_par_123
  s_waitcnt vmcnt(23)
L_par_123:
  buffer_load_dwordx4 a[44:47], v1, s[32:35], s42 offen offset:256 nt
  v_add_f32_dpp v32, v24, v25 row_ror:8 row_mask:0x1 bank_mask:0xc
  v_mfma_f32_16x16x32_bf16 v[24:27], v[8:11], a[48:51], 0
  v_mfma_f32_16x16x32_bf16 v[24:27], v[12:15], a[52:55], v[24:27]
  v_mfma_f32_16x16x32_bf16 v[24:27], v[16:19], a[56:59], v[24:27]
  s_add_u32 s42, s41, 0
  s_cmp_lg_u32 s15, 0
  s_cbranch_scc1 L_par_124
  s_waitcnt vmcnt(23)
L_par_124:
  buffer_load_dwordx4 a[48:51], v2, s[36:39], s42 offen offset:0 nt
  s_cmp_lg_u32 s15, 0
  s_cbranch_scc1 L_par_125
  s_waitcnt vmcnt(23)
L_par_125:
  buffer_load_dwordx4 a[52:55], v2, s[36:39], s42 offen offset:384 nt
  s_cmp_lg_u32 s15, 0
  s_cbranch_scc1 L_par_126
  s_waitcnt vmcnt(23)
L_par_126:
  buffer_load_dwordx4 a[56:59], v3, s[36:39], s42 offen offset:0 nt
  v_add_f32_dpp v32, v29, v28 row_ror:8 row_mask:0x2 bank_mask:0x3
  v_mfma_f32_16x16x32_bf16 v[28:31], v[8:11], a[60:63], 0
  v_mfma_f32_16x16x32_bf16 v[28:31], v[12:15], a[64:67], v[28:31]
  v_mfma_f32_16x16x32_bf16 v[28:31], v[16:19], a[68:71], v[28:31]
  s_add_u32 s42, s41, 3072
  s_cmp_lg_u32 s15, 0
  s_cbranch_scc1 L_par_127
  s_waitcnt vmcnt(23)
L_par_127:
  buffer_load_dwordx4 a[60:63], v2, s[36:39], s42 offen offset:0 nt
  s_cmp_lg_u32 s15, 0
  s_cbranch_scc1 L_par_128
  s_waitcnt vmcnt(23)
L_par_128:
  buffer_load_dwordx4 a[64:67], v2, s[36:39], s42 offen offset:384 nt
  s_cmp_lg_u32 s15, 0
  s_cbranch_scc1 L_par_129
  s_waitcnt vmcnt(23)
L_par_129:
  buffer_load_dwordx4 a[68:71], v3, s[36:39], s42 offen offset:0 nt
  v_add_f32_dpp v32, v20, v21 row_ror:8 row_mask:0x2 bank_mask:0xc
  v_mfma_f32_16x16x32_bf16 v[20:23], v[8:11], a[72:75], 0
  v_mfma_f32_16x16x32_bf16 v[20:23], v[12:15], a[76:79], v[20:23]
  v_mfma_f32_16x16x32_bf16 v[20:23], v[16:19], a[80:83], v[20:23]
  s_add_u32 s42, s41, 6144
  s_cmp_lg_u32 s15, 0
  s_cbranch_scc1 L_par_130
  s_waitcnt vmcnt(23)
L_par_130:
  buffer_load_dwordx4 a[72:75], v2, s[36:39], s42 offen offset:0 nt
  s_cmp_lg_u32 s15, 0
  s_cbranch_scc1 L_par_131
  s_waitcnt vmcnt(23)
L_par_131:
  buffer_load_dwordx4 a[76:79], v2, s[36:39], s42 offen offset:384 nt
  s_cmp_lg_u32 s15, 0
  s_cbranch_scc1 L_par_132
  s_waitcnt vmcnt(23)
L_par_132:
  buffer_load_dwordx4 a[80:83], v3, s[36:39], s42 offen offset:0 nt
  v_add_f32_dpp v32, v25, v24 row_ror:8 row_mask:0x4 bank_mask:0x3
  v_mfma_f32_16x16x32_bf16 v[24:27], v[8:11], a[84:87], 0
  v_mfma_f32_16x16x32_bf16 v[24:27], v[12:15], a[88:91], v[24:27]
  v_mfma_f32_16x16x32_bf16 v[24:27], v[16:19], a[92:95], v[24:27]
  s_add_u32 s42, s41, 9216
  s_cmp_lg_u32 s15, 0
  s_cbranch_scc1 L_par_133
  s_waitcnt vmcnt(23)
L_par_133:
  buffer_load_dwordx4 a[84:87], v2, s[36:39], s42 offen offset:0 nt
  s_cmp_lg_u32 s15, 0
  s_cbranch_scc1 L_par_134
  s_waitcnt vmcnt(23)
L_par_134:
  buffer_load_dwordx4 a[88:91], v2, s[36:39], s42 offen offset:384 nt
  s_cmp_lg_u32 s15, 0
  s_cbranch_scc1 L_par_135
  s_waitcnt vmcnt(23)
L_par_135:
  buffer_load_dwordx4 a[92:95], v3, s[36:39], s42 offen offset:0 nt
  v_add_f32_dpp v32, v28, v29 row_ror:8 row_mask:0x4 bank_mask:0xc
  v_mfma_f32_16x16x32_bf16 v[28:31], v[8:11], a[96:99], 0
  v_mfma_f32_16x16x32_bf16 v[28:31], v[12:15], a[100:103], v[28:31]
  v_mfma_f32_16x16x32_bf16 v[28:31], v[16:19], a[104:107], v[28:31]
  s_add_u32 s42, s41, 12288
  s_cmp_lg_u32 s15, 0
  s_cbranch_scc1 L_par_136
  s_waitcnt vmcnt(23)
L_par_136:
  buffer_load_dwordx4 a[96:99], v2, s[36:39], s42 offen offset:0 nt
  s_cmp_lg_u32 s15, 0
  s_cbranch_scc1 L_par_137
  s_waitcnt vmcnt(23)
L_par_137:
  buffer_load_dwordx4 a[100:103], v2, s[36:39], s42 offen offset:384 nt
  s_cmp_lg_u32 s15, 0
  s_cbranch_scc1 L_par_138
  s_waitcnt vmcnt(23)
L_par_138:
  buffer_load_dwordx4 a[104:107], v3, s[36:39], s42 offen offset:0 nt
  v_add_f32_dpp v32, v21, v20 row_ror:8 row_mask:0x8 bank_mask:0x3
  v_mfma_f32_16x16x32_bf16 v[20:23], v[8:11], a[108:111], 0
  v_mfma_f32_16x16x32_bf16 v[20:23], v[12:15], a[112:115], v[20:23]
  v_mfma_f32_16x16x32_bf16 v[20:23], v[16:19], a[116:119], v[20:23]
  s_add_u32 s42, s41, 15360
  s_cmp_lg_u32 s15, 0
  s_cbranch_scc1 L_par_139
  s_waitcnt vmcnt(23)
L_par_139:
  buffer_load_dwordx4 a[108:111], v2, s[36:39], s42 offen offset:0 nt
  s_cmp_lg_u32 s15, 0
  s_cbranch_scc1 L_par_140
  s_waitcnt vmcnt(23)
L_par_140:
  buffer_load_dwordx4 a[112:115], v2, s[36:39], s42 offen offset:384 nt
  s_cmp_lg_u32 s15, 0
  s_cbranch_scc1 L_par_141
  s_waitcnt vmcnt(23)
L_par_141:
  buffer_load_dwordx4 a[116:119], v3, s[36:39], s42 offen offset:0 nt
  v_add_f32_dpp v32, v24, v25 row_ror:8 row_mask:0x8 bank_mask:0xc
  v_mfma_f32_16x16x32_bf16 v[24:27], v[8:11], a[120:123], 0
  v_mfma_f32_16x16x32_bf16 v[24:27], v[12:15], a[124:127], v[24:27]
  v_mfma_f32_16x16x32_bf16 v[24:27], v[16:19], a[128:131], v[24:27]
  s_add_u32 s42, s41, 18432
  s_cmp_lg_u32 s15, 0
  s_cbranch_scc1 L_par_142
  s_waitcnt vmcnt(23)
L_par_142:
  buffer_load_dwordx4 a[120:123], v2, s[36:39], s42 offen offset:0 nt
  s_cmp_lg_u32 s15, 0
  s_cbranch_scc1 L_par_143
  s_waitcnt vmcnt(23)
L_par_143:
  buffer_load_dwordx4 a[124:127], v2, s[36:39], s42 offen offset:384 nt
  s_cmp_lg_u32 s15, 0
  s_cbranch_scc1 L_par_144
  s_waitcnt vmcnt(23)
L_par_144:
  buffer_load_dwordx4 a[128:131], v3, s[36:39], s42 offen offset:0 nt
  v_add_f32_dpp v33, v29, v28 row_ror:8 row_mask:0x1 bank_mask:0x3
  v_mfma_f32_16x16x32_bf16 v[28:31], v[8:11], a[132:135], 0
  v_mfma_f32_16x16x32_bf16 v[28:31], v[12:15], a[136:139], v[28:31]
  v_mfma_f32_16x16x32_bf16 v[28:31], v[16:19], a[140:143], v[28:31]
  s_add_u32 s42, s41, 21504
  s_cmp_lg_u32 s15, 0
  s_cbranch_scc1 L_par_145
  s_waitcnt vmcnt(23)
L_par_145:
  buffer_load_dwordx4 a[132:135], v2, s[36:39], s42 offen offset:0 nt
  s_cmp_lg_u32 s15, 0
  s_cbranch_scc1 L_par_146
  s_waitcnt vmcnt(23)
L_par_146:
  buffer_load_dwordx4 a[136:139], v2, s[36:39], s42 offen offset:384 nt
  s_cmp_lg_u32 s15, 0
  s_cbranch_scc1 L_par_147
  s_waitcnt vmcnt(23)
L_par_147:
  buffer_load_dwordx4 a[140:143], v3, s[36:39], s42 offen offset:0 nt
  v_add_f32_dpp v33, v20, v21 row_ror:8 row_mask:0x1 bank_mask:0xc
  v_mfma_f32_16x16x32_bf16 v[20:23], v[8:11], a[144:147], 0
  v_mfma_f32_16x16x32_bf16 v[20:23], v[12:15], a[148:151], v[20:23]
  v_mfma_f32_16x16x32_bf16 v[20:23], v[16:19], a[152:155], v[20:23]
  s_add_u32 s42, s41, 24576
  s_cmp_lg_u32 s15, 0
  s_cbranch_scc1 L_par_148
  s_waitcnt vmcnt(23)
L_par_148:
  buffer_load_dwordx4 a[144:147], v2, s[36:39], s42 offen offset:0 nt
  s_cmp_lg_u32 s15, 0
  s_cbranch_scc1 L_par_149
  s_waitcnt vmcnt(23)
L_par_149:
  buffer_load_dwordx4 a[148:151], v2, s[36:39], s42 offen offset:384 nt
  s_cmp_lg_u32 s15, 0
  s_cbranch_scc1 L_par_150
  s_waitcnt vmcnt(23)
L_par_150:
  buffer_load_dwordx4 a[152:155], v3, s[36:39], s42 offen offset:0 nt
  v_add_f32_dpp v33, v25, v24 row_ror:8 row_mask:0x2 bank_mask:0x3
  v_mfma_f32_16x16x32_bf16 v[24:27], v[8:11], a[156:159], 0
  v_mfma_f32_16x16x32_bf16 v[24:27], v[12:15], a[160:163], v[24:27]
  v_mfma_f32_16x16x32_bf16 v[24:27], v[16:19], a[164:167], v[24:27]
  s_add_u32 s42, s41, 27648
  s_cmp_lg_u32 s15, 0
  s_cbranch_scc1 L_par_151
  s_waitcnt vmcnt(23)
L_par_151:
  buffer_load_dwordx4 a[156:159], v2, s[36:39], s42 offen offset:0 nt
  s_cmp_lg_u32 s15, 0
  s_cbranch_scc1 L_par_152
  s_waitcnt vmcnt(23)
L_par_152:
  buffer_load_dwordx4 a[160:163], v2, s[36:39], s42 offen offset:384 nt
  s_cmp_lg_u32 s15, 0
  s_cbranch_scc1 L_par_153
  s_waitcnt vmcnt(23)
L_par_153:
  buffer_load_dwordx4 a[164:167], v3, s[36:39], s42 offen offset:0 nt
  v_add_f32_dpp v33, v28, v29 row_ror:8 row_mask:0x2 bank_mask:0xc
  v_mfma_f32_16x16x32_bf16 v[28:31], v[8:11], a[168:171], 0
  v_mfma_f32_16x16x32_bf16 v[28:31], v[12:15], a[172:175], v[28:31]
  v_mfma_f32_16x16x32_bf16 v[28:31], v[16:19], a[176:179], v[28:31]
  s_add_u32 s42, s41, 30720
  s_cmp_lg_u32 s15, 0
  s_cbranch_scc1 L_par_154
  s_waitcnt vmcnt(23)
L_par_154:
  buffer_load_dwordx4 a[168:171], v2, s[36:39], s42 offen offset:0 nt
  s_cmp_lg_u32 s15, 0
  s_cbranch_scc1 L_par_155
  s_waitcnt vmcnt(23)
L_par_155:
  buffer_load_dwordx4 a[172:175], v2, s[36:39], s42 offen offset:384 nt
  s_cmp_lg_u32 s15, 0
  s_cbranch_scc1 L_par_156
  s_waitcnt vmcnt(23)
L_par_156:
  buffer_load_dwordx4 a[176:179], v3, s[36:39], s42 offen offset:0 nt
  v_add_f32_dpp v33, v21, v20 row_ror:8 row_mask:0x4 bank_mask:0x3
  v_mfma_f32_16x16x32_bf16 v[20:23], v[8:11], a[180:183], 0
  v_mfma_f32_16x16x32_bf16 v[20:23], v[12:15], a[184:187], v[20:23]
  v_mfma_f32_16x16x32_bf16 v[20:23], v[16:19], a[188:191], v[20:23]
  s_add_u32 s42, s41, 33792
  s_cmp_lg_u32 s15, 0
  s_cbranch_scc1 L_par_157
  s_waitcnt vmcnt(23)
L_par_157:
  buffer_load_dwordx4 a[180:183], v2, s[36:39], s42 offen offset:0 nt
  s_cmp_lg_u32 s15, 0
  s_cbranch_scc1 L_par_158
  s_waitcnt vmcnt(23)
L_par_158:
  buffer_load_dwordx4 a[184:187], v2, s[36:39], s42 offen offset:384 nt
  s_cmp_lg_u32 s15, 0
  s_cbranch_scc1 L_par_159
  s_waitcnt vmcnt(23)
L_par_159:
  buffer_load_dwordx4 a[188:191], v3, s[36:39], s42 offen offset:0 nt
  v_add_f32_dpp v33, v24, v25 row_ror:8 row_mask:0x4 bank_mask:0xc
  v_mfma_f32_16x16x32_bf16 v[24:27], v[8:11], a[192:195], 0
  v_mfma_f32_16x16x32_bf16 v[24:27], v[12:15], a[196:199], v[24:27]
  v_mfma_f32_16x16x32_bf16 v[24:27], v[16:19], a[200:203], v[24:27]
  s_add_u32 s42, s41, 36864
  s_waitcnt vmcnt(55)
  s_cmp_lg_u32 s15, 0
  s_cbranch_scc1 L_par_160
  s_waitcnt vmcnt(23)
L_par_160:
  buffer_load_dwordx4 a[192:195], v2, s[36:39], s42 offen offset:0 nt
  s_waitcnt vmcnt(55)
  s_cmp_lg_u32 s15, 0
  s_cbranch_scc1 L_par_161
  s_waitcnt vmcnt(23)
L_par_161:
  buffer_load_dwordx4 a[196:199], v2, s[36:39], s42 offen offset:384 nt
  s_waitcnt vmcnt(55)
  s_cmp_lg_u32 s15, 0
  s_cbranch_scc1 L_par_162
  s_waitcnt vmcnt(23)
L_par_162:
  buffer_load_dwordx4 a[200:203], v3, s[36:39], s42 offen offset:0 nt
  v_add_f32_dpp v33, v29, v28 row_ror:8 row_mask:0x8 bank_mask:0x3
  v_mfma_f32_16x16x32_bf16 v[28:31], v[8:11], a[204:207], 0
  v_mfma_f32_16x16x32_bf16 v[28:31], v[12:15], a[208:211], v[28:31]
  v_mfma_f32_16x16x32_bf16 v[28:31], v[16:19], a[212:215], v[28:31]
  s_add_u32 s42, s41, 39936
  s_waitcnt vmcnt(55)
  s_cmp_lg_u32 s15, 0
  s_cbranch_scc1 L_par_163
  s_waitcnt vmcnt(23)
L_par_163:
  buffer_load_dwordx4 a[204:207], v2, s[36:39], s42 offen offset:0 nt
  s_waitcnt vmcnt(55)
  s_cmp_lg_u32 s15, 0
  s_cbranch_scc1 L_par_164
  s_waitcnt vmcnt(23)
L_par_164:
  buffer_load_dwordx4 a[208:211], v2, s[36:39], s42 offen offset:384 nt
  s_waitcnt vmcnt(55)
  s_cmp_lg_u32 s15, 0
  s_cbranch_scc1 L_par_165
  s_waitcnt vmcnt(23)
L_par_165:
  buffer_load_dwordx4 a[212:215], v3, s[36:39], s42 offen offset:0 nt
  v_add_f32_dpp v33, v20, v21 row_ror:8 row_mask:0x8 bank_mask:0xc
  v_mfma_f32_16x16x32_bf16 v[20:23], v[8:11], a[216:219], 0
  v_mfma_f32_16x16x32_bf16 v[20:23], v[12:15], a[220:223], v[20:23]
  v_mfma_f32_16x16x32_bf16 v[20:23], v[16:19], a[224:227], v[20:23]
  s_add_u32 s42, s41, 43008
  s_waitcnt vmcnt(55)
  s_cmp_lg_u32 s15, 0
  s_cbranch_scc1 L_par_166
  s_waitcnt vmcnt(23)
L_par_166:
  buffer_load_dwordx4 a[216:219], v2, s[36:39], s42 offen offset:0 nt
  s_waitcnt vmcnt(55)
  s_cmp_lg_u32 s15, 0
  s_cbranch_scc1 L_par_167
  s_waitcnt vmcnt(23)
L_par_167:
  buffer_load_dwordx4 a[220:223], v2, s[36:39], s42 offen offset:384 nt
  s_waitcnt vmcnt(55)
  s_cmp_lg_u32 s15, 0
  s_cbranch_scc1 L_par_168
  s_waitcnt vmcnt(23)
L_par_168:
  buffer_load_dwordx4 a[224:227], v3, s[36:39], s42 offen offset:0 nt
  v_add_f32_dpp v34, v25, v24 row_ror:8 row_mask:0x1 bank_mask:0x3
  v_mfma_f32_16x16x32_bf16 v[24:27], v[8:11], a[228:231], 0
  v_mfma_f32_16x16x32_bf16 v[24:27], v[12:15], a[232:235], v[24:27]
  v_mfma_f32_16x16x32_bf16 v[24:27], v[16:19], a[236:239], v[24:27]
  s_add_u32 s42, s41, 46080
  s_waitcnt vmcnt(55)
  s_cmp_lg_u32 s15, 0
  s_cbranch_scc1 L_par_169
  s_waitcnt vmcnt(23)
L_par_169:
  buffer_load_dwordx4 a[228:231], v2, s[36:39], s42 offen offset:0 nt
  s_waitcnt vmcnt(55)
  s_cmp_lg_u32 s15, 0
  s_cbranch_scc1 L_par_170
  s_waitcnt vmcnt(23)
L_par_170:
  buffer_load_dwordx4 a[232:235], v2, s[36:39], s42 offen offset:384 nt
  s_waitcnt vmcnt(55)
  s_cmp_lg_u32 s15, 0
  s_cbranch_scc1 L_par_171
  s_waitcnt vmcnt(23)
L_par_171:
  buffer_load_dwordx4 a[236:239], v3, s[36:39], s42 offen offset:0 nt
  v_add_f32_dpp v34, v28, v29 row_ror:8 row_mask:0x1 bank_mask:0xc
  v_add_f32_dpp v34, v21, v20 row_ror:8 row_mask:0x2 bank_mask:0x3
  v_add_f32_dpp v34, v24, v25 row_ror:8 row_mask:0x2 bank_mask:0xc
  v_max3_f32 v20, v32, v33, v34
  s_nop 1
  v_max_f32_dpp v20, v20, v20 row_ror:8 row_mask:0xf bank_mask:0xf
  s_nop 1
  v_max_f32_dpp v20, v20, v20 row_ror:4 row_mask:0xf bank_mask:0xf
  s_nop 1
  v_max_f32_dpp v20, v20, v20 row_ror:2 row_mask:0xf bank_mask:0xf
  s_nop 1
  v_max_f32_dpp v20, v20, v20 row_ror:1 row_mask:0xf bank_mask:0xf
  v_mov_b32 v21, v20
  s_nop 1
  v_permlane16_swap_b32 v20, v21
  v_max_f32 v20, v20, v21
  v_mov_b32 v21, v20
  s_nop 1
  v_permlane32_swap_b32 v20, v21
  v_max_f32 v20, v20, v21
  v_mul_f32 v38, s56, v20
  v_fma_f32 v32, v32, s56, -v38
  v_fma_f32 v33, v33, s56, -v38
  v_fma_f32 v34, v34, s56, -v38
  v_exp_f32 v32, v32
  v_exp_f32 v33, v33
  v_exp_f32 v34, v34
  v_cvt_pk_bf16_f32 v22, v32, v32
  v_cvt_pk_bf16_f32 v23, v33, v33
  v_cvt_pk_bf16_f32 v24, v34, v34
  ds_write_b16 v35, v22 offset:0
  ds_write_b16 v35, v23 offset:128
  ds_write_b16 v35, v24 offset:256
  v_add_f32 v39, v32, v33
  v_add_f32 v39, v39, v34
  ds_read_b128 v[28:31], v36
  ds_read_b128 v[32:35], v36 offset:64
  s_waitcnt lgkmcnt(1)
  v_perm_b32 v20, v28, v28, v4
  v_perm_b32 v21, v28, v28, v5
  v_perm_b32 v22, v28, v28, v6
  v_perm_b32 v23, v28, v28, v7
  s_nop 1
  v_mfma_f32_16x16x32_bf16 v[8:11], v[20:23], a[240:243], 0
  v_perm_b32 v24, v29, v29, v4
  v_perm_b32 v25, v29, v29, v5
  v_mfma_f32_16x16x32_bf16 v[12:15], v[20:23], a[244:247], 0
  v_perm_b32 v26, v29, v29, v6
  v_perm_b32 v27, v29, v29, v7
  v_mfma_f32_16x16x32_bf16 v[16:19], v[20:23], a[248:251], 0
  s_add_u32 s42, s41, 49152
  s_waitcnt vmcnt(55)
  s_cmp_lg_u32 s15, 0
  s_cbranch_scc1 L_par_172
  s_waitcnt vmcnt(23)
L_par_172:
  buffer_load_dwordx4 a[240:243], v2, s[36:39], s42 offen offset:0 nt
  s_waitcnt vmcnt(55)
  s_cmp_lg_u32 s15, 0
  s_cbranch_scc1 L_par_173
  s_waitcnt vmcnt(23)
L_par_173:
  buffer_load_dwordx4 a[244:247], v2, s[36:39], s42 offen offset:384 nt
  s_waitcnt vmcnt(55)
  s_cmp_lg_u32 s15, 0
  s_cbranch_scc1 L_par_174
  s_waitcnt vmcnt(23)
L_par_174:
  buffer_load_dwordx4 a[248:251], v3, s[36:39], s42 offen offset:0 nt
  v_mfma_f32_16x16x32_bf16 v[8:11], v[24:27], a[252:255], v[8:11]
  v_perm_b32 v20, v30, v30, v4
  v_perm_b32 v21, v30, v30, v5
  v_mfma_f32_16x16x32_bf16 v[12:15], v[24:27], v[40:43], v[12:15]
  v_perm_b32 v22, v30, v30, v6
  v_perm_b32 v23, v30, v30, v7
  v_mfma_f32_16x16x32_bf16 v[16:19], v[24:27], v[44:47], v[16:19]
  v_add_f32_dpp v39, v39, v39 row_ror:8 row_mask:0xf bank_mask:0xf
  s_add_u32 s42, s41, 52224
  s_waitcnt vmcnt(55)
  s_cmp_lg_u32 s15, 0
  s_cbranch_scc1 L_par_175
  s_waitcnt vmcnt(23)
L_par_175:
  buffer_load_dwordx4 a[252:255], v2, s[36:39], s42 offen offset:0 nt
  s_waitcnt vmcnt(55)
  s_cmp_lg_u32 s15, 0
  s_cbranch_scc1 L_par_176
  s_waitcnt vmcnt(23)
L_par_176:
  buffer_load_dwordx4 v[40:43], v2, s[36:39], s42 offen offset:384 nt
  s_waitcnt vmcnt(55)
  s_cmp_lg_u32 s15, 0
  s_cbranch_scc1 L_par_177
  s_waitcnt vmcnt(23)
L_par_177:
  buffer_load_dwordx4 v[44:47], v3, s[36:39], s42 offen offset:0 nt
  v_mfma_f32_16x16x32_bf16 v[8:11], v[20:23], v[48:51], v[8:11]
  v_perm_b32 v24, v31, v31, v4
  v_perm_b32 v25, v31, v31, v5
  v_mfma_f32_16x16x32_bf16 v[12:15], v[20:23], v[52:55], v[12:15]
  v_perm_b32 v26, v31, v31, v6
  v_perm_b32 v27, v31, v31, v7
  v_mfma_f32_16x16x32_bf16 v[16:19], v[20:23], v[56:59], v[16:19]
  ds_read_b128 v[28:31], v36 offset:128
  v_add_f32_dpp v39, v39, v39 row_ror:4 row_mask:0xf bank_mask:0xf
  s_add_u32 s42, s41, 55296
  s_waitcnt vmcnt(55)
  s_cmp_lg_u32 s15, 0
  s_cbranch_scc1 L_par_178
  s_waitcnt vmcnt(23)
L_par_178:
  buffer_load_dwordx4 v[48:51], v2, s[36:39], s42 offen offset:0 nt
  s_waitcnt vmcnt(55)
  s_cmp_lg_u32 s15, 0
  s_cbranch_scc1 L_par_179
  s_waitcnt vmcnt(23)
L_par_179:
  buffer_load_dwordx4 v[52:55], v2, s[36:39], s42 offen offset:384 nt
  s_waitcnt vmcnt(55)
  s_cmp_lg_u32 s15, 0
  s_cbranch_scc1 L_par_180
  s_waitcnt vmcnt(23)
L_par_180:
  buffer_load_dwordx4 v[56:59], v3, s[36:39], s42 offen offset:0 nt
  s_waitcnt lgkmcnt(1)
  v_mfma_f32_16x16x32_bf16 v[8:11], v[24:27], v[60:63], v[8:11]
  v_perm_b32 v20, v32, v32, v4
  v_perm_b32 v21, v32, v32, v5
  v_mfma_f32_16x16x32_bf16 v[12:15], v[24:27], v[64:67], v[12:15]
  v_perm_b32 v22, v32, v32, v6
  v_perm_b32 v23, v32, v32, v7
  v_mfma_f32_16x16x32_bf16 v[16:19], v[24:27], v[68:71], v[16:19]
  v_add_f32_dpp v39, v39, v39 row_ror:2 row_mask:0xf bank_mask:0xf
  s_add_u32 s42, s41, 58368
  s_waitcnt vmcnt(55)
  s_cmp_lg_u32 s15, 0
  s_cbranch_scc1 L_par_181
  s_waitcnt vmcnt(23)
L_par_181:
  buffer_load_dwordx4 v[60:63], v2, s[36:39], s42 offen offset:0 nt
  s_waitcnt vmcnt(55)
  s_cmp_lg_u32 s15, 0
  s_cbranch_scc1 L_par_182
  s_waitcnt vmcnt(23)
L_par_182:
  buffer_load_dwordx4 v[64:67], v2, s[36:39], s42 offen offset:384 nt
  s_waitcnt vmcnt(55)
  s_cmp_lg_u32 s15, 0
  s_cbranch_scc1 L_par_183
  s_waitcnt vmcnt(23)
L_par_183:
  buffer_load_dwordx4 v[68:71], v3, s[36:39], s42 offen offset:0 nt
  v_mfma_f32_16x16x32_bf16 v[8:11], v[20:23], v[72:75], v[8:11]
  v_perm_b32 v24, v33, v33, v4
  v_perm_b32 v25, v33, v33, v5
  v_mfma_f32_16x16x32_bf16 v[12:15], v[20:23], v[76:79], v[12:15]
  v_perm_b32 v26, v33, v33, v6
  v_perm_b32 v27, v33, v33, v7
  v_mfma_f32_16x16x32_bf16 v[16:19], v[20:23], v[80:83], v[16:19]
  v_add_f32_dpp v39, v39, v39 row_ror:1 row_mask:0xf bank_mask:0xf
  v_mfma_f32_16x16x32_bf16 v[8:11], v[24:27], v[84:87], v[8:11]
  v_perm_b32 v20, v34, v34, v4
  v_perm_b32 v21, v34, v34, v5
  v_mfma_f32_16x16x32_bf16 v[12:15], v[24:27], v[88:91], v[12:15]
  v_perm_b32 v22, v34, v34, v6
  v_perm_b32 v23, v34, v34, v7
  v_mfma_f32_16x16x32_bf16 v[16:19], v[24:27], v[92:95], v[16:19]
  v_mov_b32 v37, v39
  v_mfma_f32_16x16x32_bf16 v[8:11], v[20:23], v[96:99], v[8:11]
  v_perm_b32 v24, v35, v35, v4
  v_perm_b32 v25, v35, v35, v5
  v_mfma_f32_16x16x32_bf16 v[12:15], v[20:23], v[100:103], v[12:15]
  v_perm_b32 v26, v35, v35, v6
  v_perm_b32 v27, v35, v35, v7
  v_mfma_f32_16x16x32_bf16 v[16:19], v[20:23], v[104:107], v[16:19]
  ds_read_b128 v[32:35], v36 offset:192
  v_permlane16_swap_b32 v39, v37
  s_waitcnt lgkmcnt(1)
  v_mfma_f32_16x16x32_bf16 v[8:11], v[24:27], v[108:111], v[8:11]
  v_perm_b32 v20, v28, v28, v4
  v_perm_b32 v21, v28, v28, v5
  v_mfma_f32_16x16x32_bf16 v[12:15], v[24:27], v[112:115], v[12:15]
  v_perm_b32 v22, v28, v28, v6
  v_perm_b32 v23, v28, v28, v7
  v_mfma_f32_16x16x32_bf16 v[16:19], v[24:27], v[116:119], v[16:19]
  v_add_f32 v39, v39, v37
  v_mfma_f32_16x16x32_bf16 v[8:11], v[20:23], v[120:123], v[8:11]
  v_perm_b32 v24, v29, v29, v4
  v_perm_b32 v25, v29, v29, v5
  v_mfma_f32_16x16x32_bf16 v[12:15], v[20:23], v[124:127], v[12:15]
  v_perm_b32 v26, v29, v29, v6
  v_perm_b32 v27, v29, v29, v7
  v_mfma_f32_16x16x32_bf16 v[16:19], v[20:23], v[128:131], v[16:19]
  v_mov_b32 v37, v39
  v_mfma_f32_16x16x32_bf16 v[8:11], v[24:27], v[132:135], v[8:11]
  v_perm_b32 v20, v30, v30, v4
  v_perm_b32 v21, v30, v30, v5
  v_mfma_f32_16x16x32_bf16 v[12:15], v[24:27], v[136:139], v[12:15]
  v_perm_b32 v22, v30, v30, v6
  v_perm_b32 v23, v30, v30, v7
  v_mfma_f32_16x16x32_bf16 v[16:19], v[24:27], v[140:143], v[16:19]
  v_permlane32_swap_b32 v39, v37
  v_mfma_f32_16x16x32_bf16 v[8:11], v[20:23], v[144:147], v[8:11]
  v_perm_b32 v24, v31, v31, v4
  v_perm_b32 v25, v31, v31, v5
  v_mfma_f32_16x16x32_bf16 v[12:15], v[20:23], v[148:151], v[12:15]
  v_perm_b32 v26, v31, v31, v6
  v_perm_b32 v27, v31, v31, v7
  v_mfma_f32_16x16x32_bf16 v[16:19], v[20:23], v[152:155], v[16:19]
  ds_read_b128 v[28:31], v36 offset:256
  v_add_f32 v39, v39, v37
  s_waitcnt lgkmcnt(1)
  v_mfma_f32_16x16x32_bf16 v[8:11], v[24:27], v[156:159], v[8:11]
  v_perm_b32 v20, v32, v32, v4
  v_perm_b32 v21, v32, v32, v5
  v_mfma_f32_16x16x32_bf16 v[12:15], v[24:27], v[160:163], v[12:15]
  v_perm_b32 v22, v32, v32, v6
  v_perm_b32 v23, v32, v32, v7
  v_mfma_f32_16x16x32_bf16 v[16:19], v[24:27], v[164:167], v[16:19]
  s_nop 0
  v_mfma_f32_16x16x32_bf16 v[8:11], v[20:23], v[168:171], v[8:11]
  v_perm_b32 v24, v33, v33, v4
  v_perm_b32 v25, v33, v33, v5
  v_mfma_f32_16x16x32_bf16 v[12:15], v[20:23], v[172:175], v[12:15]
  v_perm_b32 v26, v33, v33, v6
  v_perm_b32 v27, v33, v33, v7
  v_mfma_f32_16x16x32_bf16 v[16:19], v[20:23], v[176:179], v[16:19]
  s_nop 0
  v_mfma_f32_16x16x32_bf16 v[8:11], v[24:27], v[180:183], v[8:11]
  v_perm_b32 v20, v34, v34, v4
  v_perm_b32 v21, v34, v34, v5
  v_mfma_f32_16x16x32_bf16 v[12:15], v[24:27], v[184:187], v[12:15]
  v_perm_b32 v22, v34, v34, v6
  v_perm_b32 v23, v34, v34, v7
  v_mfma_f32_16x16x32_bf16 v[16:19], v[24:27], v[188:191], v[16:19]
  s_nop 0
  v_mfma_f32_16x16x32_bf16 v[8:11], v[20:23], v[192:195], v[8:11]
  v_perm_b32 v24, v35, v35, v4
  v_perm_b32 v25, v35, v35, v5
  v_mfma_f32_16x16x32_bf16 v[12:15], v[20:23], v[196:199], v[12:15]
  v_perm_b32 v26, v35, v35, v6
  v_perm_b32 v27, v35, v35, v7
  v_mfma_f32_16x16x32_bf16 v[16:19], v[20:23], v[200:203], v[16:19]
  s_waitcnt lgkmcnt(0)
  v_mfma_f32_16x16x32_bf16 v[8:11], v[24:27], v[204:207], v[8:11]
  v_perm_b32 v20, v28, v28, v4
  v_perm_b32 v21, v28, v28, v5
  v_mfma_f32_16x16x32_bf16 v[12:15], v[24:27], v[208:211], v[12:15]
  v_perm_b32 v22, v28, v28, v6
  v_perm_b32 v23, v28, v28, v7
  v_mfma_f32_16x16x32_bf16 v[16:19], v[24:27], v[212:215], v[16:19]
  s_nop 0
  v_mfma_f32_16x16x32_bf16 v[8:11], v[20:23], v[216:219], v[8:11]
  v_perm_b32 v24, v29, v29, v4
  v_perm_b32 v25, v29, v29, v5
  v_mfma_f32_16x16x32_bf16 v[12:15], v[20:23], v[220:223], v[12:15]
  v_perm_b32 v26, v29, v29, v6
  v_perm_b32 v27, v29, v29, v7
  v_mfma_f32_16x16x32_bf16 v[16:19], v[20:23], v[224:227], v[16:19]
  s_nop 0
  v_mfma_f32_16x16x32_bf16 v[8:11], v[24:27], v[228:231], v[8:11]
  v_perm_b32 v20, v30, v30, v4
  v_perm_b32 v21, v30, v30, v5
  v_mfma_f32_16x16x32_bf16 v[12:15], v[24:27], v[232:235], v[12:15]
  v_perm_b32 v22, v30, v30, v6
  v_perm_b32 v23, v30, v30, v7
  v_mfma_f32_16x16x32_bf16 v[16:19], v[24:27], v[236:239], v[16:19]
  s_nop 0
  v_mfma_f32_16x16x32_bf16 v[8:11], v[20:23], v[240:243], v[8:11]
  v_perm_b32 v24, v31, v31, v4
  v_perm_b32 v25, v31, v31, v5
  v_mfma_f32_16x16x32_bf16 v[12:15], v[20:23], v[244:247], v[12:15]
  v_perm_b32 v26, v31, v31, v6
  v_perm_b32 v27, v31, v31, v7
  v_mfma_f32_16x16x32_bf16 v[16:19], v[20:23], v[248:251], v[16:19]
  ds_read_b128 v[32:35], v0 offset:49152
  ds_read_b128 v[28:31], v0 offset:50176
  v_mfma_f32_16x16x32_bf16 v[8:11], v[24:27], v[252:255], v[8:11]
  s_waitcnt lgkmcnt(1)
  v_mfma_f32_16x16x32_bf16 v[12:15], v[24:27], v[32:35], v[12:15]
  s_waitcnt lgkmcnt(0)
  v_mfma_f32_16x16x32_bf16 v[16:19], v[24:27], v[28:31], v[16:19]
  v_mbcnt_lo_u32_b32 v28, -1, 0
  v_mbcnt_hi_u32_b32 v28, -1, v28
  v_and_b32 v29, 15, v28
  v_lshrrev_b32 v30, 4, v28
  v_and_b32 v31, 1, v30
  v_lshrrev_b32 v30, 1, v30
  v_mul_u32_u24 v30, 768, v30
  v_lshl_add_u32 v30, v31, 4, v30
  v_add_u32 v30, s68, v30
  v_lshl_add_u32 v32, v29, 5, v30
  v_and_b32 v29, 7, v29
  v_lshl_add_u32 v33, v29, 5, v30
  v_mov_b32 v34, s72
  v_mov_b32 v20, v38
  v_mov_b32 v21, v39
  v_cndmask_b32 v8, v8, v12, s[70:71]
  v_cndmask_b32 v9, v9, v13, s[70:71]
  v_cndmask_b32 v10, v10, v14, s[70:71]
  v_cndmask_b32 v11, v11, v15, s[70:71]
  ds_write_b128 v32, v[8:11]
  s_mov_b32 exec_lo, 0x00ff00ff
  s_mov_b32 exec_hi, 0xff00ff00
  ds_write_b128 v33, v[16:19] offset:512
  s_mov_b64 exec, 1
  ds_write_b64 v34, v[20:21] offset:32
  s_mov_b64 exec, -1
  s_waitcnt lgkmcnt(0)
  s_barrier
  v_mbcnt_lo_u32_b32 v20, -1, 0
  v_mbcnt_hi_u32_b32 v20, -1, v20
  v_and_b32 v21, 1, v20
  v_lshrrev_b32 v22, 4, v20
  v_lshlrev_b32 v22, 4, v22
  v_lshl_add_u32 v21, v21, 6, v22
  v_add_u32 v21, 159808, v21
  v_add_u32 v36, s69, v22
  v_lshrrev_b32 v22, 5, v20
  v_lshlrev_b32 v35, 6, v22
  v_bfe_u32 v22, v20, 1, 2
  v_lshl_add_u32 v35, v22, 4, v35
  v_bfe_u32 v22, v20, 3, 2
  v_lshl_add_u32 v35, v22, 2, v35
  v_and_b32 v22, 1, v20
  v_lshl_add_u32 v35, v22, 1, v35
  v_add_u32 v35, s69, v35
  v_mov_b32 v34, 0xff800000
  ds_read_b128 v[8:11], v21 offset:384
  ds_read_b128 v[12:15], v21 offset:512
  ds_read_b128 v[16:19], v21 offset:640
  ds_read_b128 v[184:187], v0 offset:0
  ds_read_b128 v[188:191], v0 offset:1024
  ds_read_b128 v[192:195], v0 offset:2048
  ds_read_b128 v[196:199], v0 offset:3072
  ds_read_b128 v[200:203], v0 offset:4096
  ds_read_b128 v[204:207], v0 offset:5120
  s_waitcnt lgkmcnt(6)
  s_waitcnt lgkmcnt(5)
  v_mfma_f32_16x16x32_bf16 v[20:23], v[8:11], v[184:187], 0
  s_waitcnt lgkmcnt(4)
  v_mfma_f32_16x16x32_bf16 v[20:23], v[12:15], v[188:191], v[20:23]
  s_waitcnt lgkmcnt(3)
  v_mfma_f32_16x16x32_bf16 v[20:23], v[16:19], v[192:195], v[20:23]
  ds_read_b128 v[208:211], v0 offset:6144
  ds_read_b128 v[212:215], v0 offset:7168
  ds_read_b128 v[216:219], v0 offset:8192
  s_waitcnt lgkmcnt(5)
  v_mfma_f32_16x16x32_bf16 v[24:27], v[8:11], v[196:199], 0
  s_waitcnt lgkmcnt(4)
  v_mfma_f32_16x16x32_bf16 v[24:27], v[12:15], v[200:203], v[24:27]
  s_waitcnt lgkmcnt(3)
  v_mfma_f32_16x16x32_bf16 v[24:27], v[16:19], v[204:207], v[24:27]
  ds_read_b128 v[220:223], v0 offset:9216
  ds_read_b128 v[224:227], v0 offset:10240
  ds_read_b128 v[228:231], v0 offset:11264
  s_waitcnt lgkmcnt(5)
  v_mfma_f32_16x16x32_bf16 v[28:31], v[8:11], v[208:211], 0
  s_waitcnt lgkmcnt(4)
  v_mfma_f32_16x16x32_bf16 v[28:31], v[12:15], v[212:215], v[28:31]
  s_waitcnt lgkmcnt(3)
  v_mfma_f32_16x16x32_bf16 v[28:31], v[16:19], v[216:219], v[28:31]
  ds_read_b128 v[184:187], v0 offset:12288
  ds_read_b128 v[188:191], v0 offset:13312
  ds_read_b128 v[192:195], v0 offset:14336
  v_add_f32_dpp v32, v21, v20 row_ror:8 row_mask:0x1 bank_mask:0x3
  s_waitcnt lgkmcnt(5)
  v_mfma_f32_16x16x32_bf16 v[20:23], v[8:11], v[220:223], 0
  s_waitcnt lgkmcnt(4)
  v_mfma_f32_16x16x32_bf16 v[20:23], v[12:15], v[224:227], v[20:23]
  s_waitcnt lgkmcnt(3)
  v_mfma_f32_16x16x32_bf16 v[20:23], v[16:19], v[228:231], v[20:23]
  ds_read_b128 v[196:199], v0 offset:15360
  ds_read_b128 v[200:203], v0 offset:16384
  ds_read_b128 v[204:207], v0 offset:17408
  v_add_f32_dpp v32, v24, v25 row_ror:8 row_mask:0x1 bank_mask:0xc
  s_waitcnt lgkmcnt(5)
  v_mfma_f32_16x16x32_bf16 v[24:27], v[8:11], v[184:187], 0
  s_waitcnt lgkmcnt(4)
  v_mfma_f32_16x16x32_bf16 v[24:27], v[12:15], v[188:191], v[24:27]
  s_waitcnt lgkmcnt(3)
  v_mfma_f32_16x16x32_bf16 v[24:27], v[16:19], v[192:195], v[24:27]
  ds_read_b128 v[208:211], v0 offset:18432
  ds_read_b128 v[212:215], v0 offset:19456
  ds_read_b128 v[216:219], v0 offset:20480
  v_add_f32_dpp v32, v29, v28 row_ror:8 row_mask:0x2 bank_mask:0x3
  s_waitcnt lgkmcnt(5)
  v_mfma_f32_16x16x32_bf16 v[28:31], v[8:11], v[196:199], 0
  s_waitcnt lgkmcnt(4)
  v_mfma_f32_16x16x32_bf16 v[28:31], v[12:15], v[200:203], v[28:31]
  s_waitcnt lgkmcnt(3)
  v_mfma_f32_16x16x32_bf16 v[28:31], v[16:19], v[204:207], v[28:31]
  ds_read_b128 v[220:223], v0 offset:21504
  ds_read_b128 v[224:227], v0 offset:22528
  ds_read_b128 v[228:231], v0 offset:23552
  v_add_f32_dpp v32, v20, v21 row_ror:8 row_mask:0x2 bank_mask:0xc
  s_waitcnt lgkmcnt(5)
  v_mfma_f32_16x16x32_bf16 v[20:23], v[8:11], v[208:211], 0
  s_waitcnt lgkmcnt(4)
  v_mfma_f32_16x16x32_bf16 v[20:23], v[12:15], v[212:215], v[20:23]
  s_waitcnt lgkmcnt(3)
  v_mfma_f32_16x16x32_bf16 v[20:23], v[16:19], v[216:219], v[20:23]
  ds_read_b128 v[184:187], v0 offset:24576
  ds_read_b128 v[188:191], v0 offset:25600
  ds_read_b128 v[192:195], v0 offset:26624
  v_add_f32_dpp v32, v25, v24 row_ror:8 row_mask:0x4 bank_mask:0x3
  s_waitcnt lgkmcnt(5)
  v_mfma_f32_16x16x32_bf16 v[24:27], v[8:11], v[220:223], 0
  s_waitcnt lgkmcnt(4)
  v_mfma_f32_16x16x32_bf16 v[24:27], v[12:15], v[224:227], v[24:27]
  s_waitcnt lgkmcnt(3)
  v_mfma_f32_16x16x32_bf16 v[24:27], v[16:19], v[228:231], v[24:27]
  ds_read_b128 v[196:199], v0 offset:27648
  ds_read_b128 v[200:203], v0 offset:28672
  ds_read_b128 v[204:207], v0 offset:29696
  v_add_f32_dpp v32, v28, v29 row_ror:8 row_mask:0x4 bank_mask:0xc
  s_waitcnt lgkmcnt(5)
  v_mfma_f32_16x16x32_bf16 v[28:31], v[8:11], v[184:187], 0
  s_waitcnt lgkmcnt(4)
  v_mfma_f32_16x16x32_bf16 v[28:31], v[12:15], v[188:191], v[28:31]
  s_waitcnt lgkmcnt(3)
  v_mfma_f32_16x16x32_bf16 v[28:31], v[16:19], v[192:195], v[28:31]
  ds_read_b128 v[208:211], v0 offset:30720
  ds_read_b128 v[212:215], v0 offset:31744
  ds_read_b128 v[216:219], v0 offset:32768
  v_add_f32_dpp v32, v21, v20 row_ror:8 row_mask:0x8 bank_mask:0x3
  s_waitcnt lgkmcnt(5)
  v_mfma_f32_16x16x32_bf16 v[20:23], v[8:11], v[196:199], 0
  s_waitcnt lgkmcnt(4)
  v_mfma_f32_16x16x32_bf16 v[20:23], v[12:15], v[200:203], v[20:23]
  s_waitcnt lgkmcnt(3)
  v_mfma_f32_16x16x32_bf16 v[20:23], v[16:19], v[204:207], v[20:23]
  ds_read_b128 v[220:223], v0 offset:33792
  ds_read_b128 v[224:227], v0 offset:34816
  ds_read_b128 v[228:231], v0 offset:35840
  v_add_f32_dpp v32, v24, v25 row_ror:8 row_mask:0x8 bank_mask:0xc
  s_waitcnt lgkmcnt(5)
  v_mfma_f32_16x16x32_bf16 v[24:27], v[8:11], v[208:211], 0
  s_waitcnt lgkmcnt(4)
  v_mfma_f32_16x16x32_bf16 v[24:27], v[12:15], v[212:215], v[24:27]
  s_waitcnt lgkmcnt(3)
  v_mfma_f32_16x16x32_bf16 v[24:27], v[16:19], v[216:219], v[24:27]
  ds_read_b128 v[184:187], v0 offset:36864
  ds_read_b128 v[188:191], v0 offset:37888
  ds_read_b128 v[192:195], v0 offset:38912
  v_add_f32_dpp v33, v29, v28 row_ror:8 row_mask:0x1 bank_mask:0x3
  s_waitcnt lgkmcnt(5)
  v_mfma_f32_16x16x32_bf16 v[28:31], v[8:11], v[220:223], 0
  s_waitcnt lgkmcnt(4)
  v_mfma_f32_16x16x32_bf16 v[28:31], v[12:15], v[224:227], v[28:31]
  s_waitcnt lgkmcnt(3)
  v_mfma_f32_16x16x32_bf16 v[28:31], v[16:19], v[228:231], v[28:31]
  ds_read_b128 v[196:199], v0 offset:39936
  ds_read_b128 v[200:203], v0 offset:40960
  ds_read_b128 v[204:207], v0 offset:41984
  v_add_f32_dpp v33, v20, v21 row_ror:8 row_mask:0x1 bank_mask:0xc
  s_waitcnt lgkmcnt(5)
  v_mfma_f32_16x16x32_bf16 v[20:23], v[8:11], v[184:187], 0
  s_waitcnt lgkmcnt(4)
  v_mfma_f32_16x16x32_bf16 v[20:23], v[12:15], v[188:191], v[20:23]
  s_waitcnt lgkmcnt(3)
  v_mfma_f32_16x16x32_bf16 v[20:23], v[16:19], v[192:195], v[20:23]
  ds_read_b128 v[208:211], v0 offset:43008
  ds_read_b128 v[212:215], v0 offset:44032
  ds_read_b128 v[216:219], v0 offset:45056
  v_add_f32_dpp v33, v25, v24 row_ror:8 row_mask:0x2 bank_mask:0x3
  s_waitcnt lgkmcnt(5)
  v_mfma_f32_16x16x32_bf16 v[24:27], v[8:11], v[196:199], 0
  s_waitcnt lgkmcnt(4)
  v_mfma_f32_16x16x32_bf16 v[24:27], v[12:15], v[200:203], v[24:27]
  s_waitcnt lgkmcnt(3)
  v_mfma_f32_16x16x32_bf16 v[24:27], v[16:19], v[204:207], v[24:27]
  ds_read_b128 v[220:223], v0 offset:46080
  ds_read_b128 v[224:227], v0 offset:47104
  ds_read_b128 v[228:231], v0 offset:48128
  v_add_f32_dpp v33, v28, v29 row_ror:8 row_mask:0x2 bank_mask:0xc
  s_waitcnt lgkmcnt(5)
  v_mfma_f32_16x16x32_bf16 v[28:31], v[8:11], v[208:211], 0
  s_waitcnt lgkmcnt(4)
  v_mfma_f32_16x16x32_bf16 v[28:31], v[12:15], v[212:215], v[28:31]
  s_waitcnt lgkmcnt(3)
  v_mfma_f32_16x16x32_bf16 v[28:31], v[16:19], v[216:219], v[28:31]
  v_add_f32_dpp v33, v21, v20 row_ror:8 row_mask:0x4 bank_mask:0x3
  s_waitcnt lgkmcnt(2)
  v_mfma_f32_16x16x32_bf16 v[20:23], v[8:11], v[220:223], 0
  s_waitcnt lgkmcnt(1)
  v_mfma_f32_16x16x32_bf16 v[20:23], v[12:15], v[224:227], v[20:23]
  s_waitcnt lgkmcnt(0)
  v_mfma_f32_16x16x32_bf16 v[20:23], v[16:19], v[228:231], v[20:23]
  v_add_f32_dpp v33, v24, v25 row_ror:8 row_mask:0x4 bank_mask:0xc
  v_mfma_f32_16x16x32_bf16 v[24:27], v[8:11], a[0:3], 0
  v_mfma_f32_16x16x32_bf16 v[24:27], v[12:15], a[4:7], v[24:27]
  v_mfma_f32_16x16x32_bf16 v[24:27], v[16:19], a[8:11], v[24:27]
  v_add_f32_dpp v33, v29, v28 row_ror:8 row_mask:0x8 bank_mask:0x3
  v_mfma_f32_16x16x32_bf16 v[28:31], v[8:11], a[12:15], 0
  v_mfma_f32_16x16x32_bf16 v[28:31], v[12:15], a[16:19], v[28:31]
  v_mfma_f32_16x16x32_bf16 v[28:31], v[16:19], a[20:23], v[28:31]
  v_add_f32_dpp v33, v20, v21 row_ror:8 row_mask:0x8 bank_mask:0xc
  v_mfma_f32_16x16x32_bf16 v[20:23], v[8:11], a[24:27], 0
  v_mfma_f32_16x16x32_bf16 v[20:23], v[12:15], a[28:31], v[20:23]
  v_mfma_f32_16x16x32_bf16 v[20:23], v[16:19], a[32:35], v[20:23]
  v_add_f32_dpp v34, v25, v24 row_ror:8 row_mask:0x1 bank_mask:0x3
  v_mfma_f32_16x16x32_bf16 v[24:27], v[8:11], a[36:39], 0
  v_mfma_f32_16x16x32_bf16 v[24:27], v[12:15], a[40:43], v[24:27]
  v_mfma_f32_16x16x32_bf16 v[24:27], v[16:19], a[44:47], v[24:27]
  v_add_f32_dpp v34, v28, v29 row_ror:8 row_mask:0x1 bank_mask:0xc
  s_nop 2
  v_add_f32_dpp v34, v21, v20 row_ror:8 row_mask:0x2 bank_mask:0x3
  s_nop 2
  v_add_f32_dpp v34, v24, v25 row_ror:8 row_mask:0x2 bank_mask:0xc
  v_max3_f32 v20, v32, v33, v34
  s_nop 1
  v_max_f32_dpp v20, v20, v20 row_ror:8 row_mask:0xf bank_mask:0xf
  s_nop 1
  v_max_f32_dpp v20, v20, v20 row_ror:4 row_mask:0xf bank_mask:0xf
  s_nop 1
  v_max_f32_dpp v20, v20, v20 row_ror:2 row_mask:0xf bank_mask:0xf
  s_nop 1
  v_max_f32_dpp v20, v20, v20 row_ror:1 row_mask:0xf bank_mask:0xf
  v_mov_b32 v21, v20
  s_nop 1
  v_permlane16_swap_b32 v20, v21
  v_max_f32 v20, v20, v21
  v_mov_b32 v21, v20
  s_nop 1
  v_permlane32_swap_b32 v20, v21
  v_max_f32 v20, v20, v21
  v_mul_f32 v38, s56, v20
  v_fma_f32 v32, v32, s56, -v38
  v_fma_f32 v33, v33, s56, -v38
  v_fma_f32 v34, v34, s56, -v38
  v_exp_f32 v32, v32
  v_exp_f32 v33, v33
  v_exp_f32 v34, v34
  v_cvt_pk_bf16_f32 v22, v32, v32
  v_cvt_pk_bf16_f32 v23, v33, v33
  v_cvt_pk_bf16_f32 v24, v34, v34
  ds_write_b16 v35, v22 offset:0
  ds_write_b16 v35, v23 offset:128
  ds_write_b16 v35, v24 offset:256
  v_add_f32 v39, v32, v33
  v_add_f32 v39, v39, v34
  ds_read_b128 v[28:31], v36
  ds_read_b128 v[32:35], v36 offset:64
  s_waitcnt lgkmcnt(1)
  v_perm_b32 v20, v28, v28, v4
  v_perm_b32 v21, v28, v28, v5
  v_perm_b32 v22, v28, v28, v6
  v_perm_b32 v23, v28, v28, v7
  s_nop 1
  v_mfma_f32_16x16x32_bf16 v[8:11], v[20:23], a[48:51], 0
  v_perm_b32 v24, v29, v29, v4
  v_perm_b32 v25, v29, v29, v5
  v_mfma_f32_16x16x32_bf16 v[12:15], v[20:23], a[52:55], 0
  v_perm_b32 v26, v29, v29, v6
  v_perm_b32 v27, v29, v29, v7
  v_mfma_f32_16x16x32_bf16 v[16:19], v[20:23], a[56:59], 0
  s_nop 0
  v_mfma_f32_16x16x32_bf16 v[8:11], v[24:27], a[60:63], v[8:11]
  v_perm_b32 v20, v30, v30, v4
  v_perm_b32 v21, v30, v30, v5
  s_waitcnt vmcnt(55)
  v_mfma_f32_16x16x32_bf16 v[12:15], v[24:27], a[64:67], v[12:15]
  v_perm_b32 v22, v30, v30, v6
  v_perm_b32 v23, v30, v30, v7
  s_waitcnt vmcnt(54)
  v_mfma_f32_16x16x32_bf16 v[16:19], v[24:27], a[68:71], v[16:19]
  v_add_f32_dpp v39, v39, v39 row_ror:8 row_mask:0xf bank_mask:0xf
  s_waitcnt vmcnt(53)
  v_mfma_f32_16x16x32_bf16 v[8:11], v[20:23], a[72:75], v[8:11]
  v_perm_b32 v24, v31, v31, v4
  v_perm_b32 v25, v31, v31, v5
  s_waitcnt vmcnt(52)
  v_mfma_f32_16x16x32_bf16 v[12:15], v[20:23], a[76:79], v[12:15]
  v_perm_b32 v26, v31, v31, v6
  v_perm_b32 v27, v31, v31, v7
  s_waitcnt vmcnt(51)
  v_mfma_f32_16x16x32_bf16 v[16:19], v[20:23], a[80:83], v[16:19]
  ds_read_b128 v[28:31], v36 offset:128
  v_add_f32_dpp v39, v39, v39 row_ror:4 row_mask:0xf bank_mask:0xf
  s_waitcnt lgkmcnt(1)
  s_waitcnt vmcnt(50)
  v_mfma_f32_16x16x32_bf16 v[8:11], v[24:27], a[84:87], v[8:11]
  v_perm_b32 v20, v32, v32, v4
  v_perm_b32 v21, v32, v32, v5
  s_waitcnt vmcnt(49)
  v_mfma_f32_16x16x32_bf16 v[12:15], v[24:27], a[88:91], v[12:15]
  v_perm_b32 v22, v32, v32, v6
  v_perm_b32 v23, v32, v32, v7
  s_waitcnt vmcnt(48)
  v_mfma_f32_16x16x32_bf16 v[16:19], v[24:27], a[92:95], v[16:19]
  v_add_f32_dpp v39, v39, v39 row_ror:2 row_mask:0xf bank_mask:0xf
  s_waitcnt vmcnt(47)
  v_mfma_f32_16x16x32_bf16 v[8:11], v[20:23], a[96:99], v[8:11]
  v_perm_b32 v24, v33, v33, v4
  v_perm_b32 v25, v33, v33, v5
  s_waitcnt vmcnt(46)
  v_mfma_f32_16x16x32_bf16 v[12:15], v[20:23], a[100:103], v[12:15]
  v_perm_b32 v26, v33, v33, v6
  v_perm_b32 v27, v33, v33, v7
  s_waitcnt vmcnt(45)
  v_mfma_f32_16x16x32_bf16 v[16:19], v[20:23], a[104:107], v[16:19]
  v_add_f32_dpp v39, v39, v39 row_ror:1 row_mask:0xf bank_mask:0xf
  s_waitcnt vmcnt(44)
  v_mfma_f32_16x16x32_bf16 v[8:11], v[24:27], a[108:111], v[8:11]
  v_perm_b32 v20, v34, v34, v4
  v_perm_b32 v21, v34, v34, v5
  s_waitcnt vmcnt(43)
  v_mfma_f32_16x16x32_bf16 v[12:15], v[24:27], a[112:115], v[12:15]
  v_perm_b32 v22, v34, v34, v6
  v_perm_b32 v23, v34, v34, v7
  s_waitcnt vmcnt(42)
  v_mfma_f32_16x16x32_bf16 v[16:19], v[24:27], a[116:119], v[16:19]
  v_mov_b32 v37, v39
  s_waitcnt vmcnt(41)
  v_mfma_f32_16x16x32_bf16 v[8:11], v[20:23], a[120:123], v[8:11]
  v_perm_b32 v24, v35, v35, v4
  v_perm_b32 v25, v35, v35, v5
  s_waitcnt vmcnt(40)
  v_mfma_f32_16x16x32_bf16 v[12:15], v[20:23], a[124:127], v[12:15]
  v_perm_b32 v26, v35, v35, v6
  v_perm_b32 v27, v35, v35, v7
  s_waitcnt vmcnt(39)
  v_mfma_f32_16x16x32_bf16 v[16:19], v[20:23], a[128:131], v[16:19]
  ds_read_b128 v[32:35], v36 offset:192
  v_permlane16_swap_b32 v39, v37
  s_waitcnt lgkmcnt(1)
  s_waitcnt vmcnt(38)
  v_mfma_f32_16x16x32_bf16 v[8:11], v[24:27], a[132:135], v[8:11]
  v_perm_b32 v20, v28, v28, v4
  v_perm_b32 v21, v28, v28, v5
  s_waitcnt vmcnt(37)
  v_mfma_f32_16x16x32_bf16 v[12:15], v[24:27], a[136:139], v[12:15]
  v_perm_b32 v22, v28, v28, v6
  v_perm_b32 v23, v28, v28, v7
  s_waitcnt vmcnt(36)
  v_mfma_f32_16x16x32_bf16 v[16:19], v[24:27], a[140:143], v[16:19]
  v_add_f32 v39, v39, v37
  s_waitcnt vmcnt(35)
  v_mfma_f32_16x16x32_bf16 v[8:11], v[20:23], a[144:147], v[8:11]
  v_perm_b32 v24, v29, v29, v4
  v_perm_b32 v25, v29, v29, v5
  s_waitcnt vmcnt(34)
  v_mfma_f32_16x16x32_bf16 v[12:15], v[20:23], a[148:151], v[12:15]
  v_perm_b32 v26, v29, v29, v6
  v_perm_b32 v27, v29, v29, v7
  s_waitcnt vmcnt(33)
  v_mfma_f32_16x16x32_bf16 v[16:19], v[20:23], a[152:155], v[16:19]
  v_mov_b32 v37, v39
  s_waitcnt vmcnt(32)
  v_mfma_f32_16x16x32_bf16 v[8:11], v[24:27], a[156:159], v[8:11]
  v_perm_b32 v20, v30, v30, v4
  v_perm_b32 v21, v30, v30, v5
  s_waitcnt vmcnt(31)
  v_mfma_f32_16x16x32_bf16 v[12:15], v[24:27], a[160:163], v[12:15]
  v_perm_b32 v22, v30, v30, v6
  v_perm_b32 v23, v30, v30, v7
  s_waitcnt vmcnt(30)
  v_mfma_f32_16x16x32_bf16 v[16:19], v[24:27], a[164:167], v[16:19]
  v_permlane32_swap_b32 v39, v37
  s_waitcnt vmcnt(29)
  v_mfma_f32_16x16x32_bf16 v[8:11], v[20:23], a[168:171], v[8:11]
  v_perm_b32 v24, v31, v31, v4
  v_perm_b32 v25, v31, v31, v5
  s_waitcnt vmcnt(28)
  v_mfma_f32_16x16x32_bf16 v[12:15], v[20:23], a[172:175], v[12:15]
  v_perm_b32 v26, v31, v31, v6
  v_perm_b32 v27, v31, v31, v7
  s_waitcnt vmcnt(27)
  v_mfma_f32_16x16x32_bf16 v[16:19], v[20:23], a[176:179], v[16:19]
  ds_read_b128 v[28:31], v36 offset:256
  v_add_f32 v39, v39, v37
  s_waitcnt lgkmcnt(1)
  s_waitcnt vmcnt(26)
  v_mfma_f32_16x16x32_bf16 v[8:11], v[24:27], a[180:183], v[8:11]
  v_perm_b32 v20, v32, v32, v4
  v_perm_b32 v21, v32, v32, v5
  s_waitcnt vmcnt(25)
  v_mfma_f32_16x16x32_bf16 v[12:15], v[24:27], a[184:187], v[12:15]
  v_perm_b32 v22, v32, v32, v6
  v_perm_b32 v23, v32, v32, v7
  s_waitcnt vmcnt(24)
  v_mfma_f32_16x16x32_bf16 v[16:19], v[24:27], a[188:191], v[16:19]
  s_waitcnt vmcnt(23)
  v_mfma_f32_16x16x32_bf16 v[8:11], v[20:23], a[192:195], v[8:11]
  v_perm_b32 v24, v33, v33, v4
  v_perm_b32 v25, v33, v33, v5
  s_waitcnt vmcnt(22)
  v_mfma_f32_16x16x32_bf16 v[12:15], v[20:23], a[196:199], v[12:15]
  v_perm_b32 v26, v33, v33, v6
  v_perm_b32 v27, v33, v33, v7
  s_waitcnt vmcnt(21)
  v_mfma_f32_16x16x32_bf16 v[16:19], v[20:23], a[200:203], v[16:19]
  s_waitcnt vmcnt(20)
  v_mfma_f32_16x16x32_bf16 v[8:11], v[24:27], a[204:207], v[8:11]
  v_perm_b32 v20, v34, v34, v4
  v_perm_b32 v21, v34, v34, v5
  s_waitcnt vmcnt(19)
  v_mfma_f32_16x16x32_bf16 v[12:15], v[24:27], a[208:211], v[12:15]
  v_perm_b32 v22, v34, v34, v6
  v_perm_b32 v23, v34, v34, v7
  s_waitcnt vmcnt(18)
  v_mfma_f32_16x16x32_bf16 v[16:19], v[24:27], a[212:215], v[16:19]
  s_waitcnt vmcnt(17)
  v_mfma_f32_16x16x32_bf16 v[8:11], v[20:23], a[216:219], v[8:11]
  v_perm_b32 v24, v35, v35, v4
  v_perm_b32 v25, v35, v35, v5
  s_waitcnt vmcnt(16)
  v_mfma_f32_16x16x32_bf16 v[12:15], v[20:23], a[220:223], v[12:15]
  v_perm_b32 v26, v35, v35, v6
  v_perm_b32 v27, v35, v35, v7
  s_waitcnt vmcnt(15)
  v_mfma_f32_16x16x32_bf16 v[16:19], v[20:23], a[224:227], v[16:19]
  s_waitcnt lgkmcnt(0)
  s_waitcnt vmcnt(14)
  v_mfma_f32_16x16x32_bf16 v[8:11], v[24:27], a[228:231], v[8:11]
  v_perm_b32 v20, v28, v28, v4
  v_perm_b32 v21, v28, v28, v5
  s_waitcnt vmcnt(13)
  v_mfma_f32_16x16x32_bf16 v[12:15], v[24:27], a[232:235], v[12:15]
  v_perm_b32 v22, v28, v28, v6
  v_perm_b32 v23, v28, v28, v7
  s_waitcnt vmcnt(12)
  v_mfma_f32_16x16x32_bf16 v[16:19], v[24:27], a[236:239], v[16:19]
  s_waitcnt vmcnt(11)
  v_mfma_f32_16x16x32_bf16 v[8:11], v[20:23], a[240:243], v[8:11]
  v_perm_b32 v24, v29, v29, v4
  v_perm_b32 v25, v29, v29, v5
  s_waitcnt vmcnt(10)
  v_mfma_f32_16x16x32_bf16 v[12:15], v[20:23], a[244:247], v[12:15]
  v_perm_b32 v26, v29, v29, v6
  v_perm_b32 v27, v29, v29, v7
  s_waitcnt vmcnt(9)
  v_mfma_f32_16x16x32_bf16 v[16:19], v[20:23], a[248:251], v[16:19]
  s_waitcnt vmcnt(8)
  v_mfma_f32_16x16x32_bf16 v[8:11], v[24:27], a[252:255], v[8:11]
  v_perm_b32 v20, v30, v30, v4
  v_perm_b32 v21, v30, v30, v5
  s_waitcnt vmcnt(7)
  v_mfma_f32_16x16x32_bf16 v[12:15], v[24:27], v[40:43], v[12:15]
  v_perm_b32 v22, v30, v30, v6
  v_perm_b32 v23, v30, v30, v7
  s_waitcnt vmcnt(6)
  v_mfma_f32_16x16x32_bf16 v[16:19], v[24:27], v[44:47], v[16:19]
  s_waitcnt vmcnt(5)
  v_mfma_f32_16x16x32_bf16 v[8:11], v[20:23], v[48:51], v[8:11]
  v_perm_b32 v24, v31, v31, v4
  v_perm_b32 v25, v31, v31, v5
  s_waitcnt vmcnt(4)
  v_mfma_f32_16x16x32_bf16 v[12:15], v[20:23], v[52:55], v[12:15]
  v_perm_b32 v26, v31, v31, v6
  v_perm_b32 v27, v31, v31, v7
  s_waitcnt vmcnt(3)
  v_mfma_f32_16x16x32_bf16 v[16:19], v[20:23], v[56:59], v[16:19]
  s_waitcnt vmcnt(2)
  v_mfma_f32_16x16x32_bf16 v[8:11], v[24:27], v[60:63], v[8:11]
  s_waitcnt vmcnt(1)
  v_mfma_f32_16x16x32_bf16 v[12:15], v[24:27], v[64:67], v[12:15]
  s_waitcnt vmcnt(0)
  v_mfma_f32_16x16x32_bf16 v[16:19], v[24:27], v[68:71], v[16:19]
  v_mbcnt_lo_u32_b32 v28, -1, 0
  v_mbcnt_hi_u32_b32 v28, -1, v28
  v_and_b32 v29, 15, v28
  v_lshrrev_b32 v30, 4, v28
  v_and_b32 v31, 1, v30
  v_lshrrev_b32 v30, 1, v30
  v_mul_u32_u24 v30, 768, v30
  v_lshl_add_u32 v30, v31, 4, v30
  v_add_u32 v30, s69, v30
  v_lshl_add_u32 v32, v29, 5, v30
  v_and_b32 v29, 7, v29
  v_lshl_add_u32 v33, v29, 5, v30
  v_mov_b32 v34, s72
  v_mov_b32 v20, v38
  v_mov_b32 v21, v39
  v_cndmask_b32 v8, v8, v12, s[70:71]
  v_cndmask_b32 v9, v9, v13, s[70:71]
  v_cndmask_b32 v10, v10, v14, s[70:71]
  v_cndmask_b32 v11, v11, v15, s[70:71]
  ds_write_b128 v32, v[8:11]
  s_mov_b32 exec_lo, 0x00ff00ff
  s_mov_b32 exec_hi, 0xff00ff00
  ds_write_b128 v33, v[16:19] offset:512
  s_mov_b64 exec, 1
  ds_write_b64 v34, v[20:21] offset:0
  s_mov_b64 exec, -1
  s_waitcnt lgkmcnt(0)
  s_barrier
  ds_read_b128 v[72:75], v0 offset:0
  ds_read_b128 v[76:79], v0 offset:1024
  ds_read_b128 v[80:83], v0 offset:2048
  ds_read_b128 v[84:87], v0 offset:3072
  ds_read_b128 v[88:91], v0 offset:4096
  ds_read_b128 v[92:95], v0 offset:5120
  ds_read_b128 v[96:99], v0 offset:6144
  ds_read_b128 v[100:103], v0 offset:7168
  ds_read_b128 v[104:107], v0 offset:8192
  ds_read_b128 v[108:111], v0 offset:9216
  ds_read_b128 v[112:115], v0 offset:10240
  ds_read_b128 v[116:119], v0 offset:11264
  s_waitcnt lgkmcnt(4)
  ds_read_b128 v[120:123], v0 offset:12288
  ds_read_b128 v[124:127], v0 offset:13312
  ds_read_b128 v[128:131], v0 offset:14336
  ds_read_b128 v[132:135], v0 offset:15360
  ds_read_b128 v[136:139], v0 offset:16384
  ds_read_b128 v[140:143], v0 offset:17408
  ds_read_b128 v[144:147], v0 offset:18432
  ds_read_b128 v[148:151], v0 offset:19456
  s_waitcnt lgkmcnt(4)
  ds_read_b128 v[152:155], v0 offset:20480
  ds_read_b128 v[156:159], v0 offset:21504
  ds_read_b128 v[160:163], v0 offset:22528
  ds_read_b128 v[164:167], v0 offset:23552
  ds_read_b128 v[168:171], v0 offset:24576
  ds_read_b128 v[172:175], v0 offset:25600
  ds_read_b128 v[176:179], v0 offset:26624
  ds_read_b128 v[180:183], v0 offset:27648
  s_waitcnt lgkmcnt(4)
  ds_read_b128 v[184:187], v0 offset:28672
  ds_read_b128 v[188:191], v0 offset:29696
  ds_read_b128 v[192:195], v0 offset:30720
  ds_read_b128 v[196:199], v0 offset:31744
  ds_read_b128 v[200:203], v0 offset:32768
  ds_read_b128 v[204:207], v0 offset:33792
  ds_read_b128 v[208:211], v0 offset:34816
  ds_read_b128 v[212:215], v0 offset:35840
  s_waitcnt lgkmcnt(4)
  ds_read_b128 v[216:219], v0 offset:36864
  ds_read_b128 v[220:223], v0 offset:37888
  ds_read_b128 v[224:227], v0 offset:38912
  ds_read_b128 v[228:231], v0 offset:39936
  ds_read_b128 v[232:235], v0 offset:40960
  ds_read_b128 v[236:239], v0 offset:41984
  ds_read_b128 v[240:243], v0 offset:43008
  ds_read_b128 v[244:247], v0 offset:44032
  s_waitcnt lgkmcnt(4)
  ds_read_b128 v[248:251], v0 offset:45056
  ds_read_b128 v[252:255], v0 offset:46080
  s_waitcnt lgkmcnt(0)
  v_mbcnt_lo_u32_b32 v20, -1, 0
  v_mbcnt_hi_u32_b32 v20, -1, v20
  v_and_b32 v21, 1, v20
  v_lshrrev_b32 v22, 4, v20
  v_lshlrev_b32 v22, 4, v22
  v_lshl_add_u32 v21, v21, 6, v22
  v_add_u32 v21, 159808, v21
  v_add_u32 v36, s69, v22
  v_lshrrev_b32 v22, 5, v20
  v_lshlrev_b32 v35, 6, v22
  v_bfe_u32 v22, v20, 1, 2
  v_lshl_add_u32 v35, v22, 4, v35
  v_bfe_u32 v22, v20, 3, 2
  v_lshl_add_u32 v35, v22, 2, v35
  v_and_b32 v22, 1, v20
  v_lshl_add_u32 v35, v22, 1, v35
  v_add_u32 v35, s69, v35
  v_mov_b32 v34, 0xff800000
  s_barrier
  ds_read_b128 v[8:11], v21 offset:384
  ds_read_b128 v[12:15], v21 offset:512
  ds_read_b128 v[16:19], v21 offset:640
  s_waitcnt lgkmcnt(0)
  v_mfma_f32_16x16x32_bf16 v[20:23], v[8:11], v[72:75], 0
  v_mfma_f32_16x16x32_bf16 v[20:23], v[12:15], v[76:79], v[20:23]
  v_mfma_f32_16x16x32_bf16 v[20:23], v[16:19], v[80:83], v[20:23]
  ds_read_b128 v[72:75], v0 offset:47104
  ds_read_b128 v[76:79], v0 offset:48128
  v_mfma_f32_16x16x32_bf16 v[24:27], v[8:11], v[84:87], 0
  v_mfma_f32_16x16x32_bf16 v[24:27], v[12:15], v[88:91], v[24:27]
  v_mfma_f32_16x16x32_bf16 v[24:27], v[16:19], v[92:95], v[24:27]
  v_mfma_f32_16x16x32_bf16 v[28:31], v[8:11], v[96:99], 0
  v_mfma_f32_16x16x32_bf16 v[28:31], v[12:15], v[100:103], v[28:31]
  v_mfma_f32_16x16x32_bf16 v[28:31], v[16:19], v[104:107], v[28:31]
  v_add_f32_dpp v32, v21, v20 row_ror:8 row_mask:0x1 bank_mask:0x3
  v_mfma_f32_16x16x32_bf16 v[20:23], v[8:11], v[108:111], 0
  v_mfma_f32_16x16x32_bf16 v[20:23], v[12:15], v[112:115], v[20:23]
  v_mfma_f32_16x16x32_bf16 v[20:23], v[16:19], v[116:119], v[20:23]
  s_nop 0
  v_add_f32_dpp v32, v24, v25 row_ror:8 row_mask:0x1 bank_mask:0xc
  v_mfma_f32_16x16x32_bf16 v[24:27], v[8:11], v[120:123], 0
  v_mfma_f32_16x16x32_bf16 v[24:27], v[12:15], v[124:127], v[24:27]
  v_mfma_f32_16x16x32_bf16 v[24:27], v[16:19], v[128:131], v[24:27]
  v_add_f32_dpp v32, v29, v28 row_ror:8 row_mask:0x2 bank_mask:0x3
  v_mfma_f32_16x16x32_bf16 v[28:31], v[8:11], v[132:135], 0
  v_mfma_f32_16x16x32_bf16 v[28:31], v[12:15], v[136:139], v[28:31]
  v_mfma_f32_16x16x32_bf16 v[28:31], v[16:19], v[140:143], v[28:31]
  v_add_f32_dpp v32, v20, v21 row_ror:8 row_mask:0x2 bank_mask:0xc
  v_mfma_f32_16x16x32_bf16 v[20:23], v[8:11], v[144:147], 0
  v_mfma_f32_16x16x32_bf16 v[20:23], v[12:15], v[148:151], v[20:23]
  v_mfma_f32_16x16x32_bf16 v[20:23], v[16:19], v[152:155], v[20:23]
  v_add_f32_dpp v32, v25, v24 row_ror:8 row_mask:0x4 bank_mask:0x3
  v_mfma_f32_16x16x32_bf16 v[24:27], v[8:11], v[156:159], 0
  v_mfma_f32_16x16x32_bf16 v[24:27], v[12:15], v[160:163], v[24:27]
  v_mfma_f32_16x16x32_bf16 v[24:27], v[16:19], v[164:167], v[24:27]
  v_add_f32_dpp v32, v28, v29 row_ror:8 row_mask:0x4 bank_mask:0xc
  v_mfma_f32_16x16x32_bf16 v[28:31], v[8:11], v[168:171], 0
  v_mfma_f32_16x16x32_bf16 v[28:31], v[12:15], v[172:175], v[28:31]
  v_mfma_f32_16x16x32_bf16 v[28:31], v[16:19], v[176:179], v[28:31]
  v_add_f32_dpp v32, v21, v20 row_ror:8 row_mask:0x8 bank_mask:0x3
  v_mfma_f32_16x16x32_bf16 v[20:23], v[8:11], v[180:183], 0
  v_mfma_f32_16x16x32_bf16 v[20:23], v[12:15], v[184:187], v[20:23]
  v_mfma_f32_16x16x32_bf16 v[20:23], v[16:19], v[188:191], v[20:23]
  v_add_f32_dpp v32, v24, v25 row_ror:8 row_mask:0x8 bank_mask:0xc
  v_mfma_f32_16x16x32_bf16 v[24:27], v[8:11], v[192:195], 0
  v_mfma_f32_16x16x32_bf16 v[24:27], v[12:15], v[196:199], v[24:27]
  v_mfma_f32_16x16x32_bf16 v[24:27], v[16:19], v[200:203], v[24:27]
  v_add_f32_dpp v33, v29, v28 row_ror:8 row_mask:0x1 bank_mask:0x3
  v_mfma_f32_16x16x32_bf16 v[28:31], v[8:11], v[204:207], 0
  v_mfma_f32_16x16x32_bf16 v[28:31], v[12:15], v[208:211], v[28:31]
  v_mfma_f32_16x16x32_bf16 v[28:31], v[16:19], v[212:215], v[28:31]
  v_add_f32_dpp v33, v20, v21 row_ror:8 row_mask:0x1 bank_mask:0xc
  v_mfma_f32_16x16x32_bf16 v[20:23], v[8:11], v[216:219], 0
  v_mfma_f32_16x16x32_bf16 v[20:23], v[12:15], v[220:223], v[20:23]
  v_mfma_f32_16x16x32_bf16 v[20:23], v[16:19], v[224:227], v[20:23]
  v_add_f32_dpp v33, v25, v24 row_ror:8 row_mask:0x2 bank_mask:0x3
  v_mfma_f32_16x16x32_bf16 v[24:27], v[8:11], v[228:231], 0
  v_mfma_f32_16x16x32_bf16 v[24:27], v[12:15], v[232:235], v[24:27]
  v_mfma_f32_16x16x32_bf16 v[24:27], v[16:19], v[236:239], v[24:27]
  v_add_f32_dpp v33, v28, v29 row_ror:8 row_mask:0x2 bank_mask:0xc
  v_mfma_f32_16x16x32_bf16 v[28:31], v[8:11], v[240:243], 0
  v_mfma_f32_16x16x32_bf16 v[28:31], v[12:15], v[244:247], v[28:31]
  v_mfma_f32_16x16x32_bf16 v[28:31], v[16:19], v[248:251], v[28:31]
  v_add_f32_dpp v33, v21, v20 row_ror:8 row_mask:0x4 bank_mask:0x3
  s_waitcnt lgkmcnt(0)
  v_mfma_f32_16x16x32_bf16 v[20:23], v[8:11], v[252:255], 0
  v_mfma_f32_16x16x32_bf16 v[20:23], v[12:15], v[72:75], v[20:23]
  v_mfma_f32_16x16x32_bf16 v[20:23], v[16:19], v[76:79], v[20:23]
  v_add_f32_dpp v33, v24, v25 row_ror:8 row_mask:0x4 bank_mask:0xc
  v_mfma_f32_16x16x32_bf16 v[24:27], v[8:11], a[0:3], 0
  v_mfma_f32_16x16x32_bf16 v[24:27], v[12:15], a[4:7], v[24:27]
  v_mfma_f32_16x16x32_bf16 v[24:27], v[16:19], a[8:11], v[24:27]
  v_add_f32_dpp v33, v29, v28 row_ror:8 row_mask:0x8 bank_mask:0x3
  v_mfma_f32_16x16x32_bf16 v[28:31], v[8:11], a[12:15], 0
  v_mfma_f32_16x16x32_bf16 v[28:31], v[12:15], a[16:19], v[28:31]
  v_mfma_f32_16x16x32_bf16 v[28:31], v[16:19], a[20:23], v[28:31]
  v_add_f32_dpp v33, v20, v21 row_ror:8 row_mask:0x8 bank_mask:0xc
  v_mfma_f32_16x16x32_bf16 v[20:23], v[8:11], a[24:27], 0
  v_mfma_f32_16x16x32_bf16 v[20:23], v[12:15], a[28:31], v[20:23]
  v_mfma_f32_16x16x32_bf16 v[20:23], v[16:19], a[32:35], v[20:23]
  v_add_f32_dpp v34, v25, v24 row_ror:8 row_mask:0x1 bank_mask:0x3
  v_mfma_f32_16x16x32_bf16 v[24:27], v[8:11], a[36:39], 0
  v_mfma_f32_16x16x32_bf16 v[24:27], v[12:15], a[40:43], v[24:27]
  v_mfma_f32_16x16x32_bf16 v[24:27], v[16:19], a[44:47], v[24:27]
  v_add_f32_dpp v34, v28, v29 row_ror:8 row_mask:0x1 bank_mask:0xc
  s_nop 2
  v_add_f32_dpp v34, v21, v20 row_ror:8 row_mask:0x2 bank_mask:0x3
  s_nop 2
  v_add_f32_dpp v34, v24, v25 row_ror:8 row_mask:0x2 bank_mask:0xc
  v_max3_f32 v20, v32, v33, v34
  s_nop 1
  v_max_f32_dpp v20, v20, v20 row_ror:8 row_mask:0xf bank_mask:0xf
  s_nop 1
  v_max_f32_dpp v20, v20, v20 row_ror:4 row_mask:0xf bank_mask:0xf
  s_nop 1
  v_max_f32_dpp v20, v20, v20 row_ror:2 row_mask:0xf bank_mask:0xf
  s_nop 1
  v_max_f32_dpp v20, v20, v20 row_ror:1 row_mask:0xf bank_mask:0xf
  v_mov_b32 v21, v20
  s_nop 1
  v_permlane16_swap_b32 v20, v21
  v_max_f32 v20, v20, v21
  v_mov_b32 v21, v20
  s_nop 1
  v_permlane32_swap_b32 v20, v21
  v_max_f32 v20, v20, v21
  v_mul_f32 v38, s56, v20
  v_fma_f32 v32, v32, s56, -v38
  v_fma_f32 v33, v33, s56, -v38
  v_fma_f32 v34, v34, s56, -v38
  v_exp_f32 v32, v32
  v_exp_f32 v33, v33
  v_exp_f32 v34, v34
  v_cvt_pk_bf16_f32 v22, v32, v32
  v_cvt_pk_bf16_f32 v23, v33, v33
  v_cvt_pk_bf16_f32 v24, v34, v34
  ds_write_b16 v35, v22 offset:0
  ds_write_b16 v35, v23 offset:128
  ds_write_b16 v35, v24 offset:256
  v_add_f32 v39, v32, v33
  v_add_f32 v39, v39, v34
  ds_read_b128 v[28:31], v36
  ds_read_b128 v[32:35], v36 offset:64
  s_waitcnt lgkmcnt(1)
  v_perm_b32 v20, v28, v28, v4
  v_perm_b32 v21, v28, v28, v5
  v_perm_b32 v22, v28, v28, v6
  v_perm_b32 v23, v28, v28, v7
  s_nop 1
  v_mfma_f32_16x16x32_bf16 v[8:11], v[20:23], a[48:51], 0
  v_perm_b32 v24, v29, v29, v4
  v_perm_b32 v25, v29, v29, v5
  v_mfma_f32_16x16x32_bf16 v[12:15], v[20:23], a[52:55], 0
  v_perm_b32 v26, v29, v29, v6
  v_perm_b32 v27, v29, v29, v7
  v_mfma_f32_16x16x32_bf16 v[16:19], v[20:23], a[56:59], 0
  s_nop 0
  v_mfma_f32_16x16x32_bf16 v[8:11], v[24:27], a[60:63], v[8:11]
  v_perm_b32 v20, v30, v30, v4
  v_perm_b32 v21, v30, v30, v5
  v_mfma_f32_16x16x32_bf16 v[12:15], v[24:27], a[64:67], v[12:15]
  v_perm_b32 v22, v30, v30, v6
  v_perm_b32 v23, v30, v30, v7
  v_mfma_f32_16x16x32_bf16 v[16:19], v[24:27], a[68:71], v[16:19]
  v_add_f32_dpp v39, v39, v39 row_ror:8 row_mask:0xf bank_mask:0xf
  v_mfma_f32_16x16x32_bf16 v[8:11], v[20:23], a[72:75], v[8:11]
  v_perm_b32 v24, v31, v31, v4
  v_perm_b32 v25, v31, v31, v5
  v_mfma_f32_16x16x32_bf16 v[12:15], v[20:23], a[76:79], v[12:15]
  v_perm_b32 v26, v31, v31, v6
  v_perm_b32 v27, v31, v31, v7
  v_mfma_f32_16x16x32_bf16 v[16:19], v[20:23], a[80:83], v[16:19]
  ds_read_b128 v[28:31], v36 offset:128
  v_add_f32_dpp v39, v39, v39 row_ror:4 row_mask:0xf bank_mask:0xf
  s_waitcnt lgkmcnt(1)
  v_mfma_f32_16x16x32_bf16 v[8:11], v[24:27], a[84:87], v[8:11]
  v_perm_b32 v20, v32, v32, v4
  v_perm_b32 v21, v32, v32, v5
  v_mfma_f32_16x16x32_bf16 v[12:15], v[24:27], a[88:91], v[12:15]
  v_perm_b32 v22, v32, v32, v6
  v_perm_b32 v23, v32, v32, v7
  v_mfma_f32_16x16x32_bf16 v[16:19], v[24:27], a[92:95], v[16:19]
  v_add_f32_dpp v39, v39, v39 row_ror:2 row_mask:0xf bank_mask:0xf
  v_mfma_f32_16x16x32_bf16 v[8:11], v[20:23], a[96:99], v[8:11]
  v_perm_b32 v24, v33, v33, v4
  v_perm_b32 v25, v33, v33, v5
  v_mfma_f32_16x16x32_bf16 v[12:15], v[20:23], a[100:103], v[12:15]
  v_perm_b32 v26, v33, v33, v6
  v_perm_b32 v27, v33, v33, v7
  v_mfma_f32_16x16x32_bf16 v[16:19], v[20:23], a[104:107], v[16:19]
  v_add_f32_dpp v39, v39, v39 row_ror:1 row_mask:0xf bank_mask:0xf
  v_mfma_f32_16x16x32_bf16 v[8:11], v[24:27], a[108:111], v[8:11]
  v_perm_b32 v20, v34, v34, v4
  v_perm_b32 v21, v34, v34, v5
  v_mfma_f32_16x16x32_bf16 v[12:15], v[24:27], a[112:115], v[12:15]
  v_perm_b32 v22, v34, v34, v6
  v_perm_b32 v23, v34, v34, v7
  v_mfma_f32_16x16x32_bf16 v[16:19], v[24:27], a[116:119], v[16:19]
  v_mov_b32 v37, v39
  v_mfma_f32_16x16x32_bf16 v[8:11], v[20:23], a[120:123], v[8:11]
  v_perm_b32 v24, v35, v35, v4
  v_perm_b32 v25, v35, v35, v5
  v_mfma_f32_16x16x32_bf16 v[12:15], v[20:23], a[124:127], v[12:15]
  v_perm_b32 v26, v35, v35, v6
  v_perm_b32 v27, v35, v35, v7
  v_mfma_f32_16x16x32_bf16 v[16:19], v[20:23], a[128:131], v[16:19]
  ds_read_b128 v[32:35], v36 offset:192
  v_permlane16_swap_b32 v39, v37
  s_waitcnt lgkmcnt(1)
  v_mfma_f32_16x16x32_bf16 v[8:11], v[24:27], a[132:135], v[8:11]
  v_perm_b32 v20, v28, v28, v4
  v_perm_b32 v21, v28, v28, v5
  v_mfma_f32_16x16x32_bf16 v[12:15], v[24:27], a[136:139], v[12:15]
  v_perm_b32 v22, v28, v28, v6
  v_perm_b32 v23, v28, v28, v7
  v_mfma_f32_16x16x32_bf16 v[16:19], v[24:27], a[140:143], v[16:19]
  v_add_f32 v39, v39, v37
  v_mfma_f32_16x16x32_bf16 v[8:11], v[20:23], a[144:147], v[8:11]
  v_perm_b32 v24, v29, v29, v4
  v_perm_b32 v25, v29, v29, v5
  v_mfma_f32_16x16x32_bf16 v[12:15], v[20:23], a[148:151], v[12:15]
  v_perm_b32 v26, v29, v29, v6
  v_perm_b32 v27, v29, v29, v7
  v_mfma_f32_16x16x32_bf16 v[16:19], v[20:23], a[152:155], v[16:19]
  v_mov_b32 v37, v39
  v_mfma_f32_16x16x32_bf16 v[8:11], v[24:27], a[156:159], v[8:11]
  v_perm_b32 v20, v30, v30, v4
  v_perm_b32 v21, v30, v30, v5
  v_mfma_f32_16x16x32_bf16 v[12:15], v[24:27], a[160:163], v[12:15]
  v_perm_b32 v22, v30, v30, v6
  v_perm_b32 v23, v30, v30, v7
  v_mfma_f32_16x16x32_bf16 v[16:19], v[24:27], a[164:167], v[16:19]
  v_permlane32_swap_b32 v39, v37
  v_mfma_f32_16x16x32_bf16 v[8:11], v[20:23], a[168:171], v[8:11]
  v_perm_b32 v24, v31, v31, v4
  v_perm_b32 v25, v31, v31, v5
  v_mfma_f32_16x16x32_bf16 v[12:15], v[20:23], a[172:175], v[12:15]
  v_perm_b32 v26, v31, v31, v6
  v_perm_b32 v27, v31, v31, v7
  v_mfma_f32_16x16x32_bf16 v[16:19], v[20:23], a[176:179], v[16:19]
  ds_read_b128 v[28:31], v36 offset:256
  v_add_f32 v39, v39, v37
  s_waitcnt lgkmcnt(1)
  v_mfma_f32_16x16x32_bf16 v[8:11], v[24:27], a[180:183], v[8:11]
  v_perm_b32 v20, v32, v32, v4
  v_perm_b32 v21, v32, v32, v5
  v_mfma_f32_16x16x32_bf16 v[12:15], v[24:27], a[184:187], v[12:15]
  v_perm_b32 v22, v32, v32, v6
  v_perm_b32 v23, v32, v32, v7
  v_mfma_f32_16x16x32_bf16 v[16:19], v[24:27], a[188:191], v[16:19]
  s_nop 0
  v_mfma_f32_16x16x32_bf16 v[8:11], v[20:23], a[192:195], v[8:11]
  v_perm_b32 v24, v33, v33, v4
  v_perm_b32 v25, v33, v33, v5
  v_mfma_f32_16x16x32_bf16 v[12:15], v[20:23], a[196:199], v[12:15]
  v_perm_b32 v26, v33, v33, v6
  v_perm_b32 v27, v33, v33, v7
  v_mfma_f32_16x16x32_bf16 v[16:19], v[20:23], a[200:203], v[16:19]
  s_nop 0
  v_mfma_f32_16x16x32_bf16 v[8:11], v[24:27], a[204:207], v[8:11]
  v_perm_b32 v20, v34, v34, v4
  v_perm_b32 v21, v34, v34, v5
  v_mfma_f32_16x16x32_bf16 v[12:15], v[24:27], a[208:211], v[12:15]
  v_perm_b32 v22, v34, v34, v6
  v_perm_b32 v23, v34, v34, v7
  v_mfma_f32_16x16x32_bf16 v[16:19], v[24:27], a[212:215], v[16:19]
  s_nop 0
  v_mfma_f32_16x16x32_bf16 v[8:11], v[20:23], a[216:219], v[8:11]
  v_perm_b32 v24, v35, v35, v4
  v_perm_b32 v25, v35, v35, v5
  v_mfma_f32_16x16x32_bf16 v[12:15], v[20:23], a[220:223], v[12:15]
  v_perm_b32 v26, v35, v35, v6
  v_perm_b32 v27, v35, v35, v7
  v_mfma_f32_16x16x32_bf16 v[16:19], v[20:23], a[224:227], v[16:19]
  s_waitcnt lgkmcnt(0)
  v_mfma_f32_16x16x32_bf16 v[8:11], v[24:27], a[228:231], v[8:11]
  v_perm_b32 v20, v28, v28, v4
  v_perm_b32 v21, v28, v28, v5
  v_mfma_f32_16x16x32_bf16 v[12:15], v[24:27], a[232:235], v[12:15]
  v_perm_b32 v22, v28, v28, v6
  v_perm_b32 v23, v28, v28, v7
  v_mfma_f32_16x16x32_bf16 v[16:19], v[24:27], a[236:239], v[16:19]
  s_nop 0
  v_mfma_f32_16x16x32_bf16 v[8:11], v[20:23], a[240:243], v[8:11]
  v_perm_b32 v24, v29, v29, v4
  v_perm_b32 v25, v29, v29, v5
  v_mfma_f32_16x16x32_bf16 v[12:15], v[20:23], a[244:247], v[12:15]
  v_perm_b32 v26, v29, v29, v6
  v_perm_b32 v27, v29, v29, v7
  v_mfma_f32_16x16x32_bf16 v[16:19], v[20:23], a[248:251], v[16:19]
  s_nop 0
  v_mfma_f32_16x16x32_bf16 v[8:11], v[24:27], a[252:255], v[8:11]
  v_perm_b32 v20, v30, v30, v4
  v_perm_b32 v21, v30, v30, v5
  v_mfma_f32_16x16x32_bf16 v[12:15], v[24:27], v[40:43], v[12:15]
  v_perm_b32 v22, v30, v30, v6
  v_perm_b32 v23, v30, v30, v7
  v_mfma_f32_16x16x32_bf16 v[16:19], v[24:27], v[44:47], v[16:19]
  s_nop 0
  v_mfma_f32_16x16x32_bf16 v[8:11], v[20:23], v[48:51], v[8:11]
  v_perm_b32 v24, v31, v31, v4
  v_perm_b32 v25, v31, v31, v5
  v_mfma_f32_16x16x32_bf16 v[12:15], v[20:23], v[52:55], v[12:15]
  v_perm_b32 v26, v31, v31, v6
  v_perm_b32 v27, v31, v31, v7
  v_mfma_f32_16x16x32_bf16 v[16:19], v[20:23], v[56:59], v[16:19]
  s_nop 0
  v_mfma_f32_16x16x32_bf16 v[8:11], v[24:27], v[60:63], v[8:11]
  v_mfma_f32_16x16x32_bf16 v[12:15], v[24:27], v[64:67], v[12:15]
  v_mfma_f32_16x16x32_bf16 v[16:19], v[24:27], v[68:71], v[16:19]
  v_mbcnt_lo_u32_b32 v28, -1, 0
  v_mbcnt_hi_u32_b32 v28, -1, v28
  v_and_b32 v29, 15, v28
  v_lshrrev_b32 v30, 4, v28
  v_and_b32 v31, 1, v30
  v_lshrrev_b32 v30, 1, v30
  v_mul_u32_u24 v30, 768, v30
  v_lshl_add_u32 v30, v31, 4, v30
  v_add_u32 v30, s69, v30
  v_lshl_add_u32 v32, v29, 5, v30
  v_and_b32 v29, 7, v29
  v_lshl_add_u32 v33, v29, 5, v30
  v_mov_b32 v34, s72
  v_mov_b32 v20, v38
  v_mov_b32 v21, v39
  v_cndmask_b32 v8, v8, v12, s[70:71]
  v_cndmask_b32 v9, v9, v13, s[70:71]
  v_cndmask_b32 v10, v10, v14, s[70:71]
  v_cndmask_b32 v11, v11, v15, s[70:71]
  ds_write_b128 v32, v[8:11]
  s_mov_b32 exec_lo, 0x00ff00ff
  s_mov_b32 exec_hi, 0xff00ff00
  ds_write_b128 v33, v[16:19] offset:512
  s_mov_b64 exec, 1
  ds_write_b64 v34, v[20:21] offset:0
  s_mov_b64 exec, -1
  s_waitcnt lgkmcnt(0)
  s_barrier
  s_endpgm
L_chain:
  v_mbcnt_lo_u32_b32 v0, -1, 0
  v_mbcnt_hi_u32_b32 v0, -1, v0
  v_mov_b32 v74, 0x7fff0000
  s_lshl_b32 s58, s31, 13
  s_lshl_b32 s66, s30, 10
  s_add_u32 s57, s58, s66
  s_lshl_b32 s60, s28, 3
  s_add_u32 s60, s60, s30
  s_lshl_b32 s60, s60, 12
  s_lshl_b32 s66, s29, 10
  s_add_u32 s59, s60, s66
  s_lshl_b32 s62, s30, 13
  s_lshl_b32 s66, s28, 10
  s_add_u32 s61, s62, s66
  s_mov_b32 s36, s8
  s_and_b32 s37, s9, 0xffff
  s_mov_b32 s38, 100663296
  s_mov_b32 s39, 0x20000
  s_mov_b32 s48, s26
  s_and_b32 s49, s27, 0xffff
  s_mov_b32 s50, 6291456
  s_mov_b32 s51, 0x20000
  s_mov_b32 s56, 0x3dd53b95
  s_mov_b32 s70, 0
  s_mov_b32 s71, -1
  s_mul_i32 s69, s3, 1536
  s_add_u32 s69, s69, 153600
  s_lshl_b32 s72, s3, 3
  s_add_u32 s72, s72, 159744
  v_lshlrev_b32 v83, 4, v0
  s_mov_b32 vcc_lo, 0xffffffff
  s_mov_b32 vcc_hi, 0x0001ffff
  v_cndmask_b32 v5, v74, v83, vcc
  s_load_dword s73, s[26:27], 896
  v_mov_b32 v32, -1
  v_mov_b32 v33, -1
  v_mov_b32 v34, -1
  v_mov_b32 v35, -1
  s_add_u32 s63, s57, 1048576
  buffer_store_dwordx4 v[32:35], v5, s[48:51], s63 offen sc1
  s_add_u32 s63, s57, 1310720
  buffer_store_dwordx4 v[32:35], v5, s[48:51], s63 offen sc1
  s_add_u32 s63, s57, 1572864
  buffer_store_dwordx4 v[32:35], v5, s[48:51], s63 offen sc1
  v_lshlrev_b32 v84, 4, v0
  s_mov_b32 vcc_lo, 0x00ffffff
  s_mov_b32 vcc_hi, 0x00000000
  v_cndmask_b32 v36, v74, v84, vcc
  s_add_u32 s63, s57, 2359296
  buffer_store_dwordx4 v[32:35], v36, s[48:51], s63 offen sc1
  s_getreg_b32 s68, hwreg(HW_REG_XCC_ID)
  s_and_b32 s68, s68, 0xf
  s_mov_b32 s44, s4
  s_and_b32 s45, s5, 0xffff
  s_mov_b32 s46, 2560
  s_mov_b32 s47, 0x20000
  v_and_b32 v84, 31, v0
  v_lshlrev_b32 v84, 3, v84
  v_lshrrev_b32 v85, 5, v0
  v_mul_u32_u24 v85, 1280, v85
  v_add_u32 v84, v84, v85
  s_mov_b32 vcc_lo, 0x000fffff
  s_mov_b32 vcc_hi, 0x000fffff
  v_cndmask_b32 v84, v74, v84, vcc
  s_mul_i32 s66, s30, 160
  buffer_load_dwordx2 v[16:17], v84, s[44:47], s66 offen
  s_add_u32 s41, s40, 50331648
  v_and_b32 v32, 15, v0
  v_lshrrev_b32 v33, 3, v32
  v_mul_u32_u24 v33, 0x202, v33
  v_add_u32 v33, 0x100, v33
  v_or_b32 v34, 0x0c0c0000, v33
  v_lshlrev_b32 v35, 16, v33
  v_or_b32 v35, 0x0c0c, v35
  v_and_b32 v33, 1, v32
  v_cmp_eq_u32 vcc, 1, v33
  s_nop 1
  v_cndmask_b32 v34, v34, v35, vcc
  v_bfe_u32 v33, v32, 1, 2
  v_mov_b32 v35, 0x0c0c0c0c
  v_cmp_eq_u32 vcc, 0, v33
  s_nop 1
  v_cndmask_b32 v75, v35, v34, vcc
  v_cmp_eq_u32 vcc, 1, v33
  s_nop 1
  v_cndmask_b32 v76, v35, v34, vcc
  v_cmp_eq_u32 vcc, 2, v33
  s_nop 1
  v_cndmask_b32 v77, v35, v34, vcc
  v_cmp_eq_u32 vcc, 3, v33
  s_nop 1
  v_cndmask_b32 v78, v35, v34, vcc
  v_mov_b32 v35, v83
  s_mov_b32 vcc_lo, 0xffffffff
  s_mov_b32 vcc_hi, 0x0000ffff
  v_mov_b32 v83, 0x00000000
  v_cndmask_b32 v83, v83, v35, vcc
  v_and_b32 v32, 15, v0
  v_lshrrev_b32 v33, 4, v0
  v_min_u32 v34, 1, v32
  v_mul_u32_u24 v9, 384, v34
  v_lshl_add_u32 v9, v33, 4, v9
  v_add_u32 v9, 160576, v9
  v_lshlrev_b32 v12, 7, v34
  v_lshl_add_u32 v13, v33, 3, v12
  v_add_u32 v13, 161984, v13
  v_lshl_add_u32 v12, v33, 4, v12
  v_add_u32 v12, 161920, v12
  v_min_u32 v34, 2, v32
  v_mul_u32_u24 v10, 192, v34
  v_lshl_add_u32 v11, v33, 3, v10
  v_add_u32 v11, 161472, v11
  v_lshl_add_u32 v10, v33, 4, v10
  v_add_u32 v10, 161344, v10
  v_subrev_u32 v34, 1, v32
  v_min_u32 v34, 2, v34
  v_mul_u32_u24 v14, 192, v34
  v_lshl_add_u32 v15, v33, 3, v14
  v_add_u32 v15, 161472, v15
  v_lshl_add_u32 v14, v33, 4, v14
  v_add_u32 v14, 161344, v14
  v_lshlrev_b32 v34, 3, v0
  v_add_u32 v34, 153600, v34
  s_mov_b32 vcc_lo, 0xffffffff
  s_mov_b32 vcc_hi, 0x0000ffff
  v_mov_b32 v28, 0x00026200
  v_cndmask_b32 v28, v28, v34, vcc
  v_and_b32 v32, 31, v0
  v_lshrrev_b32 v33, 5, v0
  v_mul_u32_u24 v34, 192, v33
  v_lshl_add_u32 v34, v32, 3, v34
  v_add_u32 v34, 161344, v34
  s_mov_b32 vcc_lo, 0x000fffff
  s_mov_b32 vcc_hi, 0x000fffff
  v_mov_b32 v29, 0x00027980
  v_cndmask_b32 v29, v29, v34, vcc
  v_lshlrev_b32 v34, 7, v33
  v_lshl_add_u32 v34, v32, 2, v34
  v_add_u32 v34, 161920, v34
  s_mov_b32 vcc_lo, 0x00ffffff
  s_mov_b32 vcc_hi, 0x00ffffff
  v_mov_b32 v30, 0x00027980
  v_cndmask_b32 v30, v30, v34, vcc
  v_and_b32 v34, 7, v0
  v_lshlrev_b32 v34, 10, v34
  v_add_u32 v31, 768, v34
  s_mov_b32 s74, 0x00020002
  s_mov_b32 s75, 0x00020002
  s_waitcnt lgkmcnt(0)
  s_add_u32 s73, s73, 1
  s_waitcnt vmcnt(0)
  s_lshl_b32 s63, s2, 7
  s_add_u32 s63, s63, 5505024
  v_mov_b32 v72, s73
  v_mov_b32 v73, s68
  v_mov_b32 v84, 0
  s_mov_b64 exec, 1
  buffer_store_dwordx2 v[72:73], v84, s[48:51], s63 offen sc1
  s_mov_b64 exec, -1
  v_lshlrev_b32 v70, 10, v0
  s_lshl_b32 s66, s28, 7
  v_add_u32 v70, s66, v70
  s_mov_b32 s64, 5505024
  s_mov_b32 exec_lo, 0xffffffff
  s_mov_b32 exec_hi, 0x00000000
  buffer_load_dwordx2 v[68:69], v70, s[48:51], s64 offen sc1
  s_mov_b64 exec, -1
  v_mov_b32 v34, 0x3f803f80
  v_mov_b32 v35, 0x3f803f80
  v_lshlrev_b32 v36, 3, v0
  v_add_u32 v36, 161728, v36
  s_mov_b32 exec_lo, 0x00ffffff
  s_mov_b32 exec_hi, 0x00000000
  ds_write_b64 v36, v[34:35]
  s_mov_b64 exec, -1
  ds_write_b64 v29, v[16:17]
  v_lshlrev_b32 v18, 16, v17
  v_and_b32 v19, 0xffff0000, v17
  v_and_b32 v17, 0xffff0000, v16
  v_lshlrev_b32 v16, 16, v16
  s_waitcnt lgkmcnt(0)
  v_mov_b32 v85, 163792
  s_mov_b32 s65, 3200000
L_wflag_186:
  ds_read_b96 v[32:34], v85
  s_sub_u32 s65, s65, 1
  s_cbranch_scc1 L_abort
  s_waitcnt lgkmcnt(0)
  v_and_b32 v32, v32, v33
  v_and_b32 v32, v32, v34
  v_cmp_ne_u32 vcc, 1, v32
  s_cbranch_vccnz L_wflag_186
  v_and_b32 v32, 15, v0
  v_lshrrev_b32 v33, 4, v0
  v_lshrrev_b32 v34, 2, v32
  v_and_b32 v35, 3, v32
  v_mul_u32_u24 v36, 8, v33
  v_add_u32 v36, v36, v34
  v_mul_u32_u24 v36, 384, v36
  v_lshl_add_u32 v38, v35, 3, v36
  v_mul_u32_u24 v36, 4, v33
  v_add_u32 v36, v36, v34
  v_mul_u32_u24 v36, 384, v36
  v_lshl_add_u32 v39, v35, 3, v36
  ds_read_b64_tr_b16 a[2:3], v38 offset:0
  ds_read_b64_tr_b16 a[4:5], v38 offset:1536
  ds_read_b64_tr_b16 a[6:7], v38 offset:12288
  ds_read_b64_tr_b16 a[8:9], v38 offset:13824
  ds_read_b64_tr_b16 a[0:1], v39 offset:24576
  ds_read_b64_tr_b16 a[12:13], v38 offset:32
  ds_read_b64_tr_b16 a[14:15], v38 offset:1568
  ds_read_b64_tr_b16 a[16:17], v38 offset:12320
  ds_read_b64_tr_b16 a[18:19], v38 offset:13856
  ds_read_b64_tr_b16 a[10:11], v39 offset:24608
  ds_read_b64_tr_b16 a[22:23], v38 offset:64
  ds_read_b64_tr_b16 a[24:25], v38 offset:1600
  s_waitcnt lgkmcnt(4)
  ds_read_b64_tr_b16 a[26:27], v38 offset:12352
  ds_read_b64_tr_b16 a[28:29], v38 offset:13888
  ds_read_b64_tr_b16 a[20:21], v39 offset:24640
  ds_read_b64_tr_b16 a[32:33], v38 offset:96
  ds_read_b64_tr_b16 a[34:35], v38 offset:1632
  ds_read_b64_tr_b16 a[36:37], v38 offset:12384
  ds_read_b64_tr_b16 a[38:39], v38 offset:13920
  ds_read_b64_tr_b16 a[30:31], v39 offset:24672
  s_waitcnt lgkmcnt(4)
  ds_read_b64_tr_b16 a[42:43], v38 offset:128
  ds_read_b64_tr_b16 a[44:45], v38 offset:1664
  ds_read_b64_tr_b16 a[46:47], v38 offset:12416
  ds_read_b64_tr_b16 a[48:49], v38 offset:13952
  ds_read_b64_tr_b16 a[40:41], v39 offset:24704
  ds_read_b64_tr_b16 a[52:53], v38 offset:160
  ds_read_b64_tr_b16 a[54:55], v38 offset:1696
  ds_read_b64_tr_b16 a[56:57], v38 offset:12448
  ds_read_b64_tr_b16 a[58:59], v38 offset:13984
  s_waitcnt lgkmcnt(4)
  ds_read_b64_tr_b16 a[50:51], v39 offset:24736
  ds_read_b64_tr_b16 a[62:63], v38 offset:192
  ds_read_b64_tr_b16 a[64:65], v38 offset:1728
  ds_read_b64_tr_b16 a[66:67], v38 offset:12480
  ds_read_b64_tr_b16 a[68:69], v38 offset:14016
  ds_read_b64_tr_b16 a[60:61], v39 offset:24768
  ds_read_b64_tr_b16 a[72:73], v38 offset:224
  ds_read_b64_tr_b16 a[74:75], v38 offset:1760
  s_waitcnt lgkmcnt(4)
  ds_read_b64_tr_b16 a[76:77], v38 offset:12512
  ds_read_b64_tr_b16 a[78:79], v38 offset:14048
  ds_read_b64_tr_b16 a[70:71], v39 offset:24800
  ds_read_b64_tr_b16 a[82:83], v38 offset:256
  ds_read_b64_tr_b16 a[84:85], v38 offset:1792
  ds_read_b64_tr_b16 a[86:87], v38 offset:12544
  ds_read_b64_tr_b16 a[88:89], v38 offset:14080
  ds_read_b64_tr_b16 a[80:81], v39 offset:24832
  s_waitcnt lgkmcnt(4)
  ds_read_b64_tr_b16 a[92:93], v38 offset:288
  ds_read_b64_tr_b16 a[94:95], v38 offset:1824
  ds_read_b64_tr_b16 a[96:97], v38 offset:12576
  ds_read_b64_tr_b16 a[98:99], v38 offset:14112
  ds_read_b64_tr_b16 a[90:91], v39 offset:24864
  ds_read_b64_tr_b16 a[102:103], v38 offset:320
  ds_read_b64_tr_b16 a[104:105], v38 offset:1856
  ds_read_b64_tr_b16 a[106:107], v38 offset:12608
  ds_read_b64_tr_b16 a[108:109], v38 offset:14144
  s_waitcnt lgkmcnt(4)
  ds_read_b64_tr_b16 a[100:101], v39 offset:24896
  ds_read_b64_tr_b16 a[112:113], v38 offset:352
  ds_read_b64_tr_b16 a[114:115], v38 offset:1888
  ds_read_b64_tr_b16 a[116:117], v38 offset:12640
  ds_read_b64_tr_b16 a[118:119], v38 offset:14176
  ds_read_b64_tr_b16 a[110:111], v39 offset:24928
  v_mul_u32_u24 v36, 8, v33
  v_add_u32 v36, v36, v34
  v_mul_u32_u24 v36, 96, v36
  v_lshl_add_u32 v38, v35, 3, v36
  v_add_u32 v38, 51200, v38
  v_mul_u32_u24 v36, 4, v33
  v_add_u32 v36, v36, v34
  v_mul_u32_u24 v36, 96, v36
  v_lshl_add_u32 v39, v35, 3, v36
  v_add_u32 v39, 51200, v39
  ds_read_b64_tr_b16 v[198:199], v38 offset:0
  ds_read_b64_tr_b16 v[200:201], v38 offset:384
  s_waitcnt lgkmcnt(4)
  ds_read_b64_tr_b16 v[202:203], v38 offset:3072
  ds_read_b64_tr_b16 v[204:205], v38 offset:3456
  ds_read_b64_tr_b16 v[196:197], v39 offset:6144
  ds_read_b64_tr_b16 v[208:209], v38 offset:32
  ds_read_b64_tr_b16 v[210:211], v38 offset:416
  ds_read_b64_tr_b16 v[212:213], v38 offset:3104
  ds_read_b64_tr_b16 v[214:215], v38 offset:3488
  ds_read_b64_tr_b16 v[206:207], v39 offset:6176
  s_waitcnt lgkmcnt(4)
  ds_read_b64_tr_b16 v[218:219], v38 offset:64
  ds_read_b64_tr_b16 v[220:221], v38 offset:448
  ds_read_b64_tr_b16 v[222:223], v38 offset:3136
  ds_read_b64_tr_b16 v[224:225], v38 offset:3520
  ds_read_b64_tr_b16 v[216:217], v39 offset:6208
  v_mul_u32_u24 v36, 8, v33
  v_add_u32 v36, v36, v34
  v_mul_u32_u24 v36, 96, v36
  v_lshl_add_u32 v38, v35, 3, v36
  v_add_u32 v38, 58880, v38
  v_mul_u32_u24 v36, 4, v33
  v_add_u32 v36, v36, v34
  v_mul_u32_u24 v36, 96, v36
  v_lshl_add_u32 v39, v35, 3, v36
  v_add_u32 v39, 58880, v39
  ds_read_b64_tr_b16 v[228:229], v38 offset:0
  ds_read_b64_tr_b16 v[230:231], v38 offset:384
  ds_read_b64_tr_b16 v[232:233], v38 offset:3072
  ds_read_b64_tr_b16 v[234:235], v38 offset:3456
  s_waitcnt lgkmcnt(4)
  ds_read_b64_tr_b16 v[226:227], v39 offset:6144
  ds_read_b64_tr_b16 v[238:239], v38 offset:32
  ds_read_b64_tr_b16 v[240:241], v38 offset:416
  ds_read_b64_tr_b16 v[242:243], v38 offset:3104
  ds_read_b64_tr_b16 v[244:245], v38 offset:3488
  ds_read_b64_tr_b16 v[236:237], v39 offset:6176
  ds_read_b64_tr_b16 v[248:249], v38 offset:64
  ds_read_b64_tr_b16 v[250:251], v38 offset:448
  s_waitcnt lgkmcnt(4)
  ds_read_b64_tr_b16 v[252:253], v38 offset:3136
  ds_read_b64_tr_b16 v[254:255], v38 offset:3520
  ds_read_b64_tr_b16 v[246:247], v39 offset:6208
  s_waitcnt lgkmcnt(0)
  s_mov_b32 s63, 5505024
  s_mov_b32 exec_lo, 0xffffffff
  s_mov_b32 exec_hi, 0x00000000
  s_mov_b32 s65, 400000
  s_branch L_tokchk_185
L_tok_184:
  buffer_load_dwordx2 v[68:69], v70, s[48:51], s63 offen sc1
  s_sub_u32 s65, s65, 1
  s_cbranch_scc1 L_abort
L_tokchk_185:
  s_waitcnt vmcnt(0)
  v_cmp_ne_u32 vcc, s73, v68
  s_cbranch_vccnz L_tok_184
  v_cmp_ne_u32 vcc, s68, v69
  s_mov_b64 exec, -1
  s_nop 3
  s_cmp_lg_u32 vcc_lo, 0
  s_cbranch_scc1 L_global
  v_and_b32 v84, 31, v0
  v_lshlrev_b32 v84, 4, v84
  v_lshrrev_b32 v85, 5, v0
  v_lshl_add_u32 v84, v85, 9, v84
  s_mov_b32 vcc_lo, 0x000fffff
  s_mov_b32 vcc_hi, 0x000fffff
  v_cndmask_b32 v4, v74, v84, vcc
  s_mov_b32 vcc_lo, 0x00ffffff
  s_mov_b32 vcc_hi, 0x00ffffff
  v_cndmask_b32 v79, v74, v84, vcc
  v_lshrrev_b32 v84, 4, v0
  v_and_b32 v85, 15, v0
  v_lshlrev_b32 v72, 10, v84
  v_lshl_add_u32 v72, v85, 4, v72
  v_add_u32 v72, 512, v72
  v_lshlrev_b32 v73, 15, v84
  v_bfe_u32 v85, v0, 2, 2
  v_lshl_add_u32 v73, v85, 10, v73
  v_and_b32 v85, 3, v0
  v_lshl_add_u32 v73, v85, 4, v73
  v_add_u32 v73, 768, v73
  v_lshrrev_b32 v85, 5, v0
  v_and_b32 v84, 7, v0
  v_lshlrev_b32 v84, 10, v84
  v_lshl_add_u32 v84, v85, 9, v84
  v_add_u32 v84, 384, v84
  s_mov_b32 vcc_lo, 0xffffffff
  s_mov_b32 vcc_hi, 0xffffffff
  v_cndmask_b32 v80, v74, v84, vcc
  v_and_b32 v84, 15, v0
  v_lshrrev_b32 v85, 4, v0
  v_lshlrev_b32 v6, 9, v84
  v_lshl_add_u32 v7, v85, 5, v6
  v_add_u32 v81, 384, v6
  v_lshl_add_u32 v6, v85, 4, v6
  v_lshlrev_b32 v8, 18, v84
  v_add_u32 v82, 768, v8
  v_lshl_add_u32 v8, v85, 4, v8
  s_mov_b32 vcc_lo, 0x00040004
  s_mov_b32 vcc_hi, 0x00040004
  v_cndmask_b32 v6, v74, v6, vcc
  v_cndmask_b32 v7, v74, v7, vcc
  s_mov_b32 vcc_lo, 0x00000004
  s_mov_b32 vcc_hi, 0x00000000
  v_cndmask_b32 v81, v74, v81, vcc
  s_mov_b32 vcc_lo, 0x00070007
  s_mov_b32 vcc_hi, 0x00070007
  v_cndmask_b32 v8, v74, v8, vcc
  s_mov_b32 vcc_lo, 0x00000007
  s_mov_b32 vcc_hi, 0x00000000
  v_cndmask_b32 v82, v74, v82, vcc
  ds_read_b128 v[40:43], v10
  ds_read_b128 v[44:47], v10 offset:64
  ds_read_b64 v[48:49], v11
  v_mov_b32 v50, 0
  v_mov_b32 v51, 0
  ds_read_b128 v[52:55], v14
  ds_read_b128 v[56:59], v14 offset:64
  ds_read_b64 v[60:61], v15
  v_mov_b32 v62, 0
  v_mov_b32 v63, 0
  s_add_u32 s63, s57, 1048576
  s_waitcnt lgkmcnt(5)
  v_mfma_f32_16x16x32_bf16 v[64:67], a[2:5], v[40:43], 0
  s_waitcnt lgkmcnt(4)
  v_mfma_f32_16x16x32_bf16 v[64:67], a[6:9], v[44:47], v[64:67]
  s_waitcnt lgkmcnt(3)
  v_mfma_f32_16x16x32_bf16 v[64:67], a[0:3], v[48:51], v[64:67]
  s_waitcnt lgkmcnt(0)
  v_mfma_f32_16x16x32_bf16 v[36:39], v[52:55], v[40:43], 0
  v_mfma_f32_16x16x32_bf16 v[36:39], v[56:59], v[44:47], v[36:39]
  v_mfma_f32_16x16x32_bf16 v[36:39], v[60:63], v[48:51], v[36:39]
  v_mfma_f32_16x16x32_bf16 v[68:71], a[12:15], v[40:43], 0
  v_mfma_f32_16x16x32_bf16 v[68:71], a[16:19], v[44:47], v[68:71]
  v_mfma_f32_16x16x32_bf16 v[68:71], a[10:13], v[48:51], v[68:71]
  v_mfma_f32_16x16x32_bf16 v[32:35], a[22:25], v[40:43], 0
  v_mfma_f32_16x16x32_bf16 v[32:35], a[26:29], v[44:47], v[32:35]
  v_mfma_f32_16x16x32_bf16 v[32:35], a[20:23], v[48:51], v[32:35]
  v_mfma_f32_16x16x32_bf16 v[52:55], a[32:35], v[40:43], 0
  v_mfma_f32_16x16x32_bf16 v[52:55], a[36:39], v[44:47], v[52:55]
  v_mfma_f32_16x16x32_bf16 v[52:55], a[30:33], v[48:51], v[52:55]
  buffer_store_dwordx4 v[64:67], v8, s[48:51], s63 offen offset:0
  s_nop 1
  v_mfma_f32_16x16x32_bf16 v[64:67], a[42:45], v[40:43], 0
  v_mfma_f32_16x16x32_bf16 v[64:67], a[46:49], v[44:47], v[64:67]
  v_mfma_f32_16x16x32_bf16 v[64:67], a[40:43], v[48:51], v[64:67]
  buffer_store_dwordx4 v[68:71], v8, s[48:51], s63 offen offset:64
  s_nop 1
  v_mfma_f32_16x16x32_bf16 v[68:71], a[52:55], v[40:43], 0
  v_mfma_f32_16x16x32_bf16 v[68:71], a[56:59], v[44:47], v[68:71]
  v_mfma_f32_16x16x32_bf16 v[68:71], a[50:53], v[48:51], v[68:71]
  buffer_store_dwordx4 v[32:35], v8, s[48:51], s63 offen offset:128
  s_nop 1
  v_mfma_f32_16x16x32_bf16 v[32:35], a[62:65], v[40:43], 0
  v_mfma_f32_16x16x32_bf16 v[32:35], a[66:69], v[44:47], v[32:35]
  v_mfma_f32_16x16x32_bf16 v[32:35], a[60:63], v[48:51], v[32:35]
  buffer_store_dwordx4 v[52:55], v8, s[48:51], s63 offen offset:192
  s_nop 1
  v_mfma_f32_16x16x32_bf16 v[52:55], a[72:75], v[40:43], 0
  v_mfma_f32_16x16x32_bf16 v[52:55], a[76:79], v[44:47], v[52:55]
  v_mfma_f32_16x16x32_bf16 v[52:55], a[70:73], v[48:51], v[52:55]
  buffer_store_dwordx4 v[64:67], v8, s[48:51], s63 offen offset:256
  s_nop 1
  v_mfma_f32_16x16x32_bf16 v[64:67], a[82:85], v[40:43], 0
  v_mfma_f32_16x16x32_bf16 v[64:67], a[86:89], v[44:47], v[64:67]
  v_mfma_f32_16x16x32_bf16 v[64:67], a[80:83], v[48:51], v[64:67]
  buffer_store_dwordx4 v[68:71], v8, s[48:51], s63 offen offset:320
  s_nop 1
  v_mfma_f32_16x16x32_bf16 v[68:71], a[92:95], v[40:43], 0
  v_mfma_f32_16x16x32_bf16 v[68:71], a[96:99], v[44:47], v[68:71]
  v_mfma_f32_16x16x32_bf16 v[68:71], a[90:93], v[48:51], v[68:71]
  buffer_store_dwordx4 v[32:35], v8, s[48:51], s63 offen offset:384
  s_nop 1
  v_mfma_f32_16x16x32_bf16 v[32:35], a[102:105], v[40:43], 0
  v_mfma_f32_16x16x32_bf16 v[32:35], a[106:109], v[44:47], v[32:35]
  v_mfma_f32_16x16x32_bf16 v[32:35], a[100:103], v[48:51], v[32:35]
  buffer_store_dwordx4 v[52:55], v8, s[48:51], s63 offen offset:448
  s_nop 1
  v_mfma_f32_16x16x32_bf16 v[52:55], a[112:115], v[40:43], 0
  v_mfma_f32_16x16x32_bf16 v[52:55], a[116:119], v[44:47], v[52:55]
  v_mfma_f32_16x16x32_bf16 v[52:55], a[110:113], v[48:51], v[52:55]
  buffer_store_dwordx4 v[64:67], v8, s[48:51], s63 offen offset:512
  v_cndmask_b32 v37, v37, v38, s[74:75]
  buffer_store_dwordx4 v[68:71], v8, s[48:51], s63 offen offset:576
  buffer_store_dwordx4 v[32:35], v8, s[48:51], s63 offen offset:640
  s_nop 3
  buffer_store_dwordx4 v[52:55], v8, s[48:51], s63 offen offset:704
  buffer_store_dwordx4 v[36:39], v82, s[48:51], s63 offen offset:0
  ds_read_b128 v[40:43], v10
  ds_read_b128 v[44:47], v10 offset:64
  ds_read_b64 v[48:49], v11
  v_mov_b32 v50, 0
  v_mov_b32 v51, 0
  s_add_u32 s63, s57, 2358272
  s_waitcnt lgkmcnt(2)
  v_mfma_f32_16x16x32_bf16 v[64:67], v[198:201], v[40:43], 0
  s_waitcnt lgkmcnt(1)
  v_mfma_f32_16x16x32_bf16 v[64:67], v[202:205], v[44:47], v[64:67]
  s_waitcnt lgkmcnt(0)
  v_mfma_f32_16x16x32_bf16 v[64:67], v[196:199], v[48:51], v[64:67]
  v_mfma_f32_16x16x32_bf16 v[68:71], v[228:231], v[40:43], 0
  v_mfma_f32_16x16x32_bf16 v[68:71], v[232:235], v[44:47], v[68:71]
  v_mfma_f32_16x16x32_bf16 v[68:71], v[226:229], v[48:51], v[68:71]
  v_mfma_f32_16x16x32_bf16 v[52:55], v[208:211], v[40:43], 0
  v_mfma_f32_16x16x32_bf16 v[52:55], v[212:215], v[44:47], v[52:55]
  v_mfma_f32_16x16x32_bf16 v[52:55], v[206:209], v[48:51], v[52:55]
  v_mfma_f32_16x16x32_bf16 v[56:59], v[238:241], v[40:43], 0
  v_mfma_f32_16x16x32_bf16 v[56:59], v[242:245], v[44:47], v[56:59]
  v_mfma_f32_16x16x32_bf16 v[56:59], v[236:239], v[48:51], v[56:59]
  s_nop 1
  v_swap_b32 v66, v68
  v_swap_b32 v67, v69
  buffer_store_dwordx4 v[64:67], v7, s[48:51], s63 offen offset:0
  buffer_store_dwordx4 v[68:71], v7, s[48:51], s63 offen offset:16
  s_nop 0
  v_mfma_f32_16x16x32_bf16 v[64:67], v[218:221], v[40:43], 0
  v_mfma_f32_16x16x32_bf16 v[64:67], v[222:225], v[44:47], v[64:67]
  v_mfma_f32_16x16x32_bf16 v[64:67], v[216:219], v[48:51], v[64:67]
  v_mfma_f32_16x16x32_bf16 v[68:71], v[248:251], v[40:43], 0
  v_mfma_f32_16x16x32_bf16 v[68:71], v[252:255], v[44:47], v[68:71]
  v_mfma_f32_16x16x32_bf16 v[68:71], v[246:249], v[48:51], v[68:71]
  v_swap_b32 v54, v56
  v_swap_b32 v55, v57
  buffer_store_dwordx4 v[52:55], v7, s[48:51], s63 offen offset:128
  buffer_store_dwordx4 v[56:59], v7, s[48:51], s63 offen offset:144
  s_nop 3
  v_swap_b32 v66, v68
  v_swap_b32 v67, v69
  buffer_store_dwordx4 v[64:67], v7, s[48:51], s63 offen offset:256
  buffer_store_dwordx4 v[68:71], v7, s[48:51], s63 offen offset:272
  v_mov_b32 v32, -1
  v_mov_b32 v33, -1
  v_mov_b32 v34, -1
  v_mov_b32 v35, -1
  v_and_b32 v84, 31, v0
  v_lshlrev_b32 v84, 4, v84
  v_lshrrev_b32 v85, 5, v0
  v_lshl_add_u32 v84, v85, 9, v84
  s_cmp_lg_u32 s29, 0
  s_cbranch_scc1 L_norstg_187
  s_mov_b32 vcc_lo, 0x000fffff
  s_mov_b32 vcc_hi, 0x00000000
  v_cndmask_b32 v36, v74, v84, vcc
  s_add_u32 s63, s61, 4980736
  buffer_store_dwordx4 v[32:35], v36, s[48:51], s63 offen sc1
  s_add_u32 s63, s61, 5046272
  buffer_store_dwordx4 v[32:35], v36, s[48:51], s63 offen sc1
L_norstg_187:
  s_add_u32 s63, s57, 1835008
  buffer_store_dwordx4 v[32:35], v5, s[48:51], s63 offen
  s_add_u32 s63, s57, 2097152
  buffer_store_dwordx4 v[32:35], v5, s[48:51], s63 offen
  s_add_u32 s63, s57, 0
  buffer_store_dwordx4 v[32:35], v5, s[48:51], s63 offen
  s_add_u32 s63, s57, 262144
  buffer_store_dwordx4 v[32:35], v5, s[48:51], s63 offen
  s_add_u32 s63, s57, 524288
  buffer_store_dwordx4 v[32:35], v5, s[48:51], s63 offen
  s_add_u32 s63, s57, 786432
  buffer_store_dwordx4 v[32:35], v5, s[48:51], s63 offen
  s_mov_b32 vcc_lo, 0x01ffffff
  s_mov_b32 vcc_hi, 0x00000000
  v_cndmask_b32 v36, v74, v84, vcc
  s_add_u32 s63, s57, 2621440
  buffer_store_dwordx4 v[32:35], v36, s[48:51], s63 offen
  s_mov_b32 vcc_lo, 0x000fffff
  s_mov_b32 vcc_hi, 0x00000000
  v_cndmask_b32 v36, v74, v84, vcc
  s_add_u32 s63, s59, 3407872
  buffer_store_dwordx4 v[32:35], v36, s[48:51], s63 offen
  s_add_u32 s63, s59, 3670016
  buffer_store_dwordx4 v[32:35], v36, s[48:51], s63 offen
  s_mov_b32 vcc_lo, 0x00000000
  s_mov_b32 vcc_hi, 0x01ffffff
  v_cndmask_b32 v36, v74, v84, vcc
  s_add_u32 s63, s57, 2883584
  buffer_store_dwordx4 v[32:35], v36, s[48:51], s63 offen
  s_mov_b32 vcc_lo, 0x00000000
  s_mov_b32 vcc_hi, 0x000fffff
  v_cndmask_b32 v36, v74, v84, vcc
  s_add_u32 s63, s59, 3932160
  buffer_store_dwordx4 v[32:35], v36, s[48:51], s63 offen sc1
  s_add_u32 s63, s59, 4194304
  buffer_store_dwordx4 v[32:35], v36, s[48:51], s63 offen sc1
  s_mov_b32 vcc_lo, 0x01ffffff
  s_mov_b32 vcc_hi, 0x01ffffff
  v_cndmask_b32 v36, v74, v84, vcc
  s_add_u32 s63, s57, 3145728
  buffer_store_dwordx4 v[32:35], v36, s[48:51], s63 offen
  s_mov_b32 vcc_lo, 0x000fffff
  s_mov_b32 vcc_hi, 0x000fffff
  v_cndmask_b32 v36, v74, v84, vcc
  s_add_u32 s63, s59, 4456448
  buffer_store_dwordx4 v[32:35], v36, s[48:51], s63 offen sc1
  s_add_u32 s63, s59, 4718592
  buffer_store_dwordx4 v[32:35], v36, s[48:51], s63 offen sc1
  v_and_b32 v84, 31, v0
  v_lshlrev_b32 v84, 4, v84
  s_mov_b32 vcc_lo, 0x00ffffff
  s_mov_b32 vcc_hi, 0x00ffffff
  v_cndmask_b32 v72, v74, v84, vcc
  s_add_u32 s10, s58, 1048576
  s_add_u32 s11, s10, 4096
  s_add_u32 s12, s58, 1310720
  s_add_u32 s13, s12, 4096
  s_add_u32 s14, s58, 1572864
  s_add_u32 s15, s14, 4096
  s_add_u32 s16, s58, 2359296
  s_add_u32 s17, s16, 4096
  s_mov_b32 s65, 400000
L_poll_188:
  buffer_load_dwordx4 v[86:89], v5, s[48:51], s10 offen offset:0 sc1
  buffer_load_dwordx4 v[90:93], v5, s[48:51], s10 offen offset:1024 sc1
  buffer_load_dwordx4 v[94:97], v5, s[48:51], s10 offen offset:2048 sc1
  buffer_load_dwordx4 v[98:101], v5, s[48:51], s10 offen offset:3072 sc1
  buffer_load_dwordx4 v[102:105], v5, s[48:51], s11 offen offset:0 sc1
  buffer_load_dwordx4 v[106:109], v5, s[48:51], s11 offen offset:1024 sc1
  buffer_load_dwordx4 v[110:113], v5, s[48:51], s11 offen offset:2048 sc1
  buffer_load_dwordx4 v[114:117], v5, s[48:51], s11 offen offset:3072 sc1
  buffer_load_dwordx4 v[118:121], v5, s[48:51], s12 offen offset:0 sc1
  buffer_load_dwordx4 v[122:125], v5, s[48:51], s12 offen offset:1024 sc1
  buffer_load_dwordx4 v[126:129], v5, s[48:51], s12 offen offset:2048 sc1
  buffer_load_dwordx4 v[130:133], v5, s[48:51], s12 offen offset:3072 sc1
  buffer_load_dwordx4 v[134:137], v5, s[48:51], s13 offen offset:0 sc1
  buffer_load_dwordx4 v[138:141], v5, s[48:51], s13 offen offset:1024 sc1
  buffer_load_dwordx4 v[142:145], v5, s[48:51], s13 offen offset:2048 sc1
  buffer_load_dwordx4 v[146:149], v5, s[48:51], s13 offen offset:3072 sc1
  buffer_load_dwordx4 v[150:153], v5, s[48:51], s14 offen offset:0 sc1
  buffer_load_dwordx4 v[154:157], v5, s[48:51], s14 offen offset:1024 sc1
  buffer_load_dwordx4 v[158:161], v5, s[48:51], s14 offen offset:2048 sc1
  buffer_load_dwordx4 v[162:165], v5, s[48:51], s14 offen offset:3072 sc1
  buffer_load_dwordx4 v[166:169], v5, s[48:51], s15 offen offset:0 sc1
  buffer_load_dwordx4 v[170:173], v5, s[48:51], s15 offen offset:1024 sc1
  buffer_load_dwordx4 v[174:177], v5, s[48:51], s15 offen offset:2048 sc1
  buffer_load_dwordx4 v[178:181], v5, s[48:51], s15 offen offset:3072 sc1
  buffer_load_dwordx4 v[64:67], v31, s[48:51], s10 offen offset:0 sc1
  buffer_load_dwordx4 v[68:71], v31, s[48:51], s12 offen offset:0 sc1
  buffer_load_dwordx4 v[32:35], v72, s[48:51], s16 offen offset:0 sc1
  buffer_load_dwordx4 v[36:39], v72, s[48:51], s16 offen offset:1024 sc1
  buffer_load_dwordx4 v[40:43], v72, s[48:51], s16 offen offset:2048 sc1
  buffer_load_dwordx4 v[44:47], v72, s[48:51], s16 offen offset:3072 sc1
  buffer_load_dwordx4 v[48:51], v72, s[48:51], s17 offen offset:0 sc1
  buffer_load_dwordx4 v[52:55], v72, s[48:51], s17 offen offset:1024 sc1
  buffer_load_dwordx4 v[56:59], v72, s[48:51], s17 offen offset:2048 sc1
  buffer_load_dwordx4 v[60:63], v72, s[48:51], s17 offen offset:3072 sc1
  s_sub_u32 s65, s65, 1
  s_cbranch_scc1 L_abort
  s_waitcnt vmcnt(0)
  v_max3_u32 v84, v87, v89, v91
  v_max3_u32 v84, v84, v93, v95
  v_max3_u32 v84, v84, v97, v99
  v_max3_u32 v84, v84, v101, v103
  v_max3_u32 v84, v84, v105, v107
  v_max3_u32 v84, v84, v109, v111
  v_max3_u32 v84, v84, v113, v115
  v_max3_u32 v84, v84, v117, v119
  v_max3_u32 v84, v84, v121, v123
  v_max3_u32 v84, v84, v125, v127
  v_max3_u32 v84, v84, v129, v131
  v_max3_u32 v84, v84, v133, v135
  v_max3_u32 v84, v84, v137, v139
  v_max3_u32 v84, v84, v141, v143
  v_max3_u32 v84, v84, v145, v147
  v_max3_u32 v84, v84, v149, v151
  v_max3_u32 v84, v84, v153, v155
  v_max3_u32 v84, v84, v157, v159
  v_max3_u32 v84, v84, v161, v163
  v_max3_u32 v84, v84, v165, v167
  v_max3_u32 v84, v84, v169, v171
  v_max3_u32 v84, v84, v173, v175
  v_max3_u32 v84, v84, v177, v179
  v_max3_u32 v84, v84, v181, v65
  v_max3_u32 v84, v84, v67, v69
  v_max3_u32 v84, v84, v71, v33
  v_max3_u32 v84, v84, v35, v37
  v_max3_u32 v84, v84, v39, v41
  v_max3_u32 v84, v84, v43, v45
  v_max3_u32 v84, v84, v47, v49
  v_max3_u32 v84, v84, v51, v53
  v_max3_u32 v84, v84, v55, v57
  v_max3_u32 v84, v84, v59, v61
  v_max_u32 v84, v84, v63
  v_cmp_eq_u32 vcc, -1, v84
  s_cbranch_vccz L_pok_189
  s_sleep 8
  s_branch L_poll_188
L_pok_189:
  s_lshl_b32 s63, s2, 7
  s_add_u32 s63, s63, 5537792
  v_mov_b32 v72, s73
  v_mov_b32 v73, 0
  v_mov_b32 v84, 0
  s_mov_b64 exec, 1
  buffer_store_dwordx2 v[72:73], v84, s[48:51], s63 offen sc1
  s_mov_b64 exec, -1
  v_pk_add_f32 v[150:151], v[150:151], v[154:155]
  v_pk_add_f32 v[152:153], v[152:153], v[156:157]
  v_pk_add_f32 v[158:159], v[158:159], v[162:163]
  v_pk_add_f32 v[160:161], v[160:161], v[164:165]
  v_pk_add_f32 v[166:167], v[166:167], v[170:171]
  v_pk_add_f32 v[168:169], v[168:169], v[172:173]
  v_pk_add_f32 v[174:175], v[174:175], v[178:179]
  v_pk_add_f32 v[176:177], v[176:177], v[180:181]
  v_pk_add_f32 v[150:151], v[150:151], v[158:159]
  v_pk_add_f32 v[152:153], v[152:153], v[160:161]
  v_pk_add_f32 v[166:167], v[166:167], v[174:175]
  v_pk_add_f32 v[168:169], v[168:169], v[176:177]
  v_pk_add_f32 v[150:151], v[150:151], v[166:167]
  v_pk_add_f32 v[152:153], v[152:153], v[168:169]
  v_mov_b32 v20, v150
  v_mov_b32 v21, v151
  v_mov_b32 v22, v152
  v_mov_b32 v23, v153
  v_pk_add_f32 v[32:33], v[32:33], v[36:37]
  v_pk_add_f32 v[34:35], v[34:35], v[38:39]
  v_pk_add_f32 v[40:41], v[40:41], v[44:45]
  v_pk_add_f32 v[42:43], v[42:43], v[46:47]
  v_pk_add_f32 v[48:49], v[48:49], v[52:53]
  v_pk_add_f32 v[50:51], v[50:51], v[54:55]
  v_pk_add_f32 v[56:57], v[56:57], v[60:61]
  v_pk_add_f32 v[58:59], v[58:59], v[62:63]
  v_pk_add_f32 v[32:33], v[32:33], v[40:41]
  v_pk_add_f32 v[34:35], v[34:35], v[42:43]
  v_pk_add_f32 v[48:49], v[48:49], v[56:57]
  v_pk_add_f32 v[50:51], v[50:51], v[58:59]
  v_pk_add_f32 v[32:33], v[32:33], v[48:49]
  v_pk_add_f32 v[34:35], v[34:35], v[50:51]
  v_mov_b32 v24, v32
  v_mov_b32 v25, v33
  v_mov_b32 v26, v34
  v_mov_b32 v27, v35
  v_add_f32_dpp v64, v64, v64 quad_perm:[1,0,3,2] row_mask:0xf bank_mask:0xf
  v_add_f32_dpp v65, v65, v65 quad_perm:[1,0,3,2] row_mask:0xf bank_mask:0xf
  s_nop 0
  v_add_f32_dpp v64, v64, v64 quad_perm:[2,3,0,1] row_mask:0xf bank_mask:0xf
  v_add_f32_dpp v65, v65, v65 quad_perm:[2,3,0,1] row_mask:0xf bank_mask:0xf
  s_nop 0
  v_add_f32_dpp v64, v64, v64 row_half_mirror row_mask:0xf bank_mask:0xf
  v_add_f32_dpp v65, v65, v65 row_half_mirror row_mask:0xf bank_mask:0xf
  v_pk_add_f32 v[86:87], v[86:87], v[90:91]
  v_pk_add_f32 v[88:89], v[88:89], v[92:93]
  v_pk_add_f32 v[94:95], v[94:95], v[98:99]
  v_pk_add_f32 v[96:97], v[96:97], v[100:101]
  v_pk_add_f32 v[102:103], v[102:103], v[106:107]
  v_pk_add_f32 v[104:105], v[104:105], v[108:109]
  v_pk_add_f32 v[110:111], v[110:111], v[114:115]
  v_pk_add_f32 v[112:113], v[112:113], v[116:117]
  v_pk_add_f32 v[86:87], v[86:87], v[94:95]
  v_pk_add_f32 v[88:89], v[88:89], v[96:97]
  v_pk_add_f32 v[102:103], v[102:103], v[110:111]
  v_pk_add_f32 v[104:105], v[104:105], v[112:113]
  v_pk_add_f32 v[86:87], v[86:87], v[102:103]
  v_pk_add_f32 v[88:89], v[88:89], v[104:105]
  v_mul_f32 v66, 0x3acccccd, v64
  v_mul_f32 v65, 0x3acccccd, v65
  v_fma_f32 v65, -v66, v66, v65
  v_max_f32 v65, 0, v65
  v_add_f32 v65, 0x3727c5ac, v65
  v_rsq_f32 v67, v65
  v_fma_f32 v86, -v66, v20, v86
  v_fma_f32 v87, -v66, v21, v87
  v_fma_f32 v88, -v66, v22, v88
  v_fma_f32 v89, -v66, v23, v89
  v_mul_f32 v86, v67, v86
  v_mul_f32 v87, v67, v87
  v_mul_f32 v88, v67, v88
  v_mul_f32 v89, v67, v89
  v_cvt_pk_bf16_f32 v86, v86, v87
  v_cvt_pk_bf16_f32 v87, v88, v89
  ds_write_b64 v28, v[86:87] offset:6208
  v_add_f32_dpp v68, v68, v68 quad_perm:[1,0,3,2] row_mask:0xf bank_mask:0xf
  v_add_f32_dpp v69, v69, v69 quad_perm:[1,0,3,2] row_mask:0xf bank_mask:0xf
  s_nop 0
  v_add_f32_dpp v68, v68, v68 quad_perm:[2,3,0,1] row_mask:0xf bank_mask:0xf
  v_add_f32_dpp v69, v69, v69 quad_perm:[2,3,0,1] row_mask:0xf bank_mask:0xf
  s_nop 0
  v_add_f32_dpp v68, v68, v68 row_half_mirror row_mask:0xf bank_mask:0xf
  v_add_f32_dpp v69, v69, v69 row_half_mirror row_mask:0xf bank_mask:0xf
  v_pk_add_f32 v[118:119], v[118:119], v[122:123]
  v_pk_add_f32 v[120:121], v[120:121], v[124:125]
  v_pk_add_f32 v[126:127], v[126:127], v[130:131]
  v_pk_add_f32 v[128:129], v[128:129], v[132:133]
  v_pk_add_f32 v[134:135], v[134:135], v[138:139]
  v_pk_add_f32 v[136:137], v[136:137], v[140:141]
  v_pk_add_f32 v[142:143], v[142:143], v[146:147]
  v_pk_add_f32 v[144:145], v[144:145], v[148:149]
  v_pk_add_f32 v[118:119], v[118:119], v[126:127]
  v_pk_add_f32 v[120:121], v[120:121], v[128:129]
  v_pk_add_f32 v[134:135], v[134:135], v[142:143]
  v_pk_add_f32 v[136:137], v[136:137], v[144:145]
  v_pk_add_f32 v[118:119], v[118:119], v[134:135]
  v_pk_add_f32 v[120:121], v[120:121], v[136:137]
  v_mul_f32 v70, 0x3acccccd, v68
  v_mul_f32 v69, 0x3acccccd, v69
  v_fma_f32 v69, -v70, v70, v69
  v_max_f32 v69, 0, v69
  v_add_f32 v69, 0x3727c5ac, v69
  v_rsq_f32 v71, v69
  v_fma_f32 v118, -v70, v20, v118
  v_fma_f32 v119, -v70, v21, v119
  v_fma_f32 v120, -v70, v22, v120
  v_fma_f32 v121, -v70, v23, v121
  v_mul_f32 v118, v71, v118
  v_mul_f32 v119, v71, v119
  v_mul_f32 v120, v71, v120
  v_mul_f32 v121, v71, v121
  v_cvt_pk_bf16_f32 v118, v118, v119
  v_cvt_pk_bf16_f32 v119, v120, v121
  ds_write_b64 v28, v[118:119] offset:6592
  s_add_u32 s42, s40, 0
  buffer_load_dwordx4 v[86:89], v1, s[32:35], s42 offen offset:0 nt
  buffer_load_dwordx4 v[90:93], v1, s[32:35], s42 offen offset:128 nt
  buffer_load_dwordx4 v[94:97], v1, s[32:35], s42 offen offset:256 nt
  s_add_u32 s42, s40, 3072
  buffer_load_dwordx4 v[98:101], v1, s[32:35], s42 offen offset:0 nt
  buffer_load_dwordx4 v[102:105], v1, s[32:35], s42 offen offset:128 nt
  buffer_load_dwordx4 v[106:109], v1, s[32:35], s42 offen offset:256 nt
  s_add_u32 s42, s40, 6144
  buffer_load_dwordx4 v[110:113], v1, s[32:35], s42 offen offset:0 nt
  buffer_load_dwordx4 v[114:117], v1, s[32:35], s42 offen offset:128 nt
  buffer_load_dwordx4 v[118:121], v1, s[32:35], s42 offen offset:256 nt
  s_add_u32 s42, s40, 9216
  buffer_load_dwordx4 v[122:125], v1, s[32:35], s42 offen offset:0 nt
  buffer_load_dwordx4 v[126:129], v1, s[32:35], s42 offen offset:128 nt
  buffer_load_dwordx4 v[130:133], v1, s[32:35], s42 offen offset:256 nt
  s_add_u32 s42, s40, 0
  buffer_load_dwordx4 v[134:137], v2, s[36:39], s42 offen offset:0 nt
  buffer_load_dwordx4 v[138:141], v2, s[36:39], s42 offen offset:384 nt
  buffer_load_dwordx4 v[142:145], v3, s[36:39], s42 offen offset:0 nt
  s_add_u32 s42, s40, 3072
  buffer_load_dwordx4 v[146:149], v2, s[36:39], s42 offen offset:0 nt
  buffer_load_dwordx4 v[150:153], v2, s[36:39], s42 offen offset:384 nt
  buffer_load_dwordx4 v[154:157], v3, s[36:39], s42 offen offset:0 nt
  s_add_u32 s42, s40, 6144
  buffer_load_dwordx4 v[158:161], v2, s[36:39], s42 offen offset:0 nt
  buffer_load_dwordx4 v[162:165], v2, s[36:39], s42 offen offset:384 nt
  buffer_load_dwordx4 v[166:169], v3, s[36:39], s42 offen offset:0 nt
  s_add_u32 s42, s40, 9216
  buffer_load_dwordx4 v[170:173], v2, s[36:39], s42 offen offset:0 nt
  buffer_load_dwordx4 v[174:177], v2, s[36:39], s42 offen offset:384 nt
  buffer_load_dwordx4 v[178:181], v3, s[36:39], s42 offen offset:0 nt
  v_mov_b32 v85, 163808
  s_mov_b32 s65, 3200000
L_w2flag_190:
  ds_read_b96 v[32:34], v85
  s_sub_u32 s65, s65, 1
  s_cbranch_scc1 L_abort
  s_waitcnt lgkmcnt(0)
  v_and_b32 v32, v32, v33
  v_and_b32 v32, v32, v34
  v_cmp_ne_u32 vcc, 1, v32
  s_cbranch_vccnz L_w2flag_190
  v_and_b32 v32, 15, v0
  v_lshrrev_b32 v33, 4, v0
  v_lshrrev_b32 v34, 2, v32
  v_and_b32 v35, 3, v32
  v_lshl_add_u32 v36, v33, 3, v34
  v_mul_u32_u24 v36, 160, v36
  v_lshl_add_u32 v39, v35, 3, v36
  v_add_u32 v38, 35840, v39
  ds_read_b64_tr_b16 a[120:121], v38 offset:0
  ds_read_b64_tr_b16 a[122:123], v38 offset:640
  ds_read_b64_tr_b16 a[124:125], v38 offset:5120
  ds_read_b64_tr_b16 a[126:127], v38 offset:5760
  ds_read_b64_tr_b16 a[144:145], v38 offset:32
  ds_read_b64_tr_b16 a[146:147], v38 offset:672
  ds_read_b64_tr_b16 a[148:149], v38 offset:5152
  ds_read_b64_tr_b16 a[150:151], v38 offset:5792
  ds_read_b64_tr_b16 a[168:169], v38 offset:64
  ds_read_b64_tr_b16 a[170:171], v38 offset:704
  s_waitcnt lgkmcnt(4)
  ds_read_b64_tr_b16 a[172:173], v38 offset:5184
  ds_read_b64_tr_b16 a[174:175], v38 offset:5824
  ds_read_b64_tr_b16 a[192:193], v38 offset:96
  ds_read_b64_tr_b16 a[194:195], v38 offset:736
  ds_read_b64_tr_b16 a[196:197], v38 offset:5216
  ds_read_b64_tr_b16 a[198:199], v38 offset:5856
  ds_read_b64_tr_b16 a[216:217], v38 offset:128
  ds_read_b64_tr_b16 a[218:219], v38 offset:768
  s_waitcnt lgkmcnt(4)
  ds_read_b64_tr_b16 a[220:221], v38 offset:5248
  ds_read_b64_tr_b16 a[222:223], v38 offset:5888
  v_add_u32 v38, 87040, v39
  ds_read_b64_tr_b16 a[128:129], v38 offset:0
  ds_read_b64_tr_b16 a[130:131], v38 offset:640
  ds_read_b64_tr_b16 a[132:133], v38 offset:5120
  ds_read_b64_tr_b16 a[134:135], v38 offset:5760
  ds_read_b64_tr_b16 a[152:153], v38 offset:32
  ds_read_b64_tr_b16 a[154:155], v38 offset:672
  s_waitcnt lgkmcnt(4)
  ds_read_b64_tr_b16 a[156:157], v38 offset:5152
  ds_read_b64_tr_b16 a[158:159], v38 offset:5792
  ds_read_b64_tr_b16 a[176:177], v38 offset:64
  ds_read_b64_tr_b16 a[178:179], v38 offset:704
  ds_read_b64_tr_b16 a[180:181], v38 offset:5184
  ds_read_b64_tr_b16 a[182:183], v38 offset:5824
  ds_read_b64_tr_b16 a[200:201], v38 offset:96
  ds_read_b64_tr_b16 a[202:203], v38 offset:736
  s_waitcnt lgkmcnt(4)
  ds_read_b64_tr_b16 a[204:205], v38 offset:5216
  ds_read_b64_tr_b16 a[206:207], v38 offset:5856
  ds_read_b64_tr_b16 a[224:225], v38 offset:128
  ds_read_b64_tr_b16 a[226:227], v38 offset:768
  ds_read_b64_tr_b16 a[228:229], v38 offset:5248
  ds_read_b64_tr_b16 a[230:231], v38 offset:5888
  v_add_u32 v38, 138240, v39
  ds_read_b64_tr_b16 a[136:137], v38 offset:0
  ds_read_b64_tr_b16 a[138:139], v38 offset:640
  s_waitcnt lgkmcnt(4)
  ds_read_b64_tr_b16 a[140:141], v38 offset:5120
  ds_read_b64_tr_b16 a[142:143], v38 offset:5760
  ds_read_b64_tr_b16 a[160:161], v38 offset:32
  ds_read_b64_tr_b16 a[162:163], v38 offset:672
  ds_read_b64_tr_b16 a[164:165], v38 offset:5152
  ds_read_b64_tr_b16 a[166:167], v38 offset:5792
  ds_read_b64_tr_b16 a[184:185], v38 offset:64
  ds_read_b64_tr_b16 a[186:187], v38 offset:704
  s_waitcnt lgkmcnt(4)
  ds_read_b64_tr_b16 a[188:189], v38 offset:5184
  ds_read_b64_tr_b16 a[190:191], v38 offset:5824
  ds_read_b64_tr_b16 a[208:209], v38 offset:96
  ds_read_b64_tr_b16 a[210:211], v38 offset:736
  ds_read_b64_tr_b16 a[212:213], v38 offset:5216
  ds_read_b64_tr_b16 a[214:215], v38 offset:5856
  ds_read_b64_tr_b16 a[232:233], v38 offset:128
  ds_read_b64_tr_b16 a[234:235], v38 offset:768
  s_waitcnt lgkmcnt(4)
  ds_read_b64_tr_b16 a[236:237], v38 offset:5248
  ds_read_b64_tr_b16 a[238:239], v38 offset:5888
  v_lshl_add_u32 v36, v33, 3, v34
  v_and_b32 v36, 15, v36
  v_mul_u32_u24 v36, 160, v36
  v_lshrrev_b32 v38, 1, v33
  v_mul_u32_u24 v38, 51200, v38
  v_add_u32 v38, v38, v36
  v_lshl_add_u32 v38, v35, 3, v38
  v_add_u32 v38, 46080, v38
  ds_read_b64_tr_b16 a[240:241], v38 offset:0
  ds_read_b64_tr_b16 a[242:243], v38 offset:640
  ds_read_b64_tr_b16 a[244:245], v38 offset:32
  ds_read_b64_tr_b16 a[246:247], v38 offset:672
  ds_read_b64_tr_b16 a[248:249], v38 offset:64
  ds_read_b64_tr_b16 a[250:251], v38 offset:704
  s_waitcnt lgkmcnt(4)
  ds_read_b64_tr_b16 a[252:253], v38 offset:96
  ds_read_b64_tr_b16 a[254:255], v38 offset:736
  ds_read_b64_tr_b16 v[182:183], v38 offset:128
  ds_read_b64_tr_b16 v[184:185], v38 offset:768
  v_lshl_add_u32 v36, v33, 2, v34
  v_mul_u32_u24 v36, 160, v36
  v_lshl_add_u32 v39, v35, 3, v36
  v_add_u32 v39, 148480, v39
  ds_read_b64_tr_b16 v[186:187], v39 offset:0
  ds_read_b64_tr_b16 v[188:189], v39 offset:32
  ds_read_b64_tr_b16 v[190:191], v39 offset:64
  ds_read_b64_tr_b16 v[192:193], v39 offset:96
  s_waitcnt lgkmcnt(4)
  ds_read_b64_tr_b16 v[194:195], v39 offset:128
  s_waitcnt lgkmcnt(0)
  v_mov_b32 v32, 163820
  v_mov_b32 v33, 1
  ds_write_b32 v32, v33
  v_and_b32 v84, 31, v0
  v_lshlrev_b32 v84, 4, v84
  v_lshrrev_b32 v85, 5, v0
  v_lshl_add_u32 v84, v85, 9, v84
  s_mov_b32 vcc_lo, 0x000fffff
  s_mov_b32 vcc_hi, 0x00000000
  v_cndmask_b32 v4, v74, v84, vcc
  s_mov_b32 vcc_lo, 0x00ffffff
  s_mov_b32 vcc_hi, 0x00000000
  v_cndmask_b32 v79, v74, v84, vcc
  v_lshrrev_b32 v84, 4, v0
  v_and_b32 v85, 15, v0
  v_lshlrev_b32 v72, 10, v84
  v_lshl_add_u32 v72, v85, 4, v72
  v_add_u32 v72, 0, v72
  v_lshlrev_b32 v73, 15, v84
  v_bfe_u32 v85, v0, 2, 2
  v_lshl_add_u32 v73, v85, 10, v73
  v_and_b32 v85, 3, v0
  v_lshl_add_u32 v73, v85, 4, v73
  v_add_u32 v73, 256, v73
  v_lshrrev_b32 v85, 5, v0
  v_and_b32 v84, 7, v0
  v_lshlrev_b32 v84, 10, v84
  v_lshl_add_u32 v84, v85, 9, v84
  v_add_u32 v84, 384, v84
  s_mov_b32 vcc_lo, 0xffffffff
  s_mov_b32 vcc_hi, 0x00000000
  v_cndmask_b32 v80, v74, v84, vcc
  v_and_b32 v84, 15, v0
  v_lshrrev_b32 v85, 4, v0
  v_lshlrev_b32 v6, 9, v84
  v_lshl_add_u32 v7, v85, 5, v6
  v_add_u32 v81, 384, v6
  v_lshl_add_u32 v6, v85, 4, v6
  v_lshlrev_b32 v8, 18, v84
  v_add_u32 v82, 768, v8
  v_lshl_add_u32 v8, v85, 4, v8
  s_mov_b32 vcc_lo, 0x00010001
  s_mov_b32 vcc_hi, 0x00010001
  v_cndmask_b32 v6, v74, v6, vcc
  v_cndmask_b32 v7, v74, v7, vcc
  s_mov_b32 vcc_lo, 0x00000001
  s_mov_b32 vcc_hi, 0x00000000
  v_cndmask_b32 v81, v74, v81, vcc
  s_mov_b32 vcc_lo, 0x00010001
  s_mov_b32 vcc_hi, 0x00010001
  v_cndmask_b32 v8, v74, v8, vcc
  s_mov_b32 vcc_lo, 0x00000001
  s_mov_b32 vcc_hi, 0x00000000
  v_cndmask_b32 v82, v74, v82, vcc
  v_and_b32 v34, 7, v0
  s_lshl_b32 s67, s30, 3
  v_add_u32 v38, s67, v34
  v_lshlrev_b32 v35, 3, v34
  s_lshl_b32 s66, s29, 6
  s_add_u32 s66, s66, s28
  v_add_u32 v36, s66, v35
  v_lshlrev_b32 v35, 6, v34
  s_add_u32 s66, s67, s28
  v_add_u32 v37, s66, v35
  s_mov_b32 vcc_lo, 0x00000f00
  s_mov_b32 vcc_hi, 0
  v_cndmask_b32 v36, v36, v37, vcc
  s_mov_b32 vcc_lo, 0x00ff0000
  v_cndmask_b32 v36, v36, v38, vcc
  v_bfe_u32 v35, v0, 3, 2
  v_lshlrev_b32 v35, 6, v35
  v_add_u32 v38, v38, v35
  s_mov_b32 vcc_lo, 0
  s_mov_b32 vcc_hi, -1
  v_cndmask_b32 v36, v36, v38, vcc
  v_lshlrev_b32 v70, 7, v36
  s_mov_b32 s64, 5537792
  s_mov_b32 exec_lo, 0x00000fff
  s_mov_b32 exec_hi, 0x00000000
  buffer_load_dwordx2 v[68:69], v70, s[48:51], s64 offen sc1
  s_mov_b64 exec, -1
  s_waitcnt lgkmcnt(0)
  s_barrier
  v_mbcnt_lo_u32_b32 v57, -1, 0
  v_mbcnt_hi_u32_b32 v57, -1, v57
  v_and_b32 v58, 1, v57
  v_lshrrev_b32 v59, 4, v57
  v_lshlrev_b32 v59, 4, v59
  v_lshl_add_u32 v58, v58, 6, v59
  v_add_u32 v58, 159808, v58
  v_add_u32 v63, s69, v59
  v_lshrrev_b32 v59, 5, v57
  v_lshlrev_b32 v62, 6, v59
  v_bfe_u32 v59, v57, 1, 2
  v_lshl_add_u32 v62, v59, 4, v62
  v_bfe_u32 v59, v57, 3, 2
  v_lshl_add_u32 v62, v59, 2, v62
  v_and_b32 v59, 1, v57
  v_lshl_add_u32 v62, v59, 1, v62
  v_add_u32 v62, s69, v62
  v_mov_b32 v56, 0xff800000
  ds_read_b128 v[32:35], v58 offset:0
  ds_read_b128 v[36:39], v58 offset:128
  ds_read_b128 v[40:43], v58 offset:256
  s_waitcnt lgkmcnt(0)
  s_waitcnt vmcnt(22)
  v_mfma_f32_16x16x32_bf16 v[44:47], v[32:35], v[86:89], 0
  v_mfma_f32_16x16x32_bf16 v[44:47], v[36:39], v[90:93], v[44:47]
  v_mfma_f32_16x16x32_bf16 v[44:47], v[40:43], v[94:97], v[44:47]
  s_waitcnt vmcnt(19)
  v_mfma_f32_16x16x32_bf16 v[48:51], v[32:35], v[98:101], 0
  v_mfma_f32_16x16x32_bf16 v[48:51], v[36:39], v[102:105], v[48:51]
  v_mfma_f32_16x16x32_bf16 v[48:51], v[40:43], v[106:109], v[48:51]
  s_waitcnt vmcnt(16)
  v_mfma_f32_16x16x32_bf16 v[52:55], v[32:35], v[110:113], 0
  v_mfma_f32_16x16x32_bf16 v[52:55], v[36:39], v[114:117], v[52:55]
  v_mfma_f32_16x16x32_bf16 v[52:55], v[40:43], v[118:121], v[52:55]
  v_add_f32_dpp v56, v45, v44 row_ror:8 row_mask:0x1 bank_mask:0x3
  s_waitcnt vmcnt(13)
  v_mfma_f32_16x16x32_bf16 v[44:47], v[32:35], v[122:125], 0
  v_mfma_f32_16x16x32_bf16 v[44:47], v[36:39], v[126:129], v[44:47]
  v_mfma_f32_16x16x32_bf16 v[44:47], v[40:43], v[130:133], v[44:47]
  v_add_f32_dpp v56, v48, v49 row_ror:8 row_mask:0x1 bank_mask:0xc
  s_nop 1
  v_add_f32_dpp v56, v53, v52 row_ror:8 row_mask:0x2 bank_mask:0x3
  s_nop 3
  v_add_f32_dpp v56, v44, v45 row_ror:8 row_mask:0x2 bank_mask:0xc
  v_mov_b32 v44, v56
  s_nop 1
  v_max_f32_dpp v44, v44, v44 row_ror:8 row_mask:0xf bank_mask:0xf
  s_nop 1
  v_max_f32_dpp v44, v44, v44 row_ror:4 row_mask:0xf bank_mask:0xf
  s_nop 1
  v_max_f32_dpp v44, v44, v44 row_ror:2 row_mask:0xf bank_mask:0xf
  s_nop 1
  v_max_f32_dpp v44, v44, v44 row_ror:1 row_mask:0xf bank_mask:0xf
  v_mov_b32 v45, v44
  s_nop 1
  v_permlane16_swap_b32 v44, v45
  v_max_f32 v44, v44, v45
  v_mov_b32 v45, v44
  s_nop 1
  v_permlane32_swap_b32 v44, v45
  v_max_f32 v44, v44, v45
  v_mul_f32 v60, s56, v44
  v_fma_f32 v56, v56, s56, -v60
  v_exp_f32 v56, v56
  s_nop 0
  v_cvt_pk_bf16_f32 v46, v56, v56
  ds_write_b16 v62, v46 offset:0
  v_mov_b32 v61, v56
  ds_read_b128 v[52:55], v63
  s_nop 0
  v_add_f32_dpp v61, v61, v61 row_ror:8 row_mask:0xf bank_mask:0xf
  s_nop 1
  v_add_f32_dpp v61, v61, v61 row_ror:4 row_mask:0xf bank_mask:0xf
  s_nop 1
  v_add_f32_dpp v61, v61, v61 row_ror:2 row_mask:0xf bank_mask:0xf
  s_nop 1
  v_add_f32_dpp v61, v61, v61 row_ror:1 row_mask:0xf bank_mask:0xf
  v_mov_b32 v59, v61
  s_nop 1
  v_permlane16_swap_b32 v61, v59
  v_add_f32 v61, v61, v59
  v_mov_b32 v59, v61
  s_nop 1
  v_permlane32_swap_b32 v61, v59
  v_add_f32 v61, v61, v59
  s_waitcnt lgkmcnt(0)
  v_perm_b32 v44, v52, v52, v75
  v_perm_b32 v45, v52, v52, v76
  v_perm_b32 v46, v52, v52, v77
  v_perm_b32 v47, v52, v52, v78
  s_waitcnt vmcnt(12)
  s_nop 0
  v_mfma_f32_16x16x32_bf16 v[32:35], v[44:47], v[134:137], 0
  v_perm_b32 v48, v53, v53, v75
  v_perm_b32 v49, v53, v53, v76
  s_waitcnt vmcnt(11)
  v_mfma_f32_16x16x32_bf16 v[36:39], v[44:47], v[138:141], 0
  v_perm_b32 v50, v53, v53, v77
  v_perm_b32 v51, v53, v53, v78
  s_waitcnt vmcnt(10)
  v_mfma_f32_16x16x32_bf16 v[40:43], v[44:47], v[142:145], 0
  s_waitcnt vmcnt(9)
  v_mfma_f32_16x16x32_bf16 v[32:35], v[48:51], v[146:149], v[32:35]
  v_perm_b32 v44, v54, v54, v75
  v_perm_b32 v45, v54, v54, v76
  s_waitcnt vmcnt(8)
  v_mfma_f32_16x16x32_bf16 v[36:39], v[48:51], v[150:153], v[36:39]
  v_perm_b32 v46, v54, v54, v77
  v_perm_b32 v47, v54, v54, v78
  s_waitcnt vmcnt(7)
  v_mfma_f32_16x16x32_bf16 v[40:43], v[48:51], v[154:157], v[40:43]
  s_waitcnt vmcnt(6)
  v_mfma_f32_16x16x32_bf16 v[32:35], v[44:47], v[158:161], v[32:35]
  v_perm_b32 v48, v55, v55, v75
  v_perm_b32 v49, v55, v55, v76
  s_waitcnt vmcnt(5)
  v_mfma_f32_16x16x32_bf16 v[36:39], v[44:47], v[162:165], v[36:39]
  v_perm_b32 v50, v55, v55, v77
  v_perm_b32 v51, v55, v55, v78
  s_waitcnt vmcnt(4)
  v_mfma_f32_16x16x32_bf16 v[40:43], v[44:47], v[166:169], v[40:43]
  s_waitcnt vmcnt(3)
  v_mfma_f32_16x16x32_bf16 v[32:35], v[48:51], v[170:173], v[32:35]
  s_waitcnt vmcnt(2)
  v_mfma_f32_16x16x32_bf16 v[36:39], v[48:51], v[174:177], v[36:39]
  s_waitcnt vmcnt(1)
  v_mfma_f32_16x16x32_bf16 v[40:43], v[48:51], v[178:181], v[40:43]
  v_mbcnt_lo_u32_b32 v52, -1, 0
  v_mbcnt_hi_u32_b32 v52, -1, v52
  v_and_b32 v53, 15, v52
  v_lshrrev_b32 v54, 4, v52
  v_and_b32 v55, 1, v54
  v_lshrrev_b32 v54, 1, v54
  v_mul_u32_u24 v54, 768, v54
  v_lshl_add_u32 v54, v55, 4, v54
  v_add_u32 v54, s69, v54
  v_lshl_add_u32 v56, v53, 5, v54
  v_and_b32 v53, 7, v53
  v_lshl_add_u32 v57, v53, 5, v54
  v_mov_b32 v58, s72
  v_mov_b32 v44, v60
  v_mov_b32 v45, v61
  v_cndmask_b32 v32, v32, v36, s[70:71]
  v_cndmask_b32 v33, v33, v37, s[70:71]
  v_cndmask_b32 v34, v34, v38, s[70:71]
  v_cndmask_b32 v35, v35, v39, s[70:71]
  ds_write_b128 v56, v[32:35]
  s_mov_b32 exec_lo, 0x00ff00ff
  s_mov_b32 exec_hi, 0xff00ff00
  ds_write_b128 v57, v[40:43] offset:512
  s_mov_b64 exec, 1
  ds_write_b64 v58, v[44:45] offset:0
  s_mov_b64 exec, -1
  s_waitcnt lgkmcnt(0)
  s_mov_b32 s63, 5537792
  s_mov_b32 exec_lo, 0x00000fff
  s_mov_b32 exec_hi, 0x00000000
  s_mov_b32 s65, 400000
  s_branch L_tokchk_192
L_tok_191:
  buffer_load_dwordx2 v[68:69], v70, s[48:51], s63 offen sc1
  s_sub_u32 s65, s65, 1
  s_cbranch_scc1 L_abort
L_tokchk_192:
  s_waitcnt vmcnt(0)
  v_cmp_ne_u32 vcc, s73, v68
  s_cbranch_vccnz L_tok_191
  s_mov_b64 exec, -1
  s_barrier
  v_mov_b32 v84, 159744
  ds_read_b128 v[32:35], v84
  ds_read_b128 v[36:39], v84 offset:16
  v_add_u32 v85, 153600, v83
  ds_read_b128 v[40:43], v85 offset:0
  ds_read_b128 v[44:47], v85 offset:768
  ds_read_b128 v[48:51], v85 offset:1536
  ds_read_b128 v[52:55], v85 offset:2304
  ds_read_b128 v[56:59], v85 offset:3072
  ds_read_b128 v[60:63], v85 offset:3840
  ds_read_b128 v[64:67], v85 offset:4608
  ds_read_b128 v[68:71], v85 offset:5376
  s_add_u32 s63, s57, 0
  s_waitcnt lgkmcnt(8)
  v_max3_f32 v84, v32, v34, v36
  v_max_f32 v84, v84, v38
  v_sub_f32 v32, v32, v84
  v_sub_f32 v34, v34, v84
  v_sub_f32 v36, v36, v84
  v_sub_f32 v38, v38, v84
  v_exp_f32 v32, v32
  v_exp_f32 v34, v34
  v_exp_f32 v36, v36
  v_exp_f32 v38, v38
  v_mul_f32 v85, v32, v33
  v_fma_f32 v85, v34, v35, v85
  v_fma_f32 v85, v36, v37, v85
  v_fma_f32 v85, v38, v39, v85
  s_waitcnt lgkmcnt(6)
  v_pk_add_f32 v[40:41], v[40:41], v[44:45]
  v_pk_add_f32 v[42:43], v[42:43], v[46:47]
  v_mul_f32 v40, v32, v40
  v_mul_f32 v41, v32, v41
  v_mul_f32 v42, v32, v42
  v_mul_f32 v43, v32, v43
  s_waitcnt lgkmcnt(4)
  v_pk_add_f32 v[48:49], v[48:49], v[52:53]
  v_pk_add_f32 v[50:51], v[50:51], v[54:55]
  v_fmac_f32 v40, v34, v48
  v_fmac_f32 v41, v34, v49
  v_fmac_f32 v42, v34, v50
  v_fmac_f32 v43, v34, v51
  s_waitcnt lgkmcnt(2)
  v_pk_add_f32 v[56:57], v[56:57], v[60:61]
  v_pk_add_f32 v[58:59], v[58:59], v[62:63]
  v_fmac_f32 v40, v36, v56
  v_fmac_f32 v41, v36, v57
  v_fmac_f32 v42, v36, v58
  v_fmac_f32 v43, v36, v59
  s_waitcnt lgkmcnt(0)
  v_pk_add_f32 v[64:65], v[64:65], v[68:69]
  v_pk_add_f32 v[66:67], v[66:67], v[70:71]
  v_fmac_f32 v40, v38, v64
  v_fmac_f32 v41, v38, v65
  v_fmac_f32 v42, v38, v66
  v_fmac_f32 v43, v38, v67
  s_mov_b32 vcc_lo, 0
  s_mov_b32 vcc_hi, 0x00010000
  v_cndmask_b32 v40, v40, v84, vcc
  v_cndmask_b32 v41, v41, v85, vcc
  buffer_store_dwordx4 v[40:43], v5, s[48:51], s63 offen offset:0
  s_add_u32 s100, s58, 0
  s_add_u32 s101, s100, 4096
  s_mov_b32 s65, 400000
L_fpoll_193:
  buffer_load_dwordx4 v[64:67], v31, s[48:51], s100 offen offset:0 sc1
  buffer_load_dwordx4 v[32:35], v5, s[48:51], s100 offen offset:0 sc1
  buffer_load_dwordx4 v[36:39], v5, s[48:51], s100 offen offset:1024 sc1
  buffer_load_dwordx4 v[40:43], v5, s[48:51], s100 offen offset:2048 sc1
  buffer_load_dwordx4 v[44:47], v5, s[48:51], s100 offen offset:3072 sc1
  buffer_load_dwordx4 v[48:51], v5, s[48:51], s101 offen offset:0 sc1
  buffer_load_dwordx4 v[52:55], v5, s[48:51], s101 offen offset:1024 sc1
  buffer_load_dwordx4 v[56:59], v5, s[48:51], s101 offen offset:2048 sc1
  buffer_load_dwordx4 v[60:63], v5, s[48:51], s101 offen offset:3072 sc1
  s_sub_u32 s65, s65, 1
  s_cbranch_scc1 L_abort
  s_waitcnt vmcnt(8)
  v_max_u32 v84, v65, v67
  v_mov_b32 v66, v64
  s_nop 1
  v_max_f32_dpp v66, v66, v66 quad_perm:[1,0,3,2] row_mask:0xf bank_mask:0xf
  s_nop 1
  v_max_f32_dpp v66, v66, v66 quad_perm:[2,3,0,1] row_mask:0xf bank_mask:0xf
  s_nop 1
  v_max_f32_dpp v66, v66, v66 row_half_mirror row_mask:0xf bank_mask:0xf
  v_sub_f32 v67, v64, v66
  v_exp_f32 v67, v67
  s_waitcnt vmcnt(4)
  v_max3_u32 v84, v84, v33, v35
  v_max3_u32 v84, v84, v37, v39
  v_mul_f32 v65, v67, v65
  v_max3_u32 v84, v84, v41, v43
  v_max3_u32 v84, v84, v45, v47
  v_add_f32_dpp v65, v65, v65 quad_perm:[1,0,3,2] row_mask:0xf bank_mask:0xf
  s_waitcnt vmcnt(0)
  v_max3_u32 v84, v84, v49, v51
  v_max3_u32 v84, v84, v53, v55
  v_add_f32_dpp v65, v65, v65 quad_perm:[2,3,0,1] row_mask:0xf bank_mask:0xf
  v_max3_u32 v84, v84, v57, v59
  v_max3_u32 v84, v84, v61, v63
  v_add_f32_dpp v65, v65, v65 row_half_mirror row_mask:0xf bank_mask:0xf
  v_rcp_f32 v65, v65
  s_nop 0
  v_mul_f32 v67, v67, v65
  s_nop 0
  v_readlane_b32 s4, v67, 0
  v_readlane_b32 s6, v67, 1
  v_readlane_b32 s8, v67, 2
  v_readlane_b32 s10, v67, 3
  v_readlane_b32 s12, v67, 4
  v_readlane_b32 s16, v67, 5
  v_readlane_b32 s18, v67, 6
  v_readlane_b32 s20, v67, 7
  v_pk_mul_f32 v[68:69], v[32:33], s[4:5] op_sel_hi:[1,0]
  v_pk_mul_f32 v[70:71], v[34:35], s[4:5] op_sel_hi:[1,0]
  v_pk_fma_f32 v[68:69], v[36:37], s[6:7], v[68:69] op_sel_hi:[1,0,1]
  v_pk_fma_f32 v[70:71], v[38:39], s[6:7], v[70:71] op_sel_hi:[1,0,1]
  v_pk_fma_f32 v[68:69], v[40:41], s[8:9], v[68:69] op_sel_hi:[1,0,1]
  v_pk_fma_f32 v[70:71], v[42:43], s[8:9], v[70:71] op_sel_hi:[1,0,1]
  v_pk_fma_f32 v[68:69], v[44:45], s[10:11], v[68:69] op_sel_hi:[1,0,1]
  v_pk_fma_f32 v[70:71], v[46:47], s[10:11], v[70:71] op_sel_hi:[1,0,1]
  v_pk_fma_f32 v[68:69], v[48:49], s[12:13], v[68:69] op_sel_hi:[1,0,1]
  v_pk_fma_f32 v[70:71], v[50:51], s[12:13], v[70:71] op_sel_hi:[1,0,1]
  v_pk_fma_f32 v[68:69], v[52:53], s[16:17], v[68:69] op_sel_hi:[1,0,1]
  v_pk_fma_f32 v[70:71], v[54:55], s[16:17], v[70:71] op_sel_hi:[1,0,1]
  v_pk_fma_f32 v[68:69], v[56:57], s[18:19], v[68:69] op_sel_hi:[1,0,1]
  v_pk_fma_f32 v[70:71], v[58:59], s[18:19], v[70:71] op_sel_hi:[1,0,1]
  v_pk_fma_f32 v[68:69], v[60:61], s[20:21], v[68:69] op_sel_hi:[1,0,1]
  v_pk_fma_f32 v[70:71], v[62:63], s[20:21], v[70:71] op_sel_hi:[1,0,1]
  v_cmp_eq_u32 vcc, -1, v84
  s_cbranch_vccnz L_fpoll_193
  v_cvt_pk_bf16_f32 v68, v68, v69
  v_cvt_pk_bf16_f32 v69, v70, v71
  ds_write_b64 v28, v[68:69] offset:6976
  ds_read_b128 v[32:35], v9 offset:0
  ds_read_b128 v[36:39], v9 offset:64
  ds_read_b128 v[40:43], v9 offset:128
  ds_read_b128 v[44:47], v9 offset:192
  ds_read_b128 v[48:51], v9 offset:256
  ds_read_b128 v[52:55], v9 offset:320
  s_add_u32 s63, s59, 3407872
  v_and_b32 v56, 7, v0
  s_lshl_b32 s67, s30, 3
  v_add_u32 v60, s67, v56
  v_mov_b32 v58, v60
  v_bfe_u32 v57, v0, 3, 2
  v_lshlrev_b32 v57, 6, v57
  v_add_u32 v60, v60, v57
  s_mov_b32 vcc_lo, 0
  s_mov_b32 vcc_hi, -1
  v_cndmask_b32 v58, v58, v60, vcc
  v_lshlrev_b32 v70, 7, v58
  s_mov_b32 s64, 5537792
  s_mov_b32 exec_lo, 0x00ff0000
  s_mov_b32 exec_hi, 0xffffffff
  buffer_load_dwordx2 v[68:69], v70, s[48:51], s64 offen sc1
  s_mov_b64 exec, -1
  s_waitcnt lgkmcnt(5)
  v_mfma_f32_16x16x32_bf16 v[56:59], a[120:123], v[32:35], 0
  s_waitcnt lgkmcnt(4)
  v_mfma_f32_16x16x32_bf16 v[56:59], a[124:127], v[36:39], v[56:59]
  s_waitcnt lgkmcnt(3)
  v_mfma_f32_16x16x32_bf16 v[56:59], a[128:131], v[40:43], v[56:59]
  s_waitcnt lgkmcnt(2)
  v_mfma_f32_16x16x32_bf16 v[56:59], a[132:135], v[44:47], v[56:59]
  s_waitcnt lgkmcnt(1)
  v_mfma_f32_16x16x32_bf16 v[56:59], a[136:139], v[48:51], v[56:59]
  s_waitcnt lgkmcnt(0)
  v_mfma_f32_16x16x32_bf16 v[56:59], a[140:143], v[52:55], v[56:59]
  v_mfma_f32_16x16x32_bf16 v[60:63], a[144:147], v[32:35], 0
  v_mfma_f32_16x16x32_bf16 v[60:63], a[148:151], v[36:39], v[60:63]
  v_mfma_f32_16x16x32_bf16 v[60:63], a[152:155], v[40:43], v[60:63]
  v_mfma_f32_16x16x32_bf16 v[60:63], a[156:159], v[44:47], v[60:63]
  v_mfma_f32_16x16x32_bf16 v[60:63], a[160:163], v[48:51], v[60:63]
  v_mfma_f32_16x16x32_bf16 v[60:63], a[164:167], v[52:55], v[60:63]
  v_mfma_f32_16x16x32_bf16 v[64:67], a[168:171], v[32:35], 0
  v_mfma_f32_16x16x32_bf16 v[64:67], a[172:175], v[36:39], v[64:67]
  v_mfma_f32_16x16x32_bf16 v[64:67], a[176:179], v[40:43], v[64:67]
  v_mfma_f32_16x16x32_bf16 v[64:67], a[180:183], v[44:47], v[64:67]
  v_mfma_f32_16x16x32_bf16 v[64:67], a[184:187], v[48:51], v[64:67]
  v_mfma_f32_16x16x32_bf16 v[64:67], a[188:191], v[52:55], v[64:67]
  buffer_store_dwordx4 v[56:59], v6, s[48:51], s63 offen offset:0
  s_nop 1
  v_mfma_f32_16x16x32_bf16 v[56:59], a[192:195], v[32:35], 0
  v_mfma_f32_16x16x32_bf16 v[56:59], a[196:199], v[36:39], v[56:59]
  v_mfma_f32_16x16x32_bf16 v[56:59], a[200:203], v[40:43], v[56:59]
  v_mfma_f32_16x16x32_bf16 v[56:59], a[204:207], v[44:47], v[56:59]
  v_mfma_f32_16x16x32_bf16 v[56:59], a[208:211], v[48:51], v[56:59]
  v_mfma_f32_16x16x32_bf16 v[56:59], a[212:215], v[52:55], v[56:59]
  buffer_store_dwordx4 v[60:63], v6, s[48:51], s63 offen offset:64
  s_nop 1
  v_mfma_f32_16x16x32_bf16 v[60:63], a[216:219], v[32:35], 0
  v_mfma_f32_16x16x32_bf16 v[60:63], a[220:223], v[36:39], v[60:63]
  v_mfma_f32_16x16x32_bf16 v[60:63], a[224:227], v[40:43], v[60:63]
  v_mfma_f32_16x16x32_bf16 v[60:63], a[228:231], v[44:47], v[60:63]
  v_mfma_f32_16x16x32_bf16 v[60:63], a[232:235], v[48:51], v[60:63]
  v_mfma_f32_16x16x32_bf16 v[60:63], a[236:239], v[52:55], v[60:63]
  buffer_store_dwordx4 v[64:67], v6, s[48:51], s63 offen offset:128
  buffer_store_dwordx4 v[56:59], v6, s[48:51], s63 offen offset:192
  s_nop 5
  buffer_store_dwordx4 v[60:63], v6, s[48:51], s63 offen offset:256
  s_waitcnt vmcnt(5)
  s_mov_b32 exec_lo, 0x00ff0000
  s_mov_b32 exec_hi, 0xffffffff
  v_cmp_ne_u32 vcc, s73, v68
  s_cbranch_vccz L_tok2ok_194
  s_mov_b32 s65, 400000
L_tok2re_195:
  buffer_load_dwordx2 v[68:69], v70, s[48:51], s64 offen sc1
  s_sub_u32 s65, s65, 1
  s_cbranch_scc1 L_abort
  s_waitcnt vmcnt(0)
  v_cmp_ne_u32 vcc, s73, v68
  s_cbranch_vccnz L_tok2re_195
L_tok2ok_194:
  s_mov_b64 exec, -1
  s_cmp_lg_u32 s29, 0
  s_cbranch_scc1 L_notleader_196
  s_add_u32 s100, s60, 3407872
  s_add_u32 s63, s61, 4980736
  s_mov_b32 s65, 400000
L_fpoll_197:
  buffer_load_dwordx4 v[32:35], v4, s[48:51], s100 offen offset:0 sc1
  buffer_load_dwordx4 v[36:39], v4, s[48:51], s100 offen offset:1024 sc1
  buffer_load_dwordx4 v[40:43], v4, s[48:51], s100 offen offset:2048 sc1
  buffer_load_dwordx4 v[44:47], v4, s[48:51], s100 offen offset:3072 sc1
  s_sub_u32 s65, s65, 1
  s_cbranch_scc1 L_abort
  s_waitcnt vmcnt(2)
  v_max_u32 v84, v33, v35
  v_max3_u32 v84, v84, v37, v39
  v_pk_add_f32 v[32:33], v[32:33], v[36:37]
  v_pk_add_f32 v[34:35], v[34:35], v[38:39]
  s_waitcnt vmcnt(1)
  v_max3_u32 v84, v84, v41, v43
  v_pk_add_f32 v[32:33], v[32:33], v[40:41]
  v_pk_add_f32 v[34:35], v[34:35], v[42:43]
  s_waitcnt vmcnt(0)
  v_max3_u32 v84, v84, v45, v47
  v_pk_add_f32 v[32:33], v[32:33], v[44:45]
  v_pk_add_f32 v[34:35], v[34:35], v[46:47]
  v_cmp_eq_u32 vcc, -1, v84
  s_cbranch_vccnz L_fpoll_197
  buffer_store_dwordx4 v[32:35], v4, s[48:51], s63 offen sc1
L_notleader_196:
  s_add_u32 s100, s62, 4980736
  s_add_u32 s101, s100, 4096
  s_mov_b32 s65, 400000
  s_sleep 6
L_fpoll_198:
  buffer_load_dwordx4 v[32:35], v4, s[48:51], s100 offen offset:0 sc1
  buffer_load_dwordx4 v[36:39], v4, s[48:51], s100 offen offset:1024 sc1
  buffer_load_dwordx4 v[40:43], v4, s[48:51], s100 offen offset:2048 sc1
  buffer_load_dwordx4 v[44:47], v4, s[48:51], s100 offen offset:3072 sc1
  buffer_load_dwordx4 v[48:51], v4, s[48:51], s101 offen offset:0 sc1
  buffer_load_dwordx4 v[52:55], v4, s[48:51], s101 offen offset:1024 sc1
  buffer_load_dwordx4 v[56:59], v4, s[48:51], s101 offen offset:2048 sc1
  buffer_load_dwordx4 v[60:63], v4, s[48:51], s101 offen offset:3072 sc1
  s_sub_u32 s65, s65, 1
  s_cbranch_scc1 L_abort
  s_waitcnt vmcnt(6)
  v_max_u32 v84, v33, v35
  v_max3_u32 v84, v84, v37, v39
  v_pk_add_f32 v[32:33], v[32:33], v[16:17]
  v_pk_add_f32 v[34:35], v[34:35], v[18:19]
  v_pk_add_f32 v[32:33], v[32:33], v[36:37]
  v_pk_add_f32 v[34:35], v[34:35], v[38:39]
  s_waitcnt vmcnt(4)
  v_max3_u32 v84, v84, v41, v43
  v_max3_u32 v84, v84, v45, v47
  v_pk_add_f32 v[40:41], v[40:41], v[44:45]
  v_pk_add_f32 v[42:43], v[42:43], v[46:47]
  v_pk_add_f32 v[32:33], v[32:33], v[40:41]
  v_pk_add_f32 v[34:35], v[34:35], v[42:43]
  s_waitcnt vmcnt(2)
  v_max3_u32 v84, v84, v49, v51
  v_max3_u32 v84, v84, v53, v55
  v_pk_add_f32 v[48:49], v[48:49], v[52:53]
  v_pk_add_f32 v[50:51], v[50:51], v[54:55]
  v_pk_add_f32 v[32:33], v[32:33], v[48:49]
  v_pk_add_f32 v[34:35], v[34:35], v[50:51]
  s_waitcnt vmcnt(1)
  v_max3_u32 v84, v84, v57, v59
  v_pk_add_f32 v[32:33], v[32:33], v[56:57]
  v_pk_add_f32 v[34:35], v[34:35], v[58:59]
  s_waitcnt vmcnt(0)
  v_max3_u32 v84, v84, v61, v63
  v_pk_add_f32 v[32:33], v[32:33], v[60:61]
  v_pk_add_f32 v[34:35], v[34:35], v[62:63]
  v_cmp_eq_u32 vcc, -1, v84
  s_cbranch_vccnz L_fpoll_198
  v_cvt_pk_bf16_f32 v36, v32, v33
  v_cvt_pk_bf16_f32 v37, v34, v35
  ds_write_b64 v29, v[36:37]
  ds_read_b128 v[40:43], v10
  ds_read_b128 v[44:47], v10 offset:64
  ds_read_b64 v[48:49], v11
  v_mov_b32 v50, 0
  v_mov_b32 v51, 0
  ds_read_b128 v[52:55], v14
  ds_read_b128 v[56:59], v14 offset:64
  ds_read_b64 v[60:61], v15
  v_mov_b32 v62, 0
  v_mov_b32 v63, 0
  s_add_u32 s63, s57, 2621440
  v_lshlrev_b32 v16, 16, v36
  v_and_b32 v17, 0xffff0000, v36
  v_lshlrev_b32 v18, 16, v37
  v_and_b32 v19, 0xffff0000, v37
  s_add_u32 s100, s58, 2621440
  s_add_u32 s101, s100, 4096
  s_waitcnt lgkmcnt(5)
  v_mfma_f32_16x16x32_bf16 v[64:67], v[198:201], v[40:43], 0
  s_waitcnt lgkmcnt(4)
  v_mfma_f32_16x16x32_bf16 v[64:67], v[202:205], v[44:47], v[64:67]
  s_waitcnt lgkmcnt(3)
  v_mfma_f32_16x16x32_bf16 v[64:67], v[196:199], v[48:51], v[64:67]
  v_mfma_f32_16x16x32_bf16 v[68:71], v[228:231], v[40:43], 0
  v_mfma_f32_16x16x32_bf16 v[68:71], v[232:235], v[44:47], v[68:71]
  v_mfma_f32_16x16x32_bf16 v[68:71], v[226:229], v[48:51], v[68:71]
  s_waitcnt lgkmcnt(0)
  v_mfma_f32_16x16x32_bf16 v[32:35], v[52:55], v[40:43], 0
  v_mfma_f32_16x16x32_bf16 v[32:35], v[56:59], v[44:47], v[32:35]
  v_mfma_f32_16x16x32_bf16 v[32:35], v[60:63], v[48:51], v[32:35]
  v_mfma_f32_16x16x32_bf16 v[52:55], v[208:211], v[40:43], 0
  v_mfma_f32_16x16x32_bf16 v[52:55], v[212:215], v[44:47], v[52:55]
  v_mfma_f32_16x16x32_bf16 v[52:55], v[206:209], v[48:51], v[52:55]
  v_mfma_f32_16x16x32_bf16 v[56:59], v[238:241], v[40:43], 0
  v_mfma_f32_16x16x32_bf16 v[56:59], v[242:245], v[44:47], v[56:59]
  v_mfma_f32_16x16x32_bf16 v[56:59], v[236:239], v[48:51], v[56:59]
  v_swap_b32 v66, v68
  v_swap_b32 v67, v69
  buffer_store_dwordx4 v[64:67], v7, s[48:51], s63 offen offset:0
  buffer_store_dwordx4 v[68:71], v7, s[48:51], s63 offen offset:16
  v_cndmask_b32 v33, v33, v34, s[74:75]
  v_mfma_f32_16x16x32_bf16 v[64:67], v[218:221], v[40:43], 0
  v_mfma_f32_16x16x32_bf16 v[64:67], v[222:225], v[44:47], v[64:67]
  v_mfma_f32_16x16x32_bf16 v[64:67], v[216:219], v[48:51], v[64:67]
  v_mfma_f32_16x16x32_bf16 v[68:71], v[248:251], v[40:43], 0
  v_mfma_f32_16x16x32_bf16 v[68:71], v[252:255], v[44:47], v[68:71]
  v_mfma_f32_16x16x32_bf16 v[68:71], v[246:249], v[48:51], v[68:71]
  v_swap_b32 v54, v56
  v_swap_b32 v55, v57
  buffer_store_dwordx4 v[52:55], v7, s[48:51], s63 offen offset:128
  buffer_store_dwordx4 v[56:59], v7, s[48:51], s63 offen offset:144
  s_nop 3
  v_swap_b32 v66, v68
  v_swap_b32 v67, v69
  buffer_store_dwordx4 v[64:67], v7, s[48:51], s63 offen offset:256
  buffer_store_dwordx4 v[68:71], v7, s[48:51], s63 offen offset:272
  buffer_store_dwordx4 v[32:35], v81, s[48:51], s63 offen offset:0
  s_mov_b32 s65, 400000
L_fpoll_199:
  buffer_load_dwordx4 v[64:67], v80, s[48:51], s100 offen offset:0 sc1
  buffer_load_dwordx4 v[32:35], v79, s[48:51], s100 offen offset:0 sc1
  buffer_load_dwordx4 v[36:39], v79, s[48:51], s100 offen offset:1024 sc1
  buffer_load_dwordx4 v[40:43], v79, s[48:51], s100 offen offset:2048 sc1
  buffer_load_dwordx4 v[44:47], v79, s[48:51], s100 offen offset:3072 sc1
  buffer_load_dwordx4 v[48:51], v79, s[48:51], s101 offen offset:0 sc1
  buffer_load_dwordx4 v[52:55], v79, s[48:51], s101 offen offset:1024 sc1
  buffer_load_dwordx4 v[56:59], v79, s[48:51], s101 offen offset:2048 sc1
  buffer_load_dwordx4 v[60:63], v79, s[48:51], s101 offen offset:3072 sc1
  s_sub_u32 s65, s65, 1
  s_cbranch_scc1 L_abort
  s_waitcnt vmcnt(8)
  v_max_u32 v84, v65, v67
  v_add_f32_dpp v64, v64, v64 quad_perm:[1,0,3,2] row_mask:0xf bank_mask:0xf
  v_add_f32_dpp v65, v65, v65 quad_perm:[1,0,3,2] row_mask:0xf bank_mask:0xf
  s_waitcnt vmcnt(6)
  v_max3_u32 v84, v84, v33, v35
  v_add_f32_dpp v64, v64, v64 quad_perm:[2,3,0,1] row_mask:0xf bank_mask:0xf
  v_add_f32_dpp v65, v65, v65 quad_perm:[2,3,0,1] row_mask:0xf bank_mask:0xf
  v_max3_u32 v84, v84, v37, v39
  v_add_f32_dpp v64, v64, v64 row_half_mirror row_mask:0xf bank_mask:0xf
  v_add_f32_dpp v65, v65, v65 row_half_mirror row_mask:0xf bank_mask:0xf
  v_pk_add_f32 v[32:33], v[32:33], v[36:37]
  v_pk_add_f32 v[34:35], v[34:35], v[38:39]
  v_mul_f32 v66, 0x3acccccd, v64
  v_mul_f32 v65, 0x3acccccd, v65
  s_waitcnt vmcnt(4)
  v_max3_u32 v84, v84, v41, v43
  v_max3_u32 v84, v84, v45, v47
  v_fma_f32 v65, -v66, v66, v65
  v_pk_add_f32 v[40:41], v[40:41], v[44:45]
  v_pk_add_f32 v[42:43], v[42:43], v[46:47]
  v_max_f32 v65, 0, v65
  v_add_f32 v65, 0x3727c5ac, v65
  v_pk_add_f32 v[32:33], v[32:33], v[40:41]
  v_pk_add_f32 v[34:35], v[34:35], v[42:43]
  v_rsq_f32 v67, v65
  s_waitcnt vmcnt(2)
  v_max3_u32 v84, v84, v49, v51
  v_max3_u32 v84, v84, v53, v55
  v_pk_mul_f32 v[68:69], v[24:25], v[66:67] op_sel_hi:[1,0]
  v_pk_mul_f32 v[70:71], v[26:27], v[66:67] op_sel_hi:[1,0]
  v_pk_add_f32 v[48:49], v[48:49], v[52:53]
  v_pk_add_f32 v[50:51], v[50:51], v[54:55]
  v_pk_add_f32 v[32:33], v[32:33], v[68:69] neg_lo:[0,1] neg_hi:[0,1]
  v_pk_add_f32 v[34:35], v[34:35], v[70:71] neg_lo:[0,1] neg_hi:[0,1]
  v_pk_add_f32 v[32:33], v[32:33], v[48:49]
  v_pk_add_f32 v[34:35], v[34:35], v[50:51]
  s_waitcnt vmcnt(1)
  v_max3_u32 v84, v84, v57, v59
  v_pk_add_f32 v[32:33], v[32:33], v[56:57]
  v_pk_add_f32 v[34:35], v[34:35], v[58:59]
  s_waitcnt vmcnt(0)
  v_max3_u32 v84, v84, v61, v63
  v_pk_add_f32 v[32:33], v[32:33], v[60:61]
  v_pk_add_f32 v[34:35], v[34:35], v[62:63]
  v_cmp_eq_u32 vcc, -1, v84
  s_cbranch_vccnz L_fpoll_199
  v_pk_mul_f32 v[32:33], v[32:33], v[66:67] op_sel:[0,1] op_sel_hi:[1,1]
  v_pk_mul_f32 v[34:35], v[34:35], v[66:67] op_sel:[0,1] op_sel_hi:[1,1]
  v_max_f32 v32, 0, v32
  v_max_f32 v33, 0, v33
  v_pk_mul_f32 v[32:33], v[32:33], v[34:35]
  v_cvt_pk_bf16_f32 v32, v32, v33
  ds_write_b32 v30, v32
  ds_read_b128 v[32:35], v12
  ds_read_b64 v[36:37], v13
  v_mov_b32 v38, 0
  v_mov_b32 v39, 0
  s_add_u32 s63, s59, 3670016
  s_waitcnt lgkmcnt(1)
  v_mfma_f32_16x16x32_bf16 v[40:43], a[240:243], v[32:35], 0
  s_waitcnt lgkmcnt(0)
  v_mfma_f32_16x16x32_bf16 v[40:43], v[186:189], v[36:39], v[40:43]
  v_mfma_f32_16x16x32_bf16 v[44:47], a[244:247], v[32:35], 0
  v_mfma_f32_16x16x32_bf16 v[44:47], v[188:191], v[36:39], v[44:47]
  v_mfma_f32_16x16x32_bf16 v[48:51], a[248:251], v[32:35], 0
  v_mfma_f32_16x16x32_bf16 v[48:51], v[190:193], v[36:39], v[48:51]
  v_mfma_f32_16x16x32_bf16 v[52:55], a[252:255], v[32:35], 0
  v_mfma_f32_16x16x32_bf16 v[52:55], v[192:195], v[36:39], v[52:55]
  v_mfma_f32_16x16x32_bf16 v[56:59], v[182:185], v[32:35], 0
  v_mfma_f32_16x16x32_bf16 v[56:59], v[194:197], v[36:39], v[56:59]
  buffer_store_dwordx4 v[40:43], v6, s[48:51], s63 offen offset:0
  s_nop 0
  buffer_store_dwordx4 v[44:47], v6, s[48:51], s63 offen offset:64
  s_nop 0
  buffer_store_dwordx4 v[48:51], v6, s[48:51], s63 offen offset:128
  s_nop 0
  buffer_store_dwordx4 v[52:55], v6, s[48:51], s63 offen offset:192
  s_nop 0
  buffer_store_dwordx4 v[56:59], v6, s[48:51], s63 offen offset:256
  s_cmp_lg_u32 s29, 0
  s_cbranch_scc1 L_notleader_200
  s_add_u32 s100, s60, 3670016
  s_add_u32 s63, s61, 5046272
  s_mov_b32 s65, 400000
L_fpoll_201:
  buffer_load_dwordx4 v[32:35], v4, s[48:51], s100 offen offset:0 sc1
  buffer_load_dwordx4 v[36:39], v4, s[48:51], s100 offen offset:1024 sc1
  buffer_load_dwordx4 v[40:43], v4, s[48:51], s100 offen offset:2048 sc1
  buffer_load_dwordx4 v[44:47], v4, s[48:51], s100 offen offset:3072 sc1
  s_sub_u32 s65, s65, 1
  s_cbranch_scc1 L_abort
  s_waitcnt vmcnt(2)
  v_max_u32 v84, v33, v35
  v_max3_u32 v84, v84, v37, v39
  v_pk_add_f32 v[32:33], v[32:33], v[36:37]
  v_pk_add_f32 v[34:35], v[34:35], v[38:39]
  s_waitcnt vmcnt(1)
  v_max3_u32 v84, v84, v41, v43
  v_pk_add_f32 v[32:33], v[32:33], v[40:41]
  v_pk_add_f32 v[34:35], v[34:35], v[42:43]
  s_waitcnt vmcnt(0)
  v_max3_u32 v84, v84, v45, v47
  v_pk_add_f32 v[32:33], v[32:33], v[44:45]
  v_pk_add_f32 v[34:35], v[34:35], v[46:47]
  v_cmp_eq_u32 vcc, -1, v84
  s_cbranch_vccnz L_fpoll_201
  buffer_store_dwordx4 v[32:35], v4, s[48:51], s63 offen sc1
L_notleader_200:
  s_add_u32 s100, s62, 5046272
  s_add_u32 s101, s100, 4096
  s_mov_b32 s65, 400000
  s_sleep 6
L_fpoll_202:
  buffer_load_dwordx4 v[32:35], v4, s[48:51], s100 offen offset:0 sc1
  buffer_load_dwordx4 v[36:39], v4, s[48:51], s100 offen offset:1024 sc1
  buffer_load_dwordx4 v[40:43], v4, s[48:51], s100 offen offset:2048 sc1
  buffer_load_dwordx4 v[44:47], v4, s[48:51], s100 offen offset:3072 sc1
  buffer_load_dwordx4 v[48:51], v4, s[48:51], s101 offen offset:0 sc1
  buffer_load_dwordx4 v[52:55], v4, s[48:51], s101 offen offset:1024 sc1
  buffer_load_dwordx4 v[56:59], v4, s[48:51], s101 offen offset:2048 sc1
  buffer_load_dwordx4 v[60:63], v4, s[48:51], s101 offen offset:3072 sc1
  s_sub_u32 s65, s65, 1
  s_cbranch_scc1 L_abort
  s_waitcnt vmcnt(6)
  v_max_u32 v84, v33, v35
  v_max3_u32 v84, v84, v37, v39
  v_pk_add_f32 v[32:33], v[32:33], v[16:17]
  v_pk_add_f32 v[34:35], v[34:35], v[18:19]
  v_pk_add_f32 v[32:33], v[32:33], v[36:37]
  v_pk_add_f32 v[34:35], v[34:35], v[38:39]
  s_waitcnt vmcnt(4)
  v_max3_u32 v84, v84, v41, v43
  v_max3_u32 v84, v84, v45, v47
  v_pk_add_f32 v[40:41], v[40:41], v[44:45]
  v_pk_add_f32 v[42:43], v[42:43], v[46:47]
  v_pk_add_f32 v[32:33], v[32:33], v[40:41]
  v_pk_add_f32 v[34:35], v[34:35], v[42:43]
  s_waitcnt vmcnt(2)
  v_max3_u32 v84, v84, v49, v51
  v_max3_u32 v84, v84, v53, v55
  v_pk_add_f32 v[48:49], v[48:49], v[52:53]
  v_pk_add_f32 v[50:51], v[50:51], v[54:55]
  v_pk_add_f32 v[32:33], v[32:33], v[48:49]
  v_pk_add_f32 v[34:35], v[34:35], v[50:51]
  s_waitcnt vmcnt(1)
  v_max3_u32 v84, v84, v57, v59
  v_pk_add_f32 v[32:33], v[32:33], v[56:57]
  v_pk_add_f32 v[34:35], v[34:35], v[58:59]
  s_waitcnt vmcnt(0)
  v_max3_u32 v84, v84, v61, v63
  v_pk_add_f32 v[32:33], v[32:33], v[60:61]
  v_pk_add_f32 v[34:35], v[34:35], v[62:63]
  v_cmp_eq_u32 vcc, -1, v84
  s_cbranch_vccnz L_fpoll_202
  v_cvt_pk_bf16_f32 v36, v32, v33
  v_cvt_pk_bf16_f32 v37, v34, v35
  ds_write_b64 v29, v[36:37]
  ds_read_b128 v[40:43], v10
  ds_read_b128 v[44:47], v10 offset:64
  ds_read_b64 v[48:49], v11
  v_mov_b32 v50, 0
  v_mov_b32 v51, 0
  ds_read_b128 v[52:55], v14
  ds_read_b128 v[56:59], v14 offset:64
  ds_read_b64 v[60:61], v15
  v_mov_b32 v62, 0
  v_mov_b32 v63, 0
  s_add_u32 s63, s57, 1835008
  v_lshlrev_b32 v16, 16, v36
  v_and_b32 v17, 0xffff0000, v36
  v_lshlrev_b32 v18, 16, v37
  v_and_b32 v19, 0xffff0000, v37
  s_add_u32 s100, s58, 1835008
  s_add_u32 s101, s100, 4096
  s_waitcnt lgkmcnt(5)
  v_mfma_f32_16x16x32_bf16 v[64:67], a[2:5], v[40:43], 0
  s_waitcnt lgkmcnt(4)
  v_mfma_f32_16x16x32_bf16 v[64:67], a[6:9], v[44:47], v[64:67]
  s_waitcnt lgkmcnt(3)
  v_mfma_f32_16x16x32_bf16 v[64:67], a[0:3], v[48:51], v[64:67]
  s_waitcnt lgkmcnt(0)
  v_mfma_f32_16x16x32_bf16 v[36:39], v[52:55], v[40:43], 0
  v_mfma_f32_16x16x32_bf16 v[36:39], v[56:59], v[44:47], v[36:39]
  v_mfma_f32_16x16x32_bf16 v[36:39], v[60:63], v[48:51], v[36:39]
  v_mfma_f32_16x16x32_bf16 v[68:71], a[12:15], v[40:43], 0
  v_mfma_f32_16x16x32_bf16 v[68:71], a[16:19], v[44:47], v[68:71]
  v_mfma_f32_16x16x32_bf16 v[68:71], a[10:13], v[48:51], v[68:71]
  v_mfma_f32_16x16x32_bf16 v[32:35], a[22:25], v[40:43], 0
  v_mfma_f32_16x16x32_bf16 v[32:35], a[26:29], v[44:47], v[32:35]
  v_mfma_f32_16x16x32_bf16 v[32:35], a[20:23], v[48:51], v[32:35]
  v_mfma_f32_16x16x32_bf16 v[52:55], a[32:35], v[40:43], 0
  v_mfma_f32_16x16x32_bf16 v[52:55], a[36:39], v[44:47], v[52:55]
  v_mfma_f32_16x16x32_bf16 v[52:55], a[30:33], v[48:51], v[52:55]
  buffer_store_dwordx4 v[64:67], v8, s[48:51], s63 offen offset:0
  s_nop 1
  v_mfma_f32_16x16x32_bf16 v[64:67], a[42:45], v[40:43], 0
  v_mfma_f32_16x16x32_bf16 v[64:67], a[46:49], v[44:47], v[64:67]
  v_mfma_f32_16x16x32_bf16 v[64:67], a[40:43], v[48:51], v[64:67]
  buffer_store_dwordx4 v[68:71], v8, s[48:51], s63 offen offset:64
  s_nop 1
  v_mfma_f32_16x16x32_bf16 v[68:71], a[52:55], v[40:43], 0
  v_mfma_f32_16x16x32_bf16 v[68:71], a[56:59], v[44:47], v[68:71]
  v_mfma_f32_16x16x32_bf16 v[68:71], a[50:53], v[48:51], v[68:71]
  buffer_store_dwordx4 v[32:35], v8, s[48:51], s63 offen offset:128
  s_nop 1
  v_mfma_f32_16x16x32_bf16 v[32:35], a[62:65], v[40:43], 0
  v_mfma_f32_16x16x32_bf16 v[32:35], a[66:69], v[44:47], v[32:35]
  v_mfma_f32_16x16x32_bf16 v[32:35], a[60:63], v[48:51], v[32:35]
  buffer_store_dwordx4 v[52:55], v8, s[48:51], s63 offen offset:192
  s_nop 1
  v_mfma_f32_16x16x32_bf16 v[52:55], a[72:75], v[40:43], 0
  v_mfma_f32_16x16x32_bf16 v[52:55], a[76:79], v[44:47], v[52:55]
  v_mfma_f32_16x16x32_bf16 v[52:55], a[70:73], v[48:51], v[52:55]
  buffer_store_dwordx4 v[64:67], v8, s[48:51], s63 offen offset:256
  s_nop 1
  v_mfma_f32_16x16x32_bf16 v[64:67], a[82:85], v[40:43], 0
  v_mfma_f32_16x16x32_bf16 v[64:67], a[86:89], v[44:47], v[64:67]
  v_mfma_f32_16x16x32_bf16 v[64:67], a[80:83], v[48:51], v[64:67]
  buffer_store_dwordx4 v[68:71], v8, s[48:51], s63 offen offset:320
  s_nop 1
  v_mfma_f32_16x16x32_bf16 v[68:71], a[92:95], v[40:43], 0
  v_mfma_f32_16x16x32_bf16 v[68:71], a[96:99], v[44:47], v[68:71]
  v_mfma_f32_16x16x32_bf16 v[68:71], a[90:93], v[48:51], v[68:71]
  buffer_store_dwordx4 v[32:35], v8, s[48:51], s63 offen offset:384
  s_nop 1
  v_mfma_f32_16x16x32_bf16 v[32:35], a[102:105], v[40:43], 0
  v_mfma_f32_16x16x32_bf16 v[32:35], a[106:109], v[44:47], v[32:35]
  v_mfma_f32_16x16x32_bf16 v[32:35], a[100:103], v[48:51], v[32:35]
  buffer_store_dwordx4 v[52:55], v8, s[48:51], s63 offen offset:448
  s_nop 1
  v_mfma_f32_16x16x32_bf16 v[52:55], a[112:115], v[40:43], 0
  v_mfma_f32_16x16x32_bf16 v[52:55], a[116:119], v[44:47], v[52:55]
  v_mfma_f32_16x16x32_bf16 v[52:55], a[110:113], v[48:51], v[52:55]
  buffer_store_dwordx4 v[64:67], v8, s[48:51], s63 offen offset:512
  v_cndmask_b32 v37, v37, v38, s[74:75]
  buffer_store_dwordx4 v[68:71], v8, s[48:51], s63 offen offset:576
  buffer_store_dwordx4 v[32:35], v8, s[48:51], s63 offen offset:640
  s_nop 3
  buffer_store_dwordx4 v[52:55], v8, s[48:51], s63 offen offset:704
  buffer_store_dwordx4 v[36:39], v82, s[48:51], s63 offen offset:0
  s_mov_b32 s65, 400000
L_fpoll_203:
  buffer_load_dwordx4 v[64:67], v31, s[48:51], s100 offen offset:0 sc1
  buffer_load_dwordx4 v[32:35], v5, s[48:51], s100 offen offset:0 sc1
  buffer_load_dwordx4 v[36:39], v5, s[48:51], s100 offen offset:1024 sc1
  buffer_load_dwordx4 v[40:43], v5, s[48:51], s100 offen offset:2048 sc1
  buffer_load_dwordx4 v[44:47], v5, s[48:51], s100 offen offset:3072 sc1
  buffer_load_dwordx4 v[48:51], v5, s[48:51], s101 offen offset:0 sc1
  buffer_load_dwordx4 v[52:55], v5, s[48:51], s101 offen offset:1024 sc1
  buffer_load_dwordx4 v[56:59], v5, s[48:51], s101 offen offset:2048 sc1
  buffer_load_dwordx4 v[60:63], v5, s[48:51], s101 offen offset:3072 sc1
  s_sub_u32 s65, s65, 1
  s_cbranch_scc1 L_abort
  s_waitcnt vmcnt(8)
  v_max_u32 v84, v65, v67
  v_add_f32_dpp v64, v64, v64 quad_perm:[1,0,3,2] row_mask:0xf bank_mask:0xf
  v_add_f32_dpp v65, v65, v65 quad_perm:[1,0,3,2] row_mask:0xf bank_mask:0xf
  s_waitcnt vmcnt(6)
  v_max3_u32 v84, v84, v33, v35
  v_add_f32_dpp v64, v64, v64 quad_perm:[2,3,0,1] row_mask:0xf bank_mask:0xf
  v_add_f32_dpp v65, v65, v65 quad_perm:[2,3,0,1] row_mask:0xf bank_mask:0xf
  v_max3_u32 v84, v84, v37, v39
  v_add_f32_dpp v64, v64, v64 row_half_mirror row_mask:0xf bank_mask:0xf
  v_add_f32_dpp v65, v65, v65 row_half_mirror row_mask:0xf bank_mask:0xf
  v_pk_add_f32 v[32:33], v[32:33], v[36:37]
  v_pk_add_f32 v[34:35], v[34:35], v[38:39]
  v_mul_f32 v66, 0x3acccccd, v64
  v_mul_f32 v65, 0x3acccccd, v65
  s_waitcnt vmcnt(4)
  v_max3_u32 v84, v84, v41, v43
  v_max3_u32 v84, v84, v45, v47
  v_fma_f32 v65, -v66, v66, v65
  v_pk_add_f32 v[40:41], v[40:41], v[44:45]
  v_pk_add_f32 v[42:43], v[42:43], v[46:47]
  v_max_f32 v65, 0, v65
  v_add_f32 v65, 0x3727c5ac, v65
  v_pk_add_f32 v[32:33], v[32:33], v[40:41]
  v_pk_add_f32 v[34:35], v[34:35], v[42:43]
  v_rsq_f32 v67, v65
  s_waitcnt vmcnt(2)
  v_max3_u32 v84, v84, v49, v51
  v_max3_u32 v84, v84, v53, v55
  v_pk_mul_f32 v[68:69], v[20:21], v[66:67] op_sel_hi:[1,0]
  v_pk_mul_f32 v[70:71], v[22:23], v[66:67] op_sel_hi:[1,0]
  v_pk_add_f32 v[48:49], v[48:49], v[52:53]
  v_pk_add_f32 v[50:51], v[50:51], v[54:55]
  v_pk_add_f32 v[32:33], v[32:33], v[68:69] neg_lo:[0,1] neg_hi:[0,1]
  v_pk_add_f32 v[34:35], v[34:35], v[70:71] neg_lo:[0,1] neg_hi:[0,1]
  v_pk_add_f32 v[32:33], v[32:33], v[48:49]
  v_pk_add_f32 v[34:35], v[34:35], v[50:51]
  s_waitcnt vmcnt(1)
  v_max3_u32 v84, v84, v57, v59
  v_pk_add_f32 v[32:33], v[32:33], v[56:57]
  v_pk_add_f32 v[34:35], v[34:35], v[58:59]
  s_waitcnt vmcnt(0)
  v_max3_u32 v84, v84, v61, v63
  v_pk_add_f32 v[32:33], v[32:33], v[60:61]
  v_pk_add_f32 v[34:35], v[34:35], v[62:63]
  v_cmp_eq_u32 vcc, -1, v84
  s_cbranch_vccnz L_fpoll_203
  v_pk_mul_f32 v[32:33], v[32:33], v[66:67] op_sel:[0,1] op_sel_hi:[1,1]
  v_pk_mul_f32 v[34:35], v[34:35], v[66:67] op_sel:[0,1] op_sel_hi:[1,1]
  v_cvt_pk_bf16_f32 v32, v32, v33
  v_cvt_pk_bf16_f32 v33, v34, v35
  ds_write_b64 v28, v[32:33] offset:6208
  s_waitcnt lgkmcnt(0)
  s_barrier
  v_mbcnt_lo_u32_b32 v57, -1, 0
  v_mbcnt_hi_u32_b32 v57, -1, v57
  v_and_b32 v58, 1, v57
  v_lshrrev_b32 v59, 4, v57
  v_lshlrev_b32 v59, 4, v59
  v_lshl_add_u32 v58, v58, 6, v59
  v_add_u32 v58, 159808, v58
  v_add_u32 v63, s69, v59
  v_lshrrev_b32 v59, 5, v57
  v_lshlrev_b32 v62, 6, v59
  v_bfe_u32 v59, v57, 1, 2
  v_lshl_add_u32 v62, v59, 4, v62
  v_bfe_u32 v59, v57, 3, 2
  v_lshl_add_u32 v62, v59, 2, v62
  v_and_b32 v59, 1, v57
  v_lshl_add_u32 v62, v59, 1, v62
  v_add_u32 v62, s69, v62
  v_mov_b32 v56, 0xff800000
  ds_read_b128 v[32:35], v58 offset:0
  ds_read_b128 v[36:39], v58 offset:128
  ds_read_b128 v[40:43], v58 offset:256
  s_waitcnt lgkmcnt(0)
  v_mfma_f32_16x16x32_bf16 v[44:47], v[32:35], v[86:89], 0
  v_mfma_f32_16x16x32_bf16 v[44:47], v[36:39], v[90:93], v[44:47]
  v_mfma_f32_16x16x32_bf16 v[44:47], v[40:43], v[94:97], v[44:47]
  v_mfma_f32_16x16x32_bf16 v[48:51], v[32:35], v[98:101], 0
  v_mfma_f32_16x16x32_bf16 v[48:51], v[36:39], v[102:105], v[48:51]
  v_mfma_f32_16x16x32_bf16 v[48:51], v[40:43], v[106:109], v[48:51]
  v_mfma_f32_16x16x32_bf16 v[52:55], v[32:35], v[110:113], 0
  v_mfma_f32_16x16x32_bf16 v[52:55], v[36:39], v[114:117], v[52:55]
  v_mfma_f32_16x16x32_bf16 v[52:55], v[40:43], v[118:121], v[52:55]
  s_nop 1
  v_add_f32_dpp v56, v45, v44 row_ror:8 row_mask:0x1 bank_mask:0x3
  v_mfma_f32_16x16x32_bf16 v[44:47], v[32:35], v[122:125], 0
  v_mfma_f32_16x16x32_bf16 v[44:47], v[36:39], v[126:129], v[44:47]
  v_mfma_f32_16x16x32_bf16 v[44:47], v[40:43], v[130:133], v[44:47]
  v_add_f32_dpp v56, v48, v49 row_ror:8 row_mask:0x1 bank_mask:0xc
  s_nop 0
  v_add_f32_dpp v56, v53, v52 row_ror:8 row_mask:0x2 bank_mask:0x3
  s_nop 4
  v_add_f32_dpp v56, v44, v45 row_ror:8 row_mask:0x2 bank_mask:0xc
  v_mov_b32 v44, v56
  s_nop 1
  v_max_f32_dpp v44, v44, v44 row_ror:8 row_mask:0xf bank_mask:0xf
  s_nop 1
  v_max_f32_dpp v44, v44, v44 row_ror:4 row_mask:0xf bank_mask:0xf
  s_nop 1
  v_max_f32_dpp v44, v44, v44 row_ror:2 row_mask:0xf bank_mask:0xf
  s_nop 1
  v_max_f32_dpp v44, v44, v44 row_ror:1 row_mask:0xf bank_mask:0xf
  v_mov_b32 v45, v44
  s_nop 1
  v_permlane16_swap_b32 v44, v45
  v_max_f32 v44, v44, v45
  v_mov_b32 v45, v44
  s_nop 1
  v_permlane32_swap_b32 v44, v45
  v_max_f32 v44, v44, v45
  v_mul_f32 v60, s56, v44
  v_fma_f32 v56, v56, s56, -v60
  v_exp_f32 v56, v56
  s_nop 0
  v_cvt_pk_bf16_f32 v46, v56, v56
  ds_write_b16 v62, v46 offset:0
  v_mov_b32 v61, v56
  ds_read_b128 v[52:55], v63
  s_nop 0
  v_add_f32_dpp v61, v61, v61 row_ror:8 row_mask:0xf bank_mask:0xf
  s_nop 1
  v_add_f32_dpp v61, v61, v61 row_ror:4 row_mask:0xf bank_mask:0xf
  s_nop 1
  v_add_f32_dpp v61, v61, v61 row_ror:2 row_mask:0xf bank_mask:0xf
  s_nop 1
  v_add_f32_dpp v61, v61, v61 row_ror:1 row_mask:0xf bank_mask:0xf
  v_mov_b32 v59, v61
  s_nop 1
  v_permlane16_swap_b32 v61, v59
  v_add_f32 v61, v61, v59
  v_mov_b32 v59, v61
  s_nop 1
  v_permlane32_swap_b32 v61, v59
  v_add_f32 v61, v61, v59
  s_waitcnt lgkmcnt(0)
  v_perm_b32 v44, v52, v52, v75
  v_perm_b32 v45, v52, v52, v76
  v_perm_b32 v46, v52, v52, v77
  v_perm_b32 v47, v52, v52, v78
  s_nop 1
  v_mfma_f32_16x16x32_bf16 v[32:35], v[44:47], v[134:137], 0
  v_perm_b32 v48, v53, v53, v75
  v_perm_b32 v49, v53, v53, v76
  v_mfma_f32_16x16x32_bf16 v[36:39], v[44:47], v[138:141], 0
  v_perm_b32 v50, v53, v53, v77
  v_perm_b32 v51, v53, v53, v78
  v_mfma_f32_16x16x32_bf16 v[40:43], v[44:47], v[142:145], 0
  s_nop 0
  v_mfma_f32_16x16x32_bf16 v[32:35], v[48:51], v[146:149], v[32:35]
  v_perm_b32 v44, v54, v54, v75
  v_perm_b32 v45, v54, v54, v76
  v_mfma_f32_16x16x32_bf16 v[36:39], v[48:51], v[150:153], v[36:39]
  v_perm_b32 v46, v54, v54, v77
  v_perm_b32 v47, v54, v54, v78
  v_mfma_f32_16x16x32_bf16 v[40:43], v[48:51], v[154:157], v[40:43]
  s_nop 0
  v_mfma_f32_16x16x32_bf16 v[32:35], v[44:47], v[158:161], v[32:35]
  v_perm_b32 v48, v55, v55, v75
  v_perm_b32 v49, v55, v55, v76
  v_mfma_f32_16x16x32_bf16 v[36:39], v[44:47], v[162:165], v[36:39]
  v_perm_b32 v50, v55, v55, v77
  v_perm_b32 v51, v55, v55, v78
  v_mfma_f32_16x16x32_bf16 v[40:43], v[44:47], v[166:169], v[40:43]
  s_nop 0
  v_mfma_f32_16x16x32_bf16 v[32:35], v[48:51], v[170:173], v[32:35]
  v_mfma_f32_16x16x32_bf16 v[36:39], v[48:51], v[174:177], v[36:39]
  v_mfma_f32_16x16x32_bf16 v[40:43], v[48:51], v[178:181], v[40:43]
  v_mbcnt_lo_u32_b32 v52, -1, 0
  v_mbcnt_hi_u32_b32 v52, -1, v52
  v_and_b32 v53, 15, v52
  v_lshrrev_b32 v54, 4, v52
  v_and_b32 v55, 1, v54
  v_lshrrev_b32 v54, 1, v54
  v_mul_u32_u24 v54, 768, v54
  v_lshl_add_u32 v54, v55, 4, v54
  v_add_u32 v54, s69, v54
  v_lshl_add_u32 v56, v53, 5, v54
  v_and_b32 v53, 7, v53
  v_lshl_add_u32 v57, v53, 5, v54
  v_mov_b32 v58, s72
  v_mov_b32 v44, v60
  v_mov_b32 v45, v61
  v_cndmask_b32 v32, v32, v36, s[70:71]
  v_cndmask_b32 v33, v33, v37, s[70:71]
  v_cndmask_b32 v34, v34, v38, s[70:71]
  v_cndmask_b32 v35, v35, v39, s[70:71]
  ds_write_b128 v56, v[32:35]
  s_mov_b32 exec_lo, 0x00ff00ff
  s_mov_b32 exec_hi, 0xff00ff00
  ds_write_b128 v57, v[40:43] offset:512
  s_mov_b64 exec, 1
  ds_write_b64 v58, v[44:45] offset:32
  s_mov_b64 exec, -1
  s_waitcnt lgkmcnt(0)
  s_barrier
  v_mov_b32 v84, 159776
  ds_read_b128 v[32:35], v84
  ds_read_b128 v[36:39], v84 offset:16
  v_add_u32 v85, 153600, v83
  ds_read_b128 v[40:43], v85 offset:0
  ds_read_b128 v[44:47], v85 offset:768
  v_add_u32 v85, 49152, v83
  ds_read_b128 v[48:51], v85 offset:0
  ds_read_b128 v[52:55], v85 offset:768
  ds_read_b128 v[56:59], v85 offset:51200
  ds_read_b128 v[60:63], v85 offset:51968
  v_add_u32 v85, 151552, v83
  ds_read_b128 v[64:67], v85 offset:0
  ds_read_b128 v[68:71], v85 offset:768
  s_add_u32 s63, s57, 262144
  s_waitcnt lgkmcnt(8)
  v_max3_f32 v84, v32, v34, v36
  v_max_f32 v84, v84, v38
  v_sub_f32 v32, v32, v84
  v_sub_f32 v34, v34, v84
  v_sub_f32 v36, v36, v84
  v_sub_f32 v38, v38, v84
  v_exp_f32 v32, v32
  v_exp_f32 v34, v34
  v_exp_f32 v36, v36
  v_exp_f32 v38, v38
  v_mul_f32 v85, v32, v33
  v_fma_f32 v85, v34, v35, v85
  v_fma_f32 v85, v36, v37, v85
  v_fma_f32 v85, v38, v39, v85
  s_waitcnt lgkmcnt(6)
  v_pk_add_f32 v[40:41], v[40:41], v[44:45]
  v_pk_add_f32 v[42:43], v[42:43], v[46:47]
  v_mul_f32 v40, v32, v40
  v_mul_f32 v41, v32, v41
  v_mul_f32 v42, v32, v42
  v_mul_f32 v43, v32, v43
  s_waitcnt lgkmcnt(4)
  v_pk_add_f32 v[48:49], v[48:49], v[52:53]
  v_pk_add_f32 v[50:51], v[50:51], v[54:55]
  v_fmac_f32 v40, v34, v48
  v_fmac_f32 v41, v34, v49
  v_fmac_f32 v42, v34, v50
  v_fmac_f32 v43, v34, v51
  s_waitcnt lgkmcnt(2)
  v_pk_add_f32 v[56:57], v[56:57], v[60:61]
  v_pk_add_f32 v[58:59], v[58:59], v[62:63]
  v_fmac_f32 v40, v36, v56
  v_fmac_f32 v41, v36, v57
  v_fmac_f32 v42, v36, v58
  v_fmac_f32 v43, v36, v59
  s_waitcnt lgkmcnt(0)
  v_pk_add_f32 v[64:65], v[64:65], v[68:69]
  v_pk_add_f32 v[66:67], v[66:67], v[70:71]
  v_fmac_f32 v40, v38, v64
  v_fmac_f32 v41, v38, v65
  v_fmac_f32 v42, v38, v66
  v_fmac_f32 v43, v38, v67
  s_mov_b32 vcc_lo, 0
  s_mov_b32 vcc_hi, 0x00010000
  v_cndmask_b32 v40, v40, v84, vcc
  v_cndmask_b32 v41, v41, v85, vcc
  buffer_store_dwordx4 v[40:43], v5, s[48:51], s63 offen offset:0
  s_add_u32 s42, s41, 0
  buffer_load_dwordx4 v[86:89], v1, s[32:35], s42 offen offset:0 nt
  buffer_load_dwordx4 v[90:93], v1, s[32:35], s42 offen offset:128 nt
  buffer_load_dwordx4 v[94:97], v1, s[32:35], s42 offen offset:256 nt
  s_add_u32 s42, s41, 3072
  buffer_load_dwordx4 v[98:101], v1, s[32:35], s42 offen offset:0 nt
  buffer_load_dwordx4 v[102:105], v1, s[32:35], s42 offen offset:128 nt
  buffer_load_dwordx4 v[106:109], v1, s[32:35], s42 offen offset:256 nt
  s_add_u32 s42, s41, 6144
  buffer_load_dwordx4 v[110:113], v1, s[32:35], s42 offen offset:0 nt
  buffer_load_dwordx4 v[114:117], v1, s[32:35], s42 offen offset:128 nt
  buffer_load_dwordx4 v[118:121], v1, s[32:35], s42 offen offset:256 nt
  s_add_u32 s42, s41, 9216
  buffer_load_dwordx4 v[122:125], v1, s[32:35], s42 offen offset:0 nt
  buffer_load_dwordx4 v[126:129], v1, s[32:35], s42 offen offset:128 nt
  buffer_load_dwordx4 v[130:133], v1, s[32:35], s42 offen offset:256 nt
  s_add_u32 s42, s41, 0
  buffer_load_dwordx4 v[134:137], v2, s[36:39], s42 offen offset:0 nt
  buffer_load_dwordx4 v[138:141], v2, s[36:39], s42 offen offset:384 nt
  buffer_load_dwordx4 v[142:145], v3, s[36:39], s42 offen offset:0 nt
  s_add_u32 s42, s41, 3072
  buffer_load_dwordx4 v[146:149], v2, s[36:39], s42 offen offset:0 nt
  buffer_load_dwordx4 v[150:153], v2, s[36:39], s42 offen offset:384 nt
  buffer_load_dwordx4 v[154:157], v3, s[36:39], s42 offen offset:0 nt
  s_add_u32 s42, s41, 6144
  buffer_load_dwordx4 v[158:161], v2, s[36:39], s42 offen offset:0 nt
  buffer_load_dwordx4 v[162:165], v2, s[36:39], s42 offen offset:384 nt
  buffer_load_dwordx4 v[166:169], v3, s[36:39], s42 offen offset:0 nt
  s_add_u32 s42, s41, 9216
  buffer_load_dwordx4 v[170:173], v2, s[36:39], s42 offen offset:0 nt
  buffer_load_dwordx4 v[174:177], v2, s[36:39], s42 offen offset:384 nt
  buffer_load_dwordx4 v[178:181], v3, s[36:39], s42 offen offset:0 nt
  v_and_b32 v84, 31, v0
  v_lshlrev_b32 v84, 4, v84
  v_lshrrev_b32 v85, 5, v0
  v_lshl_add_u32 v84, v85, 9, v84
  s_mov_b32 vcc_lo, 0x00000000
  s_mov_b32 vcc_hi, 0x000fffff
  v_cndmask_b32 v4, v74, v84, vcc
  s_mov_b32 vcc_lo, 0x00000000
  s_mov_b32 vcc_hi, 0x00ffffff
  v_cndmask_b32 v79, v74, v84, vcc
  v_lshrrev_b32 v84, 4, v0
  v_and_b32 v85, 15, v0
  v_lshlrev_b32 v72, 10, v84
  v_lshl_add_u32 v72, v85, 4, v72
  v_add_u32 v72, 512, v72
  v_lshlrev_b32 v73, 15, v84
  v_bfe_u32 v85, v0, 2, 2
  v_lshl_add_u32 v73, v85, 10, v73
  v_and_b32 v85, 3, v0
  v_lshl_add_u32 v73, v85, 4, v73
  v_add_u32 v73, 768, v73
  v_lshrrev_b32 v85, 5, v0
  v_and_b32 v84, 7, v0
  v_lshlrev_b32 v84, 10, v84
  v_lshl_add_u32 v84, v85, 9, v84
  v_add_u32 v84, 384, v84
  s_mov_b32 vcc_lo, 0x00000000
  s_mov_b32 vcc_hi, 0xffffffff
  v_cndmask_b32 v80, v74, v84, vcc
  v_and_b32 v84, 15, v0
  v_lshrrev_b32 v85, 4, v0
  v_lshlrev_b32 v6, 9, v84
  v_lshl_add_u32 v7, v85, 5, v6
  v_add_u32 v81, 384, v6
  v_lshl_add_u32 v6, v85, 4, v6
  v_lshlrev_b32 v8, 18, v84
  v_add_u32 v82, 768, v8
  v_lshl_add_u32 v8, v85, 4, v8
  s_mov_b32 vcc_lo, 0x00020002
  s_mov_b32 vcc_hi, 0x00020002
  v_cndmask_b32 v6, v74, v6, vcc
  v_cndmask_b32 v7, v74, v7, vcc
  s_mov_b32 vcc_lo, 0x00000002
  s_mov_b32 vcc_hi, 0x00000000
  v_cndmask_b32 v81, v74, v81, vcc
  s_mov_b32 vcc_lo, 0x00020002
  s_mov_b32 vcc_hi, 0x00020002
  v_cndmask_b32 v8, v74, v8, vcc
  s_mov_b32 vcc_lo, 0x00000002
  s_mov_b32 vcc_hi, 0x00000000
  v_cndmask_b32 v82, v74, v82, vcc
  v_mbcnt_lo_u32_b32 v57, -1, 0
  v_mbcnt_hi_u32_b32 v57, -1, v57
  v_and_b32 v58, 1, v57
  v_lshrrev_b32 v59, 4, v57
  v_lshlrev_b32 v59, 4, v59
  v_lshl_add_u32 v58, v58, 6, v59
  v_add_u32 v58, 159808, v58
  v_add_u32 v63, s69, v59
  v_lshrrev_b32 v59, 5, v57
  v_lshlrev_b32 v62, 6, v59
  v_bfe_u32 v59, v57, 1, 2
  v_lshl_add_u32 v62, v59, 4, v62
  v_bfe_u32 v59, v57, 3, 2
  v_lshl_add_u32 v62, v59, 2, v62
  v_and_b32 v59, 1, v57
  v_lshl_add_u32 v62, v59, 1, v62
  v_add_u32 v62, s69, v62
  v_mov_b32 v56, 0xff800000
  ds_read_b128 v[32:35], v58 offset:384
  ds_read_b128 v[36:39], v58 offset:512
  ds_read_b128 v[40:43], v58 offset:640
  s_waitcnt lgkmcnt(0)
  s_waitcnt vmcnt(21)
  v_mfma_f32_16x16x32_bf16 v[44:47], v[32:35], v[86:89], 0
  v_mfma_f32_16x16x32_bf16 v[44:47], v[36:39], v[90:93], v[44:47]
  v_mfma_f32_16x16x32_bf16 v[44:47], v[40:43], v[94:97], v[44:47]
  s_waitcnt vmcnt(18)
  v_mfma_f32_16x16x32_bf16 v[48:51], v[32:35], v[98:101], 0
  v_mfma_f32_16x16x32_bf16 v[48:51], v[36:39], v[102:105], v[48:51]
  v_mfma_f32_16x16x32_bf16 v[48:51], v[40:43], v[106:109], v[48:51]
  s_waitcnt vmcnt(15)
  v_mfma_f32_16x16x32_bf16 v[52:55], v[32:35], v[110:113], 0
  v_mfma_f32_16x16x32_bf16 v[52:55], v[36:39], v[114:117], v[52:55]
  v_mfma_f32_16x16x32_bf16 v[52:55], v[40:43], v[118:121], v[52:55]
  v_add_f32_dpp v56, v45, v44 row_ror:8 row_mask:0x1 bank_mask:0x3
  s_waitcnt vmcnt(12)
  v_mfma_f32_16x16x32_bf16 v[44:47], v[32:35], v[122:125], 0
  v_mfma_f32_16x16x32_bf16 v[44:47], v[36:39], v[126:129], v[44:47]
  v_mfma_f32_16x16x32_bf16 v[44:47], v[40:43], v[130:133], v[44:47]
  v_add_f32_dpp v56, v48, v49 row_ror:8 row_mask:0x1 bank_mask:0xc
  s_nop 1
  v_add_f32_dpp v56, v53, v52 row_ror:8 row_mask:0x2 bank_mask:0x3
  s_nop 3
  v_add_f32_dpp v56, v44, v45 row_ror:8 row_mask:0x2 bank_mask:0xc
  v_mov_b32 v44, v56
  s_nop 1
  v_max_f32_dpp v44, v44, v44 row_ror:8 row_mask:0xf bank_mask:0xf
  s_nop 1
  v_max_f32_dpp v44, v44, v44 row_ror:4 row_mask:0xf bank_mask:0xf
  s_nop 1
  v_max_f32_dpp v44, v44, v44 row_ror:2 row_mask:0xf bank_mask:0xf
  s_nop 1
  v_max_f32_dpp v44, v44, v44 row_ror:1 row_mask:0xf bank_mask:0xf
  v_mov_b32 v45, v44
  s_nop 1
  v_permlane16_swap_b32 v44, v45
  v_max_f32 v44, v44, v45
  v_mov_b32 v45, v44
  s_nop 1
  v_permlane32_swap_b32 v44, v45
  v_max_f32 v44, v44, v45
  v_mul_f32 v60, s56, v44
  v_fma_f32 v56, v56, s56, -v60
  v_exp_f32 v56, v56
  s_nop 0
  v_cvt_pk_bf16_f32 v46, v56, v56
  ds_write_b16 v62, v46 offset:0
  v_mov_b32 v61, v56
  ds_read_b128 v[52:55], v63
  s_nop 0
  v_add_f32_dpp v61, v61, v61 row_ror:8 row_mask:0xf bank_mask:0xf
  s_nop 1
  v_add_f32_dpp v61, v61, v61 row_ror:4 row_mask:0xf bank_mask:0xf
  s_nop 1
  v_add_f32_dpp v61, v61, v61 row_ror:2 row_mask:0xf bank_mask:0xf
  s_nop 1
  v_add_f32_dpp v61, v61, v61 row_ror:1 row_mask:0xf bank_mask:0xf
  v_mov_b32 v59, v61
  s_nop 1
  v_permlane16_swap_b32 v61, v59
  v_add_f32 v61, v61, v59
  v_mov_b32 v59, v61
  s_nop 1
  v_permlane32_swap_b32 v61, v59
  v_add_f32 v61, v61, v59
  s_waitcnt lgkmcnt(0)
  v_perm_b32 v44, v52, v52, v75
  v_perm_b32 v45, v52, v52, v76
  v_perm_b32 v46, v52, v52, v77
  v_perm_b32 v47, v52, v52, v78
  s_waitcnt vmcnt(11)
  s_nop 0
  v_mfma_f32_16x16x32_bf16 v[32:35], v[44:47], v[134:137], 0
  v_perm_b32 v48, v53, v53, v75
  v_perm_b32 v49, v53, v53, v76
  s_waitcnt vmcnt(10)
  v_mfma_f32_16x16x32_bf16 v[36:39], v[44:47], v[138:141], 0
  v_perm_b32 v50, v53, v53, v77
  v_perm_b32 v51, v53, v53, v78
  s_waitcnt vmcnt(9)
  v_mfma_f32_16x16x32_bf16 v[40:43], v[44:47], v[142:145], 0
  s_waitcnt vmcnt(8)
  v_mfma_f32_16x16x32_bf16 v[32:35], v[48:51], v[146:149], v[32:35]
  v_perm_b32 v44, v54, v54, v75
  v_perm_b32 v45, v54, v54, v76
  s_waitcnt vmcnt(7)
  v_mfma_f32_16x16x32_bf16 v[36:39], v[48:51], v[150:153], v[36:39]
  v_perm_b32 v46, v54, v54, v77
  v_perm_b32 v47, v54, v54, v78
  s_waitcnt vmcnt(6)
  v_mfma_f32_16x16x32_bf16 v[40:43], v[48:51], v[154:157], v[40:43]
  s_waitcnt vmcnt(5)
  v_mfma_f32_16x16x32_bf16 v[32:35], v[44:47], v[158:161], v[32:35]
  v_perm_b32 v48, v55, v55, v75
  v_perm_b32 v49, v55, v55, v76
  s_waitcnt vmcnt(4)
  v_mfma_f32_16x16x32_bf16 v[36:39], v[44:47], v[162:165], v[36:39]
  v_perm_b32 v50, v55, v55, v77
  v_perm_b32 v51, v55, v55, v78
  s_waitcnt vmcnt(3)
  v_mfma_f32_16x16x32_bf16 v[40:43], v[44:47], v[166:169], v[40:43]
  s_waitcnt vmcnt(2)
  v_mfma_f32_16x16x32_bf16 v[32:35], v[48:51], v[170:173], v[32:35]
  s_waitcnt vmcnt(1)
  v_mfma_f32_16x16x32_bf16 v[36:39], v[48:51], v[174:177], v[36:39]
  s_waitcnt vmcnt(0)
  v_mfma_f32_16x16x32_bf16 v[40:43], v[48:51], v[178:181], v[40:43]
  v_mbcnt_lo_u32_b32 v52, -1, 0
  v_mbcnt_hi_u32_b32 v52, -1, v52
  v_and_b32 v53, 15, v52
  v_lshrrev_b32 v54, 4, v52
  v_and_b32 v55, 1, v54
  v_lshrrev_b32 v54, 1, v54
  v_mul_u32_u24 v54, 768, v54
  v_lshl_add_u32 v54, v55, 4, v54
  v_add_u32 v54, s69, v54
  v_lshl_add_u32 v56, v53, 5, v54
  v_and_b32 v53, 7, v53
  v_lshl_add_u32 v57, v53, 5, v54
  v_mov_b32 v58, s72
  v_mov_b32 v44, v60
  v_mov_b32 v45, v61
  v_cndmask_b32 v32, v32, v36, s[70:71]
  v_cndmask_b32 v33, v33, v37, s[70:71]
  v_cndmask_b32 v34, v34, v38, s[70:71]
  v_cndmask_b32 v35, v35, v39, s[70:71]
  ds_write_b128 v56, v[32:35]
  s_mov_b32 exec_lo, 0x00ff00ff
  s_mov_b32 exec_hi, 0xff00ff00
  ds_write_b128 v57, v[40:43] offset:512
  s_mov_b64 exec, 1
  ds_write_b64 v58, v[44:45] offset:0
  s_mov_b64 exec, -1
  s_waitcnt lgkmcnt(0)
  s_barrier
  v_mov_b32 v84, 159744
  ds_read_b128 v[32:35], v84
  ds_read_b128 v[36:39], v84 offset:16
  v_add_u32 v85, 153600, v83
  ds_read_b128 v[40:43], v85 offset:0
  ds_read_b128 v[44:47], v85 offset:768
  ds_read_b128 v[48:51], v85 offset:1536
  ds_read_b128 v[52:55], v85 offset:2304
  ds_read_b128 v[56:59], v85 offset:3072
  ds_read_b128 v[60:63], v85 offset:3840
  ds_read_b128 v[64:67], v85 offset:4608
  ds_read_b128 v[68:71], v85 offset:5376
  s_add_u32 s63, s57, 524288
  s_waitcnt lgkmcnt(8)
  v_max3_f32 v84, v32, v34, v36
  v_max_f32 v84, v84, v38
  v_sub_f32 v32, v32, v84
  v_sub_f32 v34, v34, v84
  v_sub_f32 v36, v36, v84
  v_sub_f32 v38, v38, v84
  v_exp_f32 v32, v32
  v_exp_f32 v34, v34
  v_exp_f32 v36, v36
  v_exp_f32 v38, v38
  v_mul_f32 v85, v32, v33
  v_fma_f32 v85, v34, v35, v85
  v_fma_f32 v85, v36, v37, v85
  v_fma_f32 v85, v38, v39, v85
  s_waitcnt lgkmcnt(6)
  v_pk_add_f32 v[40:41], v[40:41], v[44:45]
  v_pk_add_f32 v[42:43], v[42:43], v[46:47]
  v_mul_f32 v40, v32, v40
  v_mul_f32 v41, v32, v41
  v_mul_f32 v42, v32, v42
  v_mul_f32 v43, v32, v43
  s_waitcnt lgkmcnt(4)
  v_pk_add_f32 v[48:49], v[48:49], v[52:53]
  v_pk_add_f32 v[50:51], v[50:51], v[54:55]
  v_fmac_f32 v40, v34, v48
  v_fmac_f32 v41, v34, v49
  v_fmac_f32 v42, v34, v50
  v_fmac_f32 v43, v34, v51
  s_waitcnt lgkmcnt(2)
  v_pk_add_f32 v[56:57], v[56:57], v[60:61]
  v_pk_add_f32 v[58:59], v[58:59], v[62:63]
  v_fmac_f32 v40, v36, v56
  v_fmac_f32 v41, v36, v57
  v_fmac_f32 v42, v36, v58
  v_fmac_f32 v43, v36, v59
  s_waitcnt lgkmcnt(0)
  v_pk_add_f32 v[64:65], v[64:65], v[68:69]
  v_pk_add_f32 v[66:67], v[66:67], v[70:71]
  v_fmac_f32 v40, v38, v64
  v_fmac_f32 v41, v38, v65
  v_fmac_f32 v42, v38, v66
  v_fmac_f32 v43, v38, v67
  s_mov_b32 vcc_lo, 0
  s_mov_b32 vcc_hi, 0x00010000
  v_cndmask_b32 v40, v40, v84, vcc
  v_cndmask_b32 v41, v41, v85, vcc
  buffer_store_dwordx4 v[40:43], v5, s[48:51], s63 offen offset:0
  s_add_u32 s100, s58, 524288
  s_add_u32 s101, s100, 4096
  s_mov_b32 s65, 400000
L_fpoll_204:
  buffer_load_dwordx4 v[64:67], v31, s[48:51], s100 offen offset:0 sc1
  buffer_load_dwordx4 v[32:35], v5, s[48:51], s100 offen offset:0 sc1
  buffer_load_dwordx4 v[36:39], v5, s[48:51], s100 offen offset:1024 sc1
  buffer_load_dwordx4 v[40:43], v5, s[48:51], s100 offen offset:2048 sc1
  buffer_load_dwordx4 v[44:47], v5, s[48:51], s100 offen offset:3072 sc1
  buffer_load_dwordx4 v[48:51], v5, s[48:51], s101 offen offset:0 sc1
  buffer_load_dwordx4 v[52:55], v5, s[48:51], s101 offen offset:1024 sc1
  buffer_load_dwordx4 v[56:59], v5, s[48:51], s101 offen offset:2048 sc1
  buffer_load_dwordx4 v[60:63], v5, s[48:51], s101 offen offset:3072 sc1
  s_sub_u32 s65, s65, 1
  s_cbranch_scc1 L_abort
  s_waitcnt vmcnt(8)
  v_max_u32 v84, v65, v67
  v_mov_b32 v66, v64
  s_nop 1
  v_max_f32_dpp v66, v66, v66 quad_perm:[1,0,3,2] row_mask:0xf bank_mask:0xf
  s_nop 1
  v_max_f32_dpp v66, v66, v66 quad_perm:[2,3,0,1] row_mask:0xf bank_mask:0xf
  s_nop 1
  v_max_f32_dpp v66, v66, v66 row_half_mirror row_mask:0xf bank_mask:0xf
  v_sub_f32 v67, v64, v66
  v_exp_f32 v67, v67
  s_waitcnt vmcnt(4)
  v_max3_u32 v84, v84, v33, v35
  v_max3_u32 v84, v84, v37, v39
  v_mul_f32 v65, v67, v65
  v_max3_u32 v84, v84, v41, v43
  v_max3_u32 v84, v84, v45, v47
  v_add_f32_dpp v65, v65, v65 quad_perm:[1,0,3,2] row_mask:0xf bank_mask:0xf
  s_waitcnt vmcnt(0)
  v_max3_u32 v84, v84, v49, v51
  v_max3_u32 v84, v84, v53, v55
  v_add_f32_dpp v65, v65, v65 quad_perm:[2,3,0,1] row_mask:0xf bank_mask:0xf
  v_max3_u32 v84, v84, v57, v59
  v_max3_u32 v84, v84, v61, v63
  v_add_f32_dpp v65, v65, v65 row_half_mirror row_mask:0xf bank_mask:0xf
  v_rcp_f32 v65, v65
  s_nop 0
  v_mul_f32 v67, v67, v65
  s_nop 0
  v_readlane_b32 s4, v67, 0
  v_readlane_b32 s6, v67, 1
  v_readlane_b32 s8, v67, 2
  v_readlane_b32 s10, v67, 3
  v_readlane_b32 s12, v67, 4
  v_readlane_b32 s16, v67, 5
  v_readlane_b32 s18, v67, 6
  v_readlane_b32 s20, v67, 7
  v_pk_mul_f32 v[68:69], v[32:33], s[4:5] op_sel_hi:[1,0]
  v_pk_mul_f32 v[70:71], v[34:35], s[4:5] op_sel_hi:[1,0]
  v_pk_fma_f32 v[68:69], v[36:37], s[6:7], v[68:69] op_sel_hi:[1,0,1]
  v_pk_fma_f32 v[70:71], v[38:39], s[6:7], v[70:71] op_sel_hi:[1,0,1]
  v_pk_fma_f32 v[68:69], v[40:41], s[8:9], v[68:69] op_sel_hi:[1,0,1]
  v_pk_fma_f32 v[70:71], v[42:43], s[8:9], v[70:71] op_sel_hi:[1,0,1]
  v_pk_fma_f32 v[68:69], v[44:45], s[10:11], v[68:69] op_sel_hi:[1,0,1]
  v_pk_fma_f32 v[70:71], v[46:47], s[10:11], v[70:71] op_sel_hi:[1,0,1]
  v_pk_fma_f32 v[68:69], v[48:49], s[12:13], v[68:69] op_sel_hi:[1,0,1]
  v_pk_fma_f32 v[70:71], v[50:51], s[12:13], v[70:71] op_sel_hi:[1,0,1]
  v_pk_fma_f32 v[68:69], v[52:53], s[16:17], v[68:69] op_sel_hi:[1,0,1]
  v_pk_fma_f32 v[70:71], v[54:55], s[16:17], v[70:71] op_sel_hi:[1,0,1]
  v_pk_fma_f32 v[68:69], v[56:57], s[18:19], v[68:69] op_sel_hi:[1,0,1]
  v_pk_fma_f32 v[70:71], v[58:59], s[18:19], v[70:71] op_sel_hi:[1,0,1]
  v_pk_fma_f32 v[68:69], v[60:61], s[20:21], v[68:69] op_sel_hi:[1,0,1]
  v_pk_fma_f32 v[70:71], v[62:63], s[20:21], v[70:71] op_sel_hi:[1,0,1]
  v_cmp_eq_u32 vcc, -1, v84
  s_cbranch_vccnz L_fpoll_204
  v_cvt_pk_bf16_f32 v68, v68, v69
  v_cvt_pk_bf16_f32 v69, v70, v71
  ds_write_b64 v28, v[68:69] offset:7360
  ds_read_b128 v[32:35], v9 offset:0
  ds_read_b128 v[36:39], v9 offset:64
  ds_read_b128 v[40:43], v9 offset:128
  ds_read_b128 v[44:47], v9 offset:192
  ds_read_b128 v[48:51], v9 offset:256
  ds_read_b128 v[52:55], v9 offset:320
  s_add_u32 s63, s59, 3932160
  s_waitcnt lgkmcnt(5)
  v_mfma_f32_16x16x32_bf16 v[56:59], a[120:123], v[32:35], 0
  s_waitcnt lgkmcnt(4)
  v_mfma_f32_16x16x32_bf16 v[56:59], a[124:127], v[36:39], v[56:59]
  s_waitcnt lgkmcnt(3)
  v_mfma_f32_16x16x32_bf16 v[56:59], a[128:131], v[40:43], v[56:59]
  s_waitcnt lgkmcnt(2)
  v_mfma_f32_16x16x32_bf16 v[56:59], a[132:135], v[44:47], v[56:59]
  s_waitcnt lgkmcnt(1)
  v_mfma_f32_16x16x32_bf16 v[56:59], a[136:139], v[48:51], v[56:59]
  s_waitcnt lgkmcnt(0)
  v_mfma_f32_16x16x32_bf16 v[56:59], a[140:143], v[52:55], v[56:59]
  v_mfma_f32_16x16x32_bf16 v[60:63], a[144:147], v[32:35], 0
  v_mfma_f32_16x16x32_bf16 v[60:63], a[148:151], v[36:39], v[60:63]
  v_mfma_f32_16x16x32_bf16 v[60:63], a[152:155], v[40:43], v[60:63]
  v_mfma_f32_16x16x32_bf16 v[60:63], a[156:159], v[44:47], v[60:63]
  v_mfma_f32_16x16x32_bf16 v[60:63], a[160:163], v[48:51], v[60:63]
  v_mfma_f32_16x16x32_bf16 v[60:63], a[164:167], v[52:55], v[60:63]
  v_mfma_f32_16x16x32_bf16 v[64:67], a[168:171], v[32:35], 0
  v_mfma_f32_16x16x32_bf16 v[64:67], a[172:175], v[36:39], v[64:67]
  v_mfma_f32_16x16x32_bf16 v[64:67], a[176:179], v[40:43], v[64:67]
  v_mfma_f32_16x16x32_bf16 v[64:67], a[180:183], v[44:47], v[64:67]
  v_mfma_f32_16x16x32_bf16 v[64:67], a[184:187], v[48:51], v[64:67]
  v_mfma_f32_16x16x32_bf16 v[64:67], a[188:191], v[52:55], v[64:67]
  buffer_store_dwordx4 v[56:59], v6, s[48:51], s63 offen offset:0 sc1
  s_nop 1
  v_mfma_f32_16x16x32_bf16 v[56:59], a[192:195], v[32:35], 0
  v_mfma_f32_16x16x32_bf16 v[56:59], a[196:199], v[36:39], v[56:59]
  v_mfma_f32_16x16x32_bf16 v[56:59], a[200:203], v[40:43], v[56:59]
  v_mfma_f32_16x16x32_bf16 v[56:59], a[204:207], v[44:47], v[56:59]
  v_mfma_f32_16x16x32_bf16 v[56:59], a[208:211], v[48:51], v[56:59]
  v_mfma_f32_16x16x32_bf16 v[56:59], a[212:215], v[52:55], v[56:59]
  buffer_store_dwordx4 v[60:63], v6, s[48:51], s63 offen offset:64 sc1
  s_nop 1
  v_mfma_f32_16x16x32_bf16 v[60:63], a[216:219], v[32:35], 0
  v_mfma_f32_16x16x32_bf16 v[60:63], a[220:223], v[36:39], v[60:63]
  v_mfma_f32_16x16x32_bf16 v[60:63], a[224:227], v[40:43], v[60:63]
  v_mfma_f32_16x16x32_bf16 v[60:63], a[228:231], v[44:47], v[60:63]
  v_mfma_f32_16x16x32_bf16 v[60:63], a[232:235], v[48:51], v[60:63]
  v_mfma_f32_16x16x32_bf16 v[60:63], a[236:239], v[52:55], v[60:63]
  buffer_store_dwordx4 v[64:67], v6, s[48:51], s63 offen offset:128 sc1
  buffer_store_dwordx4 v[56:59], v6, s[48:51], s63 offen offset:192 sc1
  s_nop 5
  buffer_store_dwordx4 v[60:63], v6, s[48:51], s63 offen offset:256 sc1
  s_lshl_b32 s66, s30, 12
  s_add_u32 s66, s66, 3932160
  s_add_u32 s4, s66, 0
  s_add_u32 s6, s66, 32768
  s_add_u32 s8, s66, 65536
  s_add_u32 s10, s66, 98304
  s_add_u32 s12, s66, 131072
  s_add_u32 s16, s66, 163840
  s_add_u32 s18, s66, 196608
  s_add_u32 s20, s66, 229376
  s_mov_b32 s65, 400000
  s_sleep 16
L_fpoll_205:
  buffer_load_dwordx4 v[64:67], v73, s[48:51], s4 offen offset:0 sc1
  buffer_load_dwordx4 v[68:71], v73, s[48:51], s12 offen offset:0 sc1
  buffer_load_dwordx4 v[32:35], v72, s[48:51], s4 offen offset:0 sc1
  buffer_load_dwordx4 v[36:39], v72, s[48:51], s6 offen offset:0 sc1
  buffer_load_dwordx4 v[40:43], v72, s[48:51], s8 offen offset:0 sc1
  buffer_load_dwordx4 v[44:47], v72, s[48:51], s10 offen offset:0 sc1
  buffer_load_dwordx4 v[48:51], v72, s[48:51], s12 offen offset:0 sc1
  buffer_load_dwordx4 v[52:55], v72, s[48:51], s16 offen offset:0 sc1
  buffer_load_dwordx4 v[56:59], v72, s[48:51], s18 offen offset:0 sc1
  buffer_load_dwordx4 v[60:63], v72, s[48:51], s20 offen offset:0 sc1
  s_sub_u32 s65, s65, 1
  s_cbranch_scc1 L_abort
  s_waitcnt vmcnt(8)
  v_max_u32 v84, v65, v67
  v_max3_u32 v84, v84, v69, v71
  v_pk_add_f32 v[64:65], v[64:65], v[68:69]
  v_pk_add_f32 v[66:67], v[66:67], v[70:71]
  s_nop 0
  v_add_f32_dpp v64, v64, v64 row_ror:4 row_mask:0xf bank_mask:0xf
  v_add_f32_dpp v65, v65, v65 row_ror:4 row_mask:0xf bank_mask:0xf
  v_add_f32_dpp v66, v66, v66 row_ror:4 row_mask:0xf bank_mask:0xf
  v_add_f32_dpp v67, v67, v67 row_ror:4 row_mask:0xf bank_mask:0xf
  v_add_f32_dpp v64, v64, v64 row_ror:8 row_mask:0xf bank_mask:0xf
  v_add_f32_dpp v65, v65, v65 row_ror:8 row_mask:0xf bank_mask:0xf
  v_add_f32_dpp v66, v66, v66 row_ror:8 row_mask:0xf bank_mask:0xf
  v_add_f32_dpp v67, v67, v67 row_ror:8 row_mask:0xf bank_mask:0xf
  s_waitcnt vmcnt(6)
  v_max3_u32 v84, v84, v33, v35
  v_max3_u32 v84, v84, v37, v39
  v_pk_add_f32 v[32:33], v[32:33], v[36:37]
  v_pk_add_f32 v[34:35], v[34:35], v[38:39]
  v_mov_b32 v68, v64
  v_mov_b32 v69, v65
  v_mov_b32 v70, v66
  v_mov_b32 v71, v67
  v_permlane16_swap_b32 v64, v68
  v_permlane16_swap_b32 v65, v69
  v_permlane16_swap_b32 v66, v70
  v_permlane16_swap_b32 v67, v71
  v_pk_add_f32 v[64:65], v[64:65], v[68:69]
  v_pk_add_f32 v[66:67], v[66:67], v[70:71]
  v_mov_b32 v68, v64
  v_mov_b32 v69, v65
  v_mov_b32 v70, v66
  v_mov_b32 v71, v67
  v_permlane32_swap_b32 v64, v68
  v_permlane32_swap_b32 v65, v69
  v_permlane32_swap_b32 v66, v70
  v_permlane32_swap_b32 v67, v71
  v_pk_add_f32 v[64:65], v[64:65], v[68:69]
  v_pk_add_f32 v[66:67], v[66:67], v[70:71]
  s_waitcnt vmcnt(4)
  v_max3_u32 v84, v84, v41, v43
  v_max3_u32 v84, v84, v45, v47
  v_pk_add_f32 v[40:41], v[40:41], v[44:45]
  v_pk_add_f32 v[42:43], v[42:43], v[46:47]
  v_pk_add_f32 v[32:33], v[32:33], v[40:41]
  v_pk_add_f32 v[34:35], v[34:35], v[42:43]
  s_waitcnt vmcnt(2)
  v_max3_u32 v84, v84, v49, v51
  v_max3_u32 v84, v84, v53, v55
  v_pk_add_f32 v[48:49], v[48:49], v[52:53]
  v_pk_add_f32 v[50:51], v[50:51], v[54:55]
  v_pk_add_f32 v[32:33], v[32:33], v[48:49]
  v_pk_add_f32 v[34:35], v[34:35], v[50:51]
  s_waitcnt vmcnt(1)
  v_max3_u32 v84, v84, v57, v59
  v_pk_add_f32 v[32:33], v[32:33], v[56:57]
  v_pk_add_f32 v[34:35], v[34:35], v[58:59]
  s_waitcnt vmcnt(0)
  v_max3_u32 v84, v84, v61, v63
  v_pk_add_f32 v[32:33], v[32:33], v[60:61]
  v_pk_add_f32 v[34:35], v[34:35], v[62:63]
  v_cmp_eq_u32 vcc, -1, v84
  s_cbranch_vccnz L_fpoll_205
  v_mov_b32 v68, v32
  v_mov_b32 v69, v33
  v_mov_b32 v70, v34
  v_mov_b32 v71, v35
  v_permlane16_swap_b32 v32, v68
  v_permlane16_swap_b32 v33, v69
  v_permlane16_swap_b32 v34, v70
  v_permlane16_swap_b32 v35, v71
  v_pk_add_f32 v[32:33], v[32:33], v[68:69]
  v_pk_add_f32 v[34:35], v[34:35], v[70:71]
  v_mov_b32 v68, v32
  v_mov_b32 v69, v33
  v_mov_b32 v70, v34
  v_mov_b32 v71, v35
  v_permlane32_swap_b32 v32, v68
  v_permlane32_swap_b32 v33, v69
  v_permlane32_swap_b32 v34, v70
  v_permlane32_swap_b32 v35, v71
  v_pk_add_f32 v[32:33], v[32:33], v[68:69]
  v_pk_add_f32 v[34:35], v[34:35], v[70:71]
  s_mov_b32 vcc_lo, 0xffff0000
  s_mov_b32 vcc_hi, 0xffff0000
  v_cndmask_b32 v32, v32, v64, vcc
  v_cndmask_b32 v33, v33, v65, vcc
  v_cndmask_b32 v34, v34, v66, vcc
  v_cndmask_b32 v35, v35, v67, vcc
  s_mov_b32 vcc_lo, 0x00000000
  s_mov_b32 vcc_hi, 0x000fffff
  v_cndmask_b32 v32, 0, v32, vcc
  v_cndmask_b32 v33, 0, v33, vcc
  v_cndmask_b32 v34, 0, v34, vcc
  v_cndmask_b32 v35, 0, v35, vcc
  v_pk_add_f32 v[32:33], v[32:33], v[16:17]
  v_pk_add_f32 v[34:35], v[34:35], v[18:19]
  v_cvt_pk_bf16_f32 v36, v32, v33
  v_cvt_pk_bf16_f32 v37, v34, v35
  ds_write_b64 v29, v[36:37]
  ds_read_b128 v[40:43], v10
  ds_read_b128 v[44:47], v10 offset:64
  ds_read_b64 v[48:49], v11
  v_mov_b32 v50, 0
  v_mov_b32 v51, 0
  ds_read_b128 v[52:55], v14
  ds_read_b128 v[56:59], v14 offset:64
  ds_read_b64 v[60:61], v15
  v_mov_b32 v62, 0
  v_mov_b32 v63, 0
  s_add_u32 s63, s57, 2883584
  v_lshlrev_b32 v16, 16, v36
  v_and_b32 v17, 0xffff0000, v36
  v_lshlrev_b32 v18, 16, v37
  v_and_b32 v19, 0xffff0000, v37
  s_add_u32 s100, s58, 2883584
  s_add_u32 s101, s100, 4096
  s_waitcnt lgkmcnt(5)
  v_mfma_f32_16x16x32_bf16 v[64:67], v[198:201], v[40:43], 0
  s_waitcnt lgkmcnt(4)
  v_mfma_f32_16x16x32_bf16 v[64:67], v[202:205], v[44:47], v[64:67]
  s_waitcnt lgkmcnt(3)
  v_mfma_f32_16x16x32_bf16 v[64:67], v[196:199], v[48:51], v[64:67]
  v_mfma_f32_16x16x32_bf16 v[68:71], v[228:231], v[40:43], 0
  v_mfma_f32_16x16x32_bf16 v[68:71], v[232:235], v[44:47], v[68:71]
  v_mfma_f32_16x16x32_bf16 v[68:71], v[226:229], v[48:51], v[68:71]
  s_waitcnt lgkmcnt(0)
  v_mfma_f32_16x16x32_bf16 v[32:35], v[52:55], v[40:43], 0
  v_mfma_f32_16x16x32_bf16 v[32:35], v[56:59], v[44:47], v[32:35]
  v_mfma_f32_16x16x32_bf16 v[32:35], v[60:63], v[48:51], v[32:35]
  v_mfma_f32_16x16x32_bf16 v[52:55], v[208:211], v[40:43], 0
  v_mfma_f32_16x16x32_bf16 v[52:55], v[212:215], v[44:47], v[52:55]
  v_mfma_f32_16x16x32_bf16 v[52:55], v[206:209], v[48:51], v[52:55]
  v_mfma_f32_16x16x32_bf16 v[56:59], v[238:241], v[40:43], 0
  v_mfma_f32_16x16x32_bf16 v[56:59], v[242:245], v[44:47], v[56:59]
  v_mfma_f32_16x16x32_bf16 v[56:59], v[236:239], v[48:51], v[56:59]
  v_swap_b32 v66, v68
  v_swap_b32 v67, v69
  buffer_store_dwordx4 v[64:67], v7, s[48:51], s63 offen offset:0
  buffer_store_dwordx4 v[68:71], v7, s[48:51], s63 offen offset:16
  v_cndmask_b32 v33, v33, v34, s[74:75]
  v_mfma_f32_16x16x32_bf16 v[64:67], v[218:221], v[40:43], 0
  v_mfma_f32_16x16x32_bf16 v[64:67], v[222:225], v[44:47], v[64:67]
  v_mfma_f32_16x16x32_bf16 v[64:67], v[216:219], v[48:51], v[64:67]
  v_mfma_f32_16x16x32_bf16 v[68:71], v[248:251], v[40:43], 0
  v_mfma_f32_16x16x32_bf16 v[68:71], v[252:255], v[44:47], v[68:71]
  v_mfma_f32_16x16x32_bf16 v[68:71], v[246:249], v[48:51], v[68:71]
  v_swap_b32 v54, v56
  v_swap_b32 v55, v57
  buffer_store_dwordx4 v[52:55], v7, s[48:51], s63 offen offset:128
  buffer_store_dwordx4 v[56:59], v7, s[48:51], s63 offen offset:144
  s_nop 3
  v_swap_b32 v66, v68
  v_swap_b32 v67, v69
  buffer_store_dwordx4 v[64:67], v7, s[48:51], s63 offen offset:256
  buffer_store_dwordx4 v[68:71], v7, s[48:51], s63 offen offset:272
  buffer_store_dwordx4 v[32:35], v81, s[48:51], s63 offen offset:0
  s_mov_b32 s65, 400000
L_fpoll_206:
  buffer_load_dwordx4 v[64:67], v80, s[48:51], s100 offen offset:0 sc1
  buffer_load_dwordx4 v[32:35], v79, s[48:51], s100 offen offset:0 sc1
  buffer_load_dwordx4 v[36:39], v79, s[48:51], s100 offen offset:1024 sc1
  buffer_load_dwordx4 v[40:43], v79, s[48:51], s100 offen offset:2048 sc1
  buffer_load_dwordx4 v[44:47], v79, s[48:51], s100 offen offset:3072 sc1
  buffer_load_dwordx4 v[48:51], v79, s[48:51], s101 offen offset:0 sc1
  buffer_load_dwordx4 v[52:55], v79, s[48:51], s101 offen offset:1024 sc1
  buffer_load_dwordx4 v[56:59], v79, s[48:51], s101 offen offset:2048 sc1
  buffer_load_dwordx4 v[60:63], v79, s[48:51], s101 offen offset:3072 sc1
  s_sub_u32 s65, s65, 1
  s_cbranch_scc1 L_abort
  s_waitcnt vmcnt(8)
  v_max_u32 v84, v65, v67
  v_add_f32_dpp v64, v64, v64 quad_perm:[1,0,3,2] row_mask:0xf bank_mask:0xf
  v_add_f32_dpp v65, v65, v65 quad_perm:[1,0,3,2] row_mask:0xf bank_mask:0xf
  s_waitcnt vmcnt(6)
  v_max3_u32 v84, v84, v33, v35
  v_add_f32_dpp v64, v64, v64 quad_perm:[2,3,0,1] row_mask:0xf bank_mask:0xf
  v_add_f32_dpp v65, v65, v65 quad_perm:[2,3,0,1] row_mask:0xf bank_mask:0xf
  v_max3_u32 v84, v84, v37, v39
  v_add_f32_dpp v64, v64, v64 row_half_mirror row_mask:0xf bank_mask:0xf
  v_add_f32_dpp v65, v65, v65 row_half_mirror row_mask:0xf bank_mask:0xf
  v_pk_add_f32 v[32:33], v[32:33], v[36:37]
  v_pk_add_f32 v[34:35], v[34:35], v[38:39]
  v_mul_f32 v66, 0x3acccccd, v64
  v_mul_f32 v65, 0x3acccccd, v65
  s_waitcnt vmcnt(4)
  v_max3_u32 v84, v84, v41, v43
  v_max3_u32 v84, v84, v45, v47
  v_fma_f32 v65, -v66, v66, v65
  v_pk_add_f32 v[40:41], v[40:41], v[44:45]
  v_pk_add_f32 v[42:43], v[42:43], v[46:47]
  v_max_f32 v65, 0, v65
  v_add_f32 v65, 0x3727c5ac, v65
  v_pk_add_f32 v[32:33], v[32:33], v[40:41]
  v_pk_add_f32 v[34:35], v[34:35], v[42:43]
  v_rsq_f32 v67, v65
  s_waitcnt vmcnt(2)
  v_max3_u32 v84, v84, v49, v51
  v_max3_u32 v84, v84, v53, v55
  v_pk_mul_f32 v[68:69], v[24:25], v[66:67] op_sel_hi:[1,0]
  v_pk_mul_f32 v[70:71], v[26:27], v[66:67] op_sel_hi:[1,0]
  v_pk_add_f32 v[48:49], v[48:49], v[52:53]
  v_pk_add_f32 v[50:51], v[50:51], v[54:55]
  v_pk_add_f32 v[32:33], v[32:33], v[68:69] neg_lo:[0,1] neg_hi:[0,1]
  v_pk_add_f32 v[34:35], v[34:35], v[70:71] neg_lo:[0,1] neg_hi:[0,1]
  v_pk_add_f32 v[32:33], v[32:33], v[48:49]
  v_pk_add_f32 v[34:35], v[34:35], v[50:51]
  s_waitcnt vmcnt(1)
  v_max3_u32 v84, v84, v57, v59
  v_pk_add_f32 v[32:33], v[32:33], v[56:57]
  v_pk_add_f32 v[34:35], v[34:35], v[58:59]
  s_waitcnt vmcnt(0)
  v_max3_u32 v84, v84, v61, v63
  v_pk_add_f32 v[32:33], v[32:33], v[60:61]
  v_pk_add_f32 v[34:35], v[34:35], v[62:63]
  v_cmp_eq_u32 vcc, -1, v84
  s_cbranch_vccnz L_fpoll_206
  v_pk_mul_f32 v[32:33], v[32:33], v[66:67] op_sel:[0,1] op_sel_hi:[1,1]
  v_pk_mul_f32 v[34:35], v[34:35], v[66:67] op_sel:[0,1] op_sel_hi:[1,1]
  v_max_f32 v32, 0, v32
  v_max_f32 v33, 0, v33
  v_pk_mul_f32 v[32:33], v[32:33], v[34:35]
  v_cvt_pk_bf16_f32 v32, v32, v33
  ds_write_b32 v30, v32
  ds_read_b128 v[32:35], v12
  ds_read_b64 v[36:37], v13
  v_mov_b32 v38, 0
  v_mov_b32 v39, 0
  s_add_u32 s63, s59, 4194304
  s_waitcnt lgkmcnt(1)
  v_mfma_f32_16x16x32_bf16 v[40:43], a[240:243], v[32:35], 0
  s_waitcnt lgkmcnt(0)
  v_mfma_f32_16x16x32_bf16 v[40:43], v[186:189], v[36:39], v[40:43]
  v_mfma_f32_16x16x32_bf16 v[44:47], a[244:247], v[32:35], 0
  v_mfma_f32_16x16x32_bf16 v[44:47], v[188:191], v[36:39], v[44:47]
  v_mfma_f32_16x16x32_bf16 v[48:51], a[248:251], v[32:35], 0
  v_mfma_f32_16x16x32_bf16 v[48:51], v[190:193], v[36:39], v[48:51]
  v_mfma_f32_16x16x32_bf16 v[52:55], a[252:255], v[32:35], 0
  v_mfma_f32_16x16x32_bf16 v[52:55], v[192:195], v[36:39], v[52:55]
  v_mfma_f32_16x16x32_bf16 v[56:59], v[182:185], v[32:35], 0
  v_mfma_f32_16x16x32_bf16 v[56:59], v[194:197], v[36:39], v[56:59]
  buffer_store_dwordx4 v[40:43], v6, s[48:51], s63 offen offset:0 sc1
  s_nop 0
  buffer_store_dwordx4 v[44:47], v6, s[48:51], s63 offen offset:64 sc1
  s_nop 0
  buffer_store_dwordx4 v[48:51], v6, s[48:51], s63 offen offset:128 sc1
  s_nop 0
  buffer_store_dwordx4 v[52:55], v6, s[48:51], s63 offen offset:192 sc1
  s_nop 0
  buffer_store_dwordx4 v[56:59], v6, s[48:51], s63 offen offset:256 sc1
  s_lshl_b32 s66, s30, 12
  s_add_u32 s66, s66, 4194304
  s_add_u32 s4, s66, 0
  s_add_u32 s6, s66, 32768
  s_add_u32 s8, s66, 65536
  s_add_u32 s10, s66, 98304
  s_add_u32 s12, s66, 131072
  s_add_u32 s16, s66, 163840
  s_add_u32 s18, s66, 196608
  s_add_u32 s20, s66, 229376
  s_mov_b32 s65, 400000
  s_sleep 16
L_fpoll_207:
  buffer_load_dwordx4 v[64:67], v73, s[48:51], s4 offen offset:0 sc1
  buffer_load_dwordx4 v[68:71], v73, s[48:51], s12 offen offset:0 sc1
  buffer_load_dwordx4 v[32:35], v72, s[48:51], s4 offen offset:0 sc1
  buffer_load_dwordx4 v[36:39], v72, s[48:51], s6 offen offset:0 sc1
  buffer_load_dwordx4 v[40:43], v72, s[48:51], s8 offen offset:0 sc1
  buffer_load_dwordx4 v[44:47], v72, s[48:51], s10 offen offset:0 sc1
  buffer_load_dwordx4 v[48:51], v72, s[48:51], s12 offen offset:0 sc1
  buffer_load_dwordx4 v[52:55], v72, s[48:51], s16 offen offset:0 sc1
  buffer_load_dwordx4 v[56:59], v72, s[48:51], s18 offen offset:0 sc1
  buffer_load_dwordx4 v[60:63], v72, s[48:51], s20 offen offset:0 sc1
  s_sub_u32 s65, s65, 1
  s_cbranch_scc1 L_abort
  s_waitcnt vmcnt(8)
  v_max_u32 v84, v65, v67
  v_max3_u32 v84, v84, v69, v71
  v_pk_add_f32 v[64:65], v[64:65], v[68:69]
  v_pk_add_f32 v[66:67], v[66:67], v[70:71]
  s_nop 0
  v_add_f32_dpp v64, v64, v64 row_ror:4 row_mask:0xf bank_mask:0xf
  v_add_f32_dpp v65, v65, v65 row_ror:4 row_mask:0xf bank_mask:0xf
  v_add_f32_dpp v66, v66, v66 row_ror:4 row_mask:0xf bank_mask:0xf
  v_add_f32_dpp v67, v67, v67 row_ror:4 row_mask:0xf bank_mask:0xf
  v_add_f32_dpp v64, v64, v64 row_ror:8 row_mask:0xf bank_mask:0xf
  v_add_f32_dpp v65, v65, v65 row_ror:8 row_mask:0xf bank_mask:0xf
  v_add_f32_dpp v66, v66, v66 row_ror:8 row_mask:0xf bank_mask:0xf
  v_add_f32_dpp v67, v67, v67 row_ror:8 row_mask:0xf bank_mask:0xf
  s_waitcnt vmcnt(6)
  v_max3_u32 v84, v84, v33, v35
  v_max3_u32 v84, v84, v37, v39
  v_pk_add_f32 v[32:33], v[32:33], v[36:37]
  v_pk_add_f32 v[34:35], v[34:35], v[38:39]
  v_mov_b32 v68, v64
  v_mov_b32 v69, v65
  v_mov_b32 v70, v66
  v_mov_b32 v71, v67
  v_permlane16_swap_b32 v64, v68
  v_permlane16_swap_b32 v65, v69
  v_permlane16_swap_b32 v66, v70
  v_permlane16_swap_b32 v67, v71
  v_pk_add_f32 v[64:65], v[64:65], v[68:69]
  v_pk_add_f32 v[66:67], v[66:67], v[70:71]
  v_mov_b32 v68, v64
  v_mov_b32 v69, v65
  v_mov_b32 v70, v66
  v_mov_b32 v71, v67
  v_permlane32_swap_b32 v64, v68
  v_permlane32_swap_b32 v65, v69
  v_permlane32_swap_b32 v66, v70
  v_permlane32_swap_b32 v67, v71
  v_pk_add_f32 v[64:65], v[64:65], v[68:69]
  v_pk_add_f32 v[66:67], v[66:67], v[70:71]
  s_waitcnt vmcnt(4)
  v_max3_u32 v84, v84, v41, v43
  v_max3_u32 v84, v84, v45, v47
  v_pk_add_f32 v[40:41], v[40:41], v[44:45]
  v_pk_add_f32 v[42:43], v[42:43], v[46:47]
  v_pk_add_f32 v[32:33], v[32:33], v[40:41]
  v_pk_add_f32 v[34:35], v[34:35], v[42:43]
  s_waitcnt vmcnt(2)
  v_max3_u32 v84, v84, v49, v51
  v_max3_u32 v84, v84, v53, v55
  v_pk_add_f32 v[48:49], v[48:49], v[52:53]
  v_pk_add_f32 v[50:51], v[50:51], v[54:55]
  v_pk_add_f32 v[32:33], v[32:33], v[48:49]
  v_pk_add_f32 v[34:35], v[34:35], v[50:51]
  s_waitcnt vmcnt(1)
  v_max3_u32 v84, v84, v57, v59
  v_pk_add_f32 v[32:33], v[32:33], v[56:57]
  v_pk_add_f32 v[34:35], v[34:35], v[58:59]
  s_waitcnt vmcnt(0)
  v_max3_u32 v84, v84, v61, v63
  v_pk_add_f32 v[32:33], v[32:33], v[60:61]
  v_pk_add_f32 v[34:35], v[34:35], v[62:63]
  v_cmp_eq_u32 vcc, -1, v84
  s_cbranch_vccnz L_fpoll_207
  v_mov_b32 v68, v32
  v_mov_b32 v69, v33
  v_mov_b32 v70, v34
  v_mov_b32 v71, v35
  v_permlane16_swap_b32 v32, v68
  v_permlane16_swap_b32 v33, v69
  v_permlane16_swap_b32 v34, v70
  v_permlane16_swap_b32 v35, v71
  v_pk_add_f32 v[32:33], v[32:33], v[68:69]
  v_pk_add_f32 v[34:35], v[34:35], v[70:71]
  v_mov_b32 v68, v32
  v_mov_b32 v69, v33
  v_mov_b32 v70, v34
  v_mov_b32 v71, v35
  v_permlane32_swap_b32 v32, v68
  v_permlane32_swap_b32 v33, v69
  v_permlane32_swap_b32 v34, v70
  v_permlane32_swap_b32 v35, v71
  v_pk_add_f32 v[32:33], v[32:33], v[68:69]
  v_pk_add_f32 v[34:35], v[34:35], v[70:71]
  s_mov_b32 vcc_lo, 0xffff0000
  s_mov_b32 vcc_hi, 0xffff0000
  v_cndmask_b32 v32, v32, v64, vcc
  v_cndmask_b32 v33, v33, v65, vcc
  v_cndmask_b32 v34, v34, v66, vcc
  v_cndmask_b32 v35, v35, v67, vcc
  s_mov_b32 vcc_lo, 0x00000000
  s_mov_b32 vcc_hi, 0x000fffff
  v_cndmask_b32 v32, 0, v32, vcc
  v_cndmask_b32 v33, 0, v33, vcc
  v_cndmask_b32 v34, 0, v34, vcc
  v_cndmask_b32 v35, 0, v35, vcc
  v_pk_add_f32 v[32:33], v[32:33], v[16:17]
  v_pk_add_f32 v[34:35], v[34:35], v[18:19]
  v_cvt_pk_bf16_f32 v36, v32, v33
  v_cvt_pk_bf16_f32 v37, v34, v35
  ds_write_b64 v29, v[36:37]
  ds_read_b128 v[40:43], v10
  ds_read_b128 v[44:47], v10 offset:64
  ds_read_b64 v[48:49], v11
  v_mov_b32 v50, 0
  v_mov_b32 v51, 0
  ds_read_b128 v[52:55], v14
  ds_read_b128 v[56:59], v14 offset:64
  ds_read_b64 v[60:61], v15
  v_mov_b32 v62, 0
  v_mov_b32 v63, 0
  s_add_u32 s63, s57, 1835008
  v_lshlrev_b32 v16, 16, v36
  v_and_b32 v17, 0xffff0000, v36
  v_lshlrev_b32 v18, 16, v37
  v_and_b32 v19, 0xffff0000, v37
  s_add_u32 s100, s58, 2097152
  s_add_u32 s101, s100, 4096
  s_waitcnt lgkmcnt(5)
  v_mfma_f32_16x16x32_bf16 v[64:67], a[2:5], v[40:43], 0
  s_waitcnt lgkmcnt(4)
  v_mfma_f32_16x16x32_bf16 v[64:67], a[6:9], v[44:47], v[64:67]
  s_waitcnt lgkmcnt(3)
  v_mfma_f32_16x16x32_bf16 v[64:67], a[0:3], v[48:51], v[64:67]
  s_waitcnt lgkmcnt(0)
  v_mfma_f32_16x16x32_bf16 v[36:39], v[52:55], v[40:43], 0
  v_mfma_f32_16x16x32_bf16 v[36:39], v[56:59], v[44:47], v[36:39]
  v_mfma_f32_16x16x32_bf16 v[36:39], v[60:63], v[48:51], v[36:39]
  v_mfma_f32_16x16x32_bf16 v[68:71], a[12:15], v[40:43], 0
  v_mfma_f32_16x16x32_bf16 v[68:71], a[16:19], v[44:47], v[68:71]
  v_mfma_f32_16x16x32_bf16 v[68:71], a[10:13], v[48:51], v[68:71]
  v_mfma_f32_16x16x32_bf16 v[32:35], a[22:25], v[40:43], 0
  v_mfma_f32_16x16x32_bf16 v[32:35], a[26:29], v[44:47], v[32:35]
  v_mfma_f32_16x16x32_bf16 v[32:35], a[20:23], v[48:51], v[32:35]
  v_mfma_f32_16x16x32_bf16 v[52:55], a[32:35], v[40:43], 0
  v_mfma_f32_16x16x32_bf16 v[52:55], a[36:39], v[44:47], v[52:55]
  v_mfma_f32_16x16x32_bf16 v[52:55], a[30:33], v[48:51], v[52:55]
  buffer_store_dwordx4 v[64:67], v8, s[48:51], s63 offen offset:0
  s_nop 1
  v_mfma_f32_16x16x32_bf16 v[64:67], a[42:45], v[40:43], 0
  v_mfma_f32_16x16x32_bf16 v[64:67], a[46:49], v[44:47], v[64:67]
  v_mfma_f32_16x16x32_bf16 v[64:67], a[40:43], v[48:51], v[64:67]
  buffer_store_dwordx4 v[68:71], v8, s[48:51], s63 offen offset:64
  s_nop 1
  v_mfma_f32_16x16x32_bf16 v[68:71], a[52:55], v[40:43], 0
  v_mfma_f32_16x16x32_bf16 v[68:71], a[56:59], v[44:47], v[68:71]
  v_mfma_f32_16x16x32_bf16 v[68:71], a[50:53], v[48:51], v[68:71]
  buffer_store_dwordx4 v[32:35], v8, s[48:51], s63 offen offset:128
  s_nop 1
  v_mfma_f32_16x16x32_bf16 v[32:35], a[62:65], v[40:43], 0
  v_mfma_f32_16x16x32_bf16 v[32:35], a[66:69], v[44:47], v[32:35]
  v_mfma_f32_16x16x32_bf16 v[32:35], a[60:63], v[48:51], v[32:35]
  buffer_store_dwordx4 v[52:55], v8, s[48:51], s63 offen offset:192
  s_nop 1
  v_mfma_f32_16x16x32_bf16 v[52:55], a[72:75], v[40:43], 0
  v_mfma_f32_16x16x32_bf16 v[52:55], a[76:79], v[44:47], v[52:55]
  v_mfma_f32_16x16x32_bf16 v[52:55], a[70:73], v[48:51], v[52:55]
  buffer_store_dwordx4 v[64:67], v8, s[48:51], s63 offen offset:256
  s_nop 1
  v_mfma_f32_16x16x32_bf16 v[64:67], a[82:85], v[40:43], 0
  v_mfma_f32_16x16x32_bf16 v[64:67], a[86:89], v[44:47], v[64:67]
  v_mfma_f32_16x16x32_bf16 v[64:67], a[80:83], v[48:51], v[64:67]
  buffer_store_dwordx4 v[68:71], v8, s[48:51], s63 offen offset:320
  s_nop 1
  v_mfma_f32_16x16x32_bf16 v[68:71], a[92:95], v[40:43], 0
  v_mfma_f32_16x16x32_bf16 v[68:71], a[96:99], v[44:47], v[68:71]
  v_mfma_f32_16x16x32_bf16 v[68:71], a[90:93], v[48:51], v[68:71]
  buffer_store_dwordx4 v[32:35], v8, s[48:51], s63 offen offset:384
  s_nop 1
  v_mfma_f32_16x16x32_bf16 v[32:35], a[102:105], v[40:43], 0
  v_mfma_f32_16x16x32_bf16 v[32:35], a[106:109], v[44:47], v[32:35]
  v_mfma_f32_16x16x32_bf16 v[32:35], a[100:103], v[48:51], v[32:35]
  buffer_store_dwordx4 v[52:55], v8, s[48:51], s63 offen offset:448
  s_nop 1
  v_mfma_f32_16x16x32_bf16 v[52:55], a[112:115], v[40:43], 0
  v_mfma_f32_16x16x32_bf16 v[52:55], a[116:119], v[44:47], v[52:55]
  v_mfma_f32_16x16x32_bf16 v[52:55], a[110:113], v[48:51], v[52:55]
  buffer_store_dwordx4 v[64:67], v8, s[48:51], s63 offen offset:512
  v_cndmask_b32 v37, v37, v38, s[74:75]
  buffer_store_dwordx4 v[68:71], v8, s[48:51], s63 offen offset:576
  buffer_store_dwordx4 v[32:35], v8, s[48:51], s63 offen offset:640
  s_nop 3
  buffer_store_dwordx4 v[52:55], v8, s[48:51], s63 offen offset:704
  buffer_store_dwordx4 v[36:39], v82, s[48:51], s63 offen offset:0
  s_mov_b32 s65, 400000
L_fpoll_208:
  buffer_load_dwordx4 v[64:67], v31, s[48:51], s100 offen offset:0 sc1
  buffer_load_dwordx4 v[32:35], v5, s[48:51], s100 offen offset:0 sc1
  buffer_load_dwordx4 v[36:39], v5, s[48:51], s100 offen offset:1024 sc1
  buffer_load_dwordx4 v[40:43], v5, s[48:51], s100 offen offset:2048 sc1
  buffer_load_dwordx4 v[44:47], v5, s[48:51], s100 offen offset:3072 sc1
  buffer_load_dwordx4 v[48:51], v5, s[48:51], s101 offen offset:0 sc1
  buffer_load_dwordx4 v[52:55], v5, s[48:51], s101 offen offset:1024 sc1
  buffer_load_dwordx4 v[56:59], v5, s[48:51], s101 offen offset:2048 sc1
  buffer_load_dwordx4 v[60:63], v5, s[48:51], s101 offen offset:3072 sc1
  s_sub_u32 s65, s65, 1
  s_cbranch_scc1 L_abort
  s_waitcnt vmcnt(8)
  v_max_u32 v84, v65, v67
  v_add_f32_dpp v64, v64, v64 quad_perm:[1,0,3,2] row_mask:0xf bank_mask:0xf
  v_add_f32_dpp v65, v65, v65 quad_perm:[1,0,3,2] row_mask:0xf bank_mask:0xf
  s_waitcnt vmcnt(6)
  v_max3_u32 v84, v84, v33, v35
  v_add_f32_dpp v64, v64, v64 quad_perm:[2,3,0,1] row_mask:0xf bank_mask:0xf
  v_add_f32_dpp v65, v65, v65 quad_perm:[2,3,0,1] row_mask:0xf bank_mask:0xf
  v_max3_u32 v84, v84, v37, v39
  v_add_f32_dpp v64, v64, v64 row_half_mirror row_mask:0xf bank_mask:0xf
  v_add_f32_dpp v65, v65, v65 row_half_mirror row_mask:0xf bank_mask:0xf
  v_pk_add_f32 v[32:33], v[32:33], v[36:37]
  v_pk_add_f32 v[34:35], v[34:35], v[38:39]
  v_mul_f32 v66, 0x3acccccd, v64
  v_mul_f32 v65, 0x3acccccd, v65
  s_waitcnt vmcnt(4)
  v_max3_u32 v84, v84, v41, v43
  v_max3_u32 v84, v84, v45, v47
  v_fma_f32 v65, -v66, v66, v65
  v_pk_add_f32 v[40:41], v[40:41], v[44:45]
  v_pk_add_f32 v[42:43], v[42:43], v[46:47]
  v_max_f32 v65, 0, v65
  v_add_f32 v65, 0x3727c5ac, v65
  v_pk_add_f32 v[32:33], v[32:33], v[40:41]
  v_pk_add_f32 v[34:35], v[34:35], v[42:43]
  v_rsq_f32 v67, v65
  s_waitcnt vmcnt(2)
  v_max3_u32 v84, v84, v49, v51
  v_max3_u32 v84, v84, v53, v55
  v_pk_mul_f32 v[68:69], v[20:21], v[66:67] op_sel_hi:[1,0]
  v_pk_mul_f32 v[70:71], v[22:23], v[66:67] op_sel_hi:[1,0]
  v_pk_add_f32 v[48:49], v[48:49], v[52:53]
  v_pk_add_f32 v[50:51], v[50:51], v[54:55]
  v_pk_add_f32 v[32:33], v[32:33], v[68:69] neg_lo:[0,1] neg_hi:[0,1]
  v_pk_add_f32 v[34:35], v[34:35], v[70:71] neg_lo:[0,1] neg_hi:[0,1]
  v_pk_add_f32 v[32:33], v[32:33], v[48:49]
  v_pk_add_f32 v[34:35], v[34:35], v[50:51]
  s_waitcnt vmcnt(1)
  v_max3_u32 v84, v84, v57, v59
  v_pk_add_f32 v[32:33], v[32:33], v[56:57]
  v_pk_add_f32 v[34:35], v[34:35], v[58:59]
  s_waitcnt vmcnt(0)
  v_max3_u32 v84, v84, v61, v63
  v_pk_add_f32 v[32:33], v[32:33], v[60:61]
  v_pk_add_f32 v[34:35], v[34:35], v[62:63]
  v_cmp_eq_u32 vcc, -1, v84
  s_cbranch_vccnz L_fpoll_208
  v_pk_mul_f32 v[32:33], v[32:33], v[66:67] op_sel:[0,1] op_sel_hi:[1,1]
  v_pk_mul_f32 v[34:35], v[34:35], v[66:67] op_sel:[0,1] op_sel_hi:[1,1]
  v_cvt_pk_bf16_f32 v32, v32, v33
  v_cvt_pk_bf16_f32 v33, v34, v35
  ds_write_b64 v28, v[32:33] offset:6592
  s_waitcnt lgkmcnt(0)
  s_barrier
  v_mbcnt_lo_u32_b32 v57, -1, 0
  v_mbcnt_hi_u32_b32 v57, -1, v57
  v_and_b32 v58, 1, v57
  v_lshrrev_b32 v59, 4, v57
  v_lshlrev_b32 v59, 4, v59
  v_lshl_add_u32 v58, v58, 6, v59
  v_add_u32 v58, 159808, v58
  v_add_u32 v63, s69, v59
  v_lshrrev_b32 v59, 5, v57
  v_lshlrev_b32 v62, 6, v59
  v_bfe_u32 v59, v57, 1, 2
  v_lshl_add_u32 v62, v59, 4, v62
  v_bfe_u32 v59, v57, 3, 2
  v_lshl_add_u32 v62, v59, 2, v62
  v_and_b32 v59, 1, v57
  v_lshl_add_u32 v62, v59, 1, v62
  v_add_u32 v62, s69, v62
  v_mov_b32 v56, 0xff800000
  ds_read_b128 v[32:35], v58 offset:384
  ds_read_b128 v[36:39], v58 offset:512
  ds_read_b128 v[40:43], v58 offset:640
  s_waitcnt lgkmcnt(0)
  v_mfma_f32_16x16x32_bf16 v[44:47], v[32:35], v[86:89], 0
  v_mfma_f32_16x16x32_bf16 v[44:47], v[36:39], v[90:93], v[44:47]
  v_mfma_f32_16x16x32_bf16 v[44:47], v[40:43], v[94:97], v[44:47]
  v_mfma_f32_16x16x32_bf16 v[48:51], v[32:35], v[98:101], 0
  v_mfma_f32_16x16x32_bf16 v[48:51], v[36:39], v[102:105], v[48:51]
  v_mfma_f32_16x16x32_bf16 v[48:51], v[40:43], v[106:109], v[48:51]
  v_mfma_f32_16x16x32_bf16 v[52:55], v[32:35], v[110:113], 0
  v_mfma_f32_16x16x32_bf16 v[52:55], v[36:39], v[114:117], v[52:55]
  v_mfma_f32_16x16x32_bf16 v[52:55], v[40:43], v[118:121], v[52:55]
  s_nop 1
  v_add_f32_dpp v56, v45, v44 row_ror:8 row_mask:0x1 bank_mask:0x3
  v_mfma_f32_16x16x32_bf16 v[44:47], v[32:35], v[122:125], 0
  v_mfma_f32_16x16x32_bf16 v[44:47], v[36:39], v[126:129], v[44:47]
  v_mfma_f32_16x16x32_bf16 v[44:47], v[40:43], v[130:133], v[44:47]
  v_add_f32_dpp v56, v48, v49 row_ror:8 row_mask:0x1 bank_mask:0xc
  s_nop 0
  v_add_f32_dpp v56, v53, v52 row_ror:8 row_mask:0x2 bank_mask:0x3
  s_nop 4
  v_add_f32_dpp v56, v44, v45 row_ror:8 row_mask:0x2 bank_mask:0xc
  v_mov_b32 v44, v56
  s_nop 1
  v_max_f32_dpp v44, v44, v44 row_ror:8 row_mask:0xf bank_mask:0xf
  s_nop 1
  v_max_f32_dpp v44, v44, v44 row_ror:4 row_mask:0xf bank_mask:0xf
  s_nop 1
  v_max_f32_dpp v44, v44, v44 row_ror:2 row_mask:0xf bank_mask:0xf
  s_nop 1
  v_max_f32_dpp v44, v44, v44 row_ror:1 row_mask:0xf bank_mask:0xf
  v_mov_b32 v45, v44
  s_nop 1
  v_permlane16_swap_b32 v44, v45
  v_max_f32 v44, v44, v45
  v_mov_b32 v45, v44
  s_nop 1
  v_permlane32_swap_b32 v44, v45
  v_max_f32 v44, v44, v45
  v_mul_f32 v60, s56, v44
  v_fma_f32 v56, v56, s56, -v60
  v_exp_f32 v56, v56
  s_nop 0
  v_cvt_pk_bf16_f32 v46, v56, v56
  ds_write_b16 v62, v46 offset:0
  v_mov_b32 v61, v56
  ds_read_b128 v[52:55], v63
  s_nop 0
  v_add_f32_dpp v61, v61, v61 row_ror:8 row_mask:0xf bank_mask:0xf
  s_nop 1
  v_add_f32_dpp v61, v61, v61 row_ror:4 row_mask:0xf bank_mask:0xf
  s_nop 1
  v_add_f32_dpp v61, v61, v61 row_ror:2 row_mask:0xf bank_mask:0xf
  s_nop 1
  v_add_f32_dpp v61, v61, v61 row_ror:1 row_mask:0xf bank_mask:0xf
  v_mov_b32 v59, v61
  s_nop 1
  v_permlane16_swap_b32 v61, v59
  v_add_f32 v61, v61, v59
  v_mov_b32 v59, v61
  s_nop 1
  v_permlane32_swap_b32 v61, v59
  v_add_f32 v61, v61, v59
  s_waitcnt lgkmcnt(0)
  v_perm_b32 v44, v52, v52, v75
  v_perm_b32 v45, v52, v52, v76
  v_perm_b32 v46, v52, v52, v77
  v_perm_b32 v47, v52, v52, v78
  s_nop 1
  v_mfma_f32_16x16x32_bf16 v[32:35], v[44:47], v[134:137], 0
  v_perm_b32 v48, v53, v53, v75
  v_perm_b32 v49, v53, v53, v76
  v_mfma_f32_16x16x32_bf16 v[36:39], v[44:47], v[138:141], 0
  v_perm_b32 v50, v53, v53, v77
  v_perm_b32 v51, v53, v53, v78
  v_mfma_f32_16x16x32_bf16 v[40:43], v[44:47], v[142:145], 0
  s_nop 0
  v_mfma_f32_16x16x32_bf16 v[32:35], v[48:51], v[146:149], v[32:35]
  v_perm_b32 v44, v54, v54, v75
  v_perm_b32 v45, v54, v54, v76
  v_mfma_f32_16x16x32_bf16 v[36:39], v[48:51], v[150:153], v[36:39]
  v_perm_b32 v46, v54, v54, v77
  v_perm_b32 v47, v54, v54, v78
  v_mfma_f32_16x16x32_bf16 v[40:43], v[48:51], v[154:157], v[40:43]
  s_nop 0
  v_mfma_f32_16x16x32_bf16 v[32:35], v[44:47], v[158:161], v[32:35]
  v_perm_b32 v48, v55, v55, v75
  v_perm_b32 v49, v55, v55, v76
  v_mfma_f32_16x16x32_bf16 v[36:39], v[44:47], v[162:165], v[36:39]
  v_perm_b32 v50, v55, v55, v77
  v_perm_b32 v51, v55, v55, v78
  v_mfma_f32_16x16x32_bf16 v[40:43], v[44:47], v[166:169], v[40:43]
  s_nop 0
  v_mfma_f32_16x16x32_bf16 v[32:35], v[48:51], v[170:173], v[32:35]
  v_mfma_f32_16x16x32_bf16 v[36:39], v[48:51], v[174:177], v[36:39]
  v_mfma_f32_16x16x32_bf16 v[40:43], v[48:51], v[178:181], v[40:43]
  v_mbcnt_lo_u32_b32 v52, -1, 0
  v_mbcnt_hi_u32_b32 v52, -1, v52
  v_and_b32 v53, 15, v52
  v_lshrrev_b32 v54, 4, v52
  v_and_b32 v55, 1, v54
  v_lshrrev_b32 v54, 1, v54
  v_mul_u32_u24 v54, 768, v54
  v_lshl_add_u32 v54, v55, 4, v54
  v_add_u32 v54, s69, v54
  v_lshl_add_u32 v56, v53, 5, v54
  v_and_b32 v53, 7, v53
  v_lshl_add_u32 v57, v53, 5, v54
  v_mov_b32 v58, s72
  v_mov_b32 v44, v60
  v_mov_b32 v45, v61
  v_cndmask_b32 v32, v32, v36, s[70:71]
  v_cndmask_b32 v33, v33, v37, s[70:71]
  v_cndmask_b32 v34, v34, v38, s[70:71]
  v_cndmask_b32 v35, v35, v39, s[70:71]
  ds_write_b128 v56, v[32:35]
  s_mov_b32 exec_lo, 0x00ff00ff
  s_mov_b32 exec_hi, 0xff00ff00
  ds_write_b128 v57, v[40:43] offset:512
  s_mov_b64 exec, 1
  ds_write_b64 v58, v[44:45] offset:0
  s_mov_b64 exec, -1
  s_waitcnt lgkmcnt(0)
  v_and_b32 v84, 31, v0
  v_lshlrev_b32 v84, 4, v84
  v_lshrrev_b32 v85, 5, v0
  v_lshl_add_u32 v84, v85, 9, v84
  s_mov_b32 vcc_lo, 0x000fffff
  s_mov_b32 vcc_hi, 0x000fffff
  v_cndmask_b32 v4, v74, v84, vcc
  s_mov_b32 vcc_lo, 0x00ffffff
  s_mov_b32 vcc_hi, 0x00ffffff
  v_cndmask_b32 v79, v74, v84, vcc
  v_lshrrev_b32 v84, 4, v0
  v_and_b32 v85, 15, v0
  v_lshlrev_b32 v72, 10, v84
  v_lshl_add_u32 v72, v85, 4, v72
  v_add_u32 v72, 512, v72
  v_lshlrev_b32 v73, 15, v84
  v_bfe_u32 v85, v0, 2, 2
  v_lshl_add_u32 v73, v85, 10, v73
  v_and_b32 v85, 3, v0
  v_lshl_add_u32 v73, v85, 4, v73
  v_add_u32 v73, 768, v73
  v_lshrrev_b32 v85, 5, v0
  v_and_b32 v84, 7, v0
  v_lshlrev_b32 v84, 10, v84
  v_lshl_add_u32 v84, v85, 9, v84
  v_add_u32 v84, 384, v84
  s_mov_b32 vcc_lo, 0xffffffff
  s_mov_b32 vcc_hi, 0xffffffff
  v_cndmask_b32 v80, v74, v84, vcc
  v_and_b32 v84, 15, v0
  v_lshrrev_b32 v85, 4, v0
  v_lshlrev_b32 v6, 9, v84
  v_lshl_add_u32 v7, v85, 5, v6
  v_add_u32 v81, 384, v6
  v_lshl_add_u32 v6, v85, 4, v6
  v_lshlrev_b32 v8, 18, v84
  v_add_u32 v82, 768, v8
  v_lshl_add_u32 v8, v85, 4, v8
  s_mov_b32 vcc_lo, 0x00030003
  s_mov_b32 vcc_hi, 0x00030003
  v_cndmask_b32 v6, v74, v6, vcc
  v_cndmask_b32 v7, v74, v7, vcc
  s_mov_b32 vcc_lo, 0x00000003
  s_mov_b32 vcc_hi, 0x00000000
  v_cndmask_b32 v81, v74, v81, vcc
  s_mov_b32 vcc_lo, 0x00030003
  s_mov_b32 vcc_hi, 0x00030003
  v_cndmask_b32 v8, v74, v8, vcc
  s_mov_b32 vcc_lo, 0x00000003
  s_mov_b32 vcc_hi, 0x00000000
  v_cndmask_b32 v82, v74, v82, vcc
  s_add_u32 s100, s58, 262144
  s_add_u32 s101, s100, 4096
  s_mov_b32 s65, 400000
L_fpoll_209:
  buffer_load_dwordx4 v[64:67], v31, s[48:51], s100 offen offset:0 sc1
  buffer_load_dwordx4 v[32:35], v5, s[48:51], s100 offen offset:0 sc1
  buffer_load_dwordx4 v[36:39], v5, s[48:51], s100 offen offset:1024 sc1
  buffer_load_dwordx4 v[40:43], v5, s[48:51], s100 offen offset:2048 sc1
  buffer_load_dwordx4 v[44:47], v5, s[48:51], s100 offen offset:3072 sc1
  buffer_load_dwordx4 v[48:51], v5, s[48:51], s101 offen offset:0 sc1
  buffer_load_dwordx4 v[52:55], v5, s[48:51], s101 offen offset:1024 sc1
  buffer_load_dwordx4 v[56:59], v5, s[48:51], s101 offen offset:2048 sc1
  buffer_load_dwordx4 v[60:63], v5, s[48:51], s101 offen offset:3072 sc1
  s_sub_u32 s65, s65, 1
  s_cbranch_scc1 L_abort
  s_waitcnt vmcnt(8)
  v_max_u32 v84, v65, v67
  v_mov_b32 v66, v64
  s_nop 1
  v_max_f32_dpp v66, v66, v66 quad_perm:[1,0,3,2] row_mask:0xf bank_mask:0xf
  s_nop 1
  v_max_f32_dpp v66, v66, v66 quad_perm:[2,3,0,1] row_mask:0xf bank_mask:0xf
  s_nop 1
  v_max_f32_dpp v66, v66, v66 row_half_mirror row_mask:0xf bank_mask:0xf
  v_sub_f32 v67, v64, v66
  v_exp_f32 v67, v67
  s_waitcnt vmcnt(4)
  v_max3_u32 v84, v84, v33, v35
  v_max3_u32 v84, v84, v37, v39
  v_mul_f32 v65, v67, v65
  v_max3_u32 v84, v84, v41, v43
  v_max3_u32 v84, v84, v45, v47
  v_add_f32_dpp v65, v65, v65 quad_perm:[1,0,3,2] row_mask:0xf bank_mask:0xf
  s_waitcnt vmcnt(0)
  v_max3_u32 v84, v84, v49, v51
  v_max3_u32 v84, v84, v53, v55
  v_add_f32_dpp v65, v65, v65 quad_perm:[2,3,0,1] row_mask:0xf bank_mask:0xf
  v_max3_u32 v84, v84, v57, v59
  v_max3_u32 v84, v84, v61, v63
  v_add_f32_dpp v65, v65, v65 row_half_mirror row_mask:0xf bank_mask:0xf
  v_rcp_f32 v65, v65
  s_nop 0
  v_mul_f32 v67, v67, v65
  s_nop 0
  v_readlane_b32 s4, v67, 0
  v_readlane_b32 s6, v67, 1
  v_readlane_b32 s8, v67, 2
  v_readlane_b32 s10, v67, 3
  v_readlane_b32 s12, v67, 4
  v_readlane_b32 s16, v67, 5
  v_readlane_b32 s18, v67, 6
  v_readlane_b32 s20, v67, 7
  v_pk_mul_f32 v[68:69], v[32:33], s[4:5] op_sel_hi:[1,0]
  v_pk_mul_f32 v[70:71], v[34:35], s[4:5] op_sel_hi:[1,0]
  v_pk_fma_f32 v[68:69], v[36:37], s[6:7], v[68:69] op_sel_hi:[1,0,1]
  v_pk_fma_f32 v[70:71], v[38:39], s[6:7], v[70:71] op_sel_hi:[1,0,1]
  v_pk_fma_f32 v[68:69], v[40:41], s[8:9], v[68:69] op_sel_hi:[1,0,1]
  v_pk_fma_f32 v[70:71], v[42:43], s[8:9], v[70:71] op_sel_hi:[1,0,1]
  v_pk_fma_f32 v[68:69], v[44:45], s[10:11], v[68:69] op_sel_hi:[1,0,1]
  v_pk_fma_f32 v[70:71], v[46:47], s[10:11], v[70:71] op_sel_hi:[1,0,1]
  v_pk_fma_f32 v[68:69], v[48:49], s[12:13], v[68:69] op_sel_hi:[1,0,1]
  v_pk_fma_f32 v[70:71], v[50:51], s[12:13], v[70:71] op_sel_hi:[1,0,1]
  v_pk_fma_f32 v[68:69], v[52:53], s[16:17], v[68:69] op_sel_hi:[1,0,1]
  v_pk_fma_f32 v[70:71], v[54:55], s[16:17], v[70:71] op_sel_hi:[1,0,1]
  v_pk_fma_f32 v[68:69], v[56:57], s[18:19], v[68:69] op_sel_hi:[1,0,1]
  v_pk_fma_f32 v[70:71], v[58:59], s[18:19], v[70:71] op_sel_hi:[1,0,1]
  v_pk_fma_f32 v[68:69], v[60:61], s[20:21], v[68:69] op_sel_hi:[1,0,1]
  v_pk_fma_f32 v[70:71], v[62:63], s[20:21], v[70:71] op_sel_hi:[1,0,1]
  v_cmp_eq_u32 vcc, -1, v84
  s_cbranch_vccnz L_fpoll_209
  v_cvt_pk_bf16_f32 v68, v68, v69
  v_cvt_pk_bf16_f32 v69, v70, v71
  ds_write_b64 v28, v[68:69] offset:6976
  s_waitcnt lgkmcnt(0)
  s_barrier
  v_mov_b32 v84, 159744
  ds_read_b128 v[32:35], v84
  ds_read_b128 v[36:39], v84 offset:16
  v_add_u32 v85, 153600, v83
  ds_read_b128 v[40:43], v85 offset:0
  ds_read_b128 v[44:47], v85 offset:768
  ds_read_b128 v[48:51], v85 offset:1536
  ds_read_b128 v[52:55], v85 offset:2304
  ds_read_b128 v[56:59], v85 offset:3072
  ds_read_b128 v[60:63], v85 offset:3840
  ds_read_b128 v[64:67], v85 offset:4608
  ds_read_b128 v[68:71], v85 offset:5376
  s_add_u32 s63, s57, 786432
  s_waitcnt lgkmcnt(8)
  v_max3_f32 v84, v32, v34, v36
  v_max_f32 v84, v84, v38
  v_sub_f32 v32, v32, v84
  v_sub_f32 v34, v34, v84
  v_sub_f32 v36, v36, v84
  v_sub_f32 v38, v38, v84
  v_exp_f32 v32, v32
  v_exp_f32 v34, v34
  v_exp_f32 v36, v36
  v_exp_f32 v38, v38
  v_mul_f32 v85, v32, v33
  v_fma_f32 v85, v34, v35, v85
  v_fma_f32 v85, v36, v37, v85
  v_fma_f32 v85, v38, v39, v85
  s_waitcnt lgkmcnt(6)
  v_pk_add_f32 v[40:41], v[40:41], v[44:45]
  v_pk_add_f32 v[42:43], v[42:43], v[46:47]
  v_mul_f32 v40, v32, v40
  v_mul_f32 v41, v32, v41
  v_mul_f32 v42, v32, v42
  v_mul_f32 v43, v32, v43
  s_waitcnt lgkmcnt(4)
  v_pk_add_f32 v[48:49], v[48:49], v[52:53]
  v_pk_add_f32 v[50:51], v[50:51], v[54:55]
  v_fmac_f32 v40, v34, v48
  v_fmac_f32 v41, v34, v49
  v_fmac_f32 v42, v34, v50
  v_fmac_f32 v43, v34, v51
  s_waitcnt lgkmcnt(2)
  v_pk_add_f32 v[56:57], v[56:57], v[60:61]
  v_pk_add_f32 v[58:59], v[58:59], v[62:63]
  v_fmac_f32 v40, v36, v56
  v_fmac_f32 v41, v36, v57
  v_fmac_f32 v42, v36, v58
  v_fmac_f32 v43, v36, v59
  s_waitcnt lgkmcnt(0)
  v_pk_add_f32 v[64:65], v[64:65], v[68:69]
  v_pk_add_f32 v[66:67], v[66:67], v[70:71]
  v_fmac_f32 v40, v38, v64
  v_fmac_f32 v41, v38, v65
  v_fmac_f32 v42, v38, v66
  v_fmac_f32 v43, v38, v67
  s_mov_b32 vcc_lo, 0
  s_mov_b32 vcc_hi, 0x00010000
  v_cndmask_b32 v40, v40, v84, vcc
  v_cndmask_b32 v41, v41, v85, vcc
  buffer_store_dwordx4 v[40:43], v5, s[48:51], s63 offen offset:0
  s_add_u32 s100, s58, 786432
  s_add_u32 s101, s100, 4096
  s_mov_b32 s65, 400000
L_fpoll_210:
  buffer_load_dwordx4 v[64:67], v31, s[48:51], s100 offen offset:0 sc1
  buffer_load_dwordx4 v[32:35], v5, s[48:51], s100 offen offset:0 sc1
  buffer_load_dwordx4 v[36:39], v5, s[48:51], s100 offen offset:1024 sc1
  buffer_load_dwordx4 v[40:43], v5, s[48:51], s100 offen offset:2048 sc1
  buffer_load_dwordx4 v[44:47], v5, s[48:51], s100 offen offset:3072 sc1
  buffer_load_dwordx4 v[48:51], v5, s[48:51], s101 offen offset:0 sc1
  buffer_load_dwordx4 v[52:55], v5, s[48:51], s101 offen offset:1024 sc1
  buffer_load_dwordx4 v[56:59], v5, s[48:51], s101 offen offset:2048 sc1
  buffer_load_dwordx4 v[60:63], v5, s[48:51], s101 offen offset:3072 sc1
  s_sub_u32 s65, s65, 1
  s_cbranch_scc1 L_abort
  s_waitcnt vmcnt(8)
  v_max_u32 v84, v65, v67
  v_mov_b32 v66, v64
  s_nop 1
  v_max_f32_dpp v66, v66, v66 quad_perm:[1,0,3,2] row_mask:0xf bank_mask:0xf
  s_nop 1
  v_max_f32_dpp v66, v66, v66 quad_perm:[2,3,0,1] row_mask:0xf bank_mask:0xf
  s_nop 1
  v_max_f32_dpp v66, v66, v66 row_half_mirror row_mask:0xf bank_mask:0xf
  v_sub_f32 v67, v64, v66
  v_exp_f32 v67, v67
  s_waitcnt vmcnt(4)
  v_max3_u32 v84, v84, v33, v35
  v_max3_u32 v84, v84, v37, v39
  v_mul_f32 v65, v67, v65
  v_max3_u32 v84, v84, v41, v43
  v_max3_u32 v84, v84, v45, v47
  v_add_f32_dpp v65, v65, v65 quad_perm:[1,0,3,2] row_mask:0xf bank_mask:0xf
  s_waitcnt vmcnt(0)
  v_max3_u32 v84, v84, v49, v51
  v_max3_u32 v84, v84, v53, v55
  v_add_f32_dpp v65, v65, v65 quad_perm:[2,3,0,1] row_mask:0xf bank_mask:0xf
  v_max3_u32 v84, v84, v57, v59
  v_max3_u32 v84, v84, v61, v63
  v_add_f32_dpp v65, v65, v65 row_half_mirror row_mask:0xf bank_mask:0xf
  v_rcp_f32 v65, v65
  s_nop 0
  v_mul_f32 v67, v67, v65
  s_nop 0
  v_readlane_b32 s4, v67, 0
  v_readlane_b32 s6, v67, 1
  v_readlane_b32 s8, v67, 2
  v_readlane_b32 s10, v67, 3
  v_readlane_b32 s12, v67, 4
  v_readlane_b32 s16, v67, 5
  v_readlane_b32 s18, v67, 6
  v_readlane_b32 s20, v67, 7
  v_pk_mul_f32 v[68:69], v[32:33], s[4:5] op_sel_hi:[1,0]
  v_pk_mul_f32 v[70:71], v[34:35], s[4:5] op_sel_hi:[1,0]
  v_pk_fma_f32 v[68:69], v[36:37], s[6:7], v[68:69] op_sel_hi:[1,0,1]
  v_pk_fma_f32 v[70:71], v[38:39], s[6:7], v[70:71] op_sel_hi:[1,0,1]
  v_pk_fma_f32 v[68:69], v[40:41], s[8:9], v[68:69] op_sel_hi:[1,0,1]
  v_pk_fma_f32 v[70:71], v[42:43], s[8:9], v[70:71] op_sel_hi:[1,0,1]
  v_pk_fma_f32 v[68:69], v[44:45], s[10:11], v[68:69] op_sel_hi:[1,0,1]
  v_pk_fma_f32 v[70:71], v[46:47], s[10:11], v[70:71] op_sel_hi:[1,0,1]
  v_pk_fma_f32 v[68:69], v[48:49], s[12:13], v[68:69] op_sel_hi:[1,0,1]
  v_pk_fma_f32 v[70:71], v[50:51], s[12:13], v[70:71] op_sel_hi:[1,0,1]
  v_pk_fma_f32 v[68:69], v[52:53], s[16:17], v[68:69] op_sel_hi:[1,0,1]
  v_pk_fma_f32 v[70:71], v[54:55], s[16:17], v[70:71] op_sel_hi:[1,0,1]
  v_pk_fma_f32 v[68:69], v[56:57], s[18:19], v[68:69] op_sel_hi:[1,0,1]
  v_pk_fma_f32 v[70:71], v[58:59], s[18:19], v[70:71] op_sel_hi:[1,0,1]
  v_pk_fma_f32 v[68:69], v[60:61], s[20:21], v[68:69] op_sel_hi:[1,0,1]
  v_pk_fma_f32 v[70:71], v[62:63], s[20:21], v[70:71] op_sel_hi:[1,0,1]
  v_cmp_eq_u32 vcc, -1, v84
  s_cbranch_vccnz L_fpoll_210
  v_cvt_pk_bf16_f32 v68, v68, v69
  v_cvt_pk_bf16_f32 v69, v70, v71
  ds_write_b64 v28, v[68:69] offset:7360
  ds_read_b128 v[32:35], v9 offset:0
  ds_read_b128 v[36:39], v9 offset:64
  ds_read_b128 v[40:43], v9 offset:128
  ds_read_b128 v[44:47], v9 offset:192
  ds_read_b128 v[48:51], v9 offset:256
  ds_read_b128 v[52:55], v9 offset:320
  s_add_u32 s63, s59, 4456448
  s_waitcnt lgkmcnt(5)
  v_mfma_f32_16x16x32_bf16 v[56:59], a[120:123], v[32:35], 0
  s_waitcnt lgkmcnt(4)
  v_mfma_f32_16x16x32_bf16 v[56:59], a[124:127], v[36:39], v[56:59]
  s_waitcnt lgkmcnt(3)
  v_mfma_f32_16x16x32_bf16 v[56:59], a[128:131], v[40:43], v[56:59]
  s_waitcnt lgkmcnt(2)
  v_mfma_f32_16x16x32_bf16 v[56:59], a[132:135], v[44:47], v[56:59]
  s_waitcnt lgkmcnt(1)
  v_mfma_f32_16x16x32_bf16 v[56:59], a[136:139], v[48:51], v[56:59]
  s_waitcnt lgkmcnt(0)
  v_mfma_f32_16x16x32_bf16 v[56:59], a[140:143], v[52:55], v[56:59]
  v_mfma_f32_16x16x32_bf16 v[60:63], a[144:147], v[32:35], 0
  v_mfma_f32_16x16x32_bf16 v[60:63], a[148:151], v[36:39], v[60:63]
  v_mfma_f32_16x16x32_bf16 v[60:63], a[152:155], v[40:43], v[60:63]
  v_mfma_f32_16x16x32_bf16 v[60:63], a[156:159], v[44:47], v[60:63]
  v_mfma_f32_16x16x32_bf16 v[60:63], a[160:163], v[48:51], v[60:63]
  v_mfma_f32_16x16x32_bf16 v[60:63], a[164:167], v[52:55], v[60:63]
  v_mfma_f32_16x16x32_bf16 v[64:67], a[168:171], v[32:35], 0
  v_mfma_f32_16x16x32_bf16 v[64:67], a[172:175], v[36:39], v[64:67]
  v_mfma_f32_16x16x32_bf16 v[64:67], a[176:179], v[40:43], v[64:67]
  v_mfma_f32_16x16x32_bf16 v[64:67], a[180:183], v[44:47], v[64:67]
  v_mfma_f32_16x16x32_bf16 v[64:67], a[184:187], v[48:51], v[64:67]
  v_mfma_f32_16x16x32_bf16 v[64:67], a[188:191], v[52:55], v[64:67]
  buffer_store_dwordx4 v[56:59], v6, s[48:51], s63 offen offset:0 sc1
  s_nop 1
  v_mfma_f32_16x16x32_bf16 v[56:59], a[192:195], v[32:35], 0
  v_mfma_f32_16x16x32_bf16 v[56:59], a[196:199], v[36:39], v[56:59]
  v_mfma_f32_16x16x32_bf16 v[56:59], a[200:203], v[40:43], v[56:59]
  v_mfma_f32_16x16x32_bf16 v[56:59], a[204:207], v[44:47], v[56:59]
  v_mfma_f32_16x16x32_bf16 v[56:59], a[208:211], v[48:51], v[56:59]
  v_mfma_f32_16x16x32_bf16 v[56:59], a[212:215], v[52:55], v[56:59]
  buffer_store_dwordx4 v[60:63], v6, s[48:51], s63 offen offset:64 sc1
  s_nop 1
  v_mfma_f32_16x16x32_bf16 v[60:63], a[216:219], v[32:35], 0
  v_mfma_f32_16x16x32_bf16 v[60:63], a[220:223], v[36:39], v[60:63]
  v_mfma_f32_16x16x32_bf16 v[60:63], a[224:227], v[40:43], v[60:63]
  v_mfma_f32_16x16x32_bf16 v[60:63], a[228:231], v[44:47], v[60:63]
  v_mfma_f32_16x16x32_bf16 v[60:63], a[232:235], v[48:51], v[60:63]
  v_mfma_f32_16x16x32_bf16 v[60:63], a[236:239], v[52:55], v[60:63]
  buffer_store_dwordx4 v[64:67], v6, s[48:51], s63 offen offset:128 sc1
  buffer_store_dwordx4 v[56:59], v6, s[48:51], s63 offen offset:192 sc1
  s_nop 5
  buffer_store_dwordx4 v[60:63], v6, s[48:51], s63 offen offset:256 sc1
  s_lshl_b32 s66, s30, 12
  s_add_u32 s66, s66, 4456448
  s_add_u32 s4, s66, 0
  s_add_u32 s6, s66, 32768
  s_add_u32 s8, s66, 65536
  s_add_u32 s10, s66, 98304
  s_add_u32 s12, s66, 131072
  s_add_u32 s16, s66, 163840
  s_add_u32 s18, s66, 196608
  s_add_u32 s20, s66, 229376
  s_mov_b32 s65, 400000
  s_sleep 16
L_fpoll_211:
  buffer_load_dwordx4 v[32:35], v4, s[48:51], s4 offen offset:0 sc1
  buffer_load_dwordx4 v[36:39], v4, s[48:51], s4 offen offset:1024 sc1
  buffer_load_dwordx4 v[40:43], v4, s[48:51], s4 offen offset:2048 sc1
  buffer_load_dwordx4 v[44:47], v4, s[48:51], s4 offen offset:3072 sc1
  buffer_load_dwordx4 v[48:51], v4, s[48:51], s6 offen offset:0 sc1
  buffer_load_dwordx4 v[52:55], v4, s[48:51], s6 offen offset:1024 sc1
  buffer_load_dwordx4 v[56:59], v4, s[48:51], s6 offen offset:2048 sc1
  buffer_load_dwordx4 v[60:63], v4, s[48:51], s6 offen offset:3072 sc1
  buffer_load_dwordx4 v[86:89], v4, s[48:51], s8 offen offset:0 sc1
  buffer_load_dwordx4 v[90:93], v4, s[48:51], s8 offen offset:1024 sc1
  buffer_load_dwordx4 v[94:97], v4, s[48:51], s8 offen offset:2048 sc1
  buffer_load_dwordx4 v[98:101], v4, s[48:51], s8 offen offset:3072 sc1
  buffer_load_dwordx4 v[102:105], v4, s[48:51], s10 offen offset:0 sc1
  buffer_load_dwordx4 v[106:109], v4, s[48:51], s10 offen offset:1024 sc1
  buffer_load_dwordx4 v[110:113], v4, s[48:51], s10 offen offset:2048 sc1
  buffer_load_dwordx4 v[114:117], v4, s[48:51], s10 offen offset:3072 sc1
  buffer_load_dwordx4 v[118:121], v4, s[48:51], s12 offen offset:0 sc1
  buffer_load_dwordx4 v[122:125], v4, s[48:51], s12 offen offset:1024 sc1
  buffer_load_dwordx4 v[126:129], v4, s[48:51], s12 offen offset:2048 sc1
  buffer_load_dwordx4 v[130:133], v4, s[48:51], s12 offen offset:3072 sc1
  buffer_load_dwordx4 v[134:137], v4, s[48:51], s16 offen offset:0 sc1
  buffer_load_dwordx4 v[138:141], v4, s[48:51], s16 offen offset:1024 sc1
  buffer_load_dwordx4 v[142:145], v4, s[48:51], s16 offen offset:2048 sc1
  buffer_load_dwordx4 v[146:149], v4, s[48:51], s16 offen offset:3072 sc1
  buffer_load_dwordx4 v[150:153], v4, s[48:51], s18 offen offset:0 sc1
  buffer_load_dwordx4 v[154:157], v4, s[48:51], s18 offen offset:1024 sc1
  buffer_load_dwordx4 v[158:161], v4, s[48:51], s18 offen offset:2048 sc1
  buffer_load_dwordx4 v[162:165], v4, s[48:51], s18 offen offset:3072 sc1
  buffer_load_dwordx4 v[166:169], v4, s[48:51], s20 offen offset:0 sc1
  buffer_load_dwordx4 v[170:173], v4, s[48:51], s20 offen offset:1024 sc1
  buffer_load_dwordx4 v[174:177], v4, s[48:51], s20 offen offset:2048 sc1
  buffer_load_dwordx4 v[178:181], v4, s[48:51], s20 offen offset:3072 sc1
  s_sub_u32 s65, s65, 1
  s_cbranch_scc1 L_abort
  s_waitcnt vmcnt(30)
  v_max_u32 v84, v33, v35
  v_max3_u32 v84, v84, v37, v39
  v_pk_add_f32 v[32:33], v[32:33], v[16:17]
  v_pk_add_f32 v[34:35], v[34:35], v[18:19]
  s_waitcnt vmcnt(28)
  v_max3_u32 v84, v84, v41, v43
  v_max3_u32 v84, v84, v45, v47
  v_pk_add_f32 v[32:33], v[32:33], v[40:41]
  v_pk_add_f32 v[34:35], v[34:35], v[42:43]
  v_pk_add_f32 v[36:37], v[36:37], v[44:45]
  v_pk_add_f32 v[38:39], v[38:39], v[46:47]
  s_waitcnt vmcnt(26)
  v_max3_u32 v84, v84, v49, v51
  v_max3_u32 v84, v84, v53, v55
  v_pk_add_f32 v[32:33], v[32:33], v[48:49]
  v_pk_add_f32 v[34:35], v[34:35], v[50:51]
  v_pk_add_f32 v[36:37], v[36:37], v[52:53]
  v_pk_add_f32 v[38:39], v[38:39], v[54:55]
  s_waitcnt vmcnt(24)
  v_max3_u32 v84, v84, v57, v59
  v_max3_u32 v84, v84, v61, v63
  v_pk_add_f32 v[32:33], v[32:33], v[56:57]
  v_pk_add_f32 v[34:35], v[34:35], v[58:59]
  v_pk_add_f32 v[36:37], v[36:37], v[60:61]
  v_pk_add_f32 v[38:39], v[38:39], v[62:63]
  s_waitcnt vmcnt(22)
  v_max3_u32 v84, v84, v87, v89
  v_max3_u32 v84, v84, v91, v93
  v_pk_add_f32 v[32:33], v[32:33], v[86:87]
  v_pk_add_f32 v[34:35], v[34:35], v[88:89]
  v_pk_add_f32 v[36:37], v[36:37], v[90:91]
  v_pk_add_f32 v[38:39], v[38:39], v[92:93]
  s_waitcnt vmcnt(20)
  v_max3_u32 v84, v84, v95, v97
  v_max3_u32 v84, v84, v99, v101
  v_pk_add_f32 v[32:33], v[32:33], v[94:95]
  v_pk_add_f32 v[34:35], v[34:35], v[96:97]
  v_pk_add_f32 v[36:37], v[36:37], v[98:99]
  v_pk_add_f32 v[38:39], v[38:39], v[100:101]
  s_waitcnt vmcnt(18)
  v_max3_u32 v84, v84, v103, v105
  v_max3_u32 v84, v84, v107, v109
  v_pk_add_f32 v[32:33], v[32:33], v[102:103]
  v_pk_add_f32 v[34:35], v[34:35], v[104:105]
  v_pk_add_f32 v[36:37], v[36:37], v[106:107]
  v_pk_add_f32 v[38:39], v[38:39], v[108:109]
  s_waitcnt vmcnt(16)
  v_max3_u32 v84, v84, v111, v113
  v_max3_u32 v84, v84, v115, v117
  v_pk_add_f32 v[32:33], v[32:33], v[110:111]
  v_pk_add_f32 v[34:35], v[34:35], v[112:113]
  v_pk_add_f32 v[36:37], v[36:37], v[114:115]
  v_pk_add_f32 v[38:39], v[38:39], v[116:117]
  s_waitcnt vmcnt(14)
  v_max3_u32 v84, v84, v119, v121
  v_max3_u32 v84, v84, v123, v125
  v_pk_add_f32 v[32:33], v[32:33], v[118:119]
  v_pk_add_f32 v[34:35], v[34:35], v[120:121]
  v_pk_add_f32 v[36:37], v[36:37], v[122:123]
  v_pk_add_f32 v[38:39], v[38:39], v[124:125]
  s_waitcnt vmcnt(12)
  v_max3_u32 v84, v84, v127, v129
  v_max3_u32 v84, v84, v131, v133
  v_pk_add_f32 v[32:33], v[32:33], v[126:127]
  v_pk_add_f32 v[34:35], v[34:35], v[128:129]
  v_pk_add_f32 v[36:37], v[36:37], v[130:131]
  v_pk_add_f32 v[38:39], v[38:39], v[132:133]
  s_waitcnt vmcnt(10)
  v_max3_u32 v84, v84, v135, v137
  v_max3_u32 v84, v84, v139, v141
  v_pk_add_f32 v[32:33], v[32:33], v[134:135]
  v_pk_add_f32 v[34:35], v[34:35], v[136:137]
  v_pk_add_f32 v[36:37], v[36:37], v[138:139]
  v_pk_add_f32 v[38:39], v[38:39], v[140:141]
  s_waitcnt vmcnt(8)
  v_max3_u32 v84, v84, v143, v145
  v_max3_u32 v84, v84, v147, v149
  v_pk_add_f32 v[32:33], v[32:33], v[142:143]
  v_pk_add_f32 v[34:35], v[34:35], v[144:145]
  v_pk_add_f32 v[36:37], v[36:37], v[146:147]
  v_pk_add_f32 v[38:39], v[38:39], v[148:149]
  s_waitcnt vmcnt(6)
  v_max3_u32 v84, v84, v151, v153
  v_max3_u32 v84, v84, v155, v157
  v_pk_add_f32 v[32:33], v[32:33], v[150:151]
  v_pk_add_f32 v[34:35], v[34:35], v[152:153]
  v_pk_add_f32 v[36:37], v[36:37], v[154:155]
  v_pk_add_f32 v[38:39], v[38:39], v[156:157]
  s_waitcnt vmcnt(4)
  v_max3_u32 v84, v84, v159, v161
  v_max3_u32 v84, v84, v163, v165
  v_pk_add_f32 v[32:33], v[32:33], v[158:159]
  v_pk_add_f32 v[34:35], v[34:35], v[160:161]
  v_pk_add_f32 v[36:37], v[36:37], v[162:163]
  v_pk_add_f32 v[38:39], v[38:39], v[164:165]
  s_waitcnt vmcnt(2)
  v_max3_u32 v84, v84, v167, v169
  v_max3_u32 v84, v84, v171, v173
  v_pk_add_f32 v[32:33], v[32:33], v[166:167]
  v_pk_add_f32 v[34:35], v[34:35], v[168:169]
  v_pk_add_f32 v[36:37], v[36:37], v[170:171]
  v_pk_add_f32 v[38:39], v[38:39], v[172:173]
  s_waitcnt vmcnt(0)
  v_max3_u32 v84, v84, v175, v177
  v_max3_u32 v84, v84, v179, v181
  v_pk_add_f32 v[32:33], v[32:33], v[174:175]
  v_pk_add_f32 v[34:35], v[34:35], v[176:177]
  v_pk_add_f32 v[36:37], v[36:37], v[178:179]
  v_pk_add_f32 v[38:39], v[38:39], v[180:181]
  v_pk_add_f32 v[32:33], v[32:33], v[36:37]
  v_pk_add_f32 v[34:35], v[34:35], v[38:39]
  v_cmp_eq_u32 vcc, -1, v84
  s_cbranch_vccnz L_fpoll_211
  v_cvt_pk_bf16_f32 v36, v32, v33
  v_cvt_pk_bf16_f32 v37, v34, v35
  ds_write_b64 v29, v[36:37]
  ds_read_b128 v[40:43], v10
  ds_read_b128 v[44:47], v10 offset:64
  ds_read_b64 v[48:49], v11
  v_mov_b32 v50, 0
  v_mov_b32 v51, 0
  ds_read_b128 v[52:55], v14
  ds_read_b128 v[56:59], v14 offset:64
  ds_read_b64 v[60:61], v15
  v_mov_b32 v62, 0
  v_mov_b32 v63, 0
  s_add_u32 s63, s57, 3145728
  v_lshlrev_b32 v16, 16, v36
  v_and_b32 v17, 0xffff0000, v36
  v_lshlrev_b32 v18, 16, v37
  v_and_b32 v19, 0xffff0000, v37
  s_add_u32 s100, s58, 3145728
  s_add_u32 s101, s100, 4096
  s_waitcnt lgkmcnt(5)
  v_mfma_f32_16x16x32_bf16 v[64:67], v[198:201], v[40:43], 0
  s_waitcnt lgkmcnt(4)
  v_mfma_f32_16x16x32_bf16 v[64:67], v[202:205], v[44:47], v[64:67]
  s_waitcnt lgkmcnt(3)
  v_mfma_f32_16x16x32_bf16 v[64:67], v[196:199], v[48:51], v[64:67]
  v_mfma_f32_16x16x32_bf16 v[68:71], v[228:231], v[40:43], 0
  v_mfma_f32_16x16x32_bf16 v[68:71], v[232:235], v[44:47], v[68:71]
  v_mfma_f32_16x16x32_bf16 v[68:71], v[226:229], v[48:51], v[68:71]
  s_waitcnt lgkmcnt(0)
  v_mfma_f32_16x16x32_bf16 v[32:35], v[52:55], v[40:43], 0
  v_mfma_f32_16x16x32_bf16 v[32:35], v[56:59], v[44:47], v[32:35]
  v_mfma_f32_16x16x32_bf16 v[32:35], v[60:63], v[48:51], v[32:35]
  v_mfma_f32_16x16x32_bf16 v[52:55], v[208:211], v[40:43], 0
  v_mfma_f32_16x16x32_bf16 v[52:55], v[212:215], v[44:47], v[52:55]
  v_mfma_f32_16x16x32_bf16 v[52:55], v[206:209], v[48:51], v[52:55]
  v_mfma_f32_16x16x32_bf16 v[56:59], v[238:241], v[40:43], 0
  v_mfma_f32_16x16x32_bf16 v[56:59], v[242:245], v[44:47], v[56:59]
  v_mfma_f32_16x16x32_bf16 v[56:59], v[236:239], v[48:51], v[56:59]
  v_swap_b32 v66, v68
  v_swap_b32 v67, v69
  buffer_store_dwordx4 v[64:67], v7, s[48:51], s63 offen offset:0
  buffer_store_dwordx4 v[68:71], v7, s[48:51], s63 offen offset:16
  v_cndmask_b32 v33, v33, v34, s[74:75]
  v_mfma_f32_16x16x32_bf16 v[64:67], v[218:221], v[40:43], 0
  v_mfma_f32_16x16x32_bf16 v[64:67], v[222:225], v[44:47], v[64:67]
  v_mfma_f32_16x16x32_bf16 v[64:67], v[216:219], v[48:51], v[64:67]
  v_mfma_f32_16x16x32_bf16 v[68:71], v[248:251], v[40:43], 0
  v_mfma_f32_16x16x32_bf16 v[68:71], v[252:255], v[44:47], v[68:71]
  v_mfma_f32_16x16x32_bf16 v[68:71], v[246:249], v[48:51], v[68:71]
  v_swap_b32 v54, v56
  v_swap_b32 v55, v57
  buffer_store_dwordx4 v[52:55], v7, s[48:51], s63 offen offset:128
  buffer_store_dwordx4 v[56:59], v7, s[48:51], s63 offen offset:144
  s_nop 3
  v_swap_b32 v66, v68
  v_swap_b32 v67, v69
  buffer_store_dwordx4 v[64:67], v7, s[48:51], s63 offen offset:256
  buffer_store_dwordx4 v[68:71], v7, s[48:51], s63 offen offset:272
  buffer_store_dwordx4 v[32:35], v81, s[48:51], s63 offen offset:0
  s_mov_b32 s65, 400000
L_fpoll_212:
  buffer_load_dwordx4 v[64:67], v80, s[48:51], s100 offen offset:0 sc1
  buffer_load_dwordx4 v[32:35], v79, s[48:51], s100 offen offset:0 sc1
  buffer_load_dwordx4 v[36:39], v79, s[48:51], s100 offen offset:1024 sc1
  buffer_load_dwordx4 v[40:43], v79, s[48:51], s100 offen offset:2048 sc1
  buffer_load_dwordx4 v[44:47], v79, s[48:51], s100 offen offset:3072 sc1
  buffer_load_dwordx4 v[48:51], v79, s[48:51], s101 offen offset:0 sc1
  buffer_load_dwordx4 v[52:55], v79, s[48:51], s101 offen offset:1024 sc1
  buffer_load_dwordx4 v[56:59], v79, s[48:51], s101 offen offset:2048 sc1
  buffer_load_dwordx4 v[60:63], v79, s[48:51], s101 offen offset:3072 sc1
  s_sub_u32 s65, s65, 1
  s_cbranch_scc1 L_abort
  s_waitcnt vmcnt(8)
  v_max_u32 v84, v65, v67
  v_add_f32_dpp v64, v64, v64 quad_perm:[1,0,3,2] row_mask:0xf bank_mask:0xf
  v_add_f32_dpp v65, v65, v65 quad_perm:[1,0,3,2] row_mask:0xf bank_mask:0xf
  s_waitcnt vmcnt(6)
  v_max3_u32 v84, v84, v33, v35
  v_add_f32_dpp v64, v64, v64 quad_perm:[2,3,0,1] row_mask:0xf bank_mask:0xf
  v_add_f32_dpp v65, v65, v65 quad_perm:[2,3,0,1] row_mask:0xf bank_mask:0xf
  v_max3_u32 v84, v84, v37, v39
  v_add_f32_dpp v64, v64, v64 row_half_mirror row_mask:0xf bank_mask:0xf
  v_add_f32_dpp v65, v65, v65 row_half_mirror row_mask:0xf bank_mask:0xf
  v_pk_add_f32 v[32:33], v[32:33], v[36:37]
  v_pk_add_f32 v[34:35], v[34:35], v[38:39]
  v_mul_f32 v66, 0x3acccccd, v64
  v_mul_f32 v65, 0x3acccccd, v65
  s_waitcnt vmcnt(4)
  v_max3_u32 v84, v84, v41, v43
  v_max3_u32 v84, v84, v45, v47
  v_fma_f32 v65, -v66, v66, v65
  v_pk_add_f32 v[40:41], v[40:41], v[44:45]
  v_pk_add_f32 v[42:43], v[42:43], v[46:47]
  v_max_f32 v65, 0, v65
  v_add_f32 v65, 0x3727c5ac, v65
  v_pk_add_f32 v[32:33], v[32:33], v[40:41]
  v_pk_add_f32 v[34:35], v[34:35], v[42:43]
  v_rsq_f32 v67, v65
  s_waitcnt vmcnt(2)
  v_max3_u32 v84, v84, v49, v51
  v_max3_u32 v84, v84, v53, v55
  v_pk_mul_f32 v[68:69], v[24:25], v[66:67] op_sel_hi:[1,0]
  v_pk_mul_f32 v[70:71], v[26:27], v[66:67] op_sel_hi:[1,0]
  v_pk_add_f32 v[48:49], v[48:49], v[52:53]
  v_pk_add_f32 v[50:51], v[50:51], v[54:55]
  v_pk_add_f32 v[32:33], v[32:33], v[68:69] neg_lo:[0,1] neg_hi:[0,1]
  v_pk_add_f32 v[34:35], v[34:35], v[70:71] neg_lo:[0,1] neg_hi:[0,1]
  v_pk_add_f32 v[32:33], v[32:33], v[48:49]
  v_pk_add_f32 v[34:35], v[34:35], v[50:51]
  s_waitcnt vmcnt(1)
  v_max3_u32 v84, v84, v57, v59
  v_pk_add_f32 v[32:33], v[32:33], v[56:57]
  v_pk_add_f32 v[34:35], v[34:35], v[58:59]
  s_waitcnt vmcnt(0)
  v_max3_u32 v84, v84, v61, v63
  v_pk_add_f32 v[32:33], v[32:33], v[60:61]
  v_pk_add_f32 v[34:35], v[34:35], v[62:63]
  v_cmp_eq_u32 vcc, -1, v84
  s_cbranch_vccnz L_fpoll_212
  v_pk_mul_f32 v[32:33], v[32:33], v[66:67] op_sel:[0,1] op_sel_hi:[1,1]
  v_pk_mul_f32 v[34:35], v[34:35], v[66:67] op_sel:[0,1] op_sel_hi:[1,1]
  v_max_f32 v32, 0, v32
  v_max_f32 v33, 0, v33
  v_pk_mul_f32 v[32:33], v[32:33], v[34:35]
  v_cvt_pk_bf16_f32 v32, v32, v33
  ds_write_b32 v30, v32
  ds_read_b128 v[32:35], v12
  ds_read_b64 v[36:37], v13
  v_mov_b32 v38, 0
  v_mov_b32 v39, 0
  s_add_u32 s63, s59, 4718592
  s_waitcnt lgkmcnt(1)
  v_mfma_f32_16x16x32_bf16 v[40:43], a[240:243], v[32:35], 0
  s_waitcnt lgkmcnt(0)
  v_mfma_f32_16x16x32_bf16 v[40:43], v[186:189], v[36:39], v[40:43]
  v_mfma_f32_16x16x32_bf16 v[44:47], a[244:247], v[32:35], 0
  v_mfma_f32_16x16x32_bf16 v[44:47], v[188:191], v[36:39], v[44:47]
  v_mfma_f32_16x16x32_bf16 v[48:51], a[248:251], v[32:35], 0
  v_mfma_f32_16x16x32_bf16 v[48:51], v[190:193], v[36:39], v[48:51]
  v_mfma_f32_16x16x32_bf16 v[52:55], a[252:255], v[32:35], 0
  v_mfma_f32_16x16x32_bf16 v[52:55], v[192:195], v[36:39], v[52:55]
  v_mfma_f32_16x16x32_bf16 v[56:59], v[182:185], v[32:35], 0
  v_mfma_f32_16x16x32_bf16 v[56:59], v[194:197], v[36:39], v[56:59]
  buffer_store_dwordx4 v[40:43], v6, s[48:51], s63 offen offset:0 sc1
  s_nop 0
  buffer_store_dwordx4 v[44:47], v6, s[48:51], s63 offen offset:64 sc1
  s_nop 0
  buffer_store_dwordx4 v[48:51], v6, s[48:51], s63 offen offset:128 sc1
  s_nop 0
  buffer_store_dwordx4 v[52:55], v6, s[48:51], s63 offen offset:192 sc1
  s_nop 0
  buffer_store_dwordx4 v[56:59], v6, s[48:51], s63 offen offset:256 sc1
  s_cmp_lg_u32 s31, 0
  s_cbranch_scc1 L_done
  s_lshl_b32 s66, s30, 12
  s_add_u32 s66, s66, 4718592
  s_add_u32 s4, s66, 0
  s_add_u32 s6, s66, 32768
  s_add_u32 s8, s66, 65536
  s_add_u32 s10, s66, 98304
  s_add_u32 s12, s66, 131072
  s_add_u32 s16, s66, 163840
  s_add_u32 s18, s66, 196608
  s_add_u32 s20, s66, 229376
  s_mov_b32 s65, 400000
L_fpoll_213:
  buffer_load_dwordx4 v[32:35], v4, s[48:51], s4 offen offset:0 sc1
  buffer_load_dwordx4 v[36:39], v4, s[48:51], s4 offen offset:1024 sc1
  buffer_load_dwordx4 v[40:43], v4, s[48:51], s4 offen offset:2048 sc1
  buffer_load_dwordx4 v[44:47], v4, s[48:51], s4 offen offset:3072 sc1
  buffer_load_dwordx4 v[48:51], v4, s[48:51], s6 offen offset:0 sc1
  buffer_load_dwordx4 v[52:55], v4, s[48:51], s6 offen offset:1024 sc1
  buffer_load_dwordx4 v[56:59], v4, s[48:51], s6 offen offset:2048 sc1
  buffer_load_dwordx4 v[60:63], v4, s[48:51], s6 offen offset:3072 sc1
  buffer_load_dwordx4 v[86:89], v4, s[48:51], s8 offen offset:0 sc1
  buffer_load_dwordx4 v[90:93], v4, s[48:51], s8 offen offset:1024 sc1
  buffer_load_dwordx4 v[94:97], v4, s[48:51], s8 offen offset:2048 sc1
  buffer_load_dwordx4 v[98:101], v4, s[48:51], s8 offen offset:3072 sc1
  buffer_load_dwordx4 v[102:105], v4, s[48:51], s10 offen offset:0 sc1
  buffer_load_dwordx4 v[106:109], v4, s[48:51], s10 offen offset:1024 sc1
  buffer_load_dwordx4 v[110:113], v4, s[48:51], s10 offen offset:2048 sc1
  buffer_load_dwordx4 v[114:117], v4, s[48:51], s10 offen offset:3072 sc1
  buffer_load_dwordx4 v[118:121], v4, s[48:51], s12 offen offset:0 sc1
  buffer_load_dwordx4 v[122:125], v4, s[48:51], s12 offen offset:1024 sc1
  buffer_load_dwordx4 v[126:129], v4, s[48:51], s12 offen offset:2048 sc1
  buffer_load_dwordx4 v[130:133], v4, s[48:51], s12 offen offset:3072 sc1
  buffer_load_dwordx4 v[134:137], v4, s[48:51], s16 offen offset:0 sc1
  buffer_load_dwordx4 v[138:141], v4, s[48:51], s16 offen offset:1024 sc1
  buffer_load_dwordx4 v[142:145], v4, s[48:51], s16 offen offset:2048 sc1
  buffer_load_dwordx4 v[146:149], v4, s[48:51], s16 offen offset:3072 sc1
  buffer_load_dwordx4 v[150:153], v4, s[48:51], s18 offen offset:0 sc1
  buffer_load_dwordx4 v[154:157], v4, s[48:51], s18 offen offset:1024 sc1
  buffer_load_dwordx4 v[158:161], v4, s[48:51], s18 offen offset:2048 sc1
  buffer_load_dwordx4 v[162:165], v4, s[48:51], s18 offen offset:3072 sc1
  buffer_load_dwordx4 v[166:169], v4, s[48:51], s20 offen offset:0 sc1
  buffer_load_dwordx4 v[170:173], v4, s[48:51], s20 offen offset:1024 sc1
  buffer_load_dwordx4 v[174:177], v4, s[48:51], s20 offen offset:2048 sc1
  buffer_load_dwordx4 v[178:181], v4, s[48:51], s20 offen offset:3072 sc1
  s_sub_u32 s65, s65, 1
  s_cbranch_scc1 L_abort
  s_waitcnt vmcnt(30)
  v_max_u32 v84, v33, v35
  v_max3_u32 v84, v84, v37, v39
  v_pk_add_f32 v[32:33], v[32:33], v[16:17]
  v_pk_add_f32 v[34:35], v[34:35], v[18:19]
  s_waitcnt vmcnt(28)
  v_max3_u32 v84, v84, v41, v43
  v_max3_u32 v84, v84, v45, v47
  v_pk_add_f32 v[32:33], v[32:33], v[40:41]
  v_pk_add_f32 v[34:35], v[34:35], v[42:43]
  v_pk_add_f32 v[36:37], v[36:37], v[44:45]
  v_pk_add_f32 v[38:39], v[38:39], v[46:47]
  s_waitcnt vmcnt(26)
  v_max3_u32 v84, v84, v49, v51
  v_max3_u32 v84, v84, v53, v55
  v_pk_add_f32 v[32:33], v[32:33], v[48:49]
  v_pk_add_f32 v[34:35], v[34:35], v[50:51]
  v_pk_add_f32 v[36:37], v[36:37], v[52:53]
  v_pk_add_f32 v[38:39], v[38:39], v[54:55]
  s_waitcnt vmcnt(24)
  v_max3_u32 v84, v84, v57, v59
  v_max3_u32 v84, v84, v61, v63
  v_pk_add_f32 v[32:33], v[32:33], v[56:57]
  v_pk_add_f32 v[34:35], v[34:35], v[58:59]
  v_pk_add_f32 v[36:37], v[36:37], v[60:61]
  v_pk_add_f32 v[38:39], v[38:39], v[62:63]
  s_waitcnt vmcnt(22)
  v_max3_u32 v84, v84, v87, v89
  v_max3_u32 v84, v84, v91, v93
  v_pk_add_f32 v[32:33], v[32:33], v[86:87]
  v_pk_add_f32 v[34:35], v[34:35], v[88:89]
  v_pk_add_f32 v[36:37], v[36:37], v[90:91]
  v_pk_add_f32 v[38:39], v[38:39], v[92:93]
  s_waitcnt vmcnt(20)
  v_max3_u32 v84, v84, v95, v97
  v_max3_u32 v84, v84, v99, v101
  v_pk_add_f32 v[32:33], v[32:33], v[94:95]
  v_pk_add_f32 v[34:35], v[34:35], v[96:97]
  v_pk_add_f32 v[36:37], v[36:37], v[98:99]
  v_pk_add_f32 v[38:39], v[38:39], v[100:101]
  s_waitcnt vmcnt(18)
  v_max3_u32 v84, v84, v103, v105
  v_max3_u32 v84, v84, v107, v109
  v_pk_add_f32 v[32:33], v[32:33], v[102:103]
  v_pk_add_f32 v[34:35], v[34:35], v[104:105]
  v_pk_add_f32 v[36:37], v[36:37], v[106:107]
  v_pk_add_f32 v[38:39], v[38:39], v[108:109]
  s_waitcnt vmcnt(16)
  v_max3_u32 v84, v84, v111, v113
  v_max3_u32 v84, v84, v115, v117
  v_pk_add_f32 v[32:33], v[32:33], v[110:111]
  v_pk_add_f32 v[34:35], v[34:35], v[112:113]
  v_pk_add_f32 v[36:37], v[36:37], v[114:115]
  v_pk_add_f32 v[38:39], v[38:39], v[116:117]
  s_waitcnt vmcnt(14)
  v_max3_u32 v84, v84, v119, v121
  v_max3_u32 v84, v84, v123, v125
  v_pk_add_f32 v[32:33], v[32:33], v[118:119]
  v_pk_add_f32 v[34:35], v[34:35], v[120:121]
  v_pk_add_f32 v[36:37], v[36:37], v[122:123]
  v_pk_add_f32 v[38:39], v[38:39], v[124:125]
  s_waitcnt vmcnt(12)
  v_max3_u32 v84, v84, v127, v129
  v_max3_u32 v84, v84, v131, v133
  v_pk_add_f32 v[32:33], v[32:33], v[126:127]
  v_pk_add_f32 v[34:35], v[34:35], v[128:129]
  v_pk_add_f32 v[36:37], v[36:37], v[130:131]
  v_pk_add_f32 v[38:39], v[38:39], v[132:133]
  s_waitcnt vmcnt(10)
  v_max3_u32 v84, v84, v135, v137
  v_max3_u32 v84, v84, v139, v141
  v_pk_add_f32 v[32:33], v[32:33], v[134:135]
  v_pk_add_f32 v[34:35], v[34:35], v[136:137]
  v_pk_add_f32 v[36:37], v[36:37], v[138:139]
  v_pk_add_f32 v[38:39], v[38:39], v[140:141]
  s_waitcnt vmcnt(8)
  v_max3_u32 v84, v84, v143, v145
  v_max3_u32 v84, v84, v147, v149
  v_pk_add_f32 v[32:33], v[32:33], v[142:143]
  v_pk_add_f32 v[34:35], v[34:35], v[144:145]
  v_pk_add_f32 v[36:37], v[36:37], v[146:147]
  v_pk_add_f32 v[38:39], v[38:39], v[148:149]
  s_waitcnt vmcnt(6)
  v_max3_u32 v84, v84, v151, v153
  v_max3_u32 v84, v84, v155, v157
  v_pk_add_f32 v[32:33], v[32:33], v[150:151]
  v_pk_add_f32 v[34:35], v[34:35], v[152:153]
  v_pk_add_f32 v[36:37], v[36:37], v[154:155]
  v_pk_add_f32 v[38:39], v[38:39], v[156:157]
  s_waitcnt vmcnt(4)
  v_max3_u32 v84, v84, v159, v161
  v_max3_u32 v84, v84, v163, v165
  v_pk_add_f32 v[32:33], v[32:33], v[158:159]
  v_pk_add_f32 v[34:35], v[34:35], v[160:161]
  v_pk_add_f32 v[36:37], v[36:37], v[162:163]
  v_pk_add_f32 v[38:39], v[38:39], v[164:165]
  s_waitcnt vmcnt(2)
  v_max3_u32 v84, v84, v167, v169
  v_max3_u32 v84, v84, v171, v173
  v_pk_add_f32 v[32:33], v[32:33], v[166:167]
  v_pk_add_f32 v[34:35], v[34:35], v[168:169]
  v_pk_add_f32 v[36:37], v[36:37], v[170:171]
  v_pk_add_f32 v[38:39], v[38:39], v[172:173]
  s_waitcnt vmcnt(0)
  v_max3_u32 v84, v84, v175, v177
  v_max3_u32 v84, v84, v179, v181
  v_pk_add_f32 v[32:33], v[32:33], v[174:175]
  v_pk_add_f32 v[34:35], v[34:35], v[176:177]
  v_pk_add_f32 v[36:37], v[36:37], v[178:179]
  v_pk_add_f32 v[38:39], v[38:39], v[180:181]
  v_pk_add_f32 v[32:33], v[32:33], v[36:37]
  v_pk_add_f32 v[34:35], v[34:35], v[38:39]
  v_cmp_eq_u32 vcc, -1, v84
  s_cbranch_vccnz L_fpoll_213
  v_cvt_pk_bf16_f32 v36, v32, v33
  v_cvt_pk_bf16_f32 v37, v34, v35
  s_cmp_lg_u32 s31, 0
  s_cbranch_scc1 L_noout_214
  s_mov_b32 s44, s22
  s_and_b32 s45, s23, 0xffff
  s_mov_b32 s46, 2560
  s_mov_b32 s47, 0x20000
  v_and_b32 v84, 31, v0
  v_lshlrev_b32 v84, 3, v84
  s_mul_i32 s66, s30, 160
  s_add_u32 s66, s66, 0
  s_mov_b32 vcc_lo, 0x000fffff
  s_mov_b32 vcc_hi, 0x00000000
  v_cndmask_b32 v84, v74, v84, vcc
  buffer_store_dwordx2 v[36:37], v84, s[44:47], s66 offen
L_noout_214:
  s_cmp_lg_u32 s31, 0
  s_cbranch_scc1 L_noout_215
  s_mov_b32 s44, s22
  s_and_b32 s45, s23, 0xffff
  s_mov_b32 s46, 2560
  s_mov_b32 s47, 0x20000
  v_and_b32 v84, 31, v0
  v_lshlrev_b32 v84, 3, v84
  s_mul_i32 s66, s30, 160
  s_add_u32 s66, s66, 1280
  s_mov_b32 vcc_lo, 0x00000000
  s_mov_b32 vcc_hi, 0x000fffff
  v_cndmask_b32 v84, v74, v84, vcc
  buffer_store_dwordx2 v[36:37], v84, s[44:47], s66 offen
L_noout_215:
  s_cmp_lg_u32 s2, 0
  s_cbranch_scc1 L_done
  v_mov_b32 v84, s73
  v_mov_b32 v85, 896
  s_mov_b64 exec, 1
  buffer_store_dword v84, v85, s[48:51], 0 offen sc1
  s_mov_b64 exec, -1
  s_branch L_done
L_global:
  v_and_b32 v84, 31, v0
  v_lshlrev_b32 v84, 4, v84
  v_lshrrev_b32 v85, 5, v0
  v_lshl_add_u32 v84, v85, 9, v84
  s_mov_b32 vcc_lo, 0x000fffff
  s_mov_b32 vcc_hi, 0x000fffff
  v_cndmask_b32 v4, v74, v84, vcc
  s_mov_b32 vcc_lo, 0x00ffffff
  s_mov_b32 vcc_hi, 0x00ffffff
  v_cndmask_b32 v79, v74, v84, vcc
  v_lshrrev_b32 v84, 4, v0
  v_and_b32 v85, 15, v0
  v_lshlrev_b32 v72, 10, v84
  v_lshl_add_u32 v72, v85, 4, v72
  v_add_u32 v72, 512, v72
  v_lshlrev_b32 v73, 15, v84
  v_bfe_u32 v85, v0, 2, 2
  v_lshl_add_u32 v73, v85, 10, v73
  v_and_b32 v85, 3, v0
  v_lshl_add_u32 v73, v85, 4, v73
  v_add_u32 v73, 768, v73
  v_lshrrev_b32 v85, 5, v0
  v_and_b32 v84, 7, v0
  v_lshlrev_b32 v84, 10, v84
  v_lshl_add_u32 v84, v85, 9, v84
  v_add_u32 v84, 384, v84
  s_mov_b32 vcc_lo, 0xffffffff
  s_mov_b32 vcc_hi, 0xffffffff
  v_cndmask_b32 v80, v74, v84, vcc
  v_and_b32 v84, 15, v0
  v_lshrrev_b32 v85, 4, v0
  v_lshlrev_b32 v6, 9, v84
  v_lshl_add_u32 v7, v85, 5, v6
  v_add_u32 v81, 384, v6
  v_lshl_add_u32 v6, v85, 4, v6
  v_lshlrev_b32 v8, 18, v84
  v_add_u32 v82, 768, v8
  v_lshl_add_u32 v8, v85, 4, v8
  s_mov_b32 vcc_lo, 0x00040004
  s_mov_b32 vcc_hi, 0x00040004
  v_cndmask_b32 v6, v74, v6, vcc
  v_cndmask_b32 v7, v74, v7, vcc
  s_mov_b32 vcc_lo, 0x00000004
  s_mov_b32 vcc_hi, 0x00000000
  v_cndmask_b32 v81, v74, v81, vcc
  s_mov_b32 vcc_lo, 0x00070007
  s_mov_b32 vcc_hi, 0x00070007
  v_cndmask_b32 v8, v74, v8, vcc
  s_mov_b32 vcc_lo, 0x00000007
  s_mov_b32 vcc_hi, 0x00000000
  v_cndmask_b32 v82, v74, v82, vcc
  ds_read_b128 v[40:43], v10
  ds_read_b128 v[44:47], v10 offset:64
  ds_read_b64 v[48:49], v11
  v_mov_b32 v50, 0
  v_mov_b32 v51, 0
  ds_read_b128 v[52:55], v14
  ds_read_b128 v[56:59], v14 offset:64
  ds_read_b64 v[60:61], v15
  v_mov_b32 v62, 0
  v_mov_b32 v63, 0
  s_add_u32 s63, s57, 1048576
  s_waitcnt lgkmcnt(5)
  v_mfma_f32_16x16x32_bf16 v[64:67], a[2:5], v[40:43], 0
  s_waitcnt lgkmcnt(4)
  v_mfma_f32_16x16x32_bf16 v[64:67], a[6:9], v[44:47], v[64:67]
  s_waitcnt lgkmcnt(3)
  v_mfma_f32_16x16x32_bf16 v[64:67], a[0:3], v[48:51], v[64:67]
  s_waitcnt lgkmcnt(0)
  v_mfma_f32_16x16x32_bf16 v[36:39], v[52:55], v[40:43], 0
  v_mfma_f32_16x16x32_bf16 v[36:39], v[56:59], v[44:47], v[36:39]
  v_mfma_f32_16x16x32_bf16 v[36:39], v[60:63], v[48:51], v[36:39]
  v_mfma_f32_16x16x32_bf16 v[68:71], a[12:15], v[40:43], 0
  v_mfma_f32_16x16x32_bf16 v[68:71], a[16:19], v[44:47], v[68:71]
  v_mfma_f32_16x16x32_bf16 v[68:71], a[10:13], v[48:51], v[68:71]
  v_mfma_f32_16x16x32_bf16 v[32:35], a[22:25], v[40:43], 0
  v_mfma_f32_16x16x32_bf16 v[32:35], a[26:29], v[44:47], v[32:35]
  v_mfma_f32_16x16x32_bf16 v[32:35], a[20:23], v[48:51], v[32:35]
  v_mfma_f32_16x16x32_bf16 v[52:55], a[32:35], v[40:43], 0
  v_mfma_f32_16x16x32_bf16 v[52:55], a[36:39], v[44:47], v[52:55]
  v_mfma_f32_16x16x32_bf16 v[52:55], a[30:33], v[48:51], v[52:55]
  buffer_store_dwordx4 v[64:67], v8, s[48:51], s63 offen offset:0 sc1
  s_nop 1
  v_mfma_f32_16x16x32_bf16 v[64:67], a[42:45], v[40:43], 0
  v_mfma_f32_16x16x32_bf16 v[64:67], a[46:49], v[44:47], v[64:67]
  v_mfma_f32_16x16x32_bf16 v[64:67], a[40:43], v[48:51], v[64:67]
  buffer_store_dwordx4 v[68:71], v8, s[48:51], s63 offen offset:64 sc1
  s_nop 1
  v_mfma_f32_16x16x32_bf16 v[68:71], a[52:55], v[40:43], 0
  v_mfma_f32_16x16x32_bf16 v[68:71], a[56:59], v[44:47], v[68:71]
  v_mfma_f32_16x16x32_bf16 v[68:71], a[50:53], v[48:51], v[68:71]
  buffer_store_dwordx4 v[32:35], v8, s[48:51], s63 offen offset:128 sc1
  s_nop 1
  v_mfma_f32_16x16x32_bf16 v[32:35], a[62:65], v[40:43], 0
  v_mfma_f32_16x16x32_bf16 v[32:35], a[66:69], v[44:47], v[32:35]
  v_mfma_f32_16x16x32_bf16 v[32:35], a[60:63], v[48:51], v[32:35]
  buffer_store_dwordx4 v[52:55], v8, s[48:51], s63 offen offset:192 sc1
  s_nop 1
  v_mfma_f32_16x16x32_bf16 v[52:55], a[72:75], v[40:43], 0
  v_mfma_f32_16x16x32_bf16 v[52:55], a[76:79], v[44:47], v[52:55]
  v_mfma_f32_16x16x32_bf16 v[52:55], a[70:73], v[48:51], v[52:55]
  buffer_store_dwordx4 v[64:67], v8, s[48:51], s63 offen offset:256 sc1
  s_nop 1
  v_mfma_f32_16x16x32_bf16 v[64:67], a[82:85], v[40:43], 0
  v_mfma_f32_16x16x32_bf16 v[64:67], a[86:89], v[44:47], v[64:67]
  v_mfma_f32_16x16x32_bf16 v[64:67], a[80:83], v[48:51], v[64:67]
  buffer_store_dwordx4 v[68:71], v8, s[48:51], s63 offen offset:320 sc1
  s_nop 1
  v_mfma_f32_16x16x32_bf16 v[68:71], a[92:95], v[40:43], 0
  v_mfma_f32_16x16x32_bf16 v[68:71], a[96:99], v[44:47], v[68:71]
  v_mfma_f32_16x16x32_bf16 v[68:71], a[90:93], v[48:51], v[68:71]
  buffer_store_dwordx4 v[32:35], v8, s[48:51], s63 offen offset:384 sc1
  s_nop 1
  v_mfma_f32_16x16x32_bf16 v[32:35], a[102:105], v[40:43], 0
  v_mfma_f32_16x16x32_bf16 v[32:35], a[106:109], v[44:47], v[32:35]
  v_mfma_f32_16x16x32_bf16 v[32:35], a[100:103], v[48:51], v[32:35]
  buffer_store_dwordx4 v[52:55], v8, s[48:51], s63 offen offset:448 sc1
  s_nop 1
  v_mfma_f32_16x16x32_bf16 v[52:55], a[112:115], v[40:43], 0
  v_mfma_f32_16x16x32_bf16 v[52:55], a[116:119], v[44:47], v[52:55]
  v_mfma_f32_16x16x32_bf16 v[52:55], a[110:113], v[48:51], v[52:55]
  buffer_store_dwordx4 v[64:67], v8, s[48:51], s63 offen offset:512 sc1
  v_cndmask_b32 v37, v37, v38, s[74:75]
  buffer_store_dwordx4 v[68:71], v8, s[48:51], s63 offen offset:576 sc1
  buffer_store_dwordx4 v[32:35], v8, s[48:51], s63 offen offset:640 sc1
  s_nop 3
  buffer_store_dwordx4 v[52:55], v8, s[48:51], s63 offen offset:704 sc1
  buffer_store_dwordx4 v[36:39], v82, s[48:51], s63 offen offset:0 sc1
  ds_read_b128 v[40:43], v10
  ds_read_b128 v[44:47], v10 offset:64
  ds_read_b64 v[48:49], v11
  v_mov_b32 v50, 0
  v_mov_b32 v51, 0
  s_add_u32 s63, s57, 2358272
  s_waitcnt lgkmcnt(2)
  v_mfma_f32_16x16x32_bf16 v[64:67], v[198:201], v[40:43], 0
  s_waitcnt lgkmcnt(1)
  v_mfma_f32_16x16x32_bf16 v[64:67], v[202:205], v[44:47], v[64:67]
  s_waitcnt lgkmcnt(0)
  v_mfma_f32_16x16x32_bf16 v[64:67], v[196:199], v[48:51], v[64:67]
  v_mfma_f32_16x16x32_bf16 v[68:71], v[228:231], v[40:43], 0
  v_mfma_f32_16x16x32_bf16 v[68:71], v[232:235], v[44:47], v[68:71]
  v_mfma_f32_16x16x32_bf16 v[68:71], v[226:229], v[48:51], v[68:71]
  v_mfma_f32_16x16x32_bf16 v[52:55], v[208:211], v[40:43], 0
  v_mfma_f32_16x16x32_bf16 v[52:55], v[212:215], v[44:47], v[52:55]
  v_mfma_f32_16x16x32_bf16 v[52:55], v[206:209], v[48:51], v[52:55]
  v_mfma_f32_16x16x32_bf16 v[56:59], v[238:241], v[40:43], 0
  v_mfma_f32_16x16x32_bf16 v[56:59], v[242:245], v[44:47], v[56:59]
  v_mfma_f32_16x16x32_bf16 v[56:59], v[236:239], v[48:51], v[56:59]
  s_nop 1
  v_swap_b32 v66, v68
  v_swap_b32 v67, v69
  buffer_store_dwordx4 v[64:67], v7, s[48:51], s63 offen offset:0 sc1
  buffer_store_dwordx4 v[68:71], v7, s[48:51], s63 offen offset:16 sc1
  s_nop 0
  v_mfma_f32_16x16x32_bf16 v[64:67], v[218:221], v[40:43], 0
  v_mfma_f32_16x16x32_bf16 v[64:67], v[222:225], v[44:47], v[64:67]
  v_mfma_f32_16x16x32_bf16 v[64:67], v[216:219], v[48:51], v[64:67]
  v_mfma_f32_16x16x32_bf16 v[68:71], v[248:251], v[40:43], 0
  v_mfma_f32_16x16x32_bf16 v[68:71], v[252:255], v[44:47], v[68:71]
  v_mfma_f32_16x16x32_bf16 v[68:71], v[246:249], v[48:51], v[68:71]
  v_swap_b32 v54, v56
  v_swap_b32 v55, v57
  buffer_store_dwordx4 v[52:55], v7, s[48:51], s63 offen offset:128 sc1
  buffer_store_dwordx4 v[56:59], v7, s[48:51], s63 offen offset:144 sc1
  s_nop 3
  v_swap_b32 v66, v68
  v_swap_b32 v67, v69
  buffer_store_dwordx4 v[64:67], v7, s[48:51], s63 offen offset:256 sc1
  buffer_store_dwordx4 v[68:71], v7, s[48:51], s63 offen offset:272 sc1
  v_mov_b32 v32, -1
  v_mov_b32 v33, -1
  v_mov_b32 v34, -1
  v_mov_b32 v35, -1
  v_and_b32 v84, 31, v0
  v_lshlrev_b32 v84, 4, v84
  v_lshrrev_b32 v85, 5, v0
  v_lshl_add_u32 v84, v85, 9, v84
  s_cmp_lg_u32 s29, 0
  s_cbranch_scc1 L_norstg_216
  s_mov_b32 vcc_lo, 0x000fffff
  s_mov_b32 vcc_hi, 0x00000000
  v_cndmask_b32 v36, v74, v84, vcc
  s_add_u32 s63, s61, 4980736
  buffer_store_dwordx4 v[32:35], v36, s[48:51], s63 offen sc1
  s_add_u32 s63, s61, 5046272
  buffer_store_dwordx4 v[32:35], v36, s[48:51], s63 offen sc1
L_norstg_216:
  s_add_u32 s63, s57, 1835008
  buffer_store_dwordx4 v[32:35], v5, s[48:51], s63 offen sc1
  s_add_u32 s63, s57, 2097152
  buffer_store_dwordx4 v[32:35], v5, s[48:51], s63 offen sc1
  s_add_u32 s63, s57, 0
  buffer_store_dwordx4 v[32:35], v5, s[48:51], s63 offen sc1
  s_add_u32 s63, s57, 262144
  buffer_store_dwordx4 v[32:35], v5, s[48:51], s63 offen sc1
  s_add_u32 s63, s57, 524288
  buffer_store_dwordx4 v[32:35], v5, s[48:51], s63 offen sc1
  s_add_u32 s63, s57, 786432
  buffer_store_dwordx4 v[32:35], v5, s[48:51], s63 offen sc1
  s_mov_b32 vcc_lo, 0x01ffffff
  s_mov_b32 vcc_hi, 0x00000000
  v_cndmask_b32 v36, v74, v84, vcc
  s_add_u32 s63, s57, 2621440
  buffer_store_dwordx4 v[32:35], v36, s[48:51], s63 offen sc1
  s_mov_b32 vcc_lo, 0x000fffff
  s_mov_b32 vcc_hi, 0x00000000
  v_cndmask_b32 v36, v74, v84, vcc
  s_add_u32 s63, s59, 3407872
  buffer_store_dwordx4 v[32:35], v36, s[48:51], s63 offen sc1
  s_add_u32 s63, s59, 3670016
  buffer_store_dwordx4 v[32:35], v36, s[48:51], s63 offen sc1
  s_mov_b32 vcc_lo, 0x00000000
  s_mov_b32 vcc_hi, 0x01ffffff
  v_cndmask_b32 v36, v74, v84, vcc
  s_add_u32 s63, s57, 2883584
  buffer_store_dwordx4 v[32:35], v36, s[48:51], s63 offen sc1
  s_mov_b32 vcc_lo, 0x00000000
  s_mov_b32 vcc_hi, 0x000fffff
  v_cndmask_b32 v36, v74, v84, vcc
  s_add_u32 s63, s59, 3932160
  buffer_store_dwordx4 v[32:35], v36, s[48:51], s63 offen sc1
  s_add_u32 s63, s59, 4194304
  buffer_store_dwordx4 v[32:35], v36, s[48:51], s63 offen sc1
  s_mov_b32 vcc_lo, 0x01ffffff
  s_mov_b32 vcc_hi, 0x01ffffff
  v_cndmask_b32 v36, v74, v84, vcc
  s_add_u32 s63, s57, 3145728
  buffer_store_dwordx4 v[32:35], v36, s[48:51], s63 offen sc1
  s_mov_b32 vcc_lo, 0x000fffff
  s_mov_b32 vcc_hi, 0x000fffff
  v_cndmask_b32 v36, v74, v84, vcc
  s_add_u32 s63, s59, 4456448
  buffer_store_dwordx4 v[32:35], v36, s[48:51], s63 offen sc1
  s_add_u32 s63, s59, 4718592
  buffer_store_dwordx4 v[32:35], v36, s[48:51], s63 offen sc1
  v_and_b32 v84, 31, v0
  v_lshlrev_b32 v84, 4, v84
  s_mov_b32 vcc_lo, 0x00ffffff
  s_mov_b32 vcc_hi, 0x00ffffff
  v_cndmask_b32 v72, v74, v84, vcc
  s_add_u32 s10, s58, 1048576
  s_add_u32 s11, s10, 4096
  s_add_u32 s12, s58, 1310720
  s_add_u32 s13, s12, 4096
  s_add_u32 s14, s58, 1572864
  s_add_u32 s15, s14, 4096
  s_add_u32 s16, s58, 2359296
  s_add_u32 s17, s16, 4096
  s_mov_b32 s65, 400000
L_poll_217:
  buffer_load_dwordx4 v[86:89], v5, s[48:51], s10 offen offset:0 sc1
  buffer_load_dwordx4 v[90:93], v5, s[48:51], s10 offen offset:1024 sc1
  buffer_load_dwordx4 v[94:97], v5, s[48:51], s10 offen offset:2048 sc1
  buffer_load_dwordx4 v[98:101], v5, s[48:51], s10 offen offset:3072 sc1
  buffer_load_dwordx4 v[102:105], v5, s[48:51], s11 offen offset:0 sc1
  buffer_load_dwordx4 v[106:109], v5, s[48:51], s11 offen offset:1024 sc1
  buffer_load_dwordx4 v[110:113], v5, s[48:51], s11 offen offset:2048 sc1
  buffer_load_dwordx4 v[114:117], v5, s[48:51], s11 offen offset:3072 sc1
  buffer_load_dwordx4 v[118:121], v5, s[48:51], s12 offen offset:0 sc1
  buffer_load_dwordx4 v[122:125], v5, s[48:51], s12 offen offset:1024 sc1
  buffer_load_dwordx4 v[126:129], v5, s[48:51], s12 offen offset:2048 sc1
  buffer_load_dwordx4 v[130:133], v5, s[48:51], s12 offen offset:3072 sc1
  buffer_load_dwordx4 v[134:137], v5, s[48:51], s13 offen offset:0 sc1
  buffer_load_dwordx4 v[138:141], v5, s[48:51], s13 offen offset:1024 sc1
  buffer_load_dwordx4 v[142:145], v5, s[48:51], s13 offen offset:2048 sc1
  buffer_load_dwordx4 v[146:149], v5, s[48:51], s13 offen offset:3072 sc1
  buffer_load_dwordx4 v[150:153], v5, s[48:51], s14 offen offset:0 sc1
  buffer_load_dwordx4 v[154:157], v5, s[48:51], s14 offen offset:1024 sc1
  buffer_load_dwordx4 v[158:161], v5, s[48:51], s14 offen offset:2048 sc1
  buffer_load_dwordx4 v[162:165], v5, s[48:51], s14 offen offset:3072 sc1
  buffer_load_dwordx4 v[166:169], v5, s[48:51], s15 offen offset:0 sc1
  buffer_load_dwordx4 v[170:173], v5, s[48:51], s15 offen offset:1024 sc1
  buffer_load_dwordx4 v[174:177], v5, s[48:51], s15 offen offset:2048 sc1
  buffer_load_dwordx4 v[178:181], v5, s[48:51], s15 offen offset:3072 sc1
  buffer_load_dwordx4 v[64:67], v31, s[48:51], s10 offen offset:0 sc1
  buffer_load_dwordx4 v[68:71], v31, s[48:51], s12 offen offset:0 sc1
  buffer_load_dwordx4 v[32:35], v72, s[48:51], s16 offen offset:0 sc1
  buffer_load_dwordx4 v[36:39], v72, s[48:51], s16 offen offset:1024 sc1
  buffer_load_dwordx4 v[40:43], v72, s[48:51], s16 offen offset:2048 sc1
  buffer_load_dwordx4 v[44:47], v72, s[48:51], s16 offen offset:3072 sc1
  buffer_load_dwordx4 v[48:51], v72, s[48:51], s17 offen offset:0 sc1
  buffer_load_dwordx4 v[52:55], v72, s[48:51], s17 offen offset:1024 sc1
  buffer_load_dwordx4 v[56:59], v72, s[48:51], s17 offen offset:2048 sc1
  buffer_load_dwordx4 v[60:63], v72, s[48:51], s17 offen offset:3072 sc1
  s_sub_u32 s65, s65, 1
  s_cbranch_scc1 L_abort
  s_waitcnt vmcnt(0)
  v_max3_u32 v84, v87, v89, v91
  v_max3_u32 v84, v84, v93, v95
  v_max3_u32 v84, v84, v97, v99
  v_max3_u32 v84, v84, v101, v103
  v_max3_u32 v84, v84, v105, v107
  v_max3_u32 v84, v84, v109, v111
  v_max3_u32 v84, v84, v113, v115
  v_max3_u32 v84, v84, v117, v119
  v_max3_u32 v84, v84, v121, v123
  v_max3_u32 v84, v84, v125, v127
  v_max3_u32 v84, v84, v129, v131
  v_max3_u32 v84, v84, v133, v135
  v_max3_u32 v84, v84, v137, v139
  v_max3_u32 v84, v84, v141, v143
  v_max3_u32 v84, v84, v145, v147
  v_max3_u32 v84, v84, v149, v151
  v_max3_u32 v84, v84, v153, v155
  v_max3_u32 v84, v84, v157, v159
  v_max3_u32 v84, v84, v161, v163
  v_max3_u32 v84, v84, v165, v167
  v_max3_u32 v84, v84, v169, v171
  v_max3_u32 v84, v84, v173, v175
  v_max3_u32 v84, v84, v177, v179
  v_max3_u32 v84, v84, v181, v65
  v_max3_u32 v84, v84, v67, v69
  v_max3_u32 v84, v84, v71, v33
  v_max3_u32 v84, v84, v35, v37
  v_max3_u32 v84, v84, v39, v41
  v_max3_u32 v84, v84, v43, v45
  v_max3_u32 v84, v84, v47, v49
  v_max3_u32 v84, v84, v51, v53
  v_max3_u32 v84, v84, v55, v57
  v_max3_u32 v84, v84, v59, v61
  v_max_u32 v84, v84, v63
  v_cmp_eq_u32 vcc, -1, v84
  s_cbranch_vccz L_pok_218
  s_sleep 8
  s_branch L_poll_217
L_pok_218:
  s_lshl_b32 s63, s2, 7
  s_add_u32 s63, s63, 5537792
  v_mov_b32 v72, s73
  v_mov_b32 v73, 0
  v_mov_b32 v84, 0
  s_mov_b64 exec, 1
  buffer_store_dwordx2 v[72:73], v84, s[48:51], s63 offen sc1
  s_mov_b64 exec, -1
  v_pk_add_f32 v[150:151], v[150:151], v[154:155]
  v_pk_add_f32 v[152:153], v[152:153], v[156:157]
  v_pk_add_f32 v[158:159], v[158:159], v[162:163]
  v_pk_add_f32 v[160:161], v[160:161], v[164:165]
  v_pk_add_f32 v[166:167], v[166:167], v[170:171]
  v_pk_add_f32 v[168:169], v[168:169], v[172:173]
  v_pk_add_f32 v[174:175], v[174:175], v[178:179]
  v_pk_add_f32 v[176:177], v[176:177], v[180:181]
  v_pk_add_f32 v[150:151], v[150:151], v[158:159]
  v_pk_add_f32 v[152:153], v[152:153], v[160:161]
  v_pk_add_f32 v[166:167], v[166:167], v[174:175]
  v_pk_add_f32 v[168:169], v[168:169], v[176:177]
  v_pk_add_f32 v[150:151], v[150:151], v[166:167]
  v_pk_add_f32 v[152:153], v[152:153], v[168:169]
  v_mov_b32 v20, v150
  v_mov_b32 v21, v151
  v_mov_b32 v22, v152
  v_mov_b32 v23, v153
  v_pk_add_f32 v[32:33], v[32:33], v[36:37]
  v_pk_add_f32 v[34:35], v[34:35], v[38:39]
  v_pk_add_f32 v[40:41], v[40:41], v[44:45]
  v_pk_add_f32 v[42:43], v[42:43], v[46:47]
  v_pk_add_f32 v[48:49], v[48:49], v[52:53]
  v_pk_add_f32 v[50:51], v[50:51], v[54:55]
  v_pk_add_f32 v[56:57], v[56:57], v[60:61]
  v_pk_add_f32 v[58:59], v[58:59], v[62:63]
  v_pk_add_f32 v[32:33], v[32:33], v[40:41]
  v_pk_add_f32 v[34:35], v[34:35], v[42:43]
  v_pk_add_f32 v[48:49], v[48:49], v[56:57]
  v_pk_add_f32 v[50:51], v[50:51], v[58:59]
  v_pk_add_f32 v[32:33], v[32:33], v[48:49]
  v_pk_add_f32 v[34:35], v[34:35], v[50:51]
  v_mov_b32 v24, v32
  v_mov_b32 v25, v33
  v_mov_b32 v26, v34
  v_mov_b32 v27, v35
  v_add_f32_dpp v64, v64, v64 quad_perm:[1,0,3,2] row_mask:0xf bank_mask:0xf
  v_add_f32_dpp v65, v65, v65 quad_perm:[1,0,3,2] row_mask:0xf bank_mask:0xf
  s_nop 0
  v_add_f32_dpp v64, v64, v64 quad_perm:[2,3,0,1] row_mask:0xf bank_mask:0xf
  v_add_f32_dpp v65, v65, v65 quad_perm:[2,3,0,1] row_mask:0xf bank_mask:0xf
  s_nop 0
  v_add_f32_dpp v64, v64, v64 row_half_mirror row_mask:0xf bank_mask:0xf
  v_add_f32_dpp v65, v65, v65 row_half_mirror row_mask:0xf bank_mask:0xf
  v_pk_add_f32 v[86:87], v[86:87], v[90:91]
  v_pk_add_f32 v[88:89], v[88:89], v[92:93]
  v_pk_add_f32 v[94:95], v[94:95], v[98:99]
  v_pk_add_f32 v[96:97], v[96:97], v[100:101]
  v_pk_add_f32 v[102:103], v[102:103], v[106:107]
  v_pk_add_f32 v[104:105], v[104:105], v[108:109]
  v_pk_add_f32 v[110:111], v[110:111], v[114:115]
  v_pk_add_f32 v[112:113], v[112:113], v[116:117]
  v_pk_add_f32 v[86:87], v[86:87], v[94:95]
  v_pk_add_f32 v[88:89], v[88:89], v[96:97]
  v_pk_add_f32 v[102:103], v[102:103], v[110:111]
  v_pk_add_f32 v[104:105], v[104:105], v[112:113]
  v_pk_add_f32 v[86:87], v[86:87], v[102:103]
  v_pk_add_f32 v[88:89], v[88:89], v[104:105]
  v_mul_f32 v66, 0x3acccccd, v64
  v_mul_f32 v65, 0x3acccccd, v65
  v_fma_f32 v65, -v66, v66, v65
  v_max_f32 v65, 0, v65
  v_add_f32 v65, 0x3727c5ac, v65
  v_rsq_f32 v67, v65
  v_fma_f32 v86, -v66, v20, v86
  v_fma_f32 v87, -v66, v21, v87
  v_fma_f32 v88, -v66, v22, v88
  v_fma_f32 v89, -v66, v23, v89
  v_mul_f32 v86, v67, v86
  v_mul_f32 v87, v67, v87
  v_mul_f32 v88, v67, v88
  v_mul_f32 v89, v67, v89
  v_cvt_pk_bf16_f32 v86, v86, v87
  v_cvt_pk_bf16_f32 v87, v88, v89
  ds_write_b64 v28, v[86:87] offset:6208
  v_add_f32_dpp v68, v68, v68 quad_perm:[1,0,3,2] row_mask:0xf bank_mask:0xf
  v_add_f32_dpp v69, v69, v69 quad_perm:[1,0,3,2] row_mask:0xf bank_mask:0xf
  s_nop 0
  v_add_f32_dpp v68, v68, v68 quad_perm:[2,3,0,1] row_mask:0xf bank_mask:0xf
  v_add_f32_dpp v69, v69, v69 quad_perm:[2,3,0,1] row_mask:0xf bank_mask:0xf
  s_nop 0
  v_add_f32_dpp v68, v68, v68 row_half_mirror row_mask:0xf bank_mask:0xf
  v_add_f32_dpp v69, v69, v69 row_half_mirror row_mask:0xf bank_mask:0xf
  v_pk_add_f32 v[118:119], v[118:119], v[122:123]
  v_pk_add_f32 v[120:121], v[120:121], v[124:125]
  v_pk_add_f32 v[126:127], v[126:127], v[130:131]
  v_pk_add_f32 v[128:129], v[128:129], v[132:133]
  v_pk_add_f32 v[134:135], v[134:135], v[138:139]
  v_pk_add_f32 v[136:137], v[136:137], v[140:141]
  v_pk_add_f32 v[142:143], v[142:143], v[146:147]
  v_pk_add_f32 v[144:145], v[144:145], v[148:149]
  v_pk_add_f32 v[118:119], v[118:119], v[126:127]
  v_pk_add_f32 v[120:121], v[120:121], v[128:129]
  v_pk_add_f32 v[134:135], v[134:135], v[142:143]
  v_pk_add_f32 v[136:137], v[136:137], v[144:145]
  v_pk_add_f32 v[118:119], v[118:119], v[134:135]
  v_pk_add_f32 v[120:121], v[120:121], v[136:137]
  v_mul_f32 v70, 0x3acccccd, v68
  v_mul_f32 v69, 0x3acccccd, v69
  v_fma_f32 v69, -v70, v70, v69
  v_max_f32 v69, 0, v69
  v_add_f32 v69, 0x3727c5ac, v69
  v_rsq_f32 v71, v69
  v_fma_f32 v118, -v70, v20, v118
  v_fma_f32 v119, -v70, v21, v119
  v_fma_f32 v120, -v70, v22, v120
  v_fma_f32 v121, -v70, v23, v121
  v_mul_f32 v118, v71, v118
  v_mul_f32 v119, v71, v119
  v_mul_f32 v120, v71, v120
  v_mul_f32 v121, v71, v121
  v_cvt_pk_bf16_f32 v118, v118, v119
  v_cvt_pk_bf16_f32 v119, v120, v121
  ds_write_b64 v28, v[118:119] offset:6592
  s_add_u32 s42, s40, 0
  buffer_load_dwordx4 v[86:89], v1, s[32:35], s42 offen offset:0 nt
  buffer_load_dwordx4 v[90:93], v1, s[32:35], s42 offen offset:128 nt
  buffer_load_dwordx4 v[94:97], v1, s[32:35], s42 offen offset:256 nt
  s_add_u32 s42, s40, 3072
  buffer_load_dwordx4 v[98:101], v1, s[32:35], s42 offen offset:0 nt
  buffer_load_dwordx4 v[102:105], v1, s[32:35], s42 offen offset:128 nt
  buffer_load_dwordx4 v[106:109], v1, s[32:35], s42 offen offset:256 nt
  s_add_u32 s42, s40, 6144
  buffer_load_dwordx4 v[110:113], v1, s[32:35], s42 offen offset:0 nt
  buffer_load_dwordx4 v[114:117], v1, s[32:35], s42 offen offset:128 nt
  buffer_load_dwordx4 v[118:121], v1, s[32:35], s42 offen offset:256 nt
  s_add_u32 s42, s40, 9216
  buffer_load_dwordx4 v[122:125], v1, s[32:35], s42 offen offset:0 nt
  buffer_load_dwordx4 v[126:129], v1, s[32:35], s42 offen offset:128 nt
  buffer_load_dwordx4 v[130:133], v1, s[32:35], s42 offen offset:256 nt
  s_add_u32 s42, s40, 0
  buffer_load_dwordx4 v[134:137], v2, s[36:39], s42 offen offset:0 nt
  buffer_load_dwordx4 v[138:141], v2, s[36:39], s42 offen offset:384 nt
  buffer_load_dwordx4 v[142:145], v3, s[36:39], s42 offen offset:0 nt
  s_add_u32 s42, s40, 3072
  buffer_load_dwordx4 v[146:149], v2, s[36:39], s42 offen offset:0 nt
  buffer_load_dwordx4 v[150:153], v2, s[36:39], s42 offen offset:384 nt
  buffer_load_dwordx4 v[154:157], v3, s[36:39], s42 offen offset:0 nt
  s_add_u32 s42, s40, 6144
  buffer_load_dwordx4 v[158:161], v2, s[36:39], s42 offen offset:0 nt
  buffer_load_dwordx4 v[162:165], v2, s[36:39], s42 offen offset:384 nt
  buffer_load_dwordx4 v[166:169], v3, s[36:39], s42 offen offset:0 nt
  s_add_u32 s42, s40, 9216
  buffer_load_dwordx4 v[170:173], v2, s[36:39], s42 offen offset:0 nt
  buffer_load_dwordx4 v[174:177], v2, s[36:39], s42 offen offset:384 nt
  buffer_load_dwordx4 v[178:181], v3, s[36:39], s42 offen offset:0 nt
  v_mov_b32 v85, 163808
  s_mov_b32 s65, 3200000
L_w2flag_219:
  ds_read_b96 v[32:34], v85
  s_sub_u32 s65, s65, 1
  s_cbranch_scc1 L_abort
  s_waitcnt lgkmcnt(0)
  v_and_b32 v32, v32, v33
  v_and_b32 v32, v32, v34
  v_cmp_ne_u32 vcc, 1, v32
  s_cbranch_vccnz L_w2flag_219
  v_and_b32 v32, 15, v0
  v_lshrrev_b32 v33, 4, v0
  v_lshrrev_b32 v34, 2, v32
  v_and_b32 v35, 3, v32
  v_lshl_add_u32 v36, v33, 3, v34
  v_mul_u32_u24 v36, 160, v36
  v_lshl_add_u32 v39, v35, 3, v36
  v_add_u32 v38, 35840, v39
  ds_read_b64_tr_b16 a[120:121], v38 offset:0
  ds_read_b64_tr_b16 a[122:123], v38 offset:640
  ds_read_b64_tr_b16 a[124:125], v38 offset:5120
  ds_read_b64_tr_b16 a[126:127], v38 offset:5760
  ds_read_b64_tr_b16 a[144:145], v38 offset:32
  ds_read_b64_tr_b16 a[146:147], v38 offset:672
  ds_read_b64_tr_b16 a[148:149], v38 offset:5152
  ds_read_b64_tr_b16 a[150:151], v38 offset:5792
  ds_read_b64_tr_b16 a[168:169], v38 offset:64
  ds_read_b64_tr_b16 a[170:171], v38 offset:704
  s_waitcnt lgkmcnt(4)
  ds_read_b64_tr_b16 a[172:173], v38 offset:5184
  ds_read_b64_tr_b16 a[174:175], v38 offset:5824
  ds_read_b64_tr_b16 a[192:193], v38 offset:96
  ds_read_b64_tr_b16 a[194:195], v38 offset:736
  ds_read_b64_tr_b16 a[196:197], v38 offset:5216
  ds_read_b64_tr_b16 a[198:199], v38 offset:5856
  ds_read_b64_tr_b16 a[216:217], v38 offset:128
  ds_read_b64_tr_b16 a[218:219], v38 offset:768
  s_waitcnt lgkmcnt(4)
  ds_read_b64_tr_b16 a[220:221], v38 offset:5248
  ds_read_b64_tr_b16 a[222:223], v38 offset:5888
  v_add_u32 v38, 87040, v39
  ds_read_b64_tr_b16 a[128:129], v38 offset:0
  ds_read_b64_tr_b16 a[130:131], v38 offset:640
  ds_read_b64_tr_b16 a[132:133], v38 offset:5120
  ds_read_b64_tr_b16 a[134:135], v38 offset:5760
  ds_read_b64_tr_b16 a[152:153], v38 offset:32
  ds_read_b64_tr_b16 a[154:155], v38 offset:672
  s_waitcnt lgkmcnt(4)
  ds_read_b64_tr_b16 a[156:157], v38 offset:5152
  ds_read_b64_tr_b16 a[158:159], v38 offset:5792
  ds_read_b64_tr_b16 a[176:177], v38 offset:64
  ds_read_b64_tr_b16 a[178:179], v38 offset:704
  ds_read_b64_tr_b16 a[180:181], v38 offset:5184
  ds_read_b64_tr_b16 a[182:183], v38 offset:5824
  ds_read_b64_tr_b16 a[200:201], v38 offset:96
  ds_read_b64_tr_b16 a[202:203], v38 offset:736
  s_waitcnt lgkmcnt(4)
  ds_read_b64_tr_b16 a[204:205], v38 offset:5216
  ds_read_b64_tr_b16 a[206:207], v38 offset:5856
  ds_read_b64_tr_b16 a[224:225], v38 offset:128
  ds_read_b64_tr_b16 a[226:227], v38 offset:768
  ds_read_b64_tr_b16 a[228:229], v38 offset:5248
  ds_read_b64_tr_b16 a[230:231], v38 offset:5888
  v_add_u32 v38, 138240, v39
  ds_read_b64_tr_b16 a[136:137], v38 offset:0
  ds_read_b64_tr_b16 a[138:139], v38 offset:640
  s_waitcnt lgkmcnt(4)
  ds_read_b64_tr_b16 a[140:141], v38 offset:5120
  ds_read_b64_tr_b16 a[142:143], v38 offset:5760
  ds_read_b64_tr_b16 a[160:161], v38 offset:32
  ds_read_b64_tr_b16 a[162:163], v38 offset:672
  ds_read_b64_tr_b16 a[164:165], v38 offset:5152
  ds_read_b64_tr_b16 a[166:167], v38 offset:5792
  ds_read_b64_tr_b16 a[184:185], v38 offset:64
  ds_read_b64_tr_b16 a[186:187], v38 offset:704
  s_waitcnt lgkmcnt(4)
  ds_read_b64_tr_b16 a[188:189], v38 offset:5184
  ds_read_b64_tr_b16 a[190:191], v38 offset:5824
  ds_read_b64_tr_b16 a[208:209], v38 offset:96
  ds_read_b64_tr_b16 a[210:211], v38 offset:736
  ds_read_b64_tr_b16 a[212:213], v38 offset:5216
  ds_read_b64_tr_b16 a[214:215], v38 offset:5856
  ds_read_b64_tr_b16 a[232:233], v38 offset:128
  ds_read_b64_tr_b16 a[234:235], v38 offset:768
  s_waitcnt lgkmcnt(4)
  ds_read_b64_tr_b16 a[236:237], v38 offset:5248
  ds_read_b64_tr_b16 a[238:239], v38 offset:5888
  v_lshl_add_u32 v36, v33, 3, v34
  v_and_b32 v36, 15, v36
  v_mul_u32_u24 v36, 160, v36
  v_lshrrev_b32 v38, 1, v33
  v_mul_u32_u24 v38, 51200, v38
  v_add_u32 v38, v38, v36
  v_lshl_add_u32 v38, v35, 3, v38
  v_add_u32 v38, 46080, v38
  ds_read_b64_tr_b16 a[240:241], v38 offset:0
  ds_read_b64_tr_b16 a[242:243], v38 offset:640
  ds_read_b64_tr_b16 a[244:245], v38 offset:32
  ds_read_b64_tr_b16 a[246:247], v38 offset:672
  ds_read_b64_tr_b16 a[248:249], v38 offset:64
  ds_read_b64_tr_b16 a[250:251], v38 offset:704
  s_waitcnt lgkmcnt(4)
  ds_read_b64_tr_b16 a[252:253], v38 offset:96
  ds_read_b64_tr_b16 a[254:255], v38 offset:736
  ds_read_b64_tr_b16 v[182:183], v38 offset:128
  ds_read_b64_tr_b16 v[184:185], v38 offset:768
  v_lshl_add_u32 v36, v33, 2, v34
  v_mul_u32_u24 v36, 160, v36
  v_lshl_add_u32 v39, v35, 3, v36
  v_add_u32 v39, 148480, v39
  ds_read_b64_tr_b16 v[186:187], v39 offset:0
  ds_read_b64_tr_b16 v[188:189], v39 offset:32
  ds_read_b64_tr_b16 v[190:191], v39 offset:64
  ds_read_b64_tr_b16 v[192:193], v39 offset:96
  s_waitcnt lgkmcnt(4)
  ds_read_b64_tr_b16 v[194:195], v39 offset:128
  s_waitcnt lgkmcnt(0)
  v_mov_b32 v32, 163820
  v_mov_b32 v33, 1
  ds_write_b32 v32, v33
  v_and_b32 v84, 31, v0
  v_lshlrev_b32 v84, 4, v84
  v_lshrrev_b32 v85, 5, v0
  v_lshl_add_u32 v84, v85, 9, v84
  s_mov_b32 vcc_lo, 0x000fffff
  s_mov_b32 vcc_hi, 0x00000000
  v_cndmask_b32 v4, v74, v84, vcc
  s_mov_b32 vcc_lo, 0x00ffffff
  s_mov_b32 vcc_hi, 0x00000000
  v_cndmask_b32 v79, v74, v84, vcc
  v_lshrrev_b32 v84, 4, v0
  v_and_b32 v85, 15, v0
  v_lshlrev_b32 v72, 10, v84
  v_lshl_add_u32 v72, v85, 4, v72
  v_add_u32 v72, 0, v72
  v_lshlrev_b32 v73, 15, v84
  v_bfe_u32 v85, v0, 2, 2
  v_lshl_add_u32 v73, v85, 10, v73
  v_and_b32 v85, 3, v0
  v_lshl_add_u32 v73, v85, 4, v73
  v_add_u32 v73, 256, v73
  v_lshrrev_b32 v85, 5, v0
  v_and_b32 v84, 7, v0
  v_lshlrev_b32 v84, 10, v84
  v_lshl_add_u32 v84, v85, 9, v84
  v_add_u32 v84, 384, v84
  s_mov_b32 vcc_lo, 0xffffffff
  s_mov_b32 vcc_hi, 0x00000000
  v_cndmask_b32 v80, v74, v84, vcc
  v_and_b32 v84, 15, v0
  v_lshrrev_b32 v85, 4, v0
  v_lshlrev_b32 v6, 9, v84
  v_lshl_add_u32 v7, v85, 5, v6
  v_add_u32 v81, 384, v6
  v_lshl_add_u32 v6, v85, 4, v6
  v_lshlrev_b32 v8, 18, v84
  v_add_u32 v82, 768, v8
  v_lshl_add_u32 v8, v85, 4, v8
  s_mov_b32 vcc_lo, 0x00010001
  s_mov_b32 vcc_hi, 0x00010001
  v_cndmask_b32 v6, v74, v6, vcc
  v_cndmask_b32 v7, v74, v7, vcc
  s_mov_b32 vcc_lo, 0x00000001
  s_mov_b32 vcc_hi, 0x00000000
  v_cndmask_b32 v81, v74, v81, vcc
  s_mov_b32 vcc_lo, 0x00010001
  s_mov_b32 vcc_hi, 0x00010001
  v_cndmask_b32 v8, v74, v8, vcc
  s_mov_b32 vcc_lo, 0x00000001
  s_mov_b32 vcc_hi, 0x00000000
  v_cndmask_b32 v82, v74, v82, vcc
  v_and_b32 v34, 7, v0
  s_lshl_b32 s67, s30, 3
  v_add_u32 v38, s67, v34
  v_lshlrev_b32 v35, 3, v34
  s_lshl_b32 s66, s29, 6
  s_add_u32 s66, s66, s28
  v_add_u32 v36, s66, v35
  v_lshlrev_b32 v35, 6, v34
  s_add_u32 s66, s67, s28
  v_add_u32 v37, s66, v35
  s_mov_b32 vcc_lo, 0x00000f00
  s_mov_b32 vcc_hi, 0
  v_cndmask_b32 v36, v36, v37, vcc
  s_mov_b32 vcc_lo, 0x00ff0000
  v_cndmask_b32 v36, v36, v38, vcc
  v_bfe_u32 v35, v0, 3, 2
  v_lshlrev_b32 v35, 6, v35
  v_add_u32 v38, v38, v35
  s_mov_b32 vcc_lo, 0
  s_mov_b32 vcc_hi, -1
  v_cndmask_b32 v36, v36, v38, vcc
  v_lshlrev_b32 v70, 7, v36
  s_mov_b32 s64, 5537792
  s_mov_b32 exec_lo, 0x00000fff
  s_mov_b32 exec_hi, 0x00000000
  buffer_load_dwordx2 v[68:69], v70, s[48:51], s64 offen sc1
  s_mov_b64 exec, -1
  s_waitcnt lgkmcnt(0)
  s_barrier
  v_mbcnt_lo_u32_b32 v57, -1, 0
  v_mbcnt_hi_u32_b32 v57, -1, v57
  v_and_b32 v58, 1, v57
  v_lshrrev_b32 v59, 4, v57
  v_lshlrev_b32 v59, 4, v59
  v_lshl_add_u32 v58, v58, 6, v59
  v_add_u32 v58, 159808, v58
  v_add_u32 v63, s69, v59
  v_lshrrev_b32 v59, 5, v57
  v_lshlrev_b32 v62, 6, v59
  v_bfe_u32 v59, v57, 1, 2
  v_lshl_add_u32 v62, v59, 4, v62
  v_bfe_u32 v59, v57, 3, 2
  v_lshl_add_u32 v62, v59, 2, v62
  v_and_b32 v59, 1, v57
  v_lshl_add_u32 v62, v59, 1, v62
  v_add_u32 v62, s69, v62
  v_mov_b32 v56, 0xff800000
  ds_read_b128 v[32:35], v58 offset:0
  ds_read_b128 v[36:39], v58 offset:128
  ds_read_b128 v[40:43], v58 offset:256
  s_waitcnt lgkmcnt(0)
  s_waitcnt vmcnt(22)
  v_mfma_f32_16x16x32_bf16 v[44:47], v[32:35], v[86:89], 0
  v_mfma_f32_16x16x32_bf16 v[44:47], v[36:39], v[90:93], v[44:47]
  v_mfma_f32_16x16x32_bf16 v[44:47], v[40:43], v[94:97], v[44:47]
  s_waitcnt vmcnt(19)
  v_mfma_f32_16x16x32_bf16 v[48:51], v[32:35], v[98:101], 0
  v_mfma_f32_16x16x32_bf16 v[48:51], v[36:39], v[102:105], v[48:51]
  v_mfma_f32_16x16x32_bf16 v[48:51], v[40:43], v[106:109], v[48:51]
  s_waitcnt vmcnt(16)
  v_mfma_f32_16x16x32_bf16 v[52:55], v[32:35], v[110:113], 0
  v_mfma_f32_16x16x32_bf16 v[52:55], v[36:39], v[114:117], v[52:55]
  v_mfma_f32_16x16x32_bf16 v[52:55], v[40:43], v[118:121], v[52:55]
  v_add_f32_dpp v56, v45, v44 row_ror:8 row_mask:0x1 bank_mask:0x3
  s_waitcnt vmcnt(13)
  v_mfma_f32_16x16x32_bf16 v[44:47], v[32:35], v[122:125], 0
  v_mfma_f32_16x16x32_bf16 v[44:47], v[36:39], v[126:129], v[44:47]
  v_mfma_f32_16x16x32_bf16 v[44:47], v[40:43], v[130:133], v[44:47]
  v_add_f32_dpp v56, v48, v49 row_ror:8 row_mask:0x1 bank_mask:0xc
  s_nop 1
  v_add_f32_dpp v56, v53, v52 row_ror:8 row_mask:0x2 bank_mask:0x3
  s_nop 3
  v_add_f32_dpp v56, v44, v45 row_ror:8 row_mask:0x2 bank_mask:0xc
  v_mov_b32 v44, v56
  s_nop 1
  v_max_f32_dpp v44, v44, v44 row_ror:8 row_mask:0xf bank_mask:0xf
  s_nop 1
  v_max_f32_dpp v44, v44, v44 row_ror:4 row_mask:0xf bank_mask:0xf
  s_nop 1
  v_max_f32_dpp v44, v44, v44 row_ror:2 row_mask:0xf bank_mask:0xf
  s_nop 1
  v_max_f32_dpp v44, v44, v44 row_ror:1 row_mask:0xf bank_mask:0xf
  v_mov_b32 v45, v44
  s_nop 1
  v_permlane16_swap_b32 v44, v45
  v_max_f32 v44, v44, v45
  v_mov_b32 v45, v44
  s_nop 1
  v_permlane32_swap_b32 v44, v45
  v_max_f32 v44, v44, v45
  v_mul_f32 v60, s56, v44
  v_fma_f32 v56, v56, s56, -v60
  v_exp_f32 v56, v56
  s_nop 0
  v_cvt_pk_bf16_f32 v46, v56, v56
  ds_write_b16 v62, v46 offset:0
  v_mov_b32 v61, v56
  ds_read_b128 v[52:55], v63
  s_nop 0
  v_add_f32_dpp v61, v61, v61 row_ror:8 row_mask:0xf bank_mask:0xf
  s_nop 1
  v_add_f32_dpp v61, v61, v61 row_ror:4 row_mask:0xf bank_mask:0xf
  s_nop 1
  v_add_f32_dpp v61, v61, v61 row_ror:2 row_mask:0xf bank_mask:0xf
  s_nop 1
  v_add_f32_dpp v61, v61, v61 row_ror:1 row_mask:0xf bank_mask:0xf
  v_mov_b32 v59, v61
  s_nop 1
  v_permlane16_swap_b32 v61, v59
  v_add_f32 v61, v61, v59
  v_mov_b32 v59, v61
  s_nop 1
  v_permlane32_swap_b32 v61, v59
  v_add_f32 v61, v61, v59
  s_waitcnt lgkmcnt(0)
  v_perm_b32 v44, v52, v52, v75
  v_perm_b32 v45, v52, v52, v76
  v_perm_b32 v46, v52, v52, v77
  v_perm_b32 v47, v52, v52, v78
  s_waitcnt vmcnt(12)
  s_nop 0
  v_mfma_f32_16x16x32_bf16 v[32:35], v[44:47], v[134:137], 0
  v_perm_b32 v48, v53, v53, v75
  v_perm_b32 v49, v53, v53, v76
  s_waitcnt vmcnt(11)
  v_mfma_f32_16x16x32_bf16 v[36:39], v[44:47], v[138:141], 0
  v_perm_b32 v50, v53, v53, v77
  v_perm_b32 v51, v53, v53, v78
  s_waitcnt vmcnt(10)
  v_mfma_f32_16x16x32_bf16 v[40:43], v[44:47], v[142:145], 0
  s_waitcnt vmcnt(9)
  v_mfma_f32_16x16x32_bf16 v[32:35], v[48:51], v[146:149], v[32:35]
  v_perm_b32 v44, v54, v54, v75
  v_perm_b32 v45, v54, v54, v76
  s_waitcnt vmcnt(8)
  v_mfma_f32_16x16x32_bf16 v[36:39], v[48:51], v[150:153], v[36:39]
  v_perm_b32 v46, v54, v54, v77
  v_perm_b32 v47, v54, v54, v78
  s_waitcnt vmcnt(7)
  v_mfma_f32_16x16x32_bf16 v[40:43], v[48:51], v[154:157], v[40:43]
  s_waitcnt vmcnt(6)
  v_mfma_f32_16x16x32_bf16 v[32:35], v[44:47], v[158:161], v[32:35]
  v_perm_b32 v48, v55, v55, v75
  v_perm_b32 v49, v55, v55, v76
  s_waitcnt vmcnt(5)
  v_mfma_f32_16x16x32_bf16 v[36:39], v[44:47], v[162:165], v[36:39]
  v_perm_b32 v50, v55, v55, v77
  v_perm_b32 v51, v55, v55, v78
  s_waitcnt vmcnt(4)
  v_mfma_f32_16x16x32_bf16 v[40:43], v[44:47], v[166:169], v[40:43]
  s_waitcnt vmcnt(3)
  v_mfma_f32_16x16x32_bf16 v[32:35], v[48:51], v[170:173], v[32:35]
  s_waitcnt vmcnt(2)
  v_mfma_f32_16x16x32_bf16 v[36:39], v[48:51], v[174:177], v[36:39]
  s_waitcnt vmcnt(1)
  v_mfma_f32_16x16x32_bf16 v[40:43], v[48:51], v[178:181], v[40:43]
  v_mbcnt_lo_u32_b32 v52, -1, 0
  v_mbcnt_hi_u32_b32 v52, -1, v52
  v_and_b32 v53, 15, v52
  v_lshrrev_b32 v54, 4, v52
  v_and_b32 v55, 1, v54
  v_lshrrev_b32 v54, 1, v54
  v_mul_u32_u24 v54, 768, v54
  v_lshl_add_u32 v54, v55, 4, v54
  v_add_u32 v54, s69, v54
  v_lshl_add_u32 v56, v53, 5, v54
  v_and_b32 v53, 7, v53
  v_lshl_add_u32 v57, v53, 5, v54
  v_mov_b32 v58, s72
  v_mov_b32 v44, v60
  v_mov_b32 v45, v61
  v_cndmask_b32 v32, v32, v36, s[70:71]
  v_cndmask_b32 v33, v33, v37, s[70:71]
  v_cndmask_b32 v34, v34, v38, s[70:71]
  v_cndmask_b32 v35, v35, v39, s[70:71]
  ds_write_b128 v56, v[32:35]
  s_mov_b32 exec_lo, 0x00ff00ff
  s_mov_b32 exec_hi, 0xff00ff00
  ds_write_b128 v57, v[40:43] offset:512
  s_mov_b64 exec, 1
  ds_write_b64 v58, v[44:45] offset:0
  s_mov_b64 exec, -1
  s_waitcnt lgkmcnt(0)
  s_mov_b32 s63, 5537792
  s_mov_b32 exec_lo, 0x00000fff
  s_mov_b32 exec_hi, 0x00000000
  s_mov_b32 s65, 400000
  s_branch L_tokchk_221
L_tok_220:
  buffer_load_dwordx2 v[68:69], v70, s[48:51], s63 offen sc1
  s_sub_u32 s65, s65, 1
  s_cbranch_scc1 L_abort
L_tokchk_221:
  s_waitcnt vmcnt(0)
  v_cmp_ne_u32 vcc, s73, v68
  s_cbranch_vccnz L_tok_220
  s_mov_b64 exec, -1
  s_barrier
  v_mov_b32 v84, 159744
  ds_read_b128 v[32:35], v84
  ds_read_b128 v[36:39], v84 offset:16
  v_add_u32 v85, 153600, v83
  ds_read_b128 v[40:43], v85 offset:0
  ds_read_b128 v[44:47], v85 offset:768
  ds_read_b128 v[48:51], v85 offset:1536
  ds_read_b128 v[52:55], v85 offset:2304
  ds_read_b128 v[56:59], v85 offset:3072
  ds_read_b128 v[60:63], v85 offset:3840
  ds_read_b128 v[64:67], v85 offset:4608
  ds_read_b128 v[68:71], v85 offset:5376
  s_add_u32 s63, s57, 0
  s_waitcnt lgkmcnt(8)
  v_max3_f32 v84, v32, v34, v36
  v_max_f32 v84, v84, v38
  v_sub_f32 v32, v32, v84
  v_sub_f32 v34, v34, v84
  v_sub_f32 v36, v36, v84
  v_sub_f32 v38, v38, v84
  v_exp_f32 v32, v32
  v_exp_f32 v34, v34
  v_exp_f32 v36, v36
  v_exp_f32 v38, v38
  v_mul_f32 v85, v32, v33
  v_fma_f32 v85, v34, v35, v85
  v_fma_f32 v85, v36, v37, v85
  v_fma_f32 v85, v38, v39, v85
  s_waitcnt lgkmcnt(6)
  v_pk_add_f32 v[40:41], v[40:41], v[44:45]
  v_pk_add_f32 v[42:43], v[42:43], v[46:47]
  v_mul_f32 v40, v32, v40
  v_mul_f32 v41, v32, v41
  v_mul_f32 v42, v32, v42
  v_mul_f32 v43, v32, v43
  s_waitcnt lgkmcnt(4)
  v_pk_add_f32 v[48:49], v[48:49], v[52:53]
  v_pk_add_f32 v[50:51], v[50:51], v[54:55]
  v_fmac_f32 v40, v34, v48
  v_fmac_f32 v41, v34, v49
  v_fmac_f32 v42, v34, v50
  v_fmac_f32 v43, v34, v51
  s_waitcnt lgkmcnt(2)
  v_pk_add_f32 v[56:57], v[56:57], v[60:61]
  v_pk_add_f32 v[58:59], v[58:59], v[62:63]
  v_fmac_f32 v40, v36, v56
  v_fmac_f32 v41, v36, v57
  v_fmac_f32 v42, v36, v58
  v_fmac_f32 v43, v36, v59
  s_waitcnt lgkmcnt(0)
  v_pk_add_f32 v[64:65], v[64:65], v[68:69]
  v_pk_add_f32 v[66:67], v[66:67], v[70:71]
  v_fmac_f32 v40, v38, v64
  v_fmac_f32 v41, v38, v65
  v_fmac_f32 v42, v38, v66
  v_fmac_f32 v43, v38, v67
  s_mov_b32 vcc_lo, 0
  s_mov_b32 vcc_hi, 0x00010000
  v_cndmask_b32 v40, v40, v84, vcc
  v_cndmask_b32 v41, v41, v85, vcc
  buffer_store_dwordx4 v[40:43], v5, s[48:51], s63 offen offset:0 sc1
  s_add_u32 s100, s58, 0
  s_add_u32 s101, s100, 4096
  s_mov_b32 s65, 400000
L_fpoll_222:
  buffer_load_dwordx4 v[64:67], v31, s[48:51], s100 offen offset:0 sc1
  buffer_load_dwordx4 v[32:35], v5, s[48:51], s100 offen offset:0 sc1
  buffer_load_dwordx4 v[36:39], v5, s[48:51], s100 offen offset:1024 sc1
  buffer_load_dwordx4 v[40:43], v5, s[48:51], s100 offen offset:2048 sc1
  buffer_load_dwordx4 v[44:47], v5, s[48:51], s100 offen offset:3072 sc1
  buffer_load_dwordx4 v[48:51], v5, s[48:51], s101 offen offset:0 sc1
  buffer_load_dwordx4 v[52:55], v5, s[48:51], s101 offen offset:1024 sc1
  buffer_load_dwordx4 v[56:59], v5, s[48:51], s101 offen offset:2048 sc1
  buffer_load_dwordx4 v[60:63], v5, s[48:51], s101 offen offset:3072 sc1
  s_sub_u32 s65, s65, 1
  s_cbranch_scc1 L_abort
  s_waitcnt vmcnt(8)
  v_max_u32 v84, v65, v67
  v_mov_b32 v66, v64
  s_nop 1
  v_max_f32_dpp v66, v66, v66 quad_perm:[1,0,3,2] row_mask:0xf bank_mask:0xf
  s_nop 1
  v_max_f32_dpp v66, v66, v66 quad_perm:[2,3,0,1] row_mask:0xf bank_mask:0xf
  s_nop 1
  v_max_f32_dpp v66, v66, v66 row_half_mirror row_mask:0xf bank_mask:0xf
  v_sub_f32 v67, v64, v66
  v_exp_f32 v67, v67
  s_waitcnt vmcnt(4)
  v_max3_u32 v84, v84, v33, v35
  v_max3_u32 v84, v84, v37, v39
  v_mul_f32 v65, v67, v65
  v_max3_u32 v84, v84, v41, v43
  v_max3_u32 v84, v84, v45, v47
  v_add_f32_dpp v65, v65, v65 quad_perm:[1,0,3,2] row_mask:0xf bank_mask:0xf
  s_waitcnt vmcnt(0)
  v_max3_u32 v84, v84, v49, v51
  v_max3_u32 v84, v84, v53, v55
  v_add_f32_dpp v65, v65, v65 quad_perm:[2,3,0,1] row_mask:0xf bank_mask:0xf
  v_max3_u32 v84, v84, v57, v59
  v_max3_u32 v84, v84, v61, v63
  v_add_f32_dpp v65, v65, v65 row_half_mirror row_mask:0xf bank_mask:0xf
  v_rcp_f32 v65, v65
  s_nop 0
  v_mul_f32 v67, v67, v65
  s_nop 0
  v_readlane_b32 s4, v67, 0
  v_readlane_b32 s6, v67, 1
  v_readlane_b32 s8, v67, 2
  v_readlane_b32 s10, v67, 3
  v_readlane_b32 s12, v67, 4
  v_readlane_b32 s16, v67, 5
  v_readlane_b32 s18, v67, 6
  v_readlane_b32 s20, v67, 7
  v_pk_mul_f32 v[68:69], v[32:33], s[4:5] op_sel_hi:[1,0]
  v_pk_mul_f32 v[70:71], v[34:35], s[4:5] op_sel_hi:[1,0]
  v_pk_fma_f32 v[68:69], v[36:37], s[6:7], v[68:69] op_sel_hi:[1,0,1]
  v_pk_fma_f32 v[70:71], v[38:39], s[6:7], v[70:71] op_sel_hi:[1,0,1]
  v_pk_fma_f32 v[68:69], v[40:41], s[8:9], v[68:69] op_sel_hi:[1,0,1]
  v_pk_fma_f32 v[70:71], v[42:43], s[8:9], v[70:71] op_sel_hi:[1,0,1]
  v_pk_fma_f32 v[68:69], v[44:45], s[10:11], v[68:69] op_sel_hi:[1,0,1]
  v_pk_fma_f32 v[70:71], v[46:47], s[10:11], v[70:71] op_sel_hi:[1,0,1]
  v_pk_fma_f32 v[68:69], v[48:49], s[12:13], v[68:69] op_sel_hi:[1,0,1]
  v_pk_fma_f32 v[70:71], v[50:51], s[12:13], v[70:71] op_sel_hi:[1,0,1]
  v_pk_fma_f32 v[68:69], v[52:53], s[16:17], v[68:69] op_sel_hi:[1,0,1]
  v_pk_fma_f32 v[70:71], v[54:55], s[16:17], v[70:71] op_sel_hi:[1,0,1]
  v_pk_fma_f32 v[68:69], v[56:57], s[18:19], v[68:69] op_sel_hi:[1,0,1]
  v_pk_fma_f32 v[70:71], v[58:59], s[18:19], v[70:71] op_sel_hi:[1,0,1]
  v_pk_fma_f32 v[68:69], v[60:61], s[20:21], v[68:69] op_sel_hi:[1,0,1]
  v_pk_fma_f32 v[70:71], v[62:63], s[20:21], v[70:71] op_sel_hi:[1,0,1]
  v_cmp_eq_u32 vcc, -1, v84
  s_cbranch_vccnz L_fpoll_222
  v_cvt_pk_bf16_f32 v68, v68, v69
  v_cvt_pk_bf16_f32 v69, v70, v71
  ds_write_b64 v28, v[68:69] offset:6976
  ds_read_b128 v[32:35], v9 offset:0
  ds_read_b128 v[36:39], v9 offset:64
  ds_read_b128 v[40:43], v9 offset:128
  ds_read_b128 v[44:47], v9 offset:192
  ds_read_b128 v[48:51], v9 offset:256
  ds_read_b128 v[52:55], v9 offset:320
  s_add_u32 s63, s59, 3407872
  v_and_b32 v56, 7, v0
  s_lshl_b32 s67, s30, 3
  v_add_u32 v60, s67, v56
  v_mov_b32 v58, v60
  v_bfe_u32 v57, v0, 3, 2
  v_lshlrev_b32 v57, 6, v57
  v_add_u32 v60, v60, v57
  s_mov_b32 vcc_lo, 0
  s_mov_b32 vcc_hi, -1
  v_cndmask_b32 v58, v58, v60, vcc
  v_lshlrev_b32 v70, 7, v58
  s_mov_b32 s64, 5537792
  s_mov_b32 exec_lo, 0x00ff0000
  s_mov_b32 exec_hi, 0xffffffff
  buffer_load_dwordx2 v[68:69], v70, s[48:51], s64 offen sc1
  s_mov_b64 exec, -1
  s_waitcnt lgkmcnt(5)
  v_mfma_f32_16x16x32_bf16 v[56:59], a[120:123], v[32:35], 0
  s_waitcnt lgkmcnt(4)
  v_mfma_f32_16x16x32_bf16 v[56:59], a[124:127], v[36:39], v[56:59]
  s_waitcnt lgkmcnt(3)
  v_mfma_f32_16x16x32_bf16 v[56:59], a[128:131], v[40:43], v[56:59]
  s_waitcnt lgkmcnt(2)
  v_mfma_f32_16x16x32_bf16 v[56:59], a[132:135], v[44:47], v[56:59]
  s_waitcnt lgkmcnt(1)
  v_mfma_f32_16x16x32_bf16 v[56:59], a[136:139], v[48:51], v[56:59]
  s_waitcnt lgkmcnt(0)
  v_mfma_f32_16x16x32_bf16 v[56:59], a[140:143], v[52:55], v[56:59]
  v_mfma_f32_16x16x32_bf16 v[60:63], a[144:147], v[32:35], 0
  v_mfma_f32_16x16x32_bf16 v[60:63], a[148:151], v[36:39], v[60:63]
  v_mfma_f32_16x16x32_bf16 v[60:63], a[152:155], v[40:43], v[60:63]
  v_mfma_f32_16x16x32_bf16 v[60:63], a[156:159], v[44:47], v[60:63]
  v_mfma_f32_16x16x32_bf16 v[60:63], a[160:163], v[48:51], v[60:63]
  v_mfma_f32_16x16x32_bf16 v[60:63], a[164:167], v[52:55], v[60:63]
  v_mfma_f32_16x16x32_bf16 v[64:67], a[168:171], v[32:35], 0
  v_mfma_f32_16x16x32_bf16 v[64:67], a[172:175], v[36:39], v[64:67]
  v_mfma_f32_16x16x32_bf16 v[64:67], a[176:179], v[40:43], v[64:67]
  v_mfma_f32_16x16x32_bf16 v[64:67], a[180:183], v[44:47], v[64:67]
  v_mfma_f32_16x16x32_bf16 v[64:67], a[184:187], v[48:51], v[64:67]
  v_mfma_f32_16x16x32_bf16 v[64:67], a[188:191], v[52:55], v[64:67]
  buffer_store_dwordx4 v[56:59], v6, s[48:51], s63 offen offset:0 sc1
  s_nop 1
  v_mfma_f32_16x16x32_bf16 v[56:59], a[192:195], v[32:35], 0
  v_mfma_f32_16x16x32_bf16 v[56:59], a[196:199], v[36:39], v[56:59]
  v_mfma_f32_16x16x32_bf16 v[56:59], a[200:203], v[40:43], v[56:59]
  v_mfma_f32_16x16x32_bf16 v[56:59], a[204:207], v[44:47], v[56:59]
  v_mfma_f32_16x16x32_bf16 v[56:59], a[208:211], v[48:51], v[56:59]
  v_mfma_f32_16x16x32_bf16 v[56:59], a[212:215], v[52:55], v[56:59]
  buffer_store_dwordx4 v[60:63], v6, s[48:51], s63 offen offset:64 sc1
  s_nop 1
  v_mfma_f32_16x16x32_bf16 v[60:63], a[216:219], v[32:35], 0
  v_mfma_f32_16x16x32_bf16 v[60:63], a[220:223], v[36:39], v[60:63]
  v_mfma_f32_16x16x32_bf16 v[60:63], a[224:227], v[40:43], v[60:63]
  v_mfma_f32_16x16x32_bf16 v[60:63], a[228:231], v[44:47], v[60:63]
  v_mfma_f32_16x16x32_bf16 v[60:63], a[232:235], v[48:51], v[60:63]
  v_mfma_f32_16x16x32_bf16 v[60:63], a[236:239], v[52:55], v[60:63]
  buffer_store_dwordx4 v[64:67], v6, s[48:51], s63 offen offset:128 sc1
  buffer_store_dwordx4 v[56:59], v6, s[48:51], s63 offen offset:192 sc1
  s_nop 5
  buffer_store_dwordx4 v[60:63], v6, s[48:51], s63 offen offset:256 sc1
  s_waitcnt vmcnt(5)
  s_mov_b32 exec_lo, 0x00ff0000
  s_mov_b32 exec_hi, 0xffffffff
  v_cmp_ne_u32 vcc, s73, v68
  s_cbranch_vccz L_tok2ok_223
  s_mov_b32 s65, 400000
L_tok2re_224:
  buffer_load_dwordx2 v[68:69], v70, s[48:51], s64 offen sc1
  s_sub_u32 s65, s65, 1
  s_cbranch_scc1 L_abort
  s_waitcnt vmcnt(0)
  v_cmp_ne_u32 vcc, s73, v68
  s_cbranch_vccnz L_tok2re_224
L_tok2ok_223:
  s_mov_b64 exec, -1
  s_cmp_lg_u32 s29, 0
  s_cbranch_scc1 L_notleader_225
  s_add_u32 s100, s60, 3407872
  s_add_u32 s63, s61, 4980736
  s_mov_b32 s65, 400000
L_fpoll_226:
  buffer_load_dwordx4 v[32:35], v4, s[48:51], s100 offen offset:0 sc1
  buffer_load_dwordx4 v[36:39], v4, s[48:51], s100 offen offset:1024 sc1
  buffer_load_dwordx4 v[40:43], v4, s[48:51], s100 offen offset:2048 sc1
  buffer_load_dwordx4 v[44:47], v4, s[48:51], s100 offen offset:3072 sc1
  s_sub_u32 s65, s65, 1
  s_cbranch_scc1 L_abort
  s_waitcnt vmcnt(2)
  v_max_u32 v84, v33, v35
  v_max3_u32 v84, v84, v37, v39
  v_pk_add_f32 v[32:33], v[32:33], v[36:37]
  v_pk_add_f32 v[34:35], v[34:35], v[38:39]
  s_waitcnt vmcnt(1)
  v_max3_u32 v84, v84, v41, v43
  v_pk_add_f32 v[32:33], v[32:33], v[40:41]
  v_pk_add_f32 v[34:35], v[34:35], v[42:43]
  s_waitcnt vmcnt(0)
  v_max3_u32 v84, v84, v45, v47
  v_pk_add_f32 v[32:33], v[32:33], v[44:45]
  v_pk_add_f32 v[34:35], v[34:35], v[46:47]
  v_cmp_eq_u32 vcc, -1, v84
  s_cbranch_vccnz L_fpoll_226
  buffer_store_dwordx4 v[32:35], v4, s[48:51], s63 offen sc1
L_notleader_225:
  s_add_u32 s100, s62, 4980736
  s_add_u32 s101, s100, 4096
  s_mov_b32 s65, 400000
  s_sleep 6
L_fpoll_227:
  buffer_load_dwordx4 v[32:35], v4, s[48:51], s100 offen offset:0 sc1
  buffer_load_dwordx4 v[36:39], v4, s[48:51], s100 offen offset:1024 sc1
  buffer_load_dwordx4 v[40:43], v4, s[48:51], s100 offen offset:2048 sc1
  buffer_load_dwordx4 v[44:47], v4, s[48:51], s100 offen offset:3072 sc1
  buffer_load_dwordx4 v[48:51], v4, s[48:51], s101 offen offset:0 sc1
  buffer_load_dwordx4 v[52:55], v4, s[48:51], s101 offen offset:1024 sc1
  buffer_load_dwordx4 v[56:59], v4, s[48:51], s101 offen offset:2048 sc1
  buffer_load_dwordx4 v[60:63], v4, s[48:51], s101 offen offset:3072 sc1
  s_sub_u32 s65, s65, 1
  s_cbranch_scc1 L_abort
  s_waitcnt vmcnt(6)
  v_max_u32 v84, v33, v35
  v_max3_u32 v84, v84, v37, v39
  v_pk_add_f32 v[32:33], v[32:33], v[16:17]
  v_pk_add_f32 v[34:35], v[34:35], v[18:19]
  v_pk_add_f32 v[32:33], v[32:33], v[36:37]
  v_pk_add_f32 v[34:35], v[34:35], v[38:39]
  s_waitcnt vmcnt(4)
  v_max3_u32 v84, v84, v41, v43
  v_max3_u32 v84, v84, v45, v47
  v_pk_add_f32 v[40:41], v[40:41], v[44:45]
  v_pk_add_f32 v[42:43], v[42:43], v[46:47]
  v_pk_add_f32 v[32:33], v[32:33], v[40:41]
  v_pk_add_f32 v[34:35], v[34:35], v[42:43]
  s_waitcnt vmcnt(2)
  v_max3_u32 v84, v84, v49, v51
  v_max3_u32 v84, v84, v53, v55
  v_pk_add_f32 v[48:49], v[48:49], v[52:53]
  v_pk_add_f32 v[50:51], v[50:51], v[54:55]
  v_pk_add_f32 v[32:33], v[32:33], v[48:49]
  v_pk_add_f32 v[34:35], v[34:35], v[50:51]
  s_waitcnt vmcnt(1)
  v_max3_u32 v84, v84, v57, v59
  v_pk_add_f32 v[32:33], v[32:33], v[56:57]
  v_pk_add_f32 v[34:35], v[34:35], v[58:59]
  s_waitcnt vmcnt(0)
  v_max3_u32 v84, v84, v61, v63
  v_pk_add_f32 v[32:33], v[32:33], v[60:61]
  v_pk_add_f32 v[34:35], v[34:35], v[62:63]
  v_cmp_eq_u32 vcc, -1, v84
  s_cbranch_vccnz L_fpoll_227
  v_cvt_pk_bf16_f32 v36, v32, v33
  v_cvt_pk_bf16_f32 v37, v34, v35
  ds_write_b64 v29, v[36:37]
  ds_read_b128 v[40:43], v10
  ds_read_b128 v[44:47], v10 offset:64
  ds_read_b64 v[48:49], v11
  v_mov_b32 v50, 0
  v_mov_b32 v51, 0
  ds_read_b128 v[52:55], v14
  ds_read_b128 v[56:59], v14 offset:64
  ds_read_b64 v[60:61], v15
  v_mov_b32 v62, 0
  v_mov_b32 v63, 0
  s_add_u32 s63, s57, 2621440
  v_lshlrev_b32 v16, 16, v36
  v_and_b32 v17, 0xffff0000, v36
  v_lshlrev_b32 v18, 16, v37
  v_and_b32 v19, 0xffff0000, v37
  s_add_u32 s100, s58, 2621440
  s_add_u32 s101, s100, 4096
  s_waitcnt lgkmcnt(5)
  v_mfma_f32_16x16x32_bf16 v[64:67], v[198:201], v[40:43], 0
  s_waitcnt lgkmcnt(4)
  v_mfma_f32_16x16x32_bf16 v[64:67], v[202:205], v[44:47], v[64:67]
  s_waitcnt lgkmcnt(3)
  v_mfma_f32_16x16x32_bf16 v[64:67], v[196:199], v[48:51], v[64:67]
  v_mfma_f32_16x16x32_bf16 v[68:71], v[228:231], v[40:43], 0
  v_mfma_f32_16x16x32_bf16 v[68:71], v[232:235], v[44:47], v[68:71]
  v_mfma_f32_16x16x32_bf16 v[68:71], v[226:229], v[48:51], v[68:71]
  s_waitcnt lgkmcnt(0)
  v_mfma_f32_16x16x32_bf16 v[32:35], v[52:55], v[40:43], 0
  v_mfma_f32_16x16x32_bf16 v[32:35], v[56:59], v[44:47], v[32:35]
  v_mfma_f32_16x16x32_bf16 v[32:35], v[60:63], v[48:51], v[32:35]
  v_mfma_f32_16x16x32_bf16 v[52:55], v[208:211], v[40:43], 0
  v_mfma_f32_16x16x32_bf16 v[52:55], v[212:215], v[44:47], v[52:55]
  v_mfma_f32_16x16x32_bf16 v[52:55], v[206:209], v[48:51], v[52:55]
  v_mfma_f32_16x16x32_bf16 v[56:59], v[238:241], v[40:43], 0
  v_mfma_f32_16x16x32_bf16 v[56:59], v[242:245], v[44:47], v[56:59]
  v_mfma_f32_16x16x32_bf16 v[56:59], v[236:239], v[48:51], v[56:59]
  v_swap_b32 v66, v68
  v_swap_b32 v67, v69
  buffer_store_dwordx4 v[64:67], v7, s[48:51], s63 offen offset:0 sc1
  buffer_store_dwordx4 v[68:71], v7, s[48:51], s63 offen offset:16 sc1
  v_cndmask_b32 v33, v33, v34, s[74:75]
  v_mfma_f32_16x16x32_bf16 v[64:67], v[218:221], v[40:43], 0
  v_mfma_f32_16x16x32_bf16 v[64:67], v[222:225], v[44:47], v[64:67]
  v_mfma_f32_16x16x32_bf16 v[64:67], v[216:219], v[48:51], v[64:67]
  v_mfma_f32_16x16x32_bf16 v[68:71], v[248:251], v[40:43], 0
  v_mfma_f32_16x16x32_bf16 v[68:71], v[252:255], v[44:47], v[68:71]
  v_mfma_f32_16x16x32_bf16 v[68:71], v[246:249], v[48:51], v[68:71]
  v_swap_b32 v54, v56
  v_swap_b32 v55, v57
  buffer_store_dwordx4 v[52:55], v7, s[48:51], s63 offen offset:128 sc1
  buffer_store_dwordx4 v[56:59], v7, s[48:51], s63 offen offset:144 sc1
  s_nop 3
  v_swap_b32 v66, v68
  v_swap_b32 v67, v69
  buffer_store_dwordx4 v[64:67], v7, s[48:51], s63 offen offset:256 sc1
  buffer_store_dwordx4 v[68:71], v7, s[48:51], s63 offen offset:272 sc1
  buffer_store_dwordx4 v[32:35], v81, s[48:51], s63 offen offset:0 sc1
  s_mov_b32 s65, 400000
L_fpoll_228:
  buffer_load_dwordx4 v[64:67], v80, s[48:51], s100 offen offset:0 sc1
  buffer_load_dwordx4 v[32:35], v79, s[48:51], s100 offen offset:0 sc1
  buffer_load_dwordx4 v[36:39], v79, s[48:51], s100 offen offset:1024 sc1
  buffer_load_dwordx4 v[40:43], v79, s[48:51], s100 offen offset:2048 sc1
  buffer_load_dwordx4 v[44:47], v79, s[48:51], s100 offen offset:3072 sc1
  buffer_load_dwordx4 v[48:51], v79, s[48:51], s101 offen offset:0 sc1
  buffer_load_dwordx4 v[52:55], v79, s[48:51], s101 offen offset:1024 sc1
  buffer_load_dwordx4 v[56:59], v79, s[48:51], s101 offen offset:2048 sc1
  buffer_load_dwordx4 v[60:63], v79, s[48:51], s101 offen offset:3072 sc1
  s_sub_u32 s65, s65, 1
  s_cbranch_scc1 L_abort
  s_waitcnt vmcnt(8)
  v_max_u32 v84, v65, v67
  v_add_f32_dpp v64, v64, v64 quad_perm:[1,0,3,2] row_mask:0xf bank_mask:0xf
  v_add_f32_dpp v65, v65, v65 quad_perm:[1,0,3,2] row_mask:0xf bank_mask:0xf
  s_waitcnt vmcnt(6)
  v_max3_u32 v84, v84, v33, v35
  v_add_f32_dpp v64, v64, v64 quad_perm:[2,3,0,1] row_mask:0xf bank_mask:0xf
  v_add_f32_dpp v65, v65, v65 quad_perm:[2,3,0,1] row_mask:0xf bank_mask:0xf
  v_max3_u32 v84, v84, v37, v39
  v_add_f32_dpp v64, v64, v64 row_half_mirror row_mask:0xf bank_mask:0xf
  v_add_f32_dpp v65, v65, v65 row_half_mirror row_mask:0xf bank_mask:0xf
  v_pk_add_f32 v[32:33], v[32:33], v[36:37]
  v_pk_add_f32 v[34:35], v[34:35], v[38:39]
  v_mul_f32 v66, 0x3acccccd, v64
  v_mul_f32 v65, 0x3acccccd, v65
  s_waitcnt vmcnt(4)
  v_max3_u32 v84, v84, v41, v43
  v_max3_u32 v84, v84, v45, v47
  v_fma_f32 v65, -v66, v66, v65
  v_pk_add_f32 v[40:41], v[40:41], v[44:45]
  v_pk_add_f32 v[42:43], v[42:43], v[46:47]
  v_max_f32 v65, 0, v65
  v_add_f32 v65, 0x3727c5ac, v65
  v_pk_add_f32 v[32:33], v[32:33], v[40:41]
  v_pk_add_f32 v[34:35], v[34:35], v[42:43]
  v_rsq_f32 v67, v65
  s_waitcnt vmcnt(2)
  v_max3_u32 v84, v84, v49, v51
  v_max3_u32 v84, v84, v53, v55
  v_pk_mul_f32 v[68:69], v[24:25], v[66:67] op_sel_hi:[1,0]
  v_pk_mul_f32 v[70:71], v[26:27], v[66:67] op_sel_hi:[1,0]
  v_pk_add_f32 v[48:49], v[48:49], v[52:53]
  v_pk_add_f32 v[50:51], v[50:51], v[54:55]
  v_pk_add_f32 v[32:33], v[32:33], v[68:69] neg_lo:[0,1] neg_hi:[0,1]
  v_pk_add_f32 v[34:35], v[34:35], v[70:71] neg_lo:[0,1] neg_hi:[0,1]
  v_pk_add_f32 v[32:33], v[32:33], v[48:49]
  v_pk_add_f32 v[34:35], v[34:35], v[50:51]
  s_waitcnt vmcnt(1)
  v_max3_u32 v84, v84, v57, v59
  v_pk_add_f32 v[32:33], v[32:33], v[56:57]
  v_pk_add_f32 v[34:35], v[34:35], v[58:59]
  s_waitcnt vmcnt(0)
  v_max3_u32 v84, v84, v61, v63
  v_pk_add_f32 v[32:33], v[32:33], v[60:61]
  v_pk_add_f32 v[34:35], v[34:35], v[62:63]
  v_cmp_eq_u32 vcc, -1, v84
  s_cbranch_vccnz L_fpoll_228
  v_pk_mul_f32 v[32:33], v[32:33], v[66:67] op_sel:[0,1] op_sel_hi:[1,1]
  v_pk_mul_f32 v[34:35], v[34:35], v[66:67] op_sel:[0,1] op_sel_hi:[1,1]
  v_max_f32 v32, 0, v32
  v_max_f32 v33, 0, v33
  v_pk_mul_f32 v[32:33], v[32:33], v[34:35]
  v_cvt_pk_bf16_f32 v32, v32, v33
  ds_write_b32 v30, v32
  ds_read_b128 v[32:35], v12
  ds_read_b64 v[36:37], v13
  v_mov_b32 v38, 0
  v_mov_b32 v39, 0
  s_add_u32 s63, s59, 3670016
  s_waitcnt lgkmcnt(1)
  v_mfma_f32_16x16x32_bf16 v[40:43], a[240:243], v[32:35], 0
  s_waitcnt lgkmcnt(0)
  v_mfma_f32_16x16x32_bf16 v[40:43], v[186:189], v[36:39], v[40:43]
  v_mfma_f32_16x16x32_bf16 v[44:47], a[244:247], v[32:35], 0
  v_mfma_f32_16x16x32_bf16 v[44:47], v[188:191], v[36:39], v[44:47]
  v_mfma_f32_16x16x32_bf16 v[48:51], a[248:251], v[32:35], 0
  v_mfma_f32_16x16x32_bf16 v[48:51], v[190:193], v[36:39], v[48:51]
  v_mfma_f32_16x16x32_bf16 v[52:55], a[252:255], v[32:35], 0
  v_mfma_f32_16x16x32_bf16 v[52:55], v[192:195], v[36:39], v[52:55]
  v_mfma_f32_16x16x32_bf16 v[56:59], v[182:185], v[32:35], 0
  v_mfma_f32_16x16x32_bf16 v[56:59], v[194:197], v[36:39], v[56:59]
  buffer_store_dwordx4 v[40:43], v6, s[48:51], s63 offen offset:0 sc1
  s_nop 0
  buffer_store_dwordx4 v[44:47], v6, s[48:51], s63 offen offset:64 sc1
  s_nop 0
  buffer_store_dwordx4 v[48:51], v6, s[48:51], s63 offen offset:128 sc1
  s_nop 0
  buffer_store_dwordx4 v[52:55], v6, s[48:51], s63 offen offset:192 sc1
  s_nop 0
  buffer_store_dwordx4 v[56:59], v6, s[48:51], s63 offen offset:256 sc1
  s_cmp_lg_u32 s29, 0
  s_cbranch_scc1 L_notleader_229
  s_add_u32 s100, s60, 3670016
  s_add_u32 s63, s61, 5046272
  s_mov_b32 s65, 400000
L_fpoll_230:
  buffer_load_dwordx4 v[32:35], v4, s[48:51], s100 offen offset:0 sc1
  buffer_load_dwordx4 v[36:39], v4, s[48:51], s100 offen offset:1024 sc1
  buffer_load_dwordx4 v[40:43], v4, s[48:51], s100 offen offset:2048 sc1
  buffer_load_dwordx4 v[44:47], v4, s[48:51], s100 offen offset:3072 sc1
  s_sub_u32 s65, s65, 1
  s_cbranch_scc1 L_abort
  s_waitcnt vmcnt(2)
  v_max_u32 v84, v33, v35
  v_max3_u32 v84, v84, v37, v39
  v_pk_add_f32 v[32:33], v[32:33], v[36:37]
  v_pk_add_f32 v[34:35], v[34:35], v[38:39]
  s_waitcnt vmcnt(1)
  v_max3_u32 v84, v84, v41, v43
  v_pk_add_f32 v[32:33], v[32:33], v[40:41]
  v_pk_add_f32 v[34:35], v[34:35], v[42:43]
  s_waitcnt vmcnt(0)
  v_max3_u32 v84, v84, v45, v47
  v_pk_add_f32 v[32:33], v[32:33], v[44:45]
  v_pk_add_f32 v[34:35], v[34:35], v[46:47]
  v_cmp_eq_u32 vcc, -1, v84
  s_cbranch_vccnz L_fpoll_230
  buffer_store_dwordx4 v[32:35], v4, s[48:51], s63 offen sc1
L_notleader_229:
  s_add_u32 s100, s62, 5046272
  s_add_u32 s101, s100, 4096
  s_mov_b32 s65, 400000
  s_sleep 6
L_fpoll_231:
  buffer_load_dwordx4 v[32:35], v4, s[48:51], s100 offen offset:0 sc1
  buffer_load_dwordx4 v[36:39], v4, s[48:51], s100 offen offset:1024 sc1
  buffer_load_dwordx4 v[40:43], v4, s[48:51], s100 offen offset:2048 sc1
  buffer_load_dwordx4 v[44:47], v4, s[48:51], s100 offen offset:3072 sc1
  buffer_load_dwordx4 v[48:51], v4, s[48:51], s101 offen offset:0 sc1
  buffer_load_dwordx4 v[52:55], v4, s[48:51], s101 offen offset:1024 sc1
  buffer_load_dwordx4 v[56:59], v4, s[48:51], s101 offen offset:2048 sc1
  buffer_load_dwordx4 v[60:63], v4, s[48:51], s101 offen offset:3072 sc1
  s_sub_u32 s65, s65, 1
  s_cbranch_scc1 L_abort
  s_waitcnt vmcnt(6)
  v_max_u32 v84, v33, v35
  v_max3_u32 v84, v84, v37, v39
  v_pk_add_f32 v[32:33], v[32:33], v[16:17]
  v_pk_add_f32 v[34:35], v[34:35], v[18:19]
  v_pk_add_f32 v[32:33], v[32:33], v[36:37]
  v_pk_add_f32 v[34:35], v[34:35], v[38:39]
  s_waitcnt vmcnt(4)
  v_max3_u32 v84, v84, v41, v43
  v_max3_u32 v84, v84, v45, v47
  v_pk_add_f32 v[40:41], v[40:41], v[44:45]
  v_pk_add_f32 v[42:43], v[42:43], v[46:47]
  v_pk_add_f32 v[32:33], v[32:33], v[40:41]
  v_pk_add_f32 v[34:35], v[34:35], v[42:43]
  s_waitcnt vmcnt(2)
  v_max3_u32 v84, v84, v49, v51
  v_max3_u32 v84, v84, v53, v55
  v_pk_add_f32 v[48:49], v[48:49], v[52:53]
  v_pk_add_f32 v[50:51], v[50:51], v[54:55]
  v_pk_add_f32 v[32:33], v[32:33], v[48:49]
  v_pk_add_f32 v[34:35], v[34:35], v[50:51]
  s_waitcnt vmcnt(1)
  v_max3_u32 v84, v84, v57, v59
  v_pk_add_f32 v[32:33], v[32:33], v[56:57]
  v_pk_add_f32 v[34:35], v[34:35], v[58:59]
  s_waitcnt vmcnt(0)
  v_max3_u32 v84, v84, v61, v63
  v_pk_add_f32 v[32:33], v[32:33], v[60:61]
  v_pk_add_f32 v[34:35], v[34:35], v[62:63]
  v_cmp_eq_u32 vcc, -1, v84
  s_cbranch_vccnz L_fpoll_231
  v_cvt_pk_bf16_f32 v36, v32, v33
  v_cvt_pk_bf16_f32 v37, v34, v35
  ds_write_b64 v29, v[36:37]
  ds_read_b128 v[40:43], v10
  ds_read_b128 v[44:47], v10 offset:64
  ds_read_b64 v[48:49], v11
  v_mov_b32 v50, 0
  v_mov_b32 v51, 0
  ds_read_b128 v[52:55], v14
  ds_read_b128 v[56:59], v14 offset:64
  ds_read_b64 v[60:61], v15
  v_mov_b32 v62, 0
  v_mov_b32 v63, 0
  s_add_u32 s63, s57, 1835008
  v_lshlrev_b32 v16, 16, v36
  v_and_b32 v17, 0xffff0000, v36
  v_lshlrev_b32 v18, 16, v37
  v_and_b32 v19, 0xffff0000, v37
  s_add_u32 s100, s58, 1835008
  s_add_u32 s101, s100, 4096
  s_waitcnt lgkmcnt(5)
  v_mfma_f32_16x16x32_bf16 v[64:67], a[2:5], v[40:43], 0
  s_waitcnt lgkmcnt(4)
  v_mfma_f32_16x16x32_bf16 v[64:67], a[6:9], v[44:47], v[64:67]
  s_waitcnt lgkmcnt(3)
  v_mfma_f32_16x16x32_bf16 v[64:67], a[0:3], v[48:51], v[64:67]
  s_waitcnt lgkmcnt(0)
  v_mfma_f32_16x16x32_bf16 v[36:39], v[52:55], v[40:43], 0
  v_mfma_f32_16x16x32_bf16 v[36:39], v[56:59], v[44:47], v[36:39]
  v_mfma_f32_16x16x32_bf16 v[36:39], v[60:63], v[48:51], v[36:39]
  v_mfma_f32_16x16x32_bf16 v[68:71], a[12:15], v[40:43], 0
  v_mfma_f32_16x16x32_bf16 v[68:71], a[16:19], v[44:47], v[68:71]
  v_mfma_f32_16x16x32_bf16 v[68:71], a[10:13], v[48:51], v[68:71]
  v_mfma_f32_16x16x32_bf16 v[32:35], a[22:25], v[40:43], 0
  v_mfma_f32_16x16x32_bf16 v[32:35], a[26:29], v[44:47], v[32:35]
  v_mfma_f32_16x16x32_bf16 v[32:35], a[20:23], v[48:51], v[32:35]
  v_mfma_f32_16x16x32_bf16 v[52:55], a[32:35], v[40:43], 0
  v_mfma_f32_16x16x32_bf16 v[52:55], a[36:39], v[44:47], v[52:55]
  v_mfma_f32_16x16x32_bf16 v[52:55], a[30:33], v[48:51], v[52:55]
  buffer_store_dwordx4 v[64:67], v8, s[48:51], s63 offen offset:0 sc1
  s_nop 1
  v_mfma_f32_16x16x32_bf16 v[64:67], a[42:45], v[40:43], 0
  v_mfma_f32_16x16x32_bf16 v[64:67], a[46:49], v[44:47], v[64:67]
  v_mfma_f32_16x16x32_bf16 v[64:67], a[40:43], v[48:51], v[64:67]
  buffer_store_dwordx4 v[68:71], v8, s[48:51], s63 offen offset:64 sc1
  s_nop 1
  v_mfma_f32_16x16x32_bf16 v[68:71], a[52:55], v[40:43], 0
  v_mfma_f32_16x16x32_bf16 v[68:71], a[56:59], v[44:47], v[68:71]
  v_mfma_f32_16x16x32_bf16 v[68:71], a[50:53], v[48:51], v[68:71]
  buffer_store_dwordx4 v[32:35], v8, s[48:51], s63 offen offset:128 sc1
  s_nop 1
  v_mfma_f32_16x16x32_bf16 v[32:35], a[62:65], v[40:43], 0
  v_mfma_f32_16x16x32_bf16 v[32:35], a[66:69], v[44:47], v[32:35]
  v_mfma_f32_16x16x32_bf16 v[32:35], a[60:63], v[48:51], v[32:35]
  buffer_store_dwordx4 v[52:55], v8, s[48:51], s63 offen offset:192 sc1
  s_nop 1
  v_mfma_f32_16x16x32_bf16 v[52:55], a[72:75], v[40:43], 0
  v_mfma_f32_16x16x32_bf16 v[52:55], a[76:79], v[44:47], v[52:55]
  v_mfma_f32_16x16x32_bf16 v[52:55], a[70:73], v[48:51], v[52:55]
  buffer_store_dwordx4 v[64:67], v8, s[48:51], s63 offen offset:256 sc1
  s_nop 1
  v_mfma_f32_16x16x32_bf16 v[64:67], a[82:85], v[40:43], 0
  v_mfma_f32_16x16x32_bf16 v[64:67], a[86:89], v[44:47], v[64:67]
  v_mfma_f32_16x16x32_bf16 v[64:67], a[80:83], v[48:51], v[64:67]
  buffer_store_dwordx4 v[68:71], v8, s[48:51], s63 offen offset:320 sc1
  s_nop 1
  v_mfma_f32_16x16x32_bf16 v[68:71], a[92:95], v[40:43], 0
  v_mfma_f32_16x16x32_bf16 v[68:71], a[96:99], v[44:47], v[68:71]
  v_mfma_f32_16x16x32_bf16 v[68:71], a[90:93], v[48:51], v[68:71]
  buffer_store_dwordx4 v[32:35], v8, s[48:51], s63 offen offset:384 sc1
  s_nop 1
  v_mfma_f32_16x16x32_bf16 v[32:35], a[102:105], v[40:43], 0
  v_mfma_f32_16x16x32_bf16 v[32:35], a[106:109], v[44:47], v[32:35]
  v_mfma_f32_16x16x32_bf16 v[32:35], a[100:103], v[48:51], v[32:35]
  buffer_store_dwordx4 v[52:55], v8, s[48:51], s63 offen offset:448 sc1
  s_nop 1
  v_mfma_f32_16x16x32_bf16 v[52:55], a[112:115], v[40:43], 0
  v_mfma_f32_16x16x32_bf16 v[52:55], a[116:119], v[44:47], v[52:55]
  v_mfma_f32_16x16x32_bf16 v[52:55], a[110:113], v[48:51], v[52:55]
  buffer_store_dwordx4 v[64:67], v8, s[48:51], s63 offen offset:512 sc1
  v_cndmask_b32 v37, v37, v38, s[74:75]
  buffer_store_dwordx4 v[68:71], v8, s[48:51], s63 offen offset:576 sc1
  buffer_store_dwordx4 v[32:35], v8, s[48:51], s63 offen offset:640 sc1
  s_nop 3
  buffer_store_dwordx4 v[52:55], v8, s[48:51], s63 offen offset:704 sc1
  buffer_store_dwordx4 v[36:39], v82, s[48:51], s63 offen offset:0 sc1
  s_mov_b32 s65, 400000
L_fpoll_232:
  buffer_load_dwordx4 v[64:67], v31, s[48:51], s100 offen offset:0 sc1
  buffer_load_dwordx4 v[32:35], v5, s[48:51], s100 offen offset:0 sc1
  buffer_load_dwordx4 v[36:39], v5, s[48:51], s100 offen offset:1024 sc1
  buffer_load_dwordx4 v[40:43], v5, s[48:51], s100 offen offset:2048 sc1
  buffer_load_dwordx4 v[44:47], v5, s[48:51], s100 offen offset:3072 sc1
  buffer_load_dwordx4 v[48:51], v5, s[48:51], s101 offen offset:0 sc1
  buffer_load_dwordx4 v[52:55], v5, s[48:51], s101 offen offset:1024 sc1
  buffer_load_dwordx4 v[56:59], v5, s[48:51], s101 offen offset:2048 sc1
  buffer_load_dwordx4 v[60:63], v5, s[48:51], s101 offen offset:3072 sc1
  s_sub_u32 s65, s65, 1
  s_cbranch_scc1 L_abort
  s_waitcnt vmcnt(8)
  v_max_u32 v84, v65, v67
  v_add_f32_dpp v64, v64, v64 quad_perm:[1,0,3,2] row_mask:0xf bank_mask:0xf
  v_add_f32_dpp v65, v65, v65 quad_perm:[1,0,3,2] row_mask:0xf bank_mask:0xf
  s_waitcnt vmcnt(6)
  v_max3_u32 v84, v84, v33, v35
  v_add_f32_dpp v64, v64, v64 quad_perm:[2,3,0,1] row_mask:0xf bank_mask:0xf
  v_add_f32_dpp v65, v65, v65 quad_perm:[2,3,0,1] row_mask:0xf bank_mask:0xf
  v_max3_u32 v84, v84, v37, v39
  v_add_f32_dpp v64, v64, v64 row_half_mirror row_mask:0xf bank_mask:0xf
  v_add_f32_dpp v65, v65, v65 row_half_mirror row_mask:0xf bank_mask:0xf
  v_pk_add_f32 v[32:33], v[32:33], v[36:37]
  v_pk_add_f32 v[34:35], v[34:35], v[38:39]
  v_mul_f32 v66, 0x3acccccd, v64
  v_mul_f32 v65, 0x3acccccd, v65
  s_waitcnt vmcnt(4)
  v_max3_u32 v84, v84, v41, v43
  v_max3_u32 v84, v84, v45, v47
  v_fma_f32 v65, -v66, v66, v65
  v_pk_add_f32 v[40:41], v[40:41], v[44:45]
  v_pk_add_f32 v[42:43], v[42:43], v[46:47]
  v_max_f32 v65, 0, v65
  v_add_f32 v65, 0x3727c5ac, v65
  v_pk_add_f32 v[32:33], v[32:33], v[40:41]
  v_pk_add_f32 v[34:35], v[34:35], v[42:43]
  v_rsq_f32 v67, v65
  s_waitcnt vmcnt(2)
  v_max3_u32 v84, v84, v49, v51
  v_max3_u32 v84, v84, v53, v55
  v_pk_mul_f32 v[68:69], v[20:21], v[66:67] op_sel_hi:[1,0]
  v_pk_mul_f32 v[70:71], v[22:23], v[66:67] op_sel_hi:[1,0]
  v_pk_add_f32 v[48:49], v[48:49], v[52:53]
  v_pk_add_f32 v[50:51], v[50:51], v[54:55]
  v_pk_add_f32 v[32:33], v[32:33], v[68:69] neg_lo:[0,1] neg_hi:[0,1]
  v_pk_add_f32 v[34:35], v[34:35], v[70:71] neg_lo:[0,1] neg_hi:[0,1]
  v_pk_add_f32 v[32:33], v[32:33], v[48:49]
  v_pk_add_f32 v[34:35], v[34:35], v[50:51]
  s_waitcnt vmcnt(1)
  v_max3_u32 v84, v84, v57, v59
  v_pk_add_f32 v[32:33], v[32:33], v[56:57]
  v_pk_add_f32 v[34:35], v[34:35], v[58:59]
  s_waitcnt vmcnt(0)
  v_max3_u32 v84, v84, v61, v63
  v_pk_add_f32 v[32:33], v[32:33], v[60:61]
  v_pk_add_f32 v[34:35], v[34:35], v[62:63]
  v_cmp_eq_u32 vcc, -1, v84
  s_cbranch_vccnz L_fpoll_232
  v_pk_mul_f32 v[32:33], v[32:33], v[66:67] op_sel:[0,1] op_sel_hi:[1,1]
  v_pk_mul_f32 v[34:35], v[34:35], v[66:67] op_sel:[0,1] op_sel_hi:[1,1]
  v_cvt_pk_bf16_f32 v32, v32, v33
  v_cvt_pk_bf16_f32 v33, v34, v35
  ds_write_b64 v28, v[32:33] offset:6208
  s_waitcnt lgkmcnt(0)
  s_barrier
  v_mbcnt_lo_u32_b32 v57, -1, 0
  v_mbcnt_hi_u32_b32 v57, -1, v57
  v_and_b32 v58, 1, v57
  v_lshrrev_b32 v59, 4, v57
  v_lshlrev_b32 v59, 4, v59
  v_lshl_add_u32 v58, v58, 6, v59
  v_add_u32 v58, 159808, v58
  v_add_u32 v63, s69, v59
  v_lshrrev_b32 v59, 5, v57
  v_lshlrev_b32 v62, 6, v59
  v_bfe_u32 v59, v57, 1, 2
  v_lshl_add_u32 v62, v59, 4, v62
  v_bfe_u32 v59, v57, 3, 2
  v_lshl_add_u32 v62, v59, 2, v62
  v_and_b32 v59, 1, v57
  v_lshl_add_u32 v62, v59, 1, v62
  v_add_u32 v62, s69, v62
  v_mov_b32 v56, 0xff800000
  ds_read_b128 v[32:35], v58 offset:0
  ds_read_b128 v[36:39], v58 offset:128
  ds_read_b128 v[40:43], v58 offset:256
  s_waitcnt lgkmcnt(0)
  v_mfma_f32_16x16x32_bf16 v[44:47], v[32:35], v[86:89], 0
  v_mfma_f32_16x16x32_bf16 v[44:47], v[36:39], v[90:93], v[44:47]
  v_mfma_f32_16x16x32_bf16 v[44:47], v[40:43], v[94:97], v[44:47]
  v_mfma_f32_16x16x32_bf16 v[48:51], v[32:35], v[98:101], 0
  v_mfma_f32_16x16x32_bf16 v[48:51], v[36:39], v[102:105], v[48:51]
  v_mfma_f32_16x16x32_bf16 v[48:51], v[40:43], v[106:109], v[48:51]
  v_mfma_f32_16x16x32_bf16 v[52:55], v[32:35], v[110:113], 0
  v_mfma_f32_16x16x32_bf16 v[52:55], v[36:39], v[114:117], v[52:55]
  v_mfma_f32_16x16x32_bf16 v[52:55], v[40:43], v[118:121], v[52:55]
  s_nop 1
  v_add_f32_dpp v56, v45, v44 row_ror:8 row_mask:0x1 bank_mask:0x3
  v_mfma_f32_16x16x32_bf16 v[44:47], v[32:35], v[122:125], 0
  v_mfma_f32_16x16x32_bf16 v[44:47], v[36:39], v[126:129], v[44:47]
  v_mfma_f32_16x16x32_bf16 v[44:47], v[40:43], v[130:133], v[44:47]
  v_add_f32_dpp v56, v48, v49 row_ror:8 row_mask:0x1 bank_mask:0xc
  s_nop 0
  v_add_f32_dpp v56, v53, v52 row_ror:8 row_mask:0x2 bank_mask:0x3
  s_nop 4
  v_add_f32_dpp v56, v44, v45 row_ror:8 row_mask:0x2 bank_mask:0xc
  v_mov_b32 v44, v56
  s_nop 1
  v_max_f32_dpp v44, v44, v44 row_ror:8 row_mask:0xf bank_mask:0xf
  s_nop 1
  v_max_f32_dpp v44, v44, v44 row_ror:4 row_mask:0xf bank_mask:0xf
  s_nop 1
  v_max_f32_dpp v44, v44, v44 row_ror:2 row_mask:0xf bank_mask:0xf
  s_nop 1
  v_max_f32_dpp v44, v44, v44 row_ror:1 row_mask:0xf bank_mask:0xf
  v_mov_b32 v45, v44
  s_nop 1
  v_permlane16_swap_b32 v44, v45
  v_max_f32 v44, v44, v45
  v_mov_b32 v45, v44
  s_nop 1
  v_permlane32_swap_b32 v44, v45
  v_max_f32 v44, v44, v45
  v_mul_f32 v60, s56, v44
  v_fma_f32 v56, v56, s56, -v60
  v_exp_f32 v56, v56
  s_nop 0
  v_cvt_pk_bf16_f32 v46, v56, v56
  ds_write_b16 v62, v46 offset:0
  v_mov_b32 v61, v56
  ds_read_b128 v[52:55], v63
  s_nop 0
  v_add_f32_dpp v61, v61, v61 row_ror:8 row_mask:0xf bank_mask:0xf
  s_nop 1
  v_add_f32_dpp v61, v61, v61 row_ror:4 row_mask:0xf bank_mask:0xf
  s_nop 1
  v_add_f32_dpp v61, v61, v61 row_ror:2 row_mask:0xf bank_mask:0xf
  s_nop 1
  v_add_f32_dpp v61, v61, v61 row_ror:1 row_mask:0xf bank_mask:0xf
  v_mov_b32 v59, v61
  s_nop 1
  v_permlane16_swap_b32 v61, v59
  v_add_f32 v61, v61, v59
  v_mov_b32 v59, v61
  s_nop 1
  v_permlane32_swap_b32 v61, v59
  v_add_f32 v61, v61, v59
  s_waitcnt lgkmcnt(0)
  v_perm_b32 v44, v52, v52, v75
  v_perm_b32 v45, v52, v52, v76
  v_perm_b32 v46, v52, v52, v77
  v_perm_b32 v47, v52, v52, v78
  s_nop 1
  v_mfma_f32_16x16x32_bf16 v[32:35], v[44:47], v[134:137], 0
  v_perm_b32 v48, v53, v53, v75
  v_perm_b32 v49, v53, v53, v76
  v_mfma_f32_16x16x32_bf16 v[36:39], v[44:47], v[138:141], 0
  v_perm_b32 v50, v53, v53, v77
  v_perm_b32 v51, v53, v53, v78
  v_mfma_f32_16x16x32_bf16 v[40:43], v[44:47], v[142:145], 0
  s_nop 0
  v_mfma_f32_16x16x32_bf16 v[32:35], v[48:51], v[146:149], v[32:35]
  v_perm_b32 v44, v54, v54, v75
  v_perm_b32 v45, v54, v54, v76
  v_mfma_f32_16x16x32_bf16 v[36:39], v[48:51], v[150:153], v[36:39]
  v_perm_b32 v46, v54, v54, v77
  v_perm_b32 v47, v54, v54, v78
  v_mfma_f32_16x16x32_bf16 v[40:43], v[48:51], v[154:157], v[40:43]
  s_nop 0
  v_mfma_f32_16x16x32_bf16 v[32:35], v[44:47], v[158:161], v[32:35]
  v_perm_b32 v48, v55, v55, v75
  v_perm_b32 v49, v55, v55, v76
  v_mfma_f32_16x16x32_bf16 v[36:39], v[44:47], v[162:165], v[36:39]
  v_perm_b32 v50, v55, v55, v77
  v_perm_b32 v51, v55, v55, v78
  v_mfma_f32_16x16x32_bf16 v[40:43], v[44:47], v[166:169], v[40:43]
  s_nop 0
  v_mfma_f32_16x16x32_bf16 v[32:35], v[48:51], v[170:173], v[32:35]
  v_mfma_f32_16x16x32_bf16 v[36:39], v[48:51], v[174:177], v[36:39]
  v_mfma_f32_16x16x32_bf16 v[40:43], v[48:51], v[178:181], v[40:43]
  v_mbcnt_lo_u32_b32 v52, -1, 0
  v_mbcnt_hi_u32_b32 v52, -1, v52
  v_and_b32 v53, 15, v52
  v_lshrrev_b32 v54, 4, v52
  v_and_b32 v55, 1, v54
  v_lshrrev_b32 v54, 1, v54
  v_mul_u32_u24 v54, 768, v54
  v_lshl_add_u32 v54, v55, 4, v54
  v_add_u32 v54, s69, v54
  v_lshl_add_u32 v56, v53, 5, v54
  v_and_b32 v53, 7, v53
  v_lshl_add_u32 v57, v53, 5, v54
  v_mov_b32 v58, s72
  v_mov_b32 v44, v60
  v_mov_b32 v45, v61
  v_cndmask_b32 v32, v32, v36, s[70:71]
  v_cndmask_b32 v33, v33, v37, s[70:71]
  v_cndmask_b32 v34, v34, v38, s[70:71]
  v_cndmask_b32 v35, v35, v39, s[70:71]
  ds_write_b128 v56, v[32:35]
  s_mov_b32 exec_lo, 0x00ff00ff
  s_mov_b32 exec_hi, 0xff00ff00
  ds_write_b128 v57, v[40:43] offset:512
  s_mov_b64 exec, 1
  ds_write_b64 v58, v[44:45] offset:32
  s_mov_b64 exec, -1
  s_waitcnt lgkmcnt(0)
  s_barrier
  v_mov_b32 v84, 159776
  ds_read_b128 v[32:35], v84
  ds_read_b128 v[36:39], v84 offset:16
  v_add_u32 v85, 153600, v83
  ds_read_b128 v[40:43], v85 offset:0
  ds_read_b128 v[44:47], v85 offset:768
  v_add_u32 v85, 49152, v83
  ds_read_b128 v[48:51], v85 offset:0
  ds_read_b128 v[52:55], v85 offset:768
  ds_read_b128 v[56:59], v85 offset:51200
  ds_read_b128 v[60:63], v85 offset:51968
  v_add_u32 v85, 151552, v83
  ds_read_b128 v[64:67], v85 offset:0
  ds_read_b128 v[68:71], v85 offset:768
  s_add_u32 s63, s57, 262144
  s_waitcnt lgkmcnt(8)
  v_max3_f32 v84, v32, v34, v36
  v_max_f32 v84, v84, v38
  v_sub_f32 v32, v32, v84
  v_sub_f32 v34, v34, v84
  v_sub_f32 v36, v36, v84
  v_sub_f32 v38, v38, v84
  v_exp_f32 v32, v32
  v_exp_f32 v34, v34
  v_exp_f32 v36, v36
  v_exp_f32 v38, v38
  v_mul_f32 v85, v32, v33
  v_fma_f32 v85, v34, v35, v85
  v_fma_f32 v85, v36, v37, v85
  v_fma_f32 v85, v38, v39, v85
  s_waitcnt lgkmcnt(6)
  v_pk_add_f32 v[40:41], v[40:41], v[44:45]
  v_pk_add_f32 v[42:43], v[42:43], v[46:47]
  v_mul_f32 v40, v32, v40
  v_mul_f32 v41, v32, v41
  v_mul_f32 v42, v32, v42
  v_mul_f32 v43, v32, v43
  s_waitcnt lgkmcnt(4)
  v_pk_add_f32 v[48:49], v[48:49], v[52:53]
  v_pk_add_f32 v[50:51], v[50:51], v[54:55]
  v_fmac_f32 v40, v34, v48
  v_fmac_f32 v41, v34, v49
  v_fmac_f32 v42, v34, v50
  v_fmac_f32 v43, v34, v51
  s_waitcnt lgkmcnt(2)
  v_pk_add_f32 v[56:57], v[56:57], v[60:61]
  v_pk_add_f32 v[58:59], v[58:59], v[62:63]
  v_fmac_f32 v40, v36, v56
  v_fmac_f32 v41, v36, v57
  v_fmac_f32 v42, v36, v58
  v_fmac_f32 v43, v36, v59
  s_waitcnt lgkmcnt(0)
  v_pk_add_f32 v[64:65], v[64:65], v[68:69]
  v_pk_add_f32 v[66:67], v[66:67], v[70:71]
  v_fmac_f32 v40, v38, v64
  v_fmac_f32 v41, v38, v65
  v_fmac_f32 v42, v38, v66
  v_fmac_f32 v43, v38, v67
  s_mov_b32 vcc_lo, 0
  s_mov_b32 vcc_hi, 0x00010000
  v_cndmask_b32 v40, v40, v84, vcc
  v_cndmask_b32 v41, v41, v85, vcc
  buffer_store_dwordx4 v[40:43], v5, s[48:51], s63 offen offset:0 sc1
  s_add_u32 s42, s41, 0
  buffer_load_dwordx4 v[86:89], v1, s[32:35], s42 offen offset:0 nt
  buffer_load_dwordx4 v[90:93], v1, s[32:35], s42 offen offset:128 nt
  buffer_load_dwordx4 v[94:97], v1, s[32:35], s42 offen offset:256 nt
  s_add_u32 s42, s41, 3072
  buffer_load_dwordx4 v[98:101], v1, s[32:35], s42 offen offset:0 nt
  buffer_load_dwordx4 v[102:105], v1, s[32:35], s42 offen offset:128 nt
  buffer_load_dwordx4 v[106:109], v1, s[32:35], s42 offen offset:256 nt
  s_add_u32 s42, s41, 6144
  buffer_load_dwordx4 v[110:113], v1, s[32:35], s42 offen offset:0 nt
  buffer_load_dwordx4 v[114:117], v1, s[32:35], s42 offen offset:128 nt
  buffer_load_dwordx4 v[118:121], v1, s[32:35], s42 offen offset:256 nt
  s_add_u32 s42, s41, 9216
  buffer_load_dwordx4 v[122:125], v1, s[32:35], s42 offen offset:0 nt
  buffer_load_dwordx4 v[126:129], v1, s[32:35], s42 offen offset:128 nt
  buffer_load_dwordx4 v[130:133], v1, s[32:35], s42 offen offset:256 nt
  s_add_u32 s42, s41, 0
  buffer_load_dwordx4 v[134:137], v2, s[36:39], s42 offen offset:0 nt
  buffer_load_dwordx4 v[138:141], v2, s[36:39], s42 offen offset:384 nt
  buffer_load_dwordx4 v[142:145], v3, s[36:39], s42 offen offset:0 nt
  s_add_u32 s42, s41, 3072
  buffer_load_dwordx4 v[146:149], v2, s[36:39], s42 offen offset:0 nt
  buffer_load_dwordx4 v[150:153], v2, s[36:39], s42 offen offset:384 nt
  buffer_load_dwordx4 v[154:157], v3, s[36:39], s42 offen offset:0 nt
  s_add_u32 s42, s41, 6144
  buffer_load_dwordx4 v[158:161], v2, s[36:39], s42 offen offset:0 nt
  buffer_load_dwordx4 v[162:165], v2, s[36:39], s42 offen offset:384 nt
  buffer_load_dwordx4 v[166:169], v3, s[36:39], s42 offen offset:0 nt
  s_add_u32 s42, s41, 9216
  buffer_load_dwordx4 v[170:173], v2, s[36:39], s42 offen offset:0 nt
  buffer_load_dwordx4 v[174:177], v2, s[36:39], s42 offen offset:384 nt
  buffer_load_dwordx4 v[178:181], v3, s[36:39], s42 offen offset:0 nt
  v_and_b32 v84, 31, v0
  v_lshlrev_b32 v84, 4, v84
  v_lshrrev_b32 v85, 5, v0
  v_lshl_add_u32 v84, v85, 9, v84
  s_mov_b32 vcc_lo, 0x00000000
  s_mov_b32 vcc_hi, 0x000fffff
  v_cndmask_b32 v4, v74, v84, vcc
  s_mov_b32 vcc_lo, 0x00000000
  s_mov_b32 vcc_hi, 0x00ffffff
  v_cndmask_b32 v79, v74, v84, vcc
  v_lshrrev_b32 v84, 4, v0
  v_and_b32 v85, 15, v0
  v_lshlrev_b32 v72, 10, v84
  v_lshl_add_u32 v72, v85, 4, v72
  v_add_u32 v72, 512, v72
  v_lshlrev_b32 v73, 15, v84
  v_bfe_u32 v85, v0, 2, 2
  v_lshl_add_u32 v73, v85, 10, v73
  v_and_b32 v85, 3, v0
  v_lshl_add_u32 v73, v85, 4, v73
  v_add_u32 v73, 768, v73
  v_lshrrev_b32 v85, 5, v0
  v_and_b32 v84, 7, v0
  v_lshlrev_b32 v84, 10, v84
  v_lshl_add_u32 v84, v85, 9, v84
  v_add_u32 v84, 384, v84
  s_mov_b32 vcc_lo, 0x00000000
  s_mov_b32 vcc_hi, 0xffffffff
  v_cndmask_b32 v80, v74, v84, vcc
  v_and_b32 v84, 15, v0
  v_lshrrev_b32 v85, 4, v0
  v_lshlrev_b32 v6, 9, v84
  v_lshl_add_u32 v7, v85, 5, v6
  v_add_u32 v81, 384, v6
  v_lshl_add_u32 v6, v85, 4, v6
  v_lshlrev_b32 v8, 18, v84
  v_add_u32 v82, 768, v8
  v_lshl_add_u32 v8, v85, 4, v8
  s_mov_b32 vcc_lo, 0x00020002
  s_mov_b32 vcc_hi, 0x00020002
  v_cndmask_b32 v6, v74, v6, vcc
  v_cndmask_b32 v7, v74, v7, vcc
  s_mov_b32 vcc_lo, 0x00000002
  s_mov_b32 vcc_hi, 0x00000000
  v_cndmask_b32 v81, v74, v81, vcc
  s_mov_b32 vcc_lo, 0x00020002
  s_mov_b32 vcc_hi, 0x00020002
  v_cndmask_b32 v8, v74, v8, vcc
  s_mov_b32 vcc_lo, 0x00000002
  s_mov_b32 vcc_hi, 0x00000000
  v_cndmask_b32 v82, v74, v82, vcc
  v_mbcnt_lo_u32_b32 v57, -1, 0
  v_mbcnt_hi_u32_b32 v57, -1, v57
  v_and_b32 v58, 1, v57
  v_lshrrev_b32 v59, 4, v57
  v_lshlrev_b32 v59, 4, v59
  v_lshl_add_u32 v58, v58, 6, v59
  v_add_u32 v58, 159808, v58
  v_add_u32 v63, s69, v59
  v_lshrrev_b32 v59, 5, v57
  v_lshlrev_b32 v62, 6, v59
  v_bfe_u32 v59, v57, 1, 2
  v_lshl_add_u32 v62, v59, 4, v62
  v_bfe_u32 v59, v57, 3, 2
  v_lshl_add_u32 v62, v59, 2, v62
  v_and_b32 v59, 1, v57
  v_lshl_add_u32 v62, v59, 1, v62
  v_add_u32 v62, s69, v62
  v_mov_b32 v56, 0xff800000
  ds_read_b128 v[32:35], v58 offset:384
  ds_read_b128 v[36:39], v58 offset:512
  ds_read_b128 v[40:43], v58 offset:640
  s_waitcnt lgkmcnt(0)
  s_waitcnt vmcnt(21)
  v_mfma_f32_16x16x32_bf16 v[44:47], v[32:35], v[86:89], 0
  v_mfma_f32_16x16x32_bf16 v[44:47], v[36:39], v[90:93], v[44:47]
  v_mfma_f32_16x16x32_bf16 v[44:47], v[40:43], v[94:97], v[44:47]
  s_waitcnt vmcnt(18)
  v_mfma_f32_16x16x32_bf16 v[48:51], v[32:35], v[98:101], 0
  v_mfma_f32_16x16x32_bf16 v[48:51], v[36:39], v[102:105], v[48:51]
  v_mfma_f32_16x16x32_bf16 v[48:51], v[40:43], v[106:109], v[48:51]
  s_waitcnt vmcnt(15)
  v_mfma_f32_16x16x32_bf16 v[52:55], v[32:35], v[110:113], 0
  v_mfma_f32_16x16x32_bf16 v[52:55], v[36:39], v[114:117], v[52:55]
  v_mfma_f32_16x16x32_bf16 v[52:55], v[40:43], v[118:121], v[52:55]
  v_add_f32_dpp v56, v45, v44 row_ror:8 row_mask:0x1 bank_mask:0x3
  s_waitcnt vmcnt(12)
  v_mfma_f32_16x16x32_bf16 v[44:47], v[32:35], v[122:125], 0
  v_mfma_f32_16x16x32_bf16 v[44:47], v[36:39], v[126:129], v[44:47]
  v_mfma_f32_16x16x32_bf16 v[44:47], v[40:43], v[130:133], v[44:47]
  v_add_f32_dpp v56, v48, v49 row_ror:8 row_mask:0x1 bank_mask:0xc
  s_nop 1
  v_add_f32_dpp v56, v53, v52 row_ror:8 row_mask:0x2 bank_mask:0x3
  s_nop 3
  v_add_f32_dpp v56, v44, v45 row_ror:8 row_mask:0x2 bank_mask:0xc
  v_mov_b32 v44, v56
  s_nop 1
  v_max_f32_dpp v44, v44, v44 row_ror:8 row_mask:0xf bank_mask:0xf
  s_nop 1
  v_max_f32_dpp v44, v44, v44 row_ror:4 row_mask:0xf bank_mask:0xf
  s_nop 1
  v_max_f32_dpp v44, v44, v44 row_ror:2 row_mask:0xf bank_mask:0xf
  s_nop 1
  v_max_f32_dpp v44, v44, v44 row_ror:1 row_mask:0xf bank_mask:0xf
  v_mov_b32 v45, v44
  s_nop 1
  v_permlane16_swap_b32 v44, v45
  v_max_f32 v44, v44, v45
  v_mov_b32 v45, v44
  s_nop 1
  v_permlane32_swap_b32 v44, v45
  v_max_f32 v44, v44, v45
  v_mul_f32 v60, s56, v44
  v_fma_f32 v56, v56, s56, -v60
  v_exp_f32 v56, v56
  s_nop 0
  v_cvt_pk_bf16_f32 v46, v56, v56
  ds_write_b16 v62, v46 offset:0
  v_mov_b32 v61, v56
  ds_read_b128 v[52:55], v63
  s_nop 0
  v_add_f32_dpp v61, v61, v61 row_ror:8 row_mask:0xf bank_mask:0xf
  s_nop 1
  v_add_f32_dpp v61, v61, v61 row_ror:4 row_mask:0xf bank_mask:0xf
  s_nop 1
  v_add_f32_dpp v61, v61, v61 row_ror:2 row_mask:0xf bank_mask:0xf
  s_nop 1
  v_add_f32_dpp v61, v61, v61 row_ror:1 row_mask:0xf bank_mask:0xf
  v_mov_b32 v59, v61
  s_nop 1
  v_permlane16_swap_b32 v61, v59
  v_add_f32 v61, v61, v59
  v_mov_b32 v59, v61
  s_nop 1
  v_permlane32_swap_b32 v61, v59
  v_add_f32 v61, v61, v59
  s_waitcnt lgkmcnt(0)
  v_perm_b32 v44, v52, v52, v75
  v_perm_b32 v45, v52, v52, v76
  v_perm_b32 v46, v52, v52, v77
  v_perm_b32 v47, v52, v52, v78
  s_waitcnt vmcnt(11)
  s_nop 0
  v_mfma_f32_16x16x32_bf16 v[32:35], v[44:47], v[134:137], 0
  v_perm_b32 v48, v53, v53, v75
  v_perm_b32 v49, v53, v53, v76
  s_waitcnt vmcnt(10)
  v_mfma_f32_16x16x32_bf16 v[36:39], v[44:47], v[138:141], 0
  v_perm_b32 v50, v53, v53, v77
  v_perm_b32 v51, v53, v53, v78
  s_waitcnt vmcnt(9)
  v_mfma_f32_16x16x32_bf16 v[40:43], v[44:47], v[142:145], 0
  s_waitcnt vmcnt(8)
  v_mfma_f32_16x16x32_bf16 v[32:35], v[48:51], v[146:149], v[32:35]
  v_perm_b32 v44, v54, v54, v75
  v_perm_b32 v45, v54, v54, v76
  s_waitcnt vmcnt(7)
  v_mfma_f32_16x16x32_bf16 v[36:39], v[48:51], v[150:153], v[36:39]
  v_perm_b32 v46, v54, v54, v77
  v_perm_b32 v47, v54, v54, v78
  s_waitcnt vmcnt(6)
  v_mfma_f32_16x16x32_bf16 v[40:43], v[48:51], v[154:157], v[40:43]
  s_waitcnt vmcnt(5)
  v_mfma_f32_16x16x32_bf16 v[32:35], v[44:47], v[158:161], v[32:35]
  v_perm_b32 v48, v55, v55, v75
  v_perm_b32 v49, v55, v55, v76
  s_waitcnt vmcnt(4)
  v_mfma_f32_16x16x32_bf16 v[36:39], v[44:47], v[162:165], v[36:39]
  v_perm_b32 v50, v55, v55, v77
  v_perm_b32 v51, v55, v55, v78
  s_waitcnt vmcnt(3)
  v_mfma_f32_16x16x32_bf16 v[40:43], v[44:47], v[166:169], v[40:43]
  s_waitcnt vmcnt(2)
  v_mfma_f32_16x16x32_bf16 v[32:35], v[48:51], v[170:173], v[32:35]
  s_waitcnt vmcnt(1)
  v_mfma_f32_16x16x32_bf16 v[36:39], v[48:51], v[174:177], v[36:39]
  s_waitcnt vmcnt(0)
  v_mfma_f32_16x16x32_bf16 v[40:43], v[48:51], v[178:181], v[40:43]
  v_mbcnt_lo_u32_b32 v52, -1, 0
  v_mbcnt_hi_u32_b32 v52, -1, v52
  v_and_b32 v53, 15, v52
  v_lshrrev_b32 v54, 4, v52
  v_and_b32 v55, 1, v54
  v_lshrrev_b32 v54, 1, v54
  v_mul_u32_u24 v54, 768, v54
  v_lshl_add_u32 v54, v55, 4, v54
  v_add_u32 v54, s69, v54
  v_lshl_add_u32 v56, v53, 5, v54
  v_and_b32 v53, 7, v53
  v_lshl_add_u32 v57, v53, 5, v54
  v_mov_b32 v58, s72
  v_mov_b32 v44, v60
  v_mov_b32 v45, v61
  v_cndmask_b32 v32, v32, v36, s[70:71]
  v_cndmask_b32 v33, v33, v37, s[70:71]
  v_cndmask_b32 v34, v34, v38, s[70:71]
  v_cndmask_b32 v35, v35, v39, s[70:71]
  ds_write_b128 v56, v[32:35]
  s_mov_b32 exec_lo, 0x00ff00ff
  s_mov_b32 exec_hi, 0xff00ff00
  ds_write_b128 v57, v[40:43] offset:512
  s_mov_b64 exec, 1
  ds_write_b64 v58, v[44:45] offset:0
  s_mov_b64 exec, -1
  s_waitcnt lgkmcnt(0)
  s_barrier
  v_mov_b32 v84, 159744
  ds_read_b128 v[32:35], v84
  ds_read_b128 v[36:39], v84 offset:16
  v_add_u32 v85, 153600, v83
  ds_read_b128 v[40:43], v85 offset:0
  ds_read_b128 v[44:47], v85 offset:768
  ds_read_b128 v[48:51], v85 offset:1536
  ds_read_b128 v[52:55], v85 offset:2304
  ds_read_b128 v[56:59], v85 offset:3072
  ds_read_b128 v[60:63], v85 offset:3840
  ds_read_b128 v[64:67], v85 offset:4608
  ds_read_b128 v[68:71], v85 offset:5376
  s_add_u32 s63, s57, 524288
  s_waitcnt lgkmcnt(8)
  v_max3_f32 v84, v32, v34, v36
  v_max_f32 v84, v84, v38
  v_sub_f32 v32, v32, v84
  v_sub_f32 v34, v34, v84
  v_sub_f32 v36, v36, v84
  v_sub_f32 v38, v38, v84
  v_exp_f32 v32, v32
  v_exp_f32 v34, v34
  v_exp_f32 v36, v36
  v_exp_f32 v38, v38
  v_mul_f32 v85, v32, v33
  v_fma_f32 v85, v34, v35, v85
  v_fma_f32 v85, v36, v37, v85
  v_fma_f32 v85, v38, v39, v85
  s_waitcnt lgkmcnt(6)
  v_pk_add_f32 v[40:41], v[40:41], v[44:45]
  v_pk_add_f32 v[42:43], v[42:43], v[46:47]
  v_mul_f32 v40, v32, v40
  v_mul_f32 v41, v32, v41
  v_mul_f32 v42, v32, v42
  v_mul_f32 v43, v32, v43
  s_waitcnt lgkmcnt(4)
  v_pk_add_f32 v[48:49], v[48:49], v[52:53]
  v_pk_add_f32 v[50:51], v[50:51], v[54:55]
  v_fmac_f32 v40, v34, v48
  v_fmac_f32 v41, v34, v49
  v_fmac_f32 v42, v34, v50
  v_fmac_f32 v43, v34, v51
  s_waitcnt lgkmcnt(2)
  v_pk_add_f32 v[56:57], v[56:57], v[60:61]
  v_pk_add_f32 v[58:59], v[58:59], v[62:63]
  v_fmac_f32 v40, v36, v56
  v_fmac_f32 v41, v36, v57
  v_fmac_f32 v42, v36, v58
  v_fmac_f32 v43, v36, v59
  s_waitcnt lgkmcnt(0)
  v_pk_add_f32 v[64:65], v[64:65], v[68:69]
  v_pk_add_f32 v[66:67], v[66:67], v[70:71]
  v_fmac_f32 v40, v38, v64
  v_fmac_f32 v41, v38, v65
  v_fmac_f32 v42, v38, v66
  v_fmac_f32 v43, v38, v67
  s_mov_b32 vcc_lo, 0
  s_mov_b32 vcc_hi, 0x00010000
  v_cndmask_b32 v40, v40, v84, vcc
  v_cndmask_b32 v41, v41, v85, vcc
  buffer_store_dwordx4 v[40:43], v5, s[48:51], s63 offen offset:0 sc1
  s_add_u32 s100, s58, 524288
  s_add_u32 s101, s100, 4096
  s_mov_b32 s65, 400000
L_fpoll_233:
  buffer_load_dwordx4 v[64:67], v31, s[48:51], s100 offen offset:0 sc1
  buffer_load_dwordx4 v[32:35], v5, s[48:51], s100 offen offset:0 sc1
  buffer_load_dwordx4 v[36:39], v5, s[48:51], s100 offen offset:1024 sc1
  buffer_load_dwordx4 v[40:43], v5, s[48:51], s100 offen offset:2048 sc1
  buffer_load_dwordx4 v[44:47], v5, s[48:51], s100 offen offset:3072 sc1
  buffer_load_dwordx4 v[48:51], v5, s[48:51], s101 offen offset:0 sc1
  buffer_load_dwordx4 v[52:55], v5, s[48:51], s101 offen offset:1024 sc1
  buffer_load_dwordx4 v[56:59], v5, s[48:51], s101 offen offset:2048 sc1
  buffer_load_dwordx4 v[60:63], v5, s[48:51], s101 offen offset:3072 sc1
  s_sub_u32 s65, s65, 1
  s_cbranch_scc1 L_abort
  s_waitcnt vmcnt(8)
  v_max_u32 v84, v65, v67
  v_mov_b32 v66, v64
  s_nop 1
  v_max_f32_dpp v66, v66, v66 quad_perm:[1,0,3,2] row_mask:0xf bank_mask:0xf
  s_nop 1
  v_max_f32_dpp v66, v66, v66 quad_perm:[2,3,0,1] row_mask:0xf bank_mask:0xf
  s_nop 1
  v_max_f32_dpp v66, v66, v66 row_half_mirror row_mask:0xf bank_mask:0xf
  v_sub_f32 v67, v64, v66
  v_exp_f32 v67, v67
  s_waitcnt vmcnt(4)
  v_max3_u32 v84, v84, v33, v35
  v_max3_u32 v84, v84, v37, v39
  v_mul_f32 v65, v67, v65
  v_max3_u32 v84, v84, v41, v43
  v_max3_u32 v84, v84, v45, v47
  v_add_f32_dpp v65, v65, v65 quad_perm:[1,0,3,2] row_mask:0xf bank_mask:0xf
  s_waitcnt vmcnt(0)
  v_max3_u32 v84, v84, v49, v51
  v_max3_u32 v84, v84, v53, v55
  v_add_f32_dpp v65, v65, v65 quad_perm:[2,3,0,1] row_mask:0xf bank_mask:0xf
  v_max3_u32 v84, v84, v57, v59
  v_max3_u32 v84, v84, v61, v63
  v_add_f32_dpp v65, v65, v65 row_half_mirror row_mask:0xf bank_mask:0xf
  v_rcp_f32 v65, v65
  s_nop 0
  v_mul_f32 v67, v67, v65
  s_nop 0
  v_readlane_b32 s4, v67, 0
  v_readlane_b32 s6, v67, 1
  v_readlane_b32 s8, v67, 2
  v_readlane_b32 s10, v67, 3
  v_readlane_b32 s12, v67, 4
  v_readlane_b32 s16, v67, 5
  v_readlane_b32 s18, v67, 6
  v_readlane_b32 s20, v67, 7
  v_pk_mul_f32 v[68:69], v[32:33], s[4:5] op_sel_hi:[1,0]
  v_pk_mul_f32 v[70:71], v[34:35], s[4:5] op_sel_hi:[1,0]
  v_pk_fma_f32 v[68:69], v[36:37], s[6:7], v[68:69] op_sel_hi:[1,0,1]
  v_pk_fma_f32 v[70:71], v[38:39], s[6:7], v[70:71] op_sel_hi:[1,0,1]
  v_pk_fma_f32 v[68:69], v[40:41], s[8:9], v[68:69] op_sel_hi:[1,0,1]
  v_pk_fma_f32 v[70:71], v[42:43], s[8:9], v[70:71] op_sel_hi:[1,0,1]
  v_pk_fma_f32 v[68:69], v[44:45], s[10:11], v[68:69] op_sel_hi:[1,0,1]
  v_pk_fma_f32 v[70:71], v[46:47], s[10:11], v[70:71] op_sel_hi:[1,0,1]
  v_pk_fma_f32 v[68:69], v[48:49], s[12:13], v[68:69] op_sel_hi:[1,0,1]
  v_pk_fma_f32 v[70:71], v[50:51], s[12:13], v[70:71] op_sel_hi:[1,0,1]
  v_pk_fma_f32 v[68:69], v[52:53], s[16:17], v[68:69] op_sel_hi:[1,0,1]
  v_pk_fma_f32 v[70:71], v[54:55], s[16:17], v[70:71] op_sel_hi:[1,0,1]
  v_pk_fma_f32 v[68:69], v[56:57], s[18:19], v[68:69] op_sel_hi:[1,0,1]
  v_pk_fma_f32 v[70:71], v[58:59], s[18:19], v[70:71] op_sel_hi:[1,0,1]
  v_pk_fma_f32 v[68:69], v[60:61], s[20:21], v[68:69] op_sel_hi:[1,0,1]
  v_pk_fma_f32 v[70:71], v[62:63], s[20:21], v[70:71] op_sel_hi:[1,0,1]
  v_cmp_eq_u32 vcc, -1, v84
  s_cbranch_vccnz L_fpoll_233
  v_cvt_pk_bf16_f32 v68, v68, v69
  v_cvt_pk_bf16_f32 v69, v70, v71
  ds_write_b64 v28, v[68:69] offset:7360
  ds_read_b128 v[32:35], v9 offset:0
  ds_read_b128 v[36:39], v9 offset:64
  ds_read_b128 v[40:43], v9 offset:128
  ds_read_b128 v[44:47], v9 offset:192
  ds_read_b128 v[48:51], v9 offset:256
  ds_read_b128 v[52:55], v9 offset:320
  s_add_u32 s63, s59, 3932160
  s_waitcnt lgkmcnt(5)
  v_mfma_f32_16x16x32_bf16 v[56:59], a[120:123], v[32:35], 0
  s_waitcnt lgkmcnt(4)
  v_mfma_f32_16x16x32_bf16 v[56:59], a[124:127], v[36:39], v[56:59]
  s_waitcnt lgkmcnt(3)
  v_mfma_f32_16x16x32_bf16 v[56:59], a[128:131], v[40:43], v[56:59]
  s_waitcnt lgkmcnt(2)
  v_mfma_f32_16x16x32_bf16 v[56:59], a[132:135], v[44:47], v[56:59]
  s_waitcnt lgkmcnt(1)
  v_mfma_f32_16x16x32_bf16 v[56:59], a[136:139], v[48:51], v[56:59]
  s_waitcnt lgkmcnt(0)
  v_mfma_f32_16x16x32_bf16 v[56:59], a[140:143], v[52:55], v[56:59]
  v_mfma_f32_16x16x32_bf16 v[60:63], a[144:147], v[32:35], 0
  v_mfma_f32_16x16x32_bf16 v[60:63], a[148:151], v[36:39], v[60:63]
  v_mfma_f32_16x16x32_bf16 v[60:63], a[152:155], v[40:43], v[60:63]
  v_mfma_f32_16x16x32_bf16 v[60:63], a[156:159], v[44:47], v[60:63]
  v_mfma_f32_16x16x32_bf16 v[60:63], a[160:163], v[48:51], v[60:63]
  v_mfma_f32_16x16x32_bf16 v[60:63], a[164:167], v[52:55], v[60:63]
  v_mfma_f32_16x16x32_bf16 v[64:67], a[168:171], v[32:35], 0
  v_mfma_f32_16x16x32_bf16 v[64:67], a[172:175], v[36:39], v[64:67]
  v_mfma_f32_16x16x32_bf16 v[64:67], a[176:179], v[40:43], v[64:67]
  v_mfma_f32_16x16x32_bf16 v[64:67], a[180:183], v[44:47], v[64:67]
  v_mfma_f32_16x16x32_bf16 v[64:67], a[184:187], v[48:51], v[64:67]
  v_mfma_f32_16x16x32_bf16 v[64:67], a[188:191], v[52:55], v[64:67]
  buffer_store_dwordx4 v[56:59], v6, s[48:51], s63 offen offset:0 sc1
  s_nop 1
  v_mfma_f32_16x16x32_bf16 v[56:59], a[192:195], v[32:35], 0
  v_mfma_f32_16x16x32_bf16 v[56:59], a[196:199], v[36:39], v[56:59]
  v_mfma_f32_16x16x32_bf16 v[56:59], a[200:203], v[40:43], v[56:59]
  v_mfma_f32_16x16x32_bf16 v[56:59], a[204:207], v[44:47], v[56:59]
  v_mfma_f32_16x16x32_bf16 v[56:59], a[208:211], v[48:51], v[56:59]
  v_mfma_f32_16x16x32_bf16 v[56:59], a[212:215], v[52:55], v[56:59]
  buffer_store_dwordx4 v[60:63], v6, s[48:51], s63 offen offset:64 sc1
  s_nop 1
  v_mfma_f32_16x16x32_bf16 v[60:63], a[216:219], v[32:35], 0
  v_mfma_f32_16x16x32_bf16 v[60:63], a[220:223], v[36:39], v[60:63]
  v_mfma_f32_16x16x32_bf16 v[60:63], a[224:227], v[40:43], v[60:63]
  v_mfma_f32_16x16x32_bf16 v[60:63], a[228:231], v[44:47], v[60:63]
  v_mfma_f32_16x16x32_bf16 v[60:63], a[232:235], v[48:51], v[60:63]
  v_mfma_f32_16x16x32_bf16 v[60:63], a[236:239], v[52:55], v[60:63]
  buffer_store_dwordx4 v[64:67], v6, s[48:51], s63 offen offset:128 sc1
  buffer_store_dwordx4 v[56:59], v6, s[48:51], s63 offen offset:192 sc1
  s_nop 5
  buffer_store_dwordx4 v[60:63], v6, s[48:51], s63 offen offset:256 sc1
  s_lshl_b32 s66, s30, 12
  s_add_u32 s66, s66, 3932160
  s_add_u32 s4, s66, 0
  s_add_u32 s6, s66, 32768
  s_add_u32 s8, s66, 65536
  s_add_u32 s10, s66, 98304
  s_add_u32 s12, s66, 131072
  s_add_u32 s16, s66, 163840
  s_add_u32 s18, s66, 196608
  s_add_u32 s20, s66, 229376
  s_mov_b32 s65, 400000
  s_sleep 16
L_fpoll_234:
  buffer_load_dwordx4 v[64:67], v73, s[48:51], s4 offen offset:0 sc1
  buffer_load_dwordx4 v[68:71], v73, s[48:51], s12 offen offset:0 sc1
  buffer_load_dwordx4 v[32:35], v72, s[48:51], s4 offen offset:0 sc1
  buffer_load_dwordx4 v[36:39], v72, s[48:51], s6 offen offset:0 sc1
  buffer_load_dwordx4 v[40:43], v72, s[48:51], s8 offen offset:0 sc1
  buffer_load_dwordx4 v[44:47], v72, s[48:51], s10 offen offset:0 sc1
  buffer_load_dwordx4 v[48:51], v72, s[48:51], s12 offen offset:0 sc1
  buffer_load_dwordx4 v[52:55], v72, s[48:51], s16 offen offset:0 sc1
  buffer_load_dwordx4 v[56:59], v72, s[48:51], s18 offen offset:0 sc1
  buffer_load_dwordx4 v[60:63], v72, s[48:51], s20 offen offset:0 sc1
  s_sub_u32 s65, s65, 1
  s_cbranch_scc1 L_abort
  s_waitcnt vmcnt(8)
  v_max_u32 v84, v65, v67
  v_max3_u32 v84, v84, v69, v71
  v_pk_add_f32 v[64:65], v[64:65], v[68:69]
  v_pk_add_f32 v[66:67], v[66:67], v[70:71]
  s_nop 0
  v_add_f32_dpp v64, v64, v64 row_ror:4 row_mask:0xf bank_mask:0xf
  v_add_f32_dpp v65, v65, v65 row_ror:4 row_mask:0xf bank_mask:0xf
  v_add_f32_dpp v66, v66, v66 row_ror:4 row_mask:0xf bank_mask:0xf
  v_add_f32_dpp v67, v67, v67 row_ror:4 row_mask:0xf bank_mask:0xf
  v_add_f32_dpp v64, v64, v64 row_ror:8 row_mask:0xf bank_mask:0xf
  v_add_f32_dpp v65, v65, v65 row_ror:8 row_mask:0xf bank_mask:0xf
  v_add_f32_dpp v66, v66, v66 row_ror:8 row_mask:0xf bank_mask:0xf
  v_add_f32_dpp v67, v67, v67 row_ror:8 row_mask:0xf bank_mask:0xf
  s_waitcnt vmcnt(6)
  v_max3_u32 v84, v84, v33, v35
  v_max3_u32 v84, v84, v37, v39
  v_pk_add_f32 v[32:33], v[32:33], v[36:37]
  v_pk_add_f32 v[34:35], v[34:35], v[38:39]
  v_mov_b32 v68, v64
  v_mov_b32 v69, v65
  v_mov_b32 v70, v66
  v_mov_b32 v71, v67
  v_permlane16_swap_b32 v64, v68
  v_permlane16_swap_b32 v65, v69
  v_permlane16_swap_b32 v66, v70
  v_permlane16_swap_b32 v67, v71
  v_pk_add_f32 v[64:65], v[64:65], v[68:69]
  v_pk_add_f32 v[66:67], v[66:67], v[70:71]
  v_mov_b32 v68, v64
  v_mov_b32 v69, v65
  v_mov_b32 v70, v66
  v_mov_b32 v71, v67
  v_permlane32_swap_b32 v64, v68
  v_permlane32_swap_b32 v65, v69
  v_permlane32_swap_b32 v66, v70
  v_permlane32_swap_b32 v67, v71
  v_pk_add_f32 v[64:65], v[64:65], v[68:69]
  v_pk_add_f32 v[66:67], v[66:67], v[70:71]
  s_waitcnt vmcnt(4)
  v_max3_u32 v84, v84, v41, v43
  v_max3_u32 v84, v84, v45, v47
  v_pk_add_f32 v[40:41], v[40:41], v[44:45]
  v_pk_add_f32 v[42:43], v[42:43], v[46:47]
  v_pk_add_f32 v[32:33], v[32:33], v[40:41]
  v_pk_add_f32 v[34:35], v[34:35], v[42:43]
  s_waitcnt vmcnt(2)
  v_max3_u32 v84, v84, v49, v51
  v_max3_u32 v84, v84, v53, v55
  v_pk_add_f32 v[48:49], v[48:49], v[52:53]
  v_pk_add_f32 v[50:51], v[50:51], v[54:55]
  v_pk_add_f32 v[32:33], v[32:33], v[48:49]
  v_pk_add_f32 v[34:35], v[34:35], v[50:51]
  s_waitcnt vmcnt(1)
  v_max3_u32 v84, v84, v57, v59
  v_pk_add_f32 v[32:33], v[32:33], v[56:57]
  v_pk_add_f32 v[34:35], v[34:35], v[58:59]
  s_waitcnt vmcnt(0)
  v_max3_u32 v84, v84, v61, v63
  v_pk_add_f32 v[32:33], v[32:33], v[60:61]
  v_pk_add_f32 v[34:35], v[34:35], v[62:63]
  v_cmp_eq_u32 vcc, -1, v84
  s_cbranch_vccnz L_fpoll_234
  v_mov_b32 v68, v32
  v_mov_b32 v69, v33
  v_mov_b32 v70, v34
  v_mov_b32 v71, v35
  v_permlane16_swap_b32 v32, v68
  v_permlane16_swap_b32 v33, v69
  v_permlane16_swap_b32 v34, v70
  v_permlane16_swap_b32 v35, v71
  v_pk_add_f32 v[32:33], v[32:33], v[68:69]
  v_pk_add_f32 v[34:35], v[34:35], v[70:71]
  v_mov_b32 v68, v32
  v_mov_b32 v69, v33
  v_mov_b32 v70, v34
  v_mov_b32 v71, v35
  v_permlane32_swap_b32 v32, v68
  v_permlane32_swap_b32 v33, v69
  v_permlane32_swap_b32 v34, v70
  v_permlane32_swap_b32 v35, v71
  v_pk_add_f32 v[32:33], v[32:33], v[68:69]
  v_pk_add_f32 v[34:35], v[34:35], v[70:71]
  s_mov_b32 vcc_lo, 0xffff0000
  s_mov_b32 vcc_hi, 0xffff0000
  v_cndmask_b32 v32, v32, v64, vcc
  v_cndmask_b32 v33, v33, v65, vcc
  v_cndmask_b32 v34, v34, v66, vcc
  v_cndmask_b32 v35, v35, v67, vcc
  s_mov_b32 vcc_lo, 0x00000000
  s_mov_b32 vcc_hi, 0x000fffff
  v_cndmask_b32 v32, 0, v32, vcc
  v_cndmask_b32 v33, 0, v33, vcc
  v_cndmask_b32 v34, 0, v34, vcc
  v_cndmask_b32 v35, 0, v35, vcc
  v_pk_add_f32 v[32:33], v[32:33], v[16:17]
  v_pk_add_f32 v[34:35], v[34:35], v[18:19]
  v_cvt_pk_bf16_f32 v36, v32, v33
  v_cvt_pk_bf16_f32 v37, v34, v35
  ds_write_b64 v29, v[36:37]
  ds_read_b128 v[40:43], v10
  ds_read_b128 v[44:47], v10 offset:64
  ds_read_b64 v[48:49], v11
  v_mov_b32 v50, 0
  v_mov_b32 v51, 0
  ds_read_b128 v[52:55], v14
  ds_read_b128 v[56:59], v14 offset:64
  ds_read_b64 v[60:61], v15
  v_mov_b32 v62, 0
  v_mov_b32 v63, 0
  s_add_u32 s63, s57, 2883584
  v_lshlrev_b32 v16, 16, v36
  v_and_b32 v17, 0xffff0000, v36
  v_lshlrev_b32 v18, 16, v37
  v_and_b32 v19, 0xffff0000, v37
  s_add_u32 s100, s58, 2883584
  s_add_u32 s101, s100, 4096
  s_waitcnt lgkmcnt(5)
  v_mfma_f32_16x16x32_bf16 v[64:67], v[198:201], v[40:43], 0
  s_waitcnt lgkmcnt(4)
  v_mfma_f32_16x16x32_bf16 v[64:67], v[202:205], v[44:47], v[64:67]
  s_waitcnt lgkmcnt(3)
  v_mfma_f32_16x16x32_bf16 v[64:67], v[196:199], v[48:51], v[64:67]
  v_mfma_f32_16x16x32_bf16 v[68:71], v[228:231], v[40:43], 0
  v_mfma_f32_16x16x32_bf16 v[68:71], v[232:235], v[44:47], v[68:71]
  v_mfma_f32_16x16x32_bf16 v[68:71], v[226:229], v[48:51], v[68:71]
  s_waitcnt lgkmcnt(0)
  v_mfma_f32_16x16x32_bf16 v[32:35], v[52:55], v[40:43], 0
  v_mfma_f32_16x16x32_bf16 v[32:35], v[56:59], v[44:47], v[32:35]
  v_mfma_f32_16x16x32_bf16 v[32:35], v[60:63], v[48:51], v[32:35]
  v_mfma_f32_16x16x32_bf16 v[52:55], v[208:211], v[40:43], 0
  v_mfma_f32_16x16x32_bf16 v[52:55], v[212:215], v[44:47], v[52:55]
  v_mfma_f32_16x16x32_bf16 v[52:55], v[206:209], v[48:51], v[52:55]
  v_mfma_f32_16x16x32_bf16 v[56:59], v[238:241], v[40:43], 0
  v_mfma_f32_16x16x32_bf16 v[56:59], v[242:245], v[44:47], v[56:59]
  v_mfma_f32_16x16x32_bf16 v[56:59], v[236:239], v[48:51], v[56:59]
  v_swap_b32 v66, v68
  v_swap_b32 v67, v69
  buffer_store_dwordx4 v[64:67], v7, s[48:51], s63 offen offset:0 sc1
  buffer_store_dwordx4 v[68:71], v7, s[48:51], s63 offen offset:16 sc1
  v_cndmask_b32 v33, v33, v34, s[74:75]
  v_mfma_f32_16x16x32_bf16 v[64:67], v[218:221], v[40:43], 0
  v_mfma_f32_16x16x32_bf16 v[64:67], v[222:225], v[44:47], v[64:67]
  v_mfma_f32_16x16x32_bf16 v[64:67], v[216:219], v[48:51], v[64:67]
  v_mfma_f32_16x16x32_bf16 v[68:71], v[248:251], v[40:43], 0
  v_mfma_f32_16x16x32_bf16 v[68:71], v[252:255], v[44:47], v[68:71]
  v_mfma_f32_16x16x32_bf16 v[68:71], v[246:249], v[48:51], v[68:71]
  v_swap_b32 v54, v56
  v_swap_b32 v55, v57
  buffer_store_dwordx4 v[52:55], v7, s[48:51], s63 offen offset:128 sc1
  buffer_store_dwordx4 v[56:59], v7, s[48:51], s63 offen offset:144 sc1
  s_nop 3
  v_swap_b32 v66, v68
  v_swap_b32 v67, v69
  buffer_store_dwordx4 v[64:67], v7, s[48:51], s63 offen offset:256 sc1
  buffer_store_dwordx4 v[68:71], v7, s[48:51], s63 offen offset:272 sc1
  buffer_store_dwordx4 v[32:35], v81, s[48:51], s63 offen offset:0 sc1
  s_mov_b32 s65, 400000
L_fpoll_235:
  buffer_load_dwordx4 v[64:67], v80, s[48:51], s100 offen offset:0 sc1
  buffer_load_dwordx4 v[32:35], v79, s[48:51], s100 offen offset:0 sc1
  buffer_load_dwordx4 v[36:39], v79, s[48:51], s100 offen offset:1024 sc1
  buffer_load_dwordx4 v[40:43], v79, s[48:51], s100 offen offset:2048 sc1
  buffer_load_dwordx4 v[44:47], v79, s[48:51], s100 offen offset:3072 sc1
  buffer_load_dwordx4 v[48:51], v79, s[48:51], s101 offen offset:0 sc1
  buffer_load_dwordx4 v[52:55], v79, s[48:51], s101 offen offset:1024 sc1
  buffer_load_dwordx4 v[56:59], v79, s[48:51], s101 offen offset:2048 sc1
  buffer_load_dwordx4 v[60:63], v79, s[48:51], s101 offen offset:3072 sc1
  s_sub_u32 s65, s65, 1
  s_cbranch_scc1 L_abort
  s_waitcnt vmcnt(8)
  v_max_u32 v84, v65, v67
  v_add_f32_dpp v64, v64, v64 quad_perm:[1,0,3,2] row_mask:0xf bank_mask:0xf
  v_add_f32_dpp v65, v65, v65 quad_perm:[1,0,3,2] row_mask:0xf bank_mask:0xf
  s_waitcnt vmcnt(6)
  v_max3_u32 v84, v84, v33, v35
  v_add_f32_dpp v64, v64, v64 quad_perm:[2,3,0,1] row_mask:0xf bank_mask:0xf
  v_add_f32_dpp v65, v65, v65 quad_perm:[2,3,0,1] row_mask:0xf bank_mask:0xf
  v_max3_u32 v84, v84, v37, v39
  v_add_f32_dpp v64, v64, v64 row_half_mirror row_mask:0xf bank_mask:0xf
  v_add_f32_dpp v65, v65, v65 row_half_mirror row_mask:0xf bank_mask:0xf
  v_pk_add_f32 v[32:33], v[32:33], v[36:37]
  v_pk_add_f32 v[34:35], v[34:35], v[38:39]
  v_mul_f32 v66, 0x3acccccd, v64
  v_mul_f32 v65, 0x3acccccd, v65
  s_waitcnt vmcnt(4)
  v_max3_u32 v84, v84, v41, v43
  v_max3_u32 v84, v84, v45, v47
  v_fma_f32 v65, -v66, v66, v65
  v_pk_add_f32 v[40:41], v[40:41], v[44:45]
  v_pk_add_f32 v[42:43], v[42:43], v[46:47]
  v_max_f32 v65, 0, v65
  v_add_f32 v65, 0x3727c5ac, v65
  v_pk_add_f32 v[32:33], v[32:33], v[40:41]
  v_pk_add_f32 v[34:35], v[34:35], v[42:43]
  v_rsq_f32 v67, v65
  s_waitcnt vmcnt(2)
  v_max3_u32 v84, v84, v49, v51
  v_max3_u32 v84, v84, v53, v55
  v_pk_mul_f32 v[68:69], v[24:25], v[66:67] op_sel_hi:[1,0]
  v_pk_mul_f32 v[70:71], v[26:27], v[66:67] op_sel_hi:[1,0]
  v_pk_add_f32 v[48:49], v[48:49], v[52:53]
  v_pk_add_f32 v[50:51], v[50:51], v[54:55]
  v_pk_add_f32 v[32:33], v[32:33], v[68:69] neg_lo:[0,1] neg_hi:[0,1]
  v_pk_add_f32 v[34:35], v[34:35], v[70:71] neg_lo:[0,1] neg_hi:[0,1]
  v_pk_add_f32 v[32:33], v[32:33], v[48:49]
  v_pk_add_f32 v[34:35], v[34:35], v[50:51]
  s_waitcnt vmcnt(1)
  v_max3_u32 v84, v84, v57, v59
  v_pk_add_f32 v[32:33], v[32:33], v[56:57]
  v_pk_add_f32 v[34:35], v[34:35], v[58:59]
  s_waitcnt vmcnt(0)
  v_max3_u32 v84, v84, v61, v63
  v_pk_add_f32 v[32:33], v[32:33], v[60:61]
  v_pk_add_f32 v[34:35], v[34:35], v[62:63]
  v_cmp_eq_u32 vcc, -1, v84
  s_cbranch_vccnz L_fpoll_235
  v_pk_mul_f32 v[32:33], v[32:33], v[66:67] op_sel:[0,1] op_sel_hi:[1,1]
  v_pk_mul_f32 v[34:35], v[34:35], v[66:67] op_sel:[0,1] op_sel_hi:[1,1]
  v_max_f32 v32, 0, v32
  v_max_f32 v33, 0, v33
  v_pk_mul_f32 v[32:33], v[32:33], v[34:35]
  v_cvt_pk_bf16_f32 v32, v32, v33
  ds_write_b32 v30, v32
  ds_read_b128 v[32:35], v12
  ds_read_b64 v[36:37], v13
  v_mov_b32 v38, 0
  v_mov_b32 v39, 0
  s_add_u32 s63, s59, 4194304
  s_waitcnt lgkmcnt(1)
  v_mfma_f32_16x16x32_bf16 v[40:43], a[240:243], v[32:35], 0
  s_waitcnt lgkmcnt(0)
  v_mfma_f32_16x16x32_bf16 v[40:43], v[186:189], v[36:39], v[40:43]
  v_mfma_f32_16x16x32_bf16 v[44:47], a[244:247], v[32:35], 0
  v_mfma_f32_16x16x32_bf16 v[44:47], v[188:191], v[36:39], v[44:47]
  v_mfma_f32_16x16x32_bf16 v[48:51], a[248:251], v[32:35], 0
  v_mfma_f32_16x16x32_bf16 v[48:51], v[190:193], v[36:39], v[48:51]
  v_mfma_f32_16x16x32_bf16 v[52:55], a[252:255], v[32:35], 0
  v_mfma_f32_16x16x32_bf16 v[52:55], v[192:195], v[36:39], v[52:55]
  v_mfma_f32_16x16x32_bf16 v[56:59], v[182:185], v[32:35], 0
  v_mfma_f32_16x16x32_bf16 v[56:59], v[194:197], v[36:39], v[56:59]
  buffer_store_dwordx4 v[40:43], v6, s[48:51], s63 offen offset:0 sc1
  s_nop 0
  buffer_store_dwordx4 v[44:47], v6, s[48:51], s63 offen offset:64 sc1
  s_nop 0
  buffer_store_dwordx4 v[48:51], v6, s[48:51], s63 offen offset:128 sc1
  s_nop 0
  buffer_store_dwordx4 v[52:55], v6, s[48:51], s63 offen offset:192 sc1
  s_nop 0
  buffer_store_dwordx4 v[56:59], v6, s[48:51], s63 offen offset:256 sc1
  s_lshl_b32 s66, s30, 12
  s_add_u32 s66, s66, 4194304
  s_add_u32 s4, s66, 0
  s_add_u32 s6, s66, 32768
  s_add_u32 s8, s66, 65536
  s_add_u32 s10, s66, 98304
  s_add_u32 s12, s66, 131072
  s_add_u32 s16, s66, 163840
  s_add_u32 s18, s66, 196608
  s_add_u32 s20, s66, 229376
  s_mov_b32 s65, 400000
  s_sleep 16
L_fpoll_236:
  buffer_load_dwordx4 v[64:67], v73, s[48:51], s4 offen offset:0 sc1
  buffer_load_dwordx4 v[68:71], v73, s[48:51], s12 offen offset:0 sc1
  buffer_load_dwordx4 v[32:35], v72, s[48:51], s4 offen offset:0 sc1
  buffer_load_dwordx4 v[36:39], v72, s[48:51], s6 offen offset:0 sc1
  buffer_load_dwordx4 v[40:43], v72, s[48:51], s8 offen offset:0 sc1
  buffer_load_dwordx4 v[44:47], v72, s[48:51], s10 offen offset:0 sc1
  buffer_load_dwordx4 v[48:51], v72, s[48:51], s12 offen offset:0 sc1
  buffer_load_dwordx4 v[52:55], v72, s[48:51], s16 offen offset:0 sc1
  buffer_load_dwordx4 v[56:59], v72, s[48:51], s18 offen offset:0 sc1
  buffer_load_dwordx4 v[60:63], v72, s[48:51], s20 offen offset:0 sc1
  s_sub_u32 s65, s65, 1
  s_cbranch_scc1 L_abort
  s_waitcnt vmcnt(8)
  v_max_u32 v84, v65, v67
  v_max3_u32 v84, v84, v69, v71
  v_pk_add_f32 v[64:65], v[64:65], v[68:69]
  v_pk_add_f32 v[66:67], v[66:67], v[70:71]
  s_nop 0
  v_add_f32_dpp v64, v64, v64 row_ror:4 row_mask:0xf bank_mask:0xf
  v_add_f32_dpp v65, v65, v65 row_ror:4 row_mask:0xf bank_mask:0xf
  v_add_f32_dpp v66, v66, v66 row_ror:4 row_mask:0xf bank_mask:0xf
  v_add_f32_dpp v67, v67, v67 row_ror:4 row_mask:0xf bank_mask:0xf
  v_add_f32_dpp v64, v64, v64 row_ror:8 row_mask:0xf bank_mask:0xf
  v_add_f32_dpp v65, v65, v65 row_ror:8 row_mask:0xf bank_mask:0xf
  v_add_f32_dpp v66, v66, v66 row_ror:8 row_mask:0xf bank_mask:0xf
  v_add_f32_dpp v67, v67, v67 row_ror:8 row_mask:0xf bank_mask:0xf
  s_waitcnt vmcnt(6)
  v_max3_u32 v84, v84, v33, v35
  v_max3_u32 v84, v84, v37, v39
  v_pk_add_f32 v[32:33], v[32:33], v[36:37]
  v_pk_add_f32 v[34:35], v[34:35], v[38:39]
  v_mov_b32 v68, v64
  v_mov_b32 v69, v65
  v_mov_b32 v70, v66
  v_mov_b32 v71, v67
  v_permlane16_swap_b32 v64, v68
  v_permlane16_swap_b32 v65, v69
  v_permlane16_swap_b32 v66, v70
  v_permlane16_swap_b32 v67, v71
  v_pk_add_f32 v[64:65], v[64:65], v[68:69]
  v_pk_add_f32 v[66:67], v[66:67], v[70:71]
  v_mov_b32 v68, v64
  v_mov_b32 v69, v65
  v_mov_b32 v70, v66
  v_mov_b32 v71, v67
  v_permlane32_swap_b32 v64, v68
  v_permlane32_swap_b32 v65, v69
  v_permlane32_swap_b32 v66, v70
  v_permlane32_swap_b32 v67, v71
  v_pk_add_f32 v[64:65], v[64:65], v[68:69]
  v_pk_add_f32 v[66:67], v[66:67], v[70:71]
  s_waitcnt vmcnt(4)
  v_max3_u32 v84, v84, v41, v43
  v_max3_u32 v84, v84, v45, v47
  v_pk_add_f32 v[40:41], v[40:41], v[44:45]
  v_pk_add_f32 v[42:43], v[42:43], v[46:47]
  v_pk_add_f32 v[32:33], v[32:33], v[40:41]
  v_pk_add_f32 v[34:35], v[34:35], v[42:43]
  s_waitcnt vmcnt(2)
  v_max3_u32 v84, v84, v49, v51
  v_max3_u32 v84, v84, v53, v55
  v_pk_add_f32 v[48:49], v[48:49], v[52:53]
  v_pk_add_f32 v[50:51], v[50:51], v[54:55]
  v_pk_add_f32 v[32:33], v[32:33], v[48:49]
  v_pk_add_f32 v[34:35], v[34:35], v[50:51]
  s_waitcnt vmcnt(1)
  v_max3_u32 v84, v84, v57, v59
  v_pk_add_f32 v[32:33], v[32:33], v[56:57]
  v_pk_add_f32 v[34:35], v[34:35], v[58:59]
  s_waitcnt vmcnt(0)
  v_max3_u32 v84, v84, v61, v63
  v_pk_add_f32 v[32:33], v[32:33], v[60:61]
  v_pk_add_f32 v[34:35], v[34:35], v[62:63]
  v_cmp_eq_u32 vcc, -1, v84
  s_cbranch_vccnz L_fpoll_236
  v_mov_b32 v68, v32
  v_mov_b32 v69, v33
  v_mov_b32 v70, v34
  v_mov_b32 v71, v35
  v_permlane16_swap_b32 v32, v68
  v_permlane16_swap_b32 v33, v69
  v_permlane16_swap_b32 v34, v70
  v_permlane16_swap_b32 v35, v71
  v_pk_add_f32 v[32:33], v[32:33], v[68:69]
  v_pk_add_f32 v[34:35], v[34:35], v[70:71]
  v_mov_b32 v68, v32
  v_mov_b32 v69, v33
  v_mov_b32 v70, v34
  v_mov_b32 v71, v35
  v_permlane32_swap_b32 v32, v68
  v_permlane32_swap_b32 v33, v69
  v_permlane32_swap_b32 v34, v70
  v_permlane32_swap_b32 v35, v71
  v_pk_add_f32 v[32:33], v[32:33], v[68:69]
  v_pk_add_f32 v[34:35], v[34:35], v[70:71]
  s_mov_b32 vcc_lo, 0xffff0000
  s_mov_b32 vcc_hi, 0xffff0000
  v_cndmask_b32 v32, v32, v64, vcc
  v_cndmask_b32 v33, v33, v65, vcc
  v_cndmask_b32 v34, v34, v66, vcc
  v_cndmask_b32 v35, v35, v67, vcc
  s_mov_b32 vcc_lo, 0x00000000
  s_mov_b32 vcc_hi, 0x000fffff
  v_cndmask_b32 v32, 0, v32, vcc
  v_cndmask_b32 v33, 0, v33, vcc
  v_cndmask_b32 v34, 0, v34, vcc
  v_cndmask_b32 v35, 0, v35, vcc
  v_pk_add_f32 v[32:33], v[32:33], v[16:17]
  v_pk_add_f32 v[34:35], v[34:35], v[18:19]
  v_cvt_pk_bf16_f32 v36, v32, v33
  v_cvt_pk_bf16_f32 v37, v34, v35
  ds_write_b64 v29, v[36:37]
  ds_read_b128 v[40:43], v10
  ds_read_b128 v[44:47], v10 offset:64
  ds_read_b64 v[48:49], v11
  v_mov_b32 v50, 0
  v_mov_b32 v51, 0
  ds_read_b128 v[52:55], v14
  ds_read_b128 v[56:59], v14 offset:64
  ds_read_b64 v[60:61], v15
  v_mov_b32 v62, 0
  v_mov_b32 v63, 0
  s_add_u32 s63, s57, 1835008
  v_lshlrev_b32 v16, 16, v36
  v_and_b32 v17, 0xffff0000, v36
  v_lshlrev_b32 v18, 16, v37
  v_and_b32 v19, 0xffff0000, v37
  s_add_u32 s100, s58, 2097152
  s_add_u32 s101, s100, 4096
  s_waitcnt lgkmcnt(5)
  v_mfma_f32_16x16x32_bf16 v[64:67], a[2:5], v[40:43], 0
  s_waitcnt lgkmcnt(4)
  v_mfma_f32_16x16x32_bf16 v[64:67], a[6:9], v[44:47], v[64:67]
  s_waitcnt lgkmcnt(3)
  v_mfma_f32_16x16x32_bf16 v[64:67], a[0:3], v[48:51], v[64:67]
  s_waitcnt lgkmcnt(0)
  v_mfma_f32_16x16x32_bf16 v[36:39], v[52:55], v[40:43], 0
  v_mfma_f32_16x16x32_bf16 v[36:39], v[56:59], v[44:47], v[36:39]
  v_mfma_f32_16x16x32_bf16 v[36:39], v[60:63], v[48:51], v[36:39]
  v_mfma_f32_16x16x32_bf16 v[68:71], a[12:15], v[40:43], 0
  v_mfma_f32_16x16x32_bf16 v[68:71], a[16:19], v[44:47], v[68:71]
  v_mfma_f32_16x16x32_bf16 v[68:71], a[10:13], v[48:51], v[68:71]
  v_mfma_f32_16x16x32_bf16 v[32:35], a[22:25], v[40:43], 0
  v_mfma_f32_16x16x32_bf16 v[32:35], a[26:29], v[44:47], v[32:35]
  v_mfma_f32_16x16x32_bf16 v[32:35], a[20:23], v[48:51], v[32:35]
  v_mfma_f32_16x16x32_bf16 v[52:55], a[32:35], v[40:43], 0
  v_mfma_f32_16x16x32_bf16 v[52:55], a[36:39], v[44:47], v[52:55]
  v_mfma_f32_16x16x32_bf16 v[52:55], a[30:33], v[48:51], v[52:55]
  buffer_store_dwordx4 v[64:67], v8, s[48:51], s63 offen offset:0 sc1
  s_nop 1
  v_mfma_f32_16x16x32_bf16 v[64:67], a[42:45], v[40:43], 0
  v_mfma_f32_16x16x32_bf16 v[64:67], a[46:49], v[44:47], v[64:67]
  v_mfma_f32_16x16x32_bf16 v[64:67], a[40:43], v[48:51], v[64:67]
  buffer_store_dwordx4 v[68:71], v8, s[48:51], s63 offen offset:64 sc1
  s_nop 1
  v_mfma_f32_16x16x32_bf16 v[68:71], a[52:55], v[40:43], 0
  v_mfma_f32_16x16x32_bf16 v[68:71], a[56:59], v[44:47], v[68:71]
  v_mfma_f32_16x16x32_bf16 v[68:71], a[50:53], v[48:51], v[68:71]
  buffer_store_dwordx4 v[32:35], v8, s[48:51], s63 offen offset:128 sc1
  s_nop 1
  v_mfma_f32_16x16x32_bf16 v[32:35], a[62:65], v[40:43], 0
  v_mfma_f32_16x16x32_bf16 v[32:35], a[66:69], v[44:47], v[32:35]
  v_mfma_f32_16x16x32_bf16 v[32:35], a[60:63], v[48:51], v[32:35]
  buffer_store_dwordx4 v[52:55], v8, s[48:51], s63 offen offset:192 sc1
  s_nop 1
  v_mfma_f32_16x16x32_bf16 v[52:55], a[72:75], v[40:43], 0
  v_mfma_f32_16x16x32_bf16 v[52:55], a[76:79], v[44:47], v[52:55]
  v_mfma_f32_16x16x32_bf16 v[52:55], a[70:73], v[48:51], v[52:55]
  buffer_store_dwordx4 v[64:67], v8, s[48:51], s63 offen offset:256 sc1
  s_nop 1
  v_mfma_f32_16x16x32_bf16 v[64:67], a[82:85], v[40:43], 0
  v_mfma_f32_16x16x32_bf16 v[64:67], a[86:89], v[44:47], v[64:67]
  v_mfma_f32_16x16x32_bf16 v[64:67], a[80:83], v[48:51], v[64:67]
  buffer_store_dwordx4 v[68:71], v8, s[48:51], s63 offen offset:320 sc1
  s_nop 1
  v_mfma_f32_16x16x32_bf16 v[68:71], a[92:95], v[40:43], 0
  v_mfma_f32_16x16x32_bf16 v[68:71], a[96:99], v[44:47], v[68:71]
  v_mfma_f32_16x16x32_bf16 v[68:71], a[90:93], v[48:51], v[68:71]
  buffer_store_dwordx4 v[32:35], v8, s[48:51], s63 offen offset:384 sc1
  s_nop 1
  v_mfma_f32_16x16x32_bf16 v[32:35], a[102:105], v[40:43], 0
  v_mfma_f32_16x16x32_bf16 v[32:35], a[106:109], v[44:47], v[32:35]
  v_mfma_f32_16x16x32_bf16 v[32:35], a[100:103], v[48:51], v[32:35]
  buffer_store_dwordx4 v[52:55], v8, s[48:51], s63 offen offset:448 sc1
  s_nop 1
  v_mfma_f32_16x16x32_bf16 v[52:55], a[112:115], v[40:43], 0
  v_mfma_f32_16x16x32_bf16 v[52:55], a[116:119], v[44:47], v[52:55]
  v_mfma_f32_16x16x32_bf16 v[52:55], a[110:113], v[48:51], v[52:55]
  buffer_store_dwordx4 v[64:67], v8, s[48:51], s63 offen offset:512 sc1
  v_cndmask_b32 v37, v37, v38, s[74:75]
  buffer_store_dwordx4 v[68:71], v8, s[48:51], s63 offen offset:576 sc1
  buffer_store_dwordx4 v[32:35], v8, s[48:51], s63 offen offset:640 sc1
  s_nop 3
  buffer_store_dwordx4 v[52:55], v8, s[48:51], s63 offen offset:704 sc1
  buffer_store_dwordx4 v[36:39], v82, s[48:51], s63 offen offset:0 sc1
  s_mov_b32 s65, 400000
L_fpoll_237:
  buffer_load_dwordx4 v[64:67], v31, s[48:51], s100 offen offset:0 sc1
  buffer_load_dwordx4 v[32:35], v5, s[48:51], s100 offen offset:0 sc1
  buffer_load_dwordx4 v[36:39], v5, s[48:51], s100 offen offset:1024 sc1
  buffer_load_dwordx4 v[40:43], v5, s[48:51], s100 offen offset:2048 sc1
  buffer_load_dwordx4 v[44:47], v5, s[48:51], s100 offen offset:3072 sc1
  buffer_load_dwordx4 v[48:51], v5, s[48:51], s101 offen offset:0 sc1
  buffer_load_dwordx4 v[52:55], v5, s[48:51], s101 offen offset:1024 sc1
  buffer_load_dwordx4 v[56:59], v5, s[48:51], s101 offen offset:2048 sc1
  buffer_load_dwordx4 v[60:63], v5, s[48:51], s101 offen offset:3072 sc1
  s_sub_u32 s65, s65, 1
  s_cbranch_scc1 L_abort
  s_waitcnt vmcnt(8)
  v_max_u32 v84, v65, v67
  v_add_f32_dpp v64, v64, v64 quad_perm:[1,0,3,2] row_mask:0xf bank_mask:0xf
  v_add_f32_dpp v65, v65, v65 quad_perm:[1,0,3,2] row_mask:0xf bank_mask:0xf
  s_waitcnt vmcnt(6)
  v_max3_u32 v84, v84, v33, v35
  v_add_f32_dpp v64, v64, v64 quad_perm:[2,3,0,1] row_mask:0xf bank_mask:0xf
  v_add_f32_dpp v65, v65, v65 quad_perm:[2,3,0,1] row_mask:0xf bank_mask:0xf
  v_max3_u32 v84, v84, v37, v39
  v_add_f32_dpp v64, v64, v64 row_half_mirror row_mask:0xf bank_mask:0xf
  v_add_f32_dpp v65, v65, v65 row_half_mirror row_mask:0xf bank_mask:0xf
  v_pk_add_f32 v[32:33], v[32:33], v[36:37]
  v_pk_add_f32 v[34:35], v[34:35], v[38:39]
  v_mul_f32 v66, 0x3acccccd, v64
  v_mul_f32 v65, 0x3acccccd, v65
  s_waitcnt vmcnt(4)
  v_max3_u32 v84, v84, v41, v43
  v_max3_u32 v84, v84, v45, v47
  v_fma_f32 v65, -v66, v66, v65
  v_pk_add_f32 v[40:41], v[40:41], v[44:45]
  v_pk_add_f32 v[42:43], v[42:43], v[46:47]
  v_max_f32 v65, 0, v65
  v_add_f32 v65, 0x3727c5ac, v65
  v_pk_add_f32 v[32:33], v[32:33], v[40:41]
  v_pk_add_f32 v[34:35], v[34:35], v[42:43]
  v_rsq_f32 v67, v65
  s_waitcnt vmcnt(2)
  v_max3_u32 v84, v84, v49, v51
  v_max3_u32 v84, v84, v53, v55
  v_pk_mul_f32 v[68:69], v[20:21], v[66:67] op_sel_hi:[1,0]
  v_pk_mul_f32 v[70:71], v[22:23], v[66:67] op_sel_hi:[1,0]
  v_pk_add_f32 v[48:49], v[48:49], v[52:53]
  v_pk_add_f32 v[50:51], v[50:51], v[54:55]
  v_pk_add_f32 v[32:33], v[32:33], v[68:69] neg_lo:[0,1] neg_hi:[0,1]
  v_pk_add_f32 v[34:35], v[34:35], v[70:71] neg_lo:[0,1] neg_hi:[0,1]
  v_pk_add_f32 v[32:33], v[32:33], v[48:49]
  v_pk_add_f32 v[34:35], v[34:35], v[50:51]
  s_waitcnt vmcnt(1)
  v_max3_u32 v84, v84, v57, v59
  v_pk_add_f32 v[32:33], v[32:33], v[56:57]
  v_pk_add_f32 v[34:35], v[34:35], v[58:59]
  s_waitcnt vmcnt(0)
  v_max3_u32 v84, v84, v61, v63
  v_pk_add_f32 v[32:33], v[32:33], v[60:61]
  v_pk_add_f32 v[34:35], v[34:35], v[62:63]
  v_cmp_eq_u32 vcc, -1, v84
  s_cbranch_vccnz L_fpoll_237
  v_pk_mul_f32 v[32:33], v[32:33], v[66:67] op_sel:[0,1] op_sel_hi:[1,1]
  v_pk_mul_f32 v[34:35], v[34:35], v[66:67] op_sel:[0,1] op_sel_hi:[1,1]
  v_cvt_pk_bf16_f32 v32, v32, v33
  v_cvt_pk_bf16_f32 v33, v34, v35
  ds_write_b64 v28, v[32:33] offset:6592
  s_waitcnt lgkmcnt(0)
  s_barrier
  v_mbcnt_lo_u32_b32 v57, -1, 0
  v_mbcnt_hi_u32_b32 v57, -1, v57
  v_and_b32 v58, 1, v57
  v_lshrrev_b32 v59, 4, v57
  v_lshlrev_b32 v59, 4, v59
  v_lshl_add_u32 v58, v58, 6, v59
  v_add_u32 v58, 159808, v58
  v_add_u32 v63, s69, v59
  v_lshrrev_b32 v59, 5, v57
  v_lshlrev_b32 v62, 6, v59
  v_bfe_u32 v59, v57, 1, 2
  v_lshl_add_u32 v62, v59, 4, v62
  v_bfe_u32 v59, v57, 3, 2
  v_lshl_add_u32 v62, v59, 2, v62
  v_and_b32 v59, 1, v57
  v_lshl_add_u32 v62, v59, 1, v62
  v_add_u32 v62, s69, v62
  v_mov_b32 v56, 0xff800000
  ds_read_b128 v[32:35], v58 offset:384
  ds_read_b128 v[36:39], v58 offset:512
  ds_read_b128 v[40:43], v58 offset:640
  s_waitcnt lgkmcnt(0)
  v_mfma_f32_16x16x32_bf16 v[44:47], v[32:35], v[86:89], 0
  v_mfma_f32_16x16x32_bf16 v[44:47], v[36:39], v[90:93], v[44:47]
  v_mfma_f32_16x16x32_bf16 v[44:47], v[40:43], v[94:97], v[44:47]
  v_mfma_f32_16x16x32_bf16 v[48:51], v[32:35], v[98:101], 0
  v_mfma_f32_16x16x32_bf16 v[48:51], v[36:39], v[102:105], v[48:51]
  v_mfma_f32_16x16x32_bf16 v[48:51], v[40:43], v[106:109], v[48:51]
  v_mfma_f32_16x16x32_bf16 v[52:55], v[32:35], v[110:113], 0
  v_mfma_f32_16x16x32_bf16 v[52:55], v[36:39], v[114:117], v[52:55]
  v_mfma_f32_16x16x32_bf16 v[52:55], v[40:43], v[118:121], v[52:55]
  s_nop 1
  v_add_f32_dpp v56, v45, v44 row_ror:8 row_mask:0x1 bank_mask:0x3
  v_mfma_f32_16x16x32_bf16 v[44:47], v[32:35], v[122:125], 0
  v_mfma_f32_16x16x32_bf16 v[44:47], v[36:39], v[126:129], v[44:47]
  v_mfma_f32_16x16x32_bf16 v[44:47], v[40:43], v[130:133], v[44:47]
  v_add_f32_dpp v56, v48, v49 row_ror:8 row_mask:0x1 bank_mask:0xc
  s_nop 0
  v_add_f32_dpp v56, v53, v52 row_ror:8 row_mask:0x2 bank_mask:0x3
  s_nop 4
  v_add_f32_dpp v56, v44, v45 row_ror:8 row_mask:0x2 bank_mask:0xc
  v_mov_b32 v44, v56
  s_nop 1
  v_max_f32_dpp v44, v44, v44 row_ror:8 row_mask:0xf bank_mask:0xf
  s_nop 1
  v_max_f32_dpp v44, v44, v44 row_ror:4 row_mask:0xf bank_mask:0xf
  s_nop 1
  v_max_f32_dpp v44, v44, v44 row_ror:2 row_mask:0xf bank_mask:0xf
  s_nop 1
  v_max_f32_dpp v44, v44, v44 row_ror:1 row_mask:0xf bank_mask:0xf
  v_mov_b32 v45, v44
  s_nop 1
  v_permlane16_swap_b32 v44, v45
  v_max_f32 v44, v44, v45
  v_mov_b32 v45, v44
  s_nop 1
  v_permlane32_swap_b32 v44, v45
  v_max_f32 v44, v44, v45
  v_mul_f32 v60, s56, v44
  v_fma_f32 v56, v56, s56, -v60
  v_exp_f32 v56, v56
  s_nop 0
  v_cvt_pk_bf16_f32 v46, v56, v56
  ds_write_b16 v62, v46 offset:0
  v_mov_b32 v61, v56
  ds_read_b128 v[52:55], v63
  s_nop 0
  v_add_f32_dpp v61, v61, v61 row_ror:8 row_mask:0xf bank_mask:0xf
  s_nop 1
  v_add_f32_dpp v61, v61, v61 row_ror:4 row_mask:0xf bank_mask:0xf
  s_nop 1
  v_add_f32_dpp v61, v61, v61 row_ror:2 row_mask:0xf bank_mask:0xf
  s_nop 1
  v_add_f32_dpp v61, v61, v61 row_ror:1 row_mask:0xf bank_mask:0xf
  v_mov_b32 v59, v61
  s_nop 1
  v_permlane16_swap_b32 v61, v59
  v_add_f32 v61, v61, v59
  v_mov_b32 v59, v61
  s_nop 1
  v_permlane32_swap_b32 v61, v59
  v_add_f32 v61, v61, v59
  s_waitcnt lgkmcnt(0)
  v_perm_b32 v44, v52, v52, v75
  v_perm_b32 v45, v52, v52, v76
  v_perm_b32 v46, v52, v52, v77
  v_perm_b32 v47, v52, v52, v78
  s_nop 1
  v_mfma_f32_16x16x32_bf16 v[32:35], v[44:47], v[134:137], 0
  v_perm_b32 v48, v53, v53, v75
  v_perm_b32 v49, v53, v53, v76
  v_mfma_f32_16x16x32_bf16 v[36:39], v[44:47], v[138:141], 0
  v_perm_b32 v50, v53, v53, v77
  v_perm_b32 v51, v53, v53, v78
  v_mfma_f32_16x16x32_bf16 v[40:43], v[44:47], v[142:145], 0
  s_nop 0
  v_mfma_f32_16x16x32_bf16 v[32:35], v[48:51], v[146:149], v[32:35]
  v_perm_b32 v44, v54, v54, v75
  v_perm_b32 v45, v54, v54, v76
  v_mfma_f32_16x16x32_bf16 v[36:39], v[48:51], v[150:153], v[36:39]
  v_perm_b32 v46, v54, v54, v77
  v_perm_b32 v47, v54, v54, v78
  v_mfma_f32_16x16x32_bf16 v[40:43], v[48:51], v[154:157], v[40:43]
  s_nop 0
  v_mfma_f32_16x16x32_bf16 v[32:35], v[44:47], v[158:161], v[32:35]
  v_perm_b32 v48, v55, v55, v75
  v_perm_b32 v49, v55, v55, v76
  v_mfma_f32_16x16x32_bf16 v[36:39], v[44:47], v[162:165], v[36:39]
  v_perm_b32 v50, v55, v55, v77
  v_perm_b32 v51, v55, v55, v78
  v_mfma_f32_16x16x32_bf16 v[40:43], v[44:47], v[166:169], v[40:43]
  s_nop 0
  v_mfma_f32_16x16x32_bf16 v[32:35], v[48:51], v[170:173], v[32:35]
  v_mfma_f32_16x16x32_bf16 v[36:39], v[48:51], v[174:177], v[36:39]
  v_mfma_f32_16x16x32_bf16 v[40:43], v[48:51], v[178:181], v[40:43]
  v_mbcnt_lo_u32_b32 v52, -1, 0
  v_mbcnt_hi_u32_b32 v52, -1, v52
  v_and_b32 v53, 15, v52
  v_lshrrev_b32 v54, 4, v52
  v_and_b32 v55, 1, v54
  v_lshrrev_b32 v54, 1, v54
  v_mul_u32_u24 v54, 768, v54
  v_lshl_add_u32 v54, v55, 4, v54
  v_add_u32 v54, s69, v54
  v_lshl_add_u32 v56, v53, 5, v54
  v_and_b32 v53, 7, v53
  v_lshl_add_u32 v57, v53, 5, v54
  v_mov_b32 v58, s72
  v_mov_b32 v44, v60
  v_mov_b32 v45, v61
  v_cndmask_b32 v32, v32, v36, s[70:71]
  v_cndmask_b32 v33, v33, v37, s[70:71]
  v_cndmask_b32 v34, v34, v38, s[70:71]
  v_cndmask_b32 v35, v35, v39, s[70:71]
  ds_write_b128 v56, v[32:35]
  s_mov_b32 exec_lo, 0x00ff00ff
  s_mov_b32 exec_hi, 0xff00ff00
  ds_write_b128 v57, v[40:43] offset:512
  s_mov_b64 exec, 1
  ds_write_b64 v58, v[44:45] offset:0
  s_mov_b64 exec, -1
  s_waitcnt lgkmcnt(0)
  v_and_b32 v84, 31, v0
  v_lshlrev_b32 v84, 4, v84
  v_lshrrev_b32 v85, 5, v0
  v_lshl_add_u32 v84, v85, 9, v84
  s_mov_b32 vcc_lo, 0x000fffff
  s_mov_b32 vcc_hi, 0x000fffff
  v_cndmask_b32 v4, v74, v84, vcc
  s_mov_b32 vcc_lo, 0x00ffffff
  s_mov_b32 vcc_hi, 0x00ffffff
  v_cndmask_b32 v79, v74, v84, vcc
  v_lshrrev_b32 v84, 4, v0
  v_and_b32 v85, 15, v0
  v_lshlrev_b32 v72, 10, v84
  v_lshl_add_u32 v72, v85, 4, v72
  v_add_u32 v72, 512, v72
  v_lshlrev_b32 v73, 15, v84
  v_bfe_u32 v85, v0, 2, 2
  v_lshl_add_u32 v73, v85, 10, v73
  v_and_b32 v85, 3, v0
  v_lshl_add_u32 v73, v85, 4, v73
  v_add_u32 v73, 768, v73
  v_lshrrev_b32 v85, 5, v0
  v_and_b32 v84, 7, v0
  v_lshlrev_b32 v84, 10, v84
  v_lshl_add_u32 v84, v85, 9, v84
  v_add_u32 v84, 384, v84
  s_mov_b32 vcc_lo, 0xffffffff
  s_mov_b32 vcc_hi, 0xffffffff
  v_cndmask_b32 v80, v74, v84, vcc
  v_and_b32 v84, 15, v0
  v_lshrrev_b32 v85, 4, v0
  v_lshlrev_b32 v6, 9, v84
  v_lshl_add_u32 v7, v85, 5, v6
  v_add_u32 v81, 384, v6
  v_lshl_add_u32 v6, v85, 4, v6
  v_lshlrev_b32 v8, 18, v84
  v_add_u32 v82, 768, v8
  v_lshl_add_u32 v8, v85, 4, v8
  s_mov_b32 vcc_lo, 0x00030003
  s_mov_b32 vcc_hi, 0x00030003
  v_cndmask_b32 v6, v74, v6, vcc
  v_cndmask_b32 v7, v74, v7, vcc
  s_mov_b32 vcc_lo, 0x00000003
  s_mov_b32 vcc_hi, 0x00000000
  v_cndmask_b32 v81, v74, v81, vcc
  s_mov_b32 vcc_lo, 0x00030003
  s_mov_b32 vcc_hi, 0x00030003
  v_cndmask_b32 v8, v74, v8, vcc
  s_mov_b32 vcc_lo, 0x00000003
  s_mov_b32 vcc_hi, 0x00000000
  v_cndmask_b32 v82, v74, v82, vcc
  s_add_u32 s100, s58, 262144
  s_add_u32 s101, s100, 4096
  s_mov_b32 s65, 400000
L_fpoll_238:
  buffer_load_dwordx4 v[64:67], v31, s[48:51], s100 offen offset:0 sc1
  buffer_load_dwordx4 v[32:35], v5, s[48:51], s100 offen offset:0 sc1
  buffer_load_dwordx4 v[36:39], v5, s[48:51], s100 offen offset:1024 sc1
  buffer_load_dwordx4 v[40:43], v5, s[48:51], s100 offen offset:2048 sc1
  buffer_load_dwordx4 v[44:47], v5, s[48:51], s100 offen offset:3072 sc1
  buffer_load_dwordx4 v[48:51], v5, s[48:51], s101 offen offset:0 sc1
  buffer_load_dwordx4 v[52:55], v5, s[48:51], s101 offen offset:1024 sc1
  buffer_load_dwordx4 v[56:59], v5, s[48:51], s101 offen offset:2048 sc1
  buffer_load_dwordx4 v[60:63], v5, s[48:51], s101 offen offset:3072 sc1
  s_sub_u32 s65, s65, 1
  s_cbranch_scc1 L_abort
  s_waitcnt vmcnt(8)
  v_max_u32 v84, v65, v67
  v_mov_b32 v66, v64
  s_nop 1
  v_max_f32_dpp v66, v66, v66 quad_perm:[1,0,3,2] row_mask:0xf bank_mask:0xf
  s_nop 1
  v_max_f32_dpp v66, v66, v66 quad_perm:[2,3,0,1] row_mask:0xf bank_mask:0xf
  s_nop 1
  v_max_f32_dpp v66, v66, v66 row_half_mirror row_mask:0xf bank_mask:0xf
  v_sub_f32 v67, v64, v66
  v_exp_f32 v67, v67
  s_waitcnt vmcnt(4)
  v_max3_u32 v84, v84, v33, v35
  v_max3_u32 v84, v84, v37, v39
  v_mul_f32 v65, v67, v65
  v_max3_u32 v84, v84, v41, v43
  v_max3_u32 v84, v84, v45, v47
  v_add_f32_dpp v65, v65, v65 quad_perm:[1,0,3,2] row_mask:0xf bank_mask:0xf
  s_waitcnt vmcnt(0)
  v_max3_u32 v84, v84, v49, v51
  v_max3_u32 v84, v84, v53, v55
  v_add_f32_dpp v65, v65, v65 quad_perm:[2,3,0,1] row_mask:0xf bank_mask:0xf
  v_max3_u32 v84, v84, v57, v59
  v_max3_u32 v84, v84, v61, v63
  v_add_f32_dpp v65, v65, v65 row_half_mirror row_mask:0xf bank_mask:0xf
  v_rcp_f32 v65, v65
  s_nop 0
  v_mul_f32 v67, v67, v65
  s_nop 0
  v_readlane_b32 s4, v67, 0
  v_readlane_b32 s6, v67, 1
  v_readlane_b32 s8, v67, 2
  v_readlane_b32 s10, v67, 3
  v_readlane_b32 s12, v67, 4
  v_readlane_b32 s16, v67, 5
  v_readlane_b32 s18, v67, 6
  v_readlane_b32 s20, v67, 7
  v_pk_mul_f32 v[68:69], v[32:33], s[4:5] op_sel_hi:[1,0]
  v_pk_mul_f32 v[70:71], v[34:35], s[4:5] op_sel_hi:[1,0]
  v_pk_fma_f32 v[68:69], v[36:37], s[6:7], v[68:69] op_sel_hi:[1,0,1]
  v_pk_fma_f32 v[70:71], v[38:39], s[6:7], v[70:71] op_sel_hi:[1,0,1]
  v_pk_fma_f32 v[68:69], v[40:41], s[8:9], v[68:69] op_sel_hi:[1,0,1]
  v_pk_fma_f32 v[70:71], v[42:43], s[8:9], v[70:71] op_sel_hi:[1,0,1]
  v_pk_fma_f32 v[68:69], v[44:45], s[10:11], v[68:69] op_sel_hi:[1,0,1]
  v_pk_fma_f32 v[70:71], v[46:47], s[10:11], v[70:71] op_sel_hi:[1,0,1]
  v_pk_fma_f32 v[68:69], v[48:49], s[12:13], v[68:69] op_sel_hi:[1,0,1]
  v_pk_fma_f32 v[70:71], v[50:51], s[12:13], v[70:71] op_sel_hi:[1,0,1]
  v_pk_fma_f32 v[68:69], v[52:53], s[16:17], v[68:69] op_sel_hi:[1,0,1]
  v_pk_fma_f32 v[70:71], v[54:55], s[16:17], v[70:71] op_sel_hi:[1,0,1]
  v_pk_fma_f32 v[68:69], v[56:57], s[18:19], v[68:69] op_sel_hi:[1,0,1]
  v_pk_fma_f32 v[70:71], v[58:59], s[18:19], v[70:71] op_sel_hi:[1,0,1]
  v_pk_fma_f32 v[68:69], v[60:61], s[20:21], v[68:69] op_sel_hi:[1,0,1]
  v_pk_fma_f32 v[70:71], v[62:63], s[20:21], v[70:71] op_sel_hi:[1,0,1]
  v_cmp_eq_u32 vcc, -1, v84
  s_cbranch_vccnz L_fpoll_238
  v_cvt_pk_bf16_f32 v68, v68, v69
  v_cvt_pk_bf16_f32 v69, v70, v71
  ds_write_b64 v28, v[68:69] offset:6976
  s_waitcnt lgkmcnt(0)
  s_barrier
  v_mov_b32 v84, 159744
  ds_read_b128 v[32:35], v84
  ds_read_b128 v[36:39], v84 offset:16
  v_add_u32 v85, 153600, v83
  ds_read_b128 v[40:43], v85 offset:0
  ds_read_b128 v[44:47], v85 offset:768
  ds_read_b128 v[48:51], v85 offset:1536
  ds_read_b128 v[52:55], v85 offset:2304
  ds_read_b128 v[56:59], v85 offset:3072
  ds_read_b128 v[60:63], v85 offset:3840
  ds_read_b128 v[64:67], v85 offset:4608
  ds_read_b128 v[68:71], v85 offset:5376
  s_add_u32 s63, s57, 786432
  s_waitcnt lgkmcnt(8)
  v_max3_f32 v84, v32, v34, v36
  v_max_f32 v84, v84, v38
  v_sub_f32 v32, v32, v84
  v_sub_f32 v34, v34, v84
  v_sub_f32 v36, v36, v84
  v_sub_f32 v38, v38, v84
  v_exp_f32 v32, v32
  v_exp_f32 v34, v34
  v_exp_f32 v36, v36
  v_exp_f32 v38, v38
  v_mul_f32 v85, v32, v33
  v_fma_f32 v85, v34, v35, v85
  v_fma_f32 v85, v36, v37, v85
  v_fma_f32 v85, v38, v39, v85
  s_waitcnt lgkmcnt(6)
  v_pk_add_f32 v[40:41], v[40:41], v[44:45]
  v_pk_add_f32 v[42:43], v[42:43], v[46:47]
  v_mul_f32 v40, v32, v40
  v_mul_f32 v41, v32, v41
  v_mul_f32 v42, v32, v42
  v_mul_f32 v43, v32, v43
  s_waitcnt lgkmcnt(4)
  v_pk_add_f32 v[48:49], v[48:49], v[52:53]
  v_pk_add_f32 v[50:51], v[50:51], v[54:55]
  v_fmac_f32 v40, v34, v48
  v_fmac_f32 v41, v34, v49
  v_fmac_f32 v42, v34, v50
  v_fmac_f32 v43, v34, v51
  s_waitcnt lgkmcnt(2)
  v_pk_add_f32 v[56:57], v[56:57], v[60:61]
  v_pk_add_f32 v[58:59], v[58:59], v[62:63]
  v_fmac_f32 v40, v36, v56
  v_fmac_f32 v41, v36, v57
  v_fmac_f32 v42, v36, v58
  v_fmac_f32 v43, v36, v59
  s_waitcnt lgkmcnt(0)
  v_pk_add_f32 v[64:65], v[64:65], v[68:69]
  v_pk_add_f32 v[66:67], v[66:67], v[70:71]
  v_fmac_f32 v40, v38, v64
  v_fmac_f32 v41, v38, v65
  v_fmac_f32 v42, v38, v66
  v_fmac_f32 v43, v38, v67
  s_mov_b32 vcc_lo, 0
  s_mov_b32 vcc_hi, 0x00010000
  v_cndmask_b32 v40, v40, v84, vcc
  v_cndmask_b32 v41, v41, v85, vcc
  buffer_store_dwordx4 v[40:43], v5, s[48:51], s63 offen offset:0 sc1
  s_add_u32 s100, s58, 786432
  s_add_u32 s101, s100, 4096
  s_mov_b32 s65, 400000
L_fpoll_239:
  buffer_load_dwordx4 v[64:67], v31, s[48:51], s100 offen offset:0 sc1
  buffer_load_dwordx4 v[32:35], v5, s[48:51], s100 offen offset:0 sc1
  buffer_load_dwordx4 v[36:39], v5, s[48:51], s100 offen offset:1024 sc1
  buffer_load_dwordx4 v[40:43], v5, s[48:51], s100 offen offset:2048 sc1
  buffer_load_dwordx4 v[44:47], v5, s[48:51], s100 offen offset:3072 sc1
  buffer_load_dwordx4 v[48:51], v5, s[48:51], s101 offen offset:0 sc1
  buffer_load_dwordx4 v[52:55], v5, s[48:51], s101 offen offset:1024 sc1
  buffer_load_dwordx4 v[56:59], v5, s[48:51], s101 offen offset:2048 sc1
  buffer_load_dwordx4 v[60:63], v5, s[48:51], s101 offen offset:3072 sc1
  s_sub_u32 s65, s65, 1
  s_cbranch_scc1 L_abort
  s_waitcnt vmcnt(8)
  v_max_u32 v84, v65, v67
  v_mov_b32 v66, v64
  s_nop 1
  v_max_f32_dpp v66, v66, v66 quad_perm:[1,0,3,2] row_mask:0xf bank_mask:0xf
  s_nop 1
  v_max_f32_dpp v66, v66, v66 quad_perm:[2,3,0,1] row_mask:0xf bank_mask:0xf
  s_nop 1
  v_max_f32_dpp v66, v66, v66 row_half_mirror row_mask:0xf bank_mask:0xf
  v_sub_f32 v67, v64, v66
  v_exp_f32 v67, v67
  s_waitcnt vmcnt(4)
  v_max3_u32 v84, v84, v33, v35
  v_max3_u32 v84, v84, v37, v39
  v_mul_f32 v65, v67, v65
  v_max3_u32 v84, v84, v41, v43
  v_max3_u32 v84, v84, v45, v47
  v_add_f32_dpp v65, v65, v65 quad_perm:[1,0,3,2] row_mask:0xf bank_mask:0xf
  s_waitcnt vmcnt(0)
  v_max3_u32 v84, v84, v49, v51
  v_max3_u32 v84, v84, v53, v55
  v_add_f32_dpp v65, v65, v65 quad_perm:[2,3,0,1] row_mask:0xf bank_mask:0xf
  v_max3_u32 v84, v84, v57, v59
  v_max3_u32 v84, v84, v61, v63
  v_add_f32_dpp v65, v65, v65 row_half_mirror row_mask:0xf bank_mask:0xf
  v_rcp_f32 v65, v65
  s_nop 0
  v_mul_f32 v67, v67, v65
  s_nop 0
  v_readlane_b32 s4, v67, 0
  v_readlane_b32 s6, v67, 1
  v_readlane_b32 s8, v67, 2
  v_readlane_b32 s10, v67, 3
  v_readlane_b32 s12, v67, 4
  v_readlane_b32 s16, v67, 5
  v_readlane_b32 s18, v67, 6
  v_readlane_b32 s20, v67, 7
  v_pk_mul_f32 v[68:69], v[32:33], s[4:5] op_sel_hi:[1,0]
  v_pk_mul_f32 v[70:71], v[34:35], s[4:5] op_sel_hi:[1,0]
  v_pk_fma_f32 v[68:69], v[36:37], s[6:7], v[68:69] op_sel_hi:[1,0,1]
  v_pk_fma_f32 v[70:71], v[38:39], s[6:7], v[70:71] op_sel_hi:[1,0,1]
  v_pk_fma_f32 v[68:69], v[40:41], s[8:9], v[68:69] op_sel_hi:[1,0,1]
  v_pk_fma_f32 v[70:71], v[42:43], s[8:9], v[70:71] op_sel_hi:[1,0,1]
  v_pk_fma_f32 v[68:69], v[44:45], s[10:11], v[68:69] op_sel_hi:[1,0,1]
  v_pk_fma_f32 v[70:71], v[46:47], s[10:11], v[70:71] op_sel_hi:[1,0,1]
  v_pk_fma_f32 v[68:69], v[48:49], s[12:13], v[68:69] op_sel_hi:[1,0,1]
  v_pk_fma_f32 v[70:71], v[50:51], s[12:13], v[70:71] op_sel_hi:[1,0,1]
  v_pk_fma_f32 v[68:69], v[52:53], s[16:17], v[68:69] op_sel_hi:[1,0,1]
  v_pk_fma_f32 v[70:71], v[54:55], s[16:17], v[70:71] op_sel_hi:[1,0,1]
  v_pk_fma_f32 v[68:69], v[56:57], s[18:19], v[68:69] op_sel_hi:[1,0,1]
  v_pk_fma_f32 v[70:71], v[58:59], s[18:19], v[70:71] op_sel_hi:[1,0,1]
  v_pk_fma_f32 v[68:69], v[60:61], s[20:21], v[68:69] op_sel_hi:[1,0,1]
  v_pk_fma_f32 v[70:71], v[62:63], s[20:21], v[70:71] op_sel_hi:[1,0,1]
  v_cmp_eq_u32 vcc, -1, v84
  s_cbranch_vccnz L_fpoll_239
  v_cvt_pk_bf16_f32 v68, v68, v69
  v_cvt_pk_bf16_f32 v69, v70, v71
  ds_write_b64 v28, v[68:69] offset:7360
  ds_read_b128 v[32:35], v9 offset:0
  ds_read_b128 v[36:39], v9 offset:64
  ds_read_b128 v[40:43], v9 offset:128
  ds_read_b128 v[44:47], v9 offset:192
  ds_read_b128 v[48:51], v9 offset:256
  ds_read_b128 v[52:55], v9 offset:320
  s_add_u32 s63, s59, 4456448
  s_waitcnt lgkmcnt(5)
  v_mfma_f32_16x16x32_bf16 v[56:59], a[120:123], v[32:35], 0
  s_waitcnt lgkmcnt(4)
  v_mfma_f32_16x16x32_bf16 v[56:59], a[124:127], v[36:39], v[56:59]
  s_waitcnt lgkmcnt(3)
  v_mfma_f32_16x16x32_bf16 v[56:59], a[128:131], v[40:43], v[56:59]
  s_waitcnt lgkmcnt(2)
  v_mfma_f32_16x16x32_bf16 v[56:59], a[132:135], v[44:47], v[56:59]
  s_waitcnt lgkmcnt(1)
  v_mfma_f32_16x16x32_bf16 v[56:59], a[136:139], v[48:51], v[56:59]
  s_waitcnt lgkmcnt(0)
  v_mfma_f32_16x16x32_bf16 v[56:59], a[140:143], v[52:55], v[56:59]
  v_mfma_f32_16x16x32_bf16 v[60:63], a[144:147], v[32:35], 0
  v_mfma_f32_16x16x32_bf16 v[60:63], a[148:151], v[36:39], v[60:63]
  v_mfma_f32_16x16x32_bf16 v[60:63], a[152:155], v[40:43], v[60:63]
  v_mfma_f32_16x16x32_bf16 v[60:63], a[156:159], v[44:47], v[60:63]
  v_mfma_f32_16x16x32_bf16 v[60:63], a[160:163], v[48:51], v[60:63]
  v_mfma_f32_16x16x32_bf16 v[60:63], a[164:167], v[52:55], v[60:63]
  v_mfma_f32_16x16x32_bf16 v[64:67], a[168:171], v[32:35], 0
  v_mfma_f32_16x16x32_bf16 v[64:67], a[172:175], v[36:39], v[64:67]
  v_mfma_f32_16x16x32_bf16 v[64:67], a[176:179], v[40:43], v[64:67]
  v_mfma_f32_16x16x32_bf16 v[64:67], a[180:183], v[44:47], v[64:67]
  v_mfma_f32_16x16x32_bf16 v[64:67], a[184:187], v[48:51], v[64:67]
  v_mfma_f32_16x16x32_bf16 v[64:67], a[188:191], v[52:55], v[64:67]
  buffer_store_dwordx4 v[56:59], v6, s[48:51], s63 offen offset:0 sc1
  s_nop 1
  v_mfma_f32_16x16x32_bf16 v[56:59], a[192:195], v[32:35], 0
  v_mfma_f32_16x16x32_bf16 v[56:59], a[196:199], v[36:39], v[56:59]
  v_mfma_f32_16x16x32_bf16 v[56:59], a[200:203], v[40:43], v[56:59]
  v_mfma_f32_16x16x32_bf16 v[56:59], a[204:207], v[44:47], v[56:59]
  v_mfma_f32_16x16x32_bf16 v[56:59], a[208:211], v[48:51], v[56:59]
  v_mfma_f32_16x16x32_bf16 v[56:59], a[212:215], v[52:55], v[56:59]
  buffer_store_dwordx4 v[60:63], v6, s[48:51], s63 offen offset:64 sc1
  s_nop 1
  v_mfma_f32_16x16x32_bf16 v[60:63], a[216:219], v[32:35], 0
  v_mfma_f32_16x16x32_bf16 v[60:63], a[220:223], v[36:39], v[60:63]
  v_mfma_f32_16x16x32_bf16 v[60:63], a[224:227], v[40:43], v[60:63]
  v_mfma_f32_16x16x32_bf16 v[60:63], a[228:231], v[44:47], v[60:63]
  v_mfma_f32_16x16x32_bf16 v[60:63], a[232:235], v[48:51], v[60:63]
  v_mfma_f32_16x16x32_bf16 v[60:63], a[236:239], v[52:55], v[60:63]
  buffer_store_dwordx4 v[64:67], v6, s[48:51], s63 offen offset:128 sc1
  buffer_store_dwordx4 v[56:59], v6, s[48:51], s63 offen offset:192 sc1
  s_nop 5
  buffer_store_dwordx4 v[60:63], v6, s[48:51], s63 offen offset:256 sc1
  s_lshl_b32 s66, s30, 12
  s_add_u32 s66, s66, 4456448
  s_add_u32 s4, s66, 0
  s_add_u32 s6, s66, 32768
  s_add_u32 s8, s66, 65536
  s_add_u32 s10, s66, 98304
  s_add_u32 s12, s66, 131072
  s_add_u32 s16, s66, 163840
  s_add_u32 s18, s66, 196608
  s_add_u32 s20, s66, 229376
  s_mov_b32 s65, 400000
  s_sleep 16
L_fpoll_240:
  buffer_load_dwordx4 v[32:35], v4, s[48:51], s4 offen offset:0 sc1
  buffer_load_dwordx4 v[36:39], v4, s[48:51], s4 offen offset:1024 sc1
  buffer_load_dwordx4 v[40:43], v4, s[48:51], s4 offen offset:2048 sc1
  buffer_load_dwordx4 v[44:47], v4, s[48:51], s4 offen offset:3072 sc1
  buffer_load_dwordx4 v[48:51], v4, s[48:51], s6 offen offset:0 sc1
  buffer_load_dwordx4 v[52:55], v4, s[48:51], s6 offen offset:1024 sc1
  buffer_load_dwordx4 v[56:59], v4, s[48:51], s6 offen offset:2048 sc1
  buffer_load_dwordx4 v[60:63], v4, s[48:51], s6 offen offset:3072 sc1
  buffer_load_dwordx4 v[86:89], v4, s[48:51], s8 offen offset:0 sc1
  buffer_load_dwordx4 v[90:93], v4, s[48:51], s8 offen offset:1024 sc1
  buffer_load_dwordx4 v[94:97], v4, s[48:51], s8 offen offset:2048 sc1
  buffer_load_dwordx4 v[98:101], v4, s[48:51], s8 offen offset:3072 sc1
  buffer_load_dwordx4 v[102:105], v4, s[48:51], s10 offen offset:0 sc1
  buffer_load_dwordx4 v[106:109], v4, s[48:51], s10 offen offset:1024 sc1
  buffer_load_dwordx4 v[110:113], v4, s[48:51], s10 offen offset:2048 sc1
  buffer_load_dwordx4 v[114:117], v4, s[48:51], s10 offen offset:3072 sc1
  buffer_load_dwordx4 v[118:121], v4, s[48:51], s12 offen offset:0 sc1
  buffer_load_dwordx4 v[122:125], v4, s[48:51], s12 offen offset:1024 sc1
  buffer_load_dwordx4 v[126:129], v4, s[48:51], s12 offen offset:2048 sc1
  buffer_load_dwordx4 v[130:133], v4, s[48:51], s12 offen offset:3072 sc1
  buffer_load_dwordx4 v[134:137], v4, s[48:51], s16 offen offset:0 sc1
  buffer_load_dwordx4 v[138:141], v4, s[48:51], s16 offen offset:1024 sc1
  buffer_load_dwordx4 v[142:145], v4, s[48:51], s16 offen offset:2048 sc1
  buffer_load_dwordx4 v[146:149], v4, s[48:51], s16 offen offset:3072 sc1
  buffer_load_dwordx4 v[150:153], v4, s[48:51], s18 offen offset:0 sc1
  buffer_load_dwordx4 v[154:157], v4, s[48:51], s18 offen offset:1024 sc1
  buffer_load_dwordx4 v[158:161], v4, s[48:51], s18 offen offset:2048 sc1
  buffer_load_dwordx4 v[162:165], v4, s[48:51], s18 offen offset:3072 sc1
  buffer_load_dwordx4 v[166:169], v4, s[48:51], s20 offen offset:0 sc1
  buffer_load_dwordx4 v[170:173], v4, s[48:51], s20 offen offset:1024 sc1
  buffer_load_dwordx4 v[174:177], v4, s[48:51], s20 offen offset:2048 sc1
  buffer_load_dwordx4 v[178:181], v4, s[48:51], s20 offen offset:3072 sc1
  s_sub_u32 s65, s65, 1
  s_cbranch_scc1 L_abort
  s_waitcnt vmcnt(30)
  v_max_u32 v84, v33, v35
  v_max3_u32 v84, v84, v37, v39
  v_pk_add_f32 v[32:33], v[32:33], v[16:17]
  v_pk_add_f32 v[34:35], v[34:35], v[18:19]
  s_waitcnt vmcnt(28)
  v_max3_u32 v84, v84, v41, v43
  v_max3_u32 v84, v84, v45, v47
  v_pk_add_f32 v[32:33], v[32:33], v[40:41]
  v_pk_add_f32 v[34:35], v[34:35], v[42:43]
  v_pk_add_f32 v[36:37], v[36:37], v[44:45]
  v_pk_add_f32 v[38:39], v[38:39], v[46:47]
  s_waitcnt vmcnt(26)
  v_max3_u32 v84, v84, v49, v51
  v_max3_u32 v84, v84, v53, v55
  v_pk_add_f32 v[32:33], v[32:33], v[48:49]
  v_pk_add_f32 v[34:35], v[34:35], v[50:51]
  v_pk_add_f32 v[36:37], v[36:37], v[52:53]
  v_pk_add_f32 v[38:39], v[38:39], v[54:55]
  s_waitcnt vmcnt(24)
  v_max3_u32 v84, v84, v57, v59
  v_max3_u32 v84, v84, v61, v63
  v_pk_add_f32 v[32:33], v[32:33], v[56:57]
  v_pk_add_f32 v[34:35], v[34:35], v[58:59]
  v_pk_add_f32 v[36:37], v[36:37], v[60:61]
  v_pk_add_f32 v[38:39], v[38:39], v[62:63]
  s_waitcnt vmcnt(22)
  v_max3_u32 v84, v84, v87, v89
  v_max3_u32 v84, v84, v91, v93
  v_pk_add_f32 v[32:33], v[32:33], v[86:87]
  v_pk_add_f32 v[34:35], v[34:35], v[88:89]
  v_pk_add_f32 v[36:37], v[36:37], v[90:91]
  v_pk_add_f32 v[38:39], v[38:39], v[92:93]
  s_waitcnt vmcnt(20)
  v_max3_u32 v84, v84, v95, v97
  v_max3_u32 v84, v84, v99, v101
  v_pk_add_f32 v[32:33], v[32:33], v[94:95]
  v_pk_add_f32 v[34:35], v[34:35], v[96:97]
  v_pk_add_f32 v[36:37], v[36:37], v[98:99]
  v_pk_add_f32 v[38:39], v[38:39], v[100:101]
  s_waitcnt vmcnt(18)
  v_max3_u32 v84, v84, v103, v105
  v_max3_u32 v84, v84, v107, v109
  v_pk_add_f32 v[32:33], v[32:33], v[102:103]
  v_pk_add_f32 v[34:35], v[34:35], v[104:105]
  v_pk_add_f32 v[36:37], v[36:37], v[106:107]
  v_pk_add_f32 v[38:39], v[38:39], v[108:109]
  s_waitcnt vmcnt(16)
  v_max3_u32 v84, v84, v111, v113
  v_max3_u32 v84, v84, v115, v117
  v_pk_add_f32 v[32:33], v[32:33], v[110:111]
  v_pk_add_f32 v[34:35], v[34:35], v[112:113]
  v_pk_add_f32 v[36:37], v[36:37], v[114:115]
  v_pk_add_f32 v[38:39], v[38:39], v[116:117]
  s_waitcnt vmcnt(14)
  v_max3_u32 v84, v84, v119, v121
  v_max3_u32 v84, v84, v123, v125
  v_pk_add_f32 v[32:33], v[32:33], v[118:119]
  v_pk_add_f32 v[34:35], v[34:35], v[120:121]
  v_pk_add_f32 v[36:37], v[36:37], v[122:123]
  v_pk_add_f32 v[38:39], v[38:39], v[124:125]
  s_waitcnt vmcnt(12)
  v_max3_u32 v84, v84, v127, v129
  v_max3_u32 v84, v84, v131, v133
  v_pk_add_f32 v[32:33], v[32:33], v[126:127]
  v_pk_add_f32 v[34:35], v[34:35], v[128:129]
  v_pk_add_f32 v[36:37], v[36:37], v[130:131]
  v_pk_add_f32 v[38:39], v[38:39], v[132:133]
  s_waitcnt vmcnt(10)
  v_max3_u32 v84, v84, v135, v137
  v_max3_u32 v84, v84, v139, v141
  v_pk_add_f32 v[32:33], v[32:33], v[134:135]
  v_pk_add_f32 v[34:35], v[34:35], v[136:137]
  v_pk_add_f32 v[36:37], v[36:37], v[138:139]
  v_pk_add_f32 v[38:39], v[38:39], v[140:141]
  s_waitcnt vmcnt(8)
  v_max3_u32 v84, v84, v143, v145
  v_max3_u32 v84, v84, v147, v149
  v_pk_add_f32 v[32:33], v[32:33], v[142:143]
  v_pk_add_f32 v[34:35], v[34:35], v[144:145]
  v_pk_add_f32 v[36:37], v[36:37], v[146:147]
  v_pk_add_f32 v[38:39], v[38:39], v[148:149]
  s_waitcnt vmcnt(6)
  v_max3_u32 v84, v84, v151, v153
  v_max3_u32 v84, v84, v155, v157
  v_pk_add_f32 v[32:33], v[32:33], v[150:151]
  v_pk_add_f32 v[34:35], v[34:35], v[152:153]
  v_pk_add_f32 v[36:37], v[36:37], v[154:155]
  v_pk_add_f32 v[38:39], v[38:39], v[156:157]
  s_waitcnt vmcnt(4)
  v_max3_u32 v84, v84, v159, v161
  v_max3_u32 v84, v84, v163, v165
  v_pk_add_f32 v[32:33], v[32:33], v[158:159]
  v_pk_add_f32 v[34:35], v[34:35], v[160:161]
  v_pk_add_f32 v[36:37], v[36:37], v[162:163]
  v_pk_add_f32 v[38:39], v[38:39], v[164:165]
  s_waitcnt vmcnt(2)
  v_max3_u32 v84, v84, v167, v169
  v_max3_u32 v84, v84, v171, v173
  v_pk_add_f32 v[32:33], v[32:33], v[166:167]
  v_pk_add_f32 v[34:35], v[34:35], v[168:169]
  v_pk_add_f32 v[36:37], v[36:37], v[170:171]
  v_pk_add_f32 v[38:39], v[38:39], v[172:173]
  s_waitcnt vmcnt(0)
  v_max3_u32 v84, v84, v175, v177
  v_max3_u32 v84, v84, v179, v181
  v_pk_add_f32 v[32:33], v[32:33], v[174:175]
  v_pk_add_f32 v[34:35], v[34:35], v[176:177]
  v_pk_add_f32 v[36:37], v[36:37], v[178:179]
  v_pk_add_f32 v[38:39], v[38:39], v[180:181]
  v_pk_add_f32 v[32:33], v[32:33], v[36:37]
  v_pk_add_f32 v[34:35], v[34:35], v[38:39]
  v_cmp_eq_u32 vcc, -1, v84
  s_cbranch_vccnz L_fpoll_240
  v_cvt_pk_bf16_f32 v36, v32, v33
  v_cvt_pk_bf16_f32 v37, v34, v35
  ds_write_b64 v29, v[36:37]
  ds_read_b128 v[40:43], v10
  ds_read_b128 v[44:47], v10 offset:64
  ds_read_b64 v[48:49], v11
  v_mov_b32 v50, 0
  v_mov_b32 v51, 0
  ds_read_b128 v[52:55], v14
  ds_read_b128 v[56:59], v14 offset:64
  ds_read_b64 v[60:61], v15
  v_mov_b32 v62, 0
  v_mov_b32 v63, 0
  s_add_u32 s63, s57, 3145728
  v_lshlrev_b32 v16, 16, v36
  v_and_b32 v17, 0xffff0000, v36
  v_lshlrev_b32 v18, 16, v37
  v_and_b32 v19, 0xffff0000, v37
  s_add_u32 s100, s58, 3145728
  s_add_u32 s101, s100, 4096
  s_waitcnt lgkmcnt(5)
  v_mfma_f32_16x16x32_bf16 v[64:67], v[198:201], v[40:43], 0
  s_waitcnt lgkmcnt(4)
  v_mfma_f32_16x16x32_bf16 v[64:67], v[202:205], v[44:47], v[64:67]
  s_waitcnt lgkmcnt(3)
  v_mfma_f32_16x16x32_bf16 v[64:67], v[196:199], v[48:51], v[64:67]
  v_mfma_f32_16x16x32_bf16 v[68:71], v[228:231], v[40:43], 0
  v_mfma_f32_16x16x32_bf16 v[68:71], v[232:235], v[44:47], v[68:71]
  v_mfma_f32_16x16x32_bf16 v[68:71], v[226:229], v[48:51], v[68:71]
  s_waitcnt lgkmcnt(0)
  v_mfma_f32_16x16x32_bf16 v[32:35], v[52:55], v[40:43], 0
  v_mfma_f32_16x16x32_bf16 v[32:35], v[56:59], v[44:47], v[32:35]
  v_mfma_f32_16x16x32_bf16 v[32:35], v[60:63], v[48:51], v[32:35]
  v_mfma_f32_16x16x32_bf16 v[52:55], v[208:211], v[40:43], 0
  v_mfma_f32_16x16x32_bf16 v[52:55], v[212:215], v[44:47], v[52:55]
  v_mfma_f32_16x16x32_bf16 v[52:55], v[206:209], v[48:51], v[52:55]
  v_mfma_f32_16x16x32_bf16 v[56:59], v[238:241], v[40:43], 0
  v_mfma_f32_16x16x32_bf16 v[56:59], v[242:245], v[44:47], v[56:59]
  v_mfma_f32_16x16x32_bf16 v[56:59], v[236:239], v[48:51], v[56:59]
  v_swap_b32 v66, v68
  v_swap_b32 v67, v69
  buffer_store_dwordx4 v[64:67], v7, s[48:51], s63 offen offset:0 sc1
  buffer_store_dwordx4 v[68:71], v7, s[48:51], s63 offen offset:16 sc1
  v_cndmask_b32 v33, v33, v34, s[74:75]
  v_mfma_f32_16x16x32_bf16 v[64:67], v[218:221], v[40:43], 0
  v_mfma_f32_16x16x32_bf16 v[64:67], v[222:225], v[44:47], v[64:67]
  v_mfma_f32_16x16x32_bf16 v[64:67], v[216:219], v[48:51], v[64:67]
  v_mfma_f32_16x16x32_bf16 v[68:71], v[248:251], v[40:43], 0
  v_mfma_f32_16x16x32_bf16 v[68:71], v[252:255], v[44:47], v[68:71]
  v_mfma_f32_16x16x32_bf16 v[68:71], v[246:249], v[48:51], v[68:71]
  v_swap_b32 v54, v56
  v_swap_b32 v55, v57
  buffer_store_dwordx4 v[52:55], v7, s[48:51], s63 offen offset:128 sc1
  buffer_store_dwordx4 v[56:59], v7, s[48:51], s63 offen offset:144 sc1
  s_nop 3
  v_swap_b32 v66, v68
  v_swap_b32 v67, v69
  buffer_store_dwordx4 v[64:67], v7, s[48:51], s63 offen offset:256 sc1
  buffer_store_dwordx4 v[68:71], v7, s[48:51], s63 offen offset:272 sc1
  buffer_store_dwordx4 v[32:35], v81, s[48:51], s63 offen offset:0 sc1
  s_mov_b32 s65, 400000
L_fpoll_241:
  buffer_load_dwordx4 v[64:67], v80, s[48:51], s100 offen offset:0 sc1
  buffer_load_dwordx4 v[32:35], v79, s[48:51], s100 offen offset:0 sc1
  buffer_load_dwordx4 v[36:39], v79, s[48:51], s100 offen offset:1024 sc1
  buffer_load_dwordx4 v[40:43], v79, s[48:51], s100 offen offset:2048 sc1
  buffer_load_dwordx4 v[44:47], v79, s[48:51], s100 offen offset:3072 sc1
  buffer_load_dwordx4 v[48:51], v79, s[48:51], s101 offen offset:0 sc1
  buffer_load_dwordx4 v[52:55], v79, s[48:51], s101 offen offset:1024 sc1
  buffer_load_dwordx4 v[56:59], v79, s[48:51], s101 offen offset:2048 sc1
  buffer_load_dwordx4 v[60:63], v79, s[48:51], s101 offen offset:3072 sc1
  s_sub_u32 s65, s65, 1
  s_cbranch_scc1 L_abort
  s_waitcnt vmcnt(8)
  v_max_u32 v84, v65, v67
  v_add_f32_dpp v64, v64, v64 quad_perm:[1,0,3,2] row_mask:0xf bank_mask:0xf
  v_add_f32_dpp v65, v65, v65 quad_perm:[1,0,3,2] row_mask:0xf bank_mask:0xf
  s_waitcnt vmcnt(6)
  v_max3_u32 v84, v84, v33, v35
  v_add_f32_dpp v64, v64, v64 quad_perm:[2,3,0,1] row_mask:0xf bank_mask:0xf
  v_add_f32_dpp v65, v65, v65 quad_perm:[2,3,0,1] row_mask:0xf bank_mask:0xf
  v_max3_u32 v84, v84, v37, v39
  v_add_f32_dpp v64, v64, v64 row_half_mirror row_mask:0xf bank_mask:0xf
  v_add_f32_dpp v65, v65, v65 row_half_mirror row_mask:0xf bank_mask:0xf
  v_pk_add_f32 v[32:33], v[32:33], v[36:37]
  v_pk_add_f32 v[34:35], v[34:35], v[38:39]
  v_mul_f32 v66, 0x3acccccd, v64
  v_mul_f32 v65, 0x3acccccd, v65
  s_waitcnt vmcnt(4)
  v_max3_u32 v84, v84, v41, v43
  v_max3_u32 v84, v84, v45, v47
  v_fma_f32 v65, -v66, v66, v65
  v_pk_add_f32 v[40:41], v[40:41], v[44:45]
  v_pk_add_f32 v[42:43], v[42:43], v[46:47]
  v_max_f32 v65, 0, v65
  v_add_f32 v65, 0x3727c5ac, v65
  v_pk_add_f32 v[32:33], v[32:33], v[40:41]
  v_pk_add_f32 v[34:35], v[34:35], v[42:43]
  v_rsq_f32 v67, v65
  s_waitcnt vmcnt(2)
  v_max3_u32 v84, v84, v49, v51
  v_max3_u32 v84, v84, v53, v55
  v_pk_mul_f32 v[68:69], v[24:25], v[66:67] op_sel_hi:[1,0]
  v_pk_mul_f32 v[70:71], v[26:27], v[66:67] op_sel_hi:[1,0]
  v_pk_add_f32 v[48:49], v[48:49], v[52:53]
  v_pk_add_f32 v[50:51], v[50:51], v[54:55]
  v_pk_add_f32 v[32:33], v[32:33], v[68:69] neg_lo:[0,1] neg_hi:[0,1]
  v_pk_add_f32 v[34:35], v[34:35], v[70:71] neg_lo:[0,1] neg_hi:[0,1]
  v_pk_add_f32 v[32:33], v[32:33], v[48:49]
  v_pk_add_f32 v[34:35], v[34:35], v[50:51]
  s_waitcnt vmcnt(1)
  v_max3_u32 v84, v84, v57, v59
  v_pk_add_f32 v[32:33], v[32:33], v[56:57]
  v_pk_add_f32 v[34:35], v[34:35], v[58:59]
  s_waitcnt vmcnt(0)
  v_max3_u32 v84, v84, v61, v63
  v_pk_add_f32 v[32:33], v[32:33], v[60:61]
  v_pk_add_f32 v[34:35], v[34:35], v[62:63]
  v_cmp_eq_u32 vcc, -1, v84
  s_cbranch_vccnz L_fpoll_241
  v_pk_mul_f32 v[32:33], v[32:33], v[66:67] op_sel:[0,1] op_sel_hi:[1,1]
  v_pk_mul_f32 v[34:35], v[34:35], v[66:67] op_sel:[0,1] op_sel_hi:[1,1]
  v_max_f32 v32, 0, v32
  v_max_f32 v33, 0, v33
  v_pk_mul_f32 v[32:33], v[32:33], v[34:35]
  v_cvt_pk_bf16_f32 v32, v32, v33
  ds_write_b32 v30, v32
  ds_read_b128 v[32:35], v12
  ds_read_b64 v[36:37], v13
  v_mov_b32 v38, 0
  v_mov_b32 v39, 0
  s_add_u32 s63, s59, 4718592
  s_waitcnt lgkmcnt(1)
  v_mfma_f32_16x16x32_bf16 v[40:43], a[240:243], v[32:35], 0
  s_waitcnt lgkmcnt(0)
  v_mfma_f32_16x16x32_bf16 v[40:43], v[186:189], v[36:39], v[40:43]
  v_mfma_f32_16x16x32_bf16 v[44:47], a[244:247], v[32:35], 0
  v_mfma_f32_16x16x32_bf16 v[44:47], v[188:191], v[36:39], v[44:47]
  v_mfma_f32_16x16x32_bf16 v[48:51], a[248:251], v[32:35], 0
  v_mfma_f32_16x16x32_bf16 v[48:51], v[190:193], v[36:39], v[48:51]
  v_mfma_f32_16x16x32_bf16 v[52:55], a[252:255], v[32:35], 0
  v_mfma_f32_16x16x32_bf16 v[52:55], v[192:195], v[36:39], v[52:55]
  v_mfma_f32_16x16x32_bf16 v[56:59], v[182:185], v[32:35], 0
  v_mfma_f32_16x16x32_bf16 v[56:59], v[194:197], v[36:39], v[56:59]
  buffer_store_dwordx4 v[40:43], v6, s[48:51], s63 offen offset:0 sc1
  s_nop 0
  buffer_store_dwordx4 v[44:47], v6, s[48:51], s63 offen offset:64 sc1
  s_nop 0
  buffer_store_dwordx4 v[48:51], v6, s[48:51], s63 offen offset:128 sc1
  s_nop 0
  buffer_store_dwordx4 v[52:55], v6, s[48:51], s63 offen offset:192 sc1
  s_nop 0
  buffer_store_dwordx4 v[56:59], v6, s[48:51], s63 offen offset:256 sc1
  s_cmp_lg_u32 s31, 0
  s_cbranch_scc1 L_done
  s_lshl_b32 s66, s30, 12
  s_add_u32 s66, s66, 4718592
  s_add_u32 s4, s66, 0
  s_add_u32 s6, s66, 32768
  s_add_u32 s8, s66, 65536
  s_add_u32 s10, s66, 98304
  s_add_u32 s12, s66, 131072
  s_add_u32 s16, s66, 163840
  s_add_u32 s18, s66, 196608
  s_add_u32 s20, s66, 229376
  s_mov_b32 s65, 400000
L_fpoll_242:
  buffer_load_dwordx4 v[32:35], v4, s[48:51], s4 offen offset:0 sc1
  buffer_load_dwordx4 v[36:39], v4, s[48:51], s4 offen offset:1024 sc1
  buffer_load_dwordx4 v[40:43], v4, s[48:51], s4 offen offset:2048 sc1
  buffer_load_dwordx4 v[44:47], v4, s[48:51], s4 offen offset:3072 sc1
  buffer_load_dwordx4 v[48:51], v4, s[48:51], s6 offen offset:0 sc1
  buffer_load_dwordx4 v[52:55], v4, s[48:51], s6 offen offset:1024 sc1
  buffer_load_dwordx4 v[56:59], v4, s[48:51], s6 offen offset:2048 sc1
  buffer_load_dwordx4 v[60:63], v4, s[48:51], s6 offen offset:3072 sc1
  buffer_load_dwordx4 v[86:89], v4, s[48:51], s8 offen offset:0 sc1
  buffer_load_dwordx4 v[90:93], v4, s[48:51], s8 offen offset:1024 sc1
  buffer_load_dwordx4 v[94:97], v4, s[48:51], s8 offen offset:2048 sc1
  buffer_load_dwordx4 v[98:101], v4, s[48:51], s8 offen offset:3072 sc1
  buffer_load_dwordx4 v[102:105], v4, s[48:51], s10 offen offset:0 sc1
  buffer_load_dwordx4 v[106:109], v4, s[48:51], s10 offen offset:1024 sc1
  buffer_load_dwordx4 v[110:113], v4, s[48:51], s10 offen offset:2048 sc1
  buffer_load_dwordx4 v[114:117], v4, s[48:51], s10 offen offset:3072 sc1
  buffer_load_dwordx4 v[118:121], v4, s[48:51], s12 offen offset:0 sc1
  buffer_load_dwordx4 v[122:125], v4, s[48:51], s12 offen offset:1024 sc1
  buffer_load_dwordx4 v[126:129], v4, s[48:51], s12 offen offset:2048 sc1
  buffer_load_dwordx4 v[130:133], v4, s[48:51], s12 offen offset:3072 sc1
  buffer_load_dwordx4 v[134:137], v4, s[48:51], s16 offen offset:0 sc1
  buffer_load_dwordx4 v[138:141], v4, s[48:51], s16 offen offset:1024 sc1
  buffer_load_dwordx4 v[142:145], v4, s[48:51], s16 offen offset:2048 sc1
  buffer_load_dwordx4 v[146:149], v4, s[48:51], s16 offen offset:3072 sc1
  buffer_load_dwordx4 v[150:153], v4, s[48:51], s18 offen offset:0 sc1
  buffer_load_dwordx4 v[154:157], v4, s[48:51], s18 offen offset:1024 sc1
  buffer_load_dwordx4 v[158:161], v4, s[48:51], s18 offen offset:2048 sc1
  buffer_load_dwordx4 v[162:165], v4, s[48:51], s18 offen offset:3072 sc1
  buffer_load_dwordx4 v[166:169], v4, s[48:51], s20 offen offset:0 sc1
  buffer_load_dwordx4 v[170:173], v4, s[48:51], s20 offen offset:1024 sc1
  buffer_load_dwordx4 v[174:177], v4, s[48:51], s20 offen offset:2048 sc1
  buffer_load_dwordx4 v[178:181], v4, s[48:51], s20 offen offset:3072 sc1
  s_sub_u32 s65, s65, 1
  s_cbranch_scc1 L_abort
  s_waitcnt vmcnt(30)
  v_max_u32 v84, v33, v35
  v_max3_u32 v84, v84, v37, v39
  v_pk_add_f32 v[32:33], v[32:33], v[16:17]
  v_pk_add_f32 v[34:35], v[34:35], v[18:19]
  s_waitcnt vmcnt(28)
  v_max3_u32 v84, v84, v41, v43
  v_max3_u32 v84, v84, v45, v47
  v_pk_add_f32 v[32:33], v[32:33], v[40:41]
  v_pk_add_f32 v[34:35], v[34:35], v[42:43]
  v_pk_add_f32 v[36:37], v[36:37], v[44:45]
  v_pk_add_f32 v[38:39], v[38:39], v[46:47]
  s_waitcnt vmcnt(26)
  v_max3_u32 v84, v84, v49, v51
  v_max3_u32 v84, v84, v53, v55
  v_pk_add_f32 v[32:33], v[32:33], v[48:49]
  v_pk_add_f32 v[34:35], v[34:35], v[50:51]
  v_pk_add_f32 v[36:37], v[36:37], v[52:53]
  v_pk_add_f32 v[38:39], v[38:39], v[54:55]
  s_waitcnt vmcnt(24)
  v_max3_u32 v84, v84, v57, v59
  v_max3_u32 v84, v84, v61, v63
  v_pk_add_f32 v[32:33], v[32:33], v[56:57]
  v_pk_add_f32 v[34:35], v[34:35], v[58:59]
  v_pk_add_f32 v[36:37], v[36:37], v[60:61]
  v_pk_add_f32 v[38:39], v[38:39], v[62:63]
  s_waitcnt vmcnt(22)
  v_max3_u32 v84, v84, v87, v89
  v_max3_u32 v84, v84, v91, v93
  v_pk_add_f32 v[32:33], v[32:33], v[86:87]
  v_pk_add_f32 v[34:35], v[34:35], v[88:89]
  v_pk_add_f32 v[36:37], v[36:37], v[90:91]
  v_pk_add_f32 v[38:39], v[38:39], v[92:93]
  s_waitcnt vmcnt(20)
  v_max3_u32 v84, v84, v95, v97
  v_max3_u32 v84, v84, v99, v101
  v_pk_add_f32 v[32:33], v[32:33], v[94:95]
  v_pk_add_f32 v[34:35], v[34:35], v[96:97]
  v_pk_add_f32 v[36:37], v[36:37], v[98:99]
  v_pk_add_f32 v[38:39], v[38:39], v[100:101]
  s_waitcnt vmcnt(18)
  v_max3_u32 v84, v84, v103, v105
  v_max3_u32 v84, v84, v107, v109
  v_pk_add_f32 v[32:33], v[32:33], v[102:103]
  v_pk_add_f32 v[34:35], v[34:35], v[104:105]
  v_pk_add_f32 v[36:37], v[36:37], v[106:107]
  v_pk_add_f32 v[38:39], v[38:39], v[108:109]
  s_waitcnt vmcnt(16)
  v_max3_u32 v84, v84, v111, v113
  v_max3_u32 v84, v84, v115, v117
  v_pk_add_f32 v[32:33], v[32:33], v[110:111]
  v_pk_add_f32 v[34:35], v[34:35], v[112:113]
  v_pk_add_f32 v[36:37], v[36:37], v[114:115]
  v_pk_add_f32 v[38:39], v[38:39], v[116:117]
  s_waitcnt vmcnt(14)
  v_max3_u32 v84, v84, v119, v121
  v_max3_u32 v84, v84, v123, v125
  v_pk_add_f32 v[32:33], v[32:33], v[118:119]
  v_pk_add_f32 v[34:35], v[34:35], v[120:121]
  v_pk_add_f32 v[36:37], v[36:37], v[122:123]
  v_pk_add_f32 v[38:39], v[38:39], v[124:125]
  s_waitcnt vmcnt(12)
  v_max3_u32 v84, v84, v127, v129
  v_max3_u32 v84, v84, v131, v133
  v_pk_add_f32 v[32:33], v[32:33], v[126:127]
  v_pk_add_f32 v[34:35], v[34:35], v[128:129]
  v_pk_add_f32 v[36:37], v[36:37], v[130:131]
  v_pk_add_f32 v[38:39], v[38:39], v[132:133]
  s_waitcnt vmcnt(10)
  v_max3_u32 v84, v84, v135, v137
  v_max3_u32 v84, v84, v139, v141
  v_pk_add_f32 v[32:33], v[32:33], v[134:135]
  v_pk_add_f32 v[34:35], v[34:35], v[136:137]
  v_pk_add_f32 v[36:37], v[36:37], v[138:139]
  v_pk_add_f32 v[38:39], v[38:39], v[140:141]
  s_waitcnt vmcnt(8)
  v_max3_u32 v84, v84, v143, v145
  v_max3_u32 v84, v84, v147, v149
  v_pk_add_f32 v[32:33], v[32:33], v[142:143]
  v_pk_add_f32 v[34:35], v[34:35], v[144:145]
  v_pk_add_f32 v[36:37], v[36:37], v[146:147]
  v_pk_add_f32 v[38:39], v[38:39], v[148:149]
  s_waitcnt vmcnt(6)
  v_max3_u32 v84, v84, v151, v153
  v_max3_u32 v84, v84, v155, v157
  v_pk_add_f32 v[32:33], v[32:33], v[150:151]
  v_pk_add_f32 v[34:35], v[34:35], v[152:153]
  v_pk_add_f32 v[36:37], v[36:37], v[154:155]
  v_pk_add_f32 v[38:39], v[38:39], v[156:157]
  s_waitcnt vmcnt(4)
  v_max3_u32 v84, v84, v159, v161
  v_max3_u32 v84, v84, v163, v165
  v_pk_add_f32 v[32:33], v[32:33], v[158:159]
  v_pk_add_f32 v[34:35], v[34:35], v[160:161]
  v_pk_add_f32 v[36:37], v[36:37], v[162:163]
  v_pk_add_f32 v[38:39], v[38:39], v[164:165]
  s_waitcnt vmcnt(2)
  v_max3_u32 v84, v84, v167, v169
  v_max3_u32 v84, v84, v171, v173
  v_pk_add_f32 v[32:33], v[32:33], v[166:167]
  v_pk_add_f32 v[34:35], v[34:35], v[168:169]
  v_pk_add_f32 v[36:37], v[36:37], v[170:171]
  v_pk_add_f32 v[38:39], v[38:39], v[172:173]
  s_waitcnt vmcnt(0)
  v_max3_u32 v84, v84, v175, v177
  v_max3_u32 v84, v84, v179, v181
  v_pk_add_f32 v[32:33], v[32:33], v[174:175]
  v_pk_add_f32 v[34:35], v[34:35], v[176:177]
  v_pk_add_f32 v[36:37], v[36:37], v[178:179]
  v_pk_add_f32 v[38:39], v[38:39], v[180:181]
  v_pk_add_f32 v[32:33], v[32:33], v[36:37]
  v_pk_add_f32 v[34:35], v[34:35], v[38:39]
  v_cmp_eq_u32 vcc, -1, v84
  s_cbranch_vccnz L_fpoll_242
  v_cvt_pk_bf16_f32 v36, v32, v33
  v_cvt_pk_bf16_f32 v37, v34, v35
  s_cmp_lg_u32 s31, 0
  s_cbranch_scc1 L_noout_243
  s_mov_b32 s44, s22
  s_and_b32 s45, s23, 0xffff
  s_mov_b32 s46, 2560
  s_mov_b32 s47, 0x20000
  v_and_b32 v84, 31, v0
  v_lshlrev_b32 v84, 3, v84
  s_mul_i32 s66, s30, 160
  s_add_u32 s66, s66, 0
  s_mov_b32 vcc_lo, 0x000fffff
  s_mov_b32 vcc_hi, 0x00000000
  v_cndmask_b32 v84, v74, v84, vcc
  buffer_store_dwordx2 v[36:37], v84, s[44:47], s66 offen
L_noout_243:
  s_cmp_lg_u32 s31, 0
  s_cbranch_scc1 L_noout_244
  s_mov_b32 s44, s22
  s_and_b32 s45, s23, 0xffff
  s_mov_b32 s46, 2560
  s_mov_b32 s47, 0x20000
  v_and_b32 v84, 31, v0
  v_lshlrev_b32 v84, 3, v84
  s_mul_i32 s66, s30, 160
  s_add_u32 s66, s66, 1280
  s_mov_b32 vcc_lo, 0x00000000
  s_mov_b32 vcc_hi, 0x000fffff
  v_cndmask_b32 v84, v74, v84, vcc
  buffer_store_dwordx2 v[36:37], v84, s[44:47], s66 offen
L_noout_244:
  s_cmp_lg_u32 s2, 0
  s_cbranch_scc1 L_done
  v_mov_b32 v84, s73
  v_mov_b32 v85, 896
  s_mov_b64 exec, 1
  buffer_store_dword v84, v85, s[48:51], 0 offen sc1
  s_mov_b64 exec, -1
  s_branch L_done
L_abort:
L_done:
  s_endpgm

.section .rodata,"a"
.p2align 6
.amdhsa_kernel interleave_layers__mha_block_cached__glu_gated_reglu__decode_kernel
  .amdhsa_next_free_vgpr 512
  .amdhsa_next_free_sgpr 102
  .amdhsa_accum_offset 256
  .amdhsa_group_segment_fixed_size 0
  .amdhsa_kernarg_size 96
  .amdhsa_user_sgpr_count 2
  .amdhsa_user_sgpr_kernarg_segment_ptr 1
  .amdhsa_system_sgpr_workgroup_id_x 1
  .amdhsa_float_denorm_mode_32 3
.end_amdhsa_kernel
```
